```python
import torch

def _softmax(x, axis=-1):
    return torch.softmax(x, dim=axis)

def _gelu(x):
    return torch.nn.functional.gelu(x, approximate='tanh')

def _silu(x):
    return torch.nn.functional.silu(x)

def _sigmoid(x):
    return torch.sigmoid(x)

def _layernorm(x, axis=-1, eps=1e-05):
    m = x.mean(dim=axis, keepdim=True)
    v = x.var(dim=axis, keepdim=True, unbiased=False)
    return (x - m) / torch.sqrt(v + eps)

def _scatter_add(tgt, idx, src, axis=0):
    return tgt.clone().index_add_(axis, idx, src)

def _segment_sum(src, seg, n):
    out = torch.zeros((n,) + src.shape[1:], dtype=src.dtype)
    return out.index_add_(0, seg, src)

def _pad(x, pw):
    flat = tuple((v for pair in reversed(pw) for v in pair))
    return torch.nn.functional.pad(x, flat)
kernel_name = 'gated_mix__softmax_full_mha__memory_aug_recurrent_mem_tr__prompt'

def setup_inputs():

    _w = lambda a: (lambda t: t.to(torch.bfloat16) if t.is_floating_point() else t)(torch.as_tensor(a))

    def _A_setup():
        B, S, D = (1, 2048, 576)
        return {'x': _w((lambda *s: torch.randn(*s, dtype=torch.bfloat16) * 0.05)(B, S, D)), 'wqkv': _w((lambda *s: torch.randn(*s, dtype=torch.bfloat16) * 0.8)(D, 3 * D)), 'wo': _w((lambda *s: torch.randn(*s, dtype=torch.bfloat16) * 0.05)(D, D))}
    _A_in = _A_setup()

    def _B_setup():
        B, S, Dm = (1, 2048, 576)
        H, Dh = (32, 128)
        M, seg = (8, 32)
        seg = min(seg, S)
        S = S // seg * seg
        return {'x': _w((lambda *s: torch.randn(*s, dtype=torch.bfloat16) * 0.05)(B, S, Dm)), 'mem0': _w((lambda *s: torch.randn(*s, dtype=torch.bfloat16) * 0.8)(B, M, Dm)), 'Wq': _w((lambda *s: torch.randn(*s, dtype=torch.bfloat16) * 3.2)(Dm, H, Dh) * Dm ** (-0.5)), 'Wk': _w((lambda *s: torch.randn(*s, dtype=torch.bfloat16) * 3.2)(Dm, H, Dh) * Dm ** (-0.5)), 'Wv': _w((lambda *s: torch.randn(*s, dtype=torch.bfloat16) * 0.8)(Dm, H, Dh) * Dm ** (-0.5)), 'Wo': _w((lambda *s: torch.randn(*s, dtype=torch.bfloat16) * 0.8)(H, Dh, Dm) * (H * Dh) ** (-0.5)), 'seg_len': seg}
    _B_in = _B_setup()
    return {'A_x': _A_in['x'], 'A_wqkv': _A_in['wqkv'], 'A_wo': _A_in['wo'], 'B_x': _B_in['x'], 'B_mem0': _B_in['mem0'], 'B_Wq': _B_in['Wq'], 'B_Wk': _B_in['Wk'], 'B_Wv': _B_in['Wv'], 'B_Wo': _B_in['Wo'], 'B_seg_len': _B_in['seg_len'], 'gate_w': _w((lambda *s: torch.randn(*s, dtype=torch.bfloat16) * 0.05)(576) * 16.0)}

def reference(A_x, A_wqkv, A_wo, B_x, B_mem0, B_Wq, B_Wk, B_Wv, B_Wo, B_seg_len, gate_w):

    def _A_ref(x, wqkv, wo):
        B, S, D = x.shape
        H = 32
        Dh = D // H
        qkv = (lambda x, *d: x.permute(*d))((x @ wqkv).reshape(B, S, 3, H, Dh), 2, 0, 3, 1, 4)
        q, k, v = (qkv[0], qkv[1], qkv[2])
        scale = Dh ** (-0.5)
        scores = torch.einsum('bhqd,bhkd->bhqk', q, k) * scale
        p = _softmax(scores, axis=-1)
        o = torch.einsum('bhqk,bhkd->bhqd', p, v)
        return (lambda x, *d: x.permute(*d))(o, 0, 2, 1, 3).reshape(B, S, D) @ wo

    def _B_ref(x, mem0, Wq, Wk, Wv, Wo, seg_len):
        B, S, Dm = x.shape
        H, Dh = (Wq.shape[1], Wq.shape[2])
        M = mem0.shape[1]
        scale = Dh ** (-0.5)
        n_seg = S // seg_len
        L = M + seg_len
        idx = torch.arange(L)
        mask = (idx[:, None] < M) | (idx[:, None] >= idx[None, :])
        mem = mem0
        outs = []
        for s in range(n_seg):
            xs = x[:, s * seg_len:(s + 1) * seg_len, :].clone()
            h = torch.concatenate([mem, xs], axis=1)
            q = torch.einsum('btd,dhe->bhte', h, Wq)
            k = torch.einsum('btd,dhe->bhte', h, Wk)
            v = torch.einsum('btd,dhe->bhte', h, Wv)
            scores = torch.einsum('bhqe,bhke->bhqk', q, k) * scale
            scores = torch.where(mask[None, None], scores, -1000000000.0)
            p = _softmax(scores, axis=-1)
            o = torch.einsum('bhqk,bhke->bhqe', p, v)
            o = torch.einsum('bhte,hed->btd', o, Wo)
            mem = o[:, :M, :].clone()
            outs.append(o[:, M:, :])
        return torch.concatenate(outs, axis=1)
    x = A_x
    g = _sigmoid((x * gate_w).sum(-1, keepdims=True))
    a = _A_ref(x, A_wqkv, A_wo)
    b = _B_ref(x, B_mem0, B_Wq, B_Wk, B_Wv, B_Wo, B_seg_len)
    return g * a + (1 - g) * b
```

```asm
; @launch kernel=gated_mix__softmax_full_mha__memory_aug_recurrent_mem_tr__prompt_kernel grid=(256,1,1) block=(256,1,1) lds=163840
.amdgcn_target "amdgcn-amd-amdhsa--gfx950"
.text
.globl gated_mix__softmax_full_mha__memory_aug_recurrent_mem_tr__prompt_kernel
.p2align 8
.type gated_mix__softmax_full_mha__memory_aug_recurrent_mem_tr__prompt_kernel,@function
gated_mix__softmax_full_mha__memory_aug_recurrent_mem_tr__prompt_kernel:
s_cmp_ge_u32 s2, 256
s_cbranch_scc1 EXIT0
s_load_dwordx2 s[16:17], s[0:1], 96
s_load_dwordx2 s[14:15], s[0:1], 104
s_load_dwordx4 s[4:7], s[0:1], 40
s_load_dwordx4 s[8:11], s[0:1], 56
s_load_dwordx2 s[12:13], s[0:1], 32
s_getreg_b32 s48, hwreg(HW_REG_XCC_ID, 0, 4)
v_lshrrev_b32 v1, 6, v0
s_nop 0
v_readfirstlane_b32 s19, v1
s_waitcnt lgkmcnt(0)
v_mov_b32 v2, 0
s_cmp_eq_u32 s19, 0
s_cbranch_scc1 RZ_4
s_cmp_lg_u32 s48, 0
s_cbranch_scc1 RB_1
s_lshr_b32 s49, s2, 3
s_lshl_b32 s49, s49, 8
s_mov_b32 s50, 2621440
s_cmp_eq_u32 s19, 2
s_cselect_b32 s50, 4194304, s50
s_cmp_eq_u32 s19, 3
s_cselect_b32 s50, 0, s50
s_add_u32 s49, s49, s50
s_cmp_eq_u32 s19, 1
s_cselect_b64 s[52:53], s[8:9], s[4:5]
s_add_u32 s52, s52, s49
s_addc_u32 s53, s53, 0
v_and_b32 v5, 63, v0
v_lshlrev_b32 v5, 13, v5
global_load_dword v70, v5, s[52:53]
global_load_dword v71, v5, s[52:53] offset:128
s_branch RB_1
RZ_4:
s_mov_b64 exec, 1
v_mov_b32 v3, 1
s_cmp_lg_u32 s48, 0
s_cbranch_scc1 RW_2
global_atomic_add v4, v2, v3, s[16:17] sc0
s_waitcnt vmcnt(0)
v_readfirstlane_b32 s49, v4
s_nop 0
s_cmp_lt_u32 s49, 32
s_cbranch_scc1 RD_3
RW_2:
global_atomic_add v4, v2, v3, s[16:17] offset:128 sc0
s_waitcnt vmcnt(0)
v_readfirstlane_b32 s49, v4
v_add_u32 v4, 32, v4
s_cmp_lt_u32 s49, 224
s_cbranch_scc1 RD_3
v_sub_u32 v4, 287, v4
global_atomic_add v2, v3, s[16:17] offset:8
s_waitcnt vmcnt(0)
RD_3:
ds_write_b32 v2, v4
s_waitcnt lgkmcnt(0)
s_mov_b64 exec, -1
RB_1:
s_barrier
ds_read_b32 v4, v2
s_waitcnt lgkmcnt(0)
v_readfirstlane_b32 s18, v4
s_barrier
s_cmp_lt_u32 s18, 32
s_cbranch_scc1 CHAIN
s_sub_u32 s18, s18, 32
s_branch WORKER
EXIT0:
s_endpgm
WORKER:
s_load_dwordx4 s[20:23], s[0:1], 0
s_load_dwordx2 s[24:25], s[0:1], 16
s_load_dwordx4 s[36:39], s[0:1], 80
s_mov_b32 s30, 0x8000
s_waitcnt vmcnt(0) lgkmcnt(0)
s_mov_b64 s[26:27], s[36:37]
s_mov_b64 s[28:29], s[38:39]
s_cmp_lg_u32 s18, 0
s_cbranch_scc1 NI_5
v_lshlrev_b32 v2, 7, v0
v_add_u32 v2, 0x20000, v2
v_mov_b32 v3, 0
global_store_dword v2, v3, s[14:15] sc1
v_and_b32 v2, 31, v0
v_mul_u32_u24 v2, 4352, v2
v_add_u32 v2, 0x40000, v2
global_store_dword v2, v3, s[14:15] sc1
s_waitcnt vmcnt(0)
s_barrier
s_mov_b64 exec, 1
v_mov_b32 v2, 12
v_mov_b32 v3, 1
global_atomic_add v2, v3, s[16:17]
s_mov_b64 exec, -1
NI_5:
v_and_b32 v0, 63, v0
s_getreg_b32 s68, hwreg(HW_REG_XCC_ID, 0, 4)
s_max_u32 s68, s68, 1
s_sub_u32 s68, s68, 1
s_min_u32 s68, s68, 6
s_mov_b32 s69, 0
s_mov_b32 s70, 0
s_mov_b32 s52, s20
s_and_b32 s53, s21, 0xffff
s_mov_b32 s54, 2359296
s_mov_b32 s55, 0x20000
s_mov_b32 s51, 0x20000
v_lshrrev_b32 v10, 2, v0
s_lshl_b32 s32, s19, 4
v_add_u32 v10, s32, v10
v_mul_u32_u24 v10, 1152, v10
v_lshrrev_b32 v11, 4, v0
v_xor_b32 v11, v0, v11
v_and_b32 v11, 3, v11
v_lshl_add_u32 v1, v11, 4, v10
GT_6:
s_lshl_b32 s32, s68, 2
s_add_u32 s32, s32, 136
v_mov_b32 v2, 163832
s_cmp_lg_u32 s19, 0
s_cbranch_scc1 CL_7
s_mov_b64 exec, 1
v_mov_b32 v3, s32
v_mov_b32 v10, 1
global_atomic_add v3, v3, v10, s[16:17] sc0
s_waitcnt vmcnt(0)
ds_write_b32 v2, v3
s_waitcnt lgkmcnt(0)
s_mov_b64 exec, -1
CL_7:
s_barrier
ds_read_b32 v3, v2
s_waitcnt lgkmcnt(0)
v_readfirstlane_b32 s56, v3
s_barrier
s_cmp_lt_u32 s68, 4
s_cselect_b32 s37, 5, 4
s_cselect_b32 s38, 0, 4
s_mul_i32 s32, s68, s37
s_add_u32 s38, s38, s32
s_mul_i32 s33, s37, 11
s_mov_b32 s71, 0
s_cmp_ge_u32 s56, s33
s_cbranch_scc1 GO_8
s_cmp_lt_u32 s68, 4
s_mov_b32 s32, 0x40000000
s_cselect_b32 s32, 0x33333334, s32
s_mul_hi_u32 s57, s56, s32
s_mul_i32 s32, s57, s37
s_sub_u32 s58, s56, s32
s_add_u32 s58, s58, s38
s_lshr_b32 s59, s58, 4
s_and_b32 s58, s58, 15
s_cmp_lt_u32 s57, 6
s_cselect_b32 s71, 1, 0
s_lshl_b32 s32, s57, 1
s_sub_u32 s32, s32, 6
s_cmp_lt_u32 s57, 6
s_cselect_b32 s63, s57, s32
s_lshr_b32 s57, s63, 1
s_cmp_eq_u32 s59, 0
s_cselect_b32 s48, s6, s8
s_cselect_b32 s49, s7, s9
s_branch GD_12
GS_9:
s_add_u32 s69, s69, 1
s_cmp_ge_u32 s69, 7
s_cbranch_scc1 W1
s_add_u32 s68, s68, 1
s_cmp_ge_u32 s68, 7
s_cselect_b32 s68, 0, s68
s_branch GT_6
GO_8:
s_sub_u32 s32, s56, s33
s_cmp_ge_u32 s32, 32
s_cbranch_scc1 GS_9
s_and_b32 s57, s32, 7
s_lshr_b32 s32, s32, 3
s_mul_i32 s32, s32, 7
s_add_u32 s58, s32, s68
s_lshl_b32 s63, s57, 1
s_cmp_lt_u32 s58, 12
s_cbranch_scc1 GA_10
s_sub_u32 s58, s58, 12
s_mov_b32 s59, 2
s_mov_b32 s48, s4
s_mov_b32 s49, s5
s_branch GD_12
GA_10:
s_lshr_b32 s59, s58, 2
s_add_u32 s59, s59, 3
s_mov_b32 s48, s22
s_mov_b32 s49, s23
GD_12:
s_and_b32 s49, s49, 0xffff
s_cmp_ge_u32 s59, 3
s_mov_b32 s34, 8192
s_cselect_b32 s34, 3456, s34
s_cselect_b32 s35, 36, 64
s_mov_b32 s50, 4718592
s_cselect_b32 s50, 1990656, s50
s_lshl_b32 s32, s35, 3
s_mul_i32 s61, s58, s32
s_lshl_b32 s62, s34, 3
s_mul_i32 s60, s63, 147456
v_lshrrev_b32 v10, 5, v0
s_lshl_b32 s32, s19, 1
v_add_u32 v10, s32, v10
v_bfe_u32 v11, v0, 2, 3
v_and_b32 v12, 3, v10
v_xor_b32 v11, v11, v12
v_mul_lo_u32 v10, v10, s34
v_mul_lo_u32 v11, v11, s35
v_and_b32 v12, 3, v0
v_lshlrev_b32 v12, 4, v12
v_add3_u32 v4, v10, v11, v12
s_lshl_b32 s36, s19, 10
s_cmp_lg_u32 s71, 0
s_cbranch_scc1 GF_13
s_add_u32 s32, s60, 0
s_add_u32 m0, s36, 0
s_nop 0
buffer_load_dwordx4 v1, s[52:55], s32 offen lds
s_add_u32 s32, s60, 73728
s_add_u32 m0, s36, 4096
s_nop 0
buffer_load_dwordx4 v1, s[52:55], s32 offen lds
s_add_u32 s32, s60, 147456
s_add_u32 m0, s36, 8192
s_nop 0
buffer_load_dwordx4 v1, s[52:55], s32 offen lds
s_add_u32 s32, s60, 221184
s_add_u32 m0, s36, 12288
s_nop 0
buffer_load_dwordx4 v1, s[52:55], s32 offen lds
s_add_u32 m0, s36, 16384
s_nop 0
buffer_load_dwordx4 v4, s[48:51], s61 offen lds
s_add_u32 s61, s61, s62
s_add_u32 m0, s36, 20480
s_nop 0
buffer_load_dwordx4 v4, s[48:51], s61 offen lds
s_add_u32 s61, s61, s62
s_add_u32 m0, s36, 24576
s_nop 0
buffer_load_dwordx4 v4, s[48:51], s61 offen lds
s_add_u32 s61, s61, s62
s_add_u32 m0, s36, 28672
s_nop 0
buffer_load_dwordx4 v4, s[48:51], s61 offen lds
s_add_u32 s61, s61, s62
s_add_u32 s32, s60, 64
s_add_u32 m0, s36, 32768
s_nop 0
buffer_load_dwordx4 v1, s[52:55], s32 offen lds
s_add_u32 s32, s60, 73792
s_add_u32 m0, s36, 36864
s_nop 0
buffer_load_dwordx4 v1, s[52:55], s32 offen lds
s_add_u32 s32, s60, 147520
s_add_u32 m0, s36, 40960
s_nop 0
buffer_load_dwordx4 v1, s[52:55], s32 offen lds
s_add_u32 s32, s60, 221248
s_add_u32 m0, s36, 45056
s_nop 0
buffer_load_dwordx4 v1, s[52:55], s32 offen lds
s_add_u32 m0, s36, 49152
s_nop 0
buffer_load_dwordx4 v4, s[48:51], s61 offen lds
s_add_u32 s61, s61, s62
s_add_u32 m0, s36, 53248
s_nop 0
buffer_load_dwordx4 v4, s[48:51], s61 offen lds
s_add_u32 s61, s61, s62
s_add_u32 m0, s36, 57344
s_nop 0
buffer_load_dwordx4 v4, s[48:51], s61 offen lds
s_add_u32 s61, s61, s62
s_add_u32 m0, s36, 61440
s_nop 0
buffer_load_dwordx4 v4, s[48:51], s61 offen lds
s_add_u32 s61, s61, s62
s_branch GG_14
GF_13:
s_add_u32 s32, s60, 0
s_add_u32 m0, s36, 0
s_nop 0
buffer_load_dwordx4 v1, s[52:55], s32 offen lds
s_add_u32 s32, s60, 73728
s_add_u32 m0, s36, 4096
s_nop 0
buffer_load_dwordx4 v1, s[52:55], s32 offen lds
s_add_u32 m0, s36, 16384
s_nop 0
buffer_load_dwordx4 v4, s[48:51], s61 offen lds
s_add_u32 s61, s61, s62
s_add_u32 m0, s36, 20480
s_nop 0
buffer_load_dwordx4 v4, s[48:51], s61 offen lds
s_add_u32 s61, s61, s62
s_add_u32 m0, s36, 24576
s_nop 0
buffer_load_dwordx4 v4, s[48:51], s61 offen lds
s_add_u32 s61, s61, s62
s_add_u32 m0, s36, 28672
s_nop 0
buffer_load_dwordx4 v4, s[48:51], s61 offen lds
s_add_u32 s61, s61, s62
s_add_u32 s32, s60, 64
s_add_u32 m0, s36, 32768
s_nop 0
buffer_load_dwordx4 v1, s[52:55], s32 offen lds
s_add_u32 s32, s60, 73792
s_add_u32 m0, s36, 36864
s_nop 0
buffer_load_dwordx4 v1, s[52:55], s32 offen lds
s_add_u32 m0, s36, 49152
s_nop 0
buffer_load_dwordx4 v4, s[48:51], s61 offen lds
s_add_u32 s61, s61, s62
s_add_u32 m0, s36, 53248
s_nop 0
buffer_load_dwordx4 v4, s[48:51], s61 offen lds
s_add_u32 s61, s61, s62
s_add_u32 m0, s36, 57344
s_nop 0
buffer_load_dwordx4 v4, s[48:51], s61 offen lds
s_add_u32 s61, s61, s62
s_add_u32 m0, s36, 61440
s_nop 0
buffer_load_dwordx4 v4, s[48:51], s61 offen lds
s_add_u32 s61, s61, s62
GG_14:
v_mov_b32 v3, 12
global_load_dword v3, v3, s[16:17] sc1
v_and_b32 v10, 31, v0
v_lshrrev_b32 v11, 1, v10
v_xor_b32 v11, v11, v10
v_and_b32 v11, 8, v11
v_mul_u32_u24 v11, 3, v11
v_xor_b32 v11, v11, v10
s_cmp_eq_u32 s59, 1
s_cselect_b64 vcc, -1, 0
v_cndmask_b32 v10, v10, v11, vcc
v_bfe_u32 v11, v10, 2, 2
v_lshrrev_b32 v12, 5, v0
v_xor_b32 v11, v11, v12
v_lshlrev_b32 v11, 4, v11
v_lshl_add_u32 v10, v10, 6, v11
s_lshr_b32 s32, s19, 1
s_sub_u32 s33, 13, s71
s_lshl_b32 s32, s32, s33
v_add_u32 v5, s32, v10
v_xor_b32 v8, 32, v5
v_and_b32 v10, 3, v0
v_bfe_u32 v11, v0, 4, 1
v_lshl_add_u32 v12, v11, 2, v10
v_lshrrev_b32 v13, 1, v10
v_lshlrev_b32 v13, 2, v13
v_lshl_add_u32 v13, v11, 1, v13
v_and_b32 v10, 1, v10
v_add_u32 v13, v13, v10
s_and_b32 s32, s59, 5
s_cmp_eq_u32 s32, 0
s_cselect_b64 vcc, -1, 0
v_cndmask_b32 v12, v12, v13, vcc
v_bfe_u32 v10, v0, 2, 2
v_lshrrev_b32 v11, 5, v0
v_lshl_add_u32 v11, v11, 3, v10
v_lshlrev_b32 v11, 9, v11
v_lshl_add_u32 v11, v12, 3, v11
v_lshl_add_u32 v11, v10, 6, v11
s_and_b32 s32, s19, 1
s_lshl_b32 s32, s32, 8
s_add_u32 s32, s32, 16384
v_add_u32 v6, s32, v11
v_xor_b32 v7, 64, v6
v_xor_b32 v9, 128, v6
v_xor_b32 v15, 192, v6
v_add_u32 v10, 0x10000, v5
v_add_u32 v11, 0x10000, v8
v_add_u32 v12, 0x10000, v6
v_add_u32 v13, 0x10000, v7
v_add_u32 v14, 0x10000, v9
v_add_u32 v2, 0x10000, v15
s_cmp_lg_u32 s71, 0
s_cbranch_scc1 GY_17
s_cmp_eq_u32 s59, 1
s_cbranch_scc1 GX_15
s_cmp_eq_u32 s59, 5
s_cbranch_scc1 GX_15
s_waitcnt vmcnt(9)
s_barrier
ds_read_b128 a[16:19], v5
ds_read_b128 a[20:23], v5 offset:2048
ds_read_b128 a[24:27], v5 offset:4096
ds_read_b128 a[28:31], v5 offset:6144
ds_read_b64_tr_b16 a[32:33], v6
ds_read_b64_tr_b16 a[34:35], v6 offset:2048
ds_read_b64_tr_b16 a[36:37], v7
ds_read_b64_tr_b16 a[38:39], v7 offset:2048
ds_read_b64_tr_b16 a[40:41], v9
ds_read_b64_tr_b16 a[42:43], v9 offset:2048
ds_read_b64_tr_b16 a[44:45], v15
ds_read_b64_tr_b16 a[46:47], v15 offset:2048
s_add_u32 s32, s60, 128
s_add_u32 m0, s36, 65536
s_nop 0
buffer_load_dwordx4 v1, s[52:55], s32 offen lds
s_add_u32 s32, s60, 73856
s_add_u32 m0, s36, 69632
s_nop 0
buffer_load_dwordx4 v1, s[52:55], s32 offen lds
s_add_u32 s32, s60, 147584
s_add_u32 m0, s36, 73728
s_nop 0
buffer_load_dwordx4 v1, s[52:55], s32 offen lds
s_add_u32 s32, s60, 221312
s_add_u32 m0, s36, 77824
s_nop 0
buffer_load_dwordx4 v1, s[52:55], s32 offen lds
s_add_u32 m0, s36, 81920
s_nop 0
buffer_load_dwordx4 v4, s[48:51], s61 offen lds
s_add_u32 s61, s61, s62
s_add_u32 m0, s36, 86016
s_nop 0
buffer_load_dwordx4 v4, s[48:51], s61 offen lds
s_add_u32 s61, s61, s62
s_add_u32 m0, s36, 90112
s_nop 0
buffer_load_dwordx4 v4, s[48:51], s61 offen lds
s_add_u32 s61, s61, s62
s_add_u32 m0, s36, 94208
s_nop 0
buffer_load_dwordx4 v4, s[48:51], s61 offen lds
s_add_u32 s61, s61, s62
s_waitcnt lgkmcnt(0)
v_mfma_f32_32x32x16_bf16 v[16:31], a[32:35], a[16:19], 0
ds_read_b128 a[48:51], v8
ds_read_b128 a[52:55], v8 offset:2048
v_mfma_f32_32x32x16_bf16 v[32:47], a[36:39], a[16:19], 0
ds_read_b128 a[56:59], v8 offset:4096
ds_read_b128 a[60:63], v8 offset:6144
v_mfma_f32_32x32x16_bf16 v[48:63], a[40:43], a[16:19], 0
ds_read_b64_tr_b16 a[64:65], v6 offset:8192
ds_read_b64_tr_b16 a[66:67], v6 offset:10240
v_mfma_f32_32x32x16_bf16 v[64:79], a[44:47], a[16:19], 0
ds_read_b64_tr_b16 a[68:69], v7 offset:8192
ds_read_b64_tr_b16 a[70:71], v7 offset:10240
v_mfma_f32_32x32x16_bf16 v[80:95], a[32:35], a[20:23], 0
ds_read_b64_tr_b16 a[72:73], v9 offset:8192
ds_read_b64_tr_b16 a[74:75], v9 offset:10240
v_mfma_f32_32x32x16_bf16 v[96:111], a[36:39], a[20:23], 0
ds_read_b64_tr_b16 a[76:77], v15 offset:8192
ds_read_b64_tr_b16 a[78:79], v15 offset:10240
v_mfma_f32_32x32x16_bf16 v[112:127], a[40:43], a[20:23], 0
v_mfma_f32_32x32x16_bf16 v[128:143], a[44:47], a[20:23], 0
v_mfma_f32_32x32x16_bf16 v[144:159], a[32:35], a[24:27], 0
v_mfma_f32_32x32x16_bf16 v[160:175], a[36:39], a[24:27], 0
v_mfma_f32_32x32x16_bf16 v[176:191], a[40:43], a[24:27], 0
v_mfma_f32_32x32x16_bf16 v[192:207], a[44:47], a[24:27], 0
v_mfma_f32_32x32x16_bf16 v[208:223], a[32:35], a[28:31], 0
v_mfma_f32_32x32x16_bf16 v[224:239], a[36:39], a[28:31], 0
v_mfma_f32_32x32x16_bf16 v[240:255], a[40:43], a[28:31], 0
v_mfma_f32_32x32x16_bf16 a[0:15], a[44:47], a[28:31], 0
s_waitcnt lgkmcnt(0)
s_waitcnt vmcnt(9)
s_barrier
v_mfma_f32_32x32x16_bf16 v[16:31], a[64:67], a[48:51], v[16:31]
ds_read_b128 a[16:19], v5 offset:32768
ds_read_b128 a[20:23], v5 offset:34816
v_mfma_f32_32x32x16_bf16 v[32:47], a[68:71], a[48:51], v[32:47]
ds_read_b128 a[24:27], v5 offset:36864
ds_read_b128 a[28:31], v5 offset:38912
v_mfma_f32_32x32x16_bf16 v[48:63], a[72:75], a[48:51], v[48:63]
ds_read_b64_tr_b16 a[32:33], v6 offset:32768
ds_read_b64_tr_b16 a[34:35], v6 offset:34816
v_mfma_f32_32x32x16_bf16 v[64:79], a[76:79], a[48:51], v[64:79]
ds_read_b64_tr_b16 a[36:37], v7 offset:32768
ds_read_b64_tr_b16 a[38:39], v7 offset:34816
v_mfma_f32_32x32x16_bf16 v[80:95], a[64:67], a[52:55], v[80:95]
ds_read_b64_tr_b16 a[40:41], v9 offset:32768
ds_read_b64_tr_b16 a[42:43], v9 offset:34816
v_mfma_f32_32x32x16_bf16 v[96:111], a[68:71], a[52:55], v[96:111]
ds_read_b64_tr_b16 a[44:45], v15 offset:32768
ds_read_b64_tr_b16 a[46:47], v15 offset:34816
v_mfma_f32_32x32x16_bf16 v[112:127], a[72:75], a[52:55], v[112:127]
s_add_u32 s32, s60, 192
s_add_u32 m0, s36, 98304
s_nop 0
buffer_load_dwordx4 v1, s[52:55], s32 offen lds
v_mfma_f32_32x32x16_bf16 v[128:143], a[76:79], a[52:55], v[128:143]
s_add_u32 s32, s60, 73920
s_add_u32 m0, s36, 102400
s_nop 0
buffer_load_dwordx4 v1, s[52:55], s32 offen lds
v_mfma_f32_32x32x16_bf16 v[144:159], a[64:67], a[56:59], v[144:159]
s_add_u32 s32, s60, 147648
s_add_u32 m0, s36, 106496
s_nop 0
buffer_load_dwordx4 v1, s[52:55], s32 offen lds
v_mfma_f32_32x32x16_bf16 v[160:175], a[68:71], a[56:59], v[160:175]
s_add_u32 s32, s60, 221376
s_add_u32 m0, s36, 110592
s_nop 0
buffer_load_dwordx4 v1, s[52:55], s32 offen lds
v_mfma_f32_32x32x16_bf16 v[176:191], a[72:75], a[56:59], v[176:191]
s_add_u32 m0, s36, 114688
s_nop 0
buffer_load_dwordx4 v4, s[48:51], s61 offen lds
s_add_u32 s61, s61, s62
v_mfma_f32_32x32x16_bf16 v[192:207], a[76:79], a[56:59], v[192:207]
s_add_u32 m0, s36, 118784
s_nop 0
buffer_load_dwordx4 v4, s[48:51], s61 offen lds
s_add_u32 s61, s61, s62
v_mfma_f32_32x32x16_bf16 v[208:223], a[64:67], a[60:63], v[208:223]
s_add_u32 m0, s36, 122880
s_nop 0
buffer_load_dwordx4 v4, s[48:51], s61 offen lds
s_add_u32 s61, s61, s62
v_mfma_f32_32x32x16_bf16 v[224:239], a[68:71], a[60:63], v[224:239]
s_add_u32 m0, s36, 126976
s_nop 0
buffer_load_dwordx4 v4, s[48:51], s61 offen lds
s_add_u32 s61, s61, s62
v_mfma_f32_32x32x16_bf16 v[240:255], a[72:75], a[60:63], v[240:255]
v_mfma_f32_32x32x16_bf16 a[0:15], a[76:79], a[60:63], a[0:15]
s_waitcnt lgkmcnt(0)
v_mfma_f32_32x32x16_bf16 v[16:31], a[32:35], a[16:19], v[16:31]
ds_read_b128 a[48:51], v8 offset:32768
ds_read_b128 a[52:55], v8 offset:34816
v_mfma_f32_32x32x16_bf16 v[32:47], a[36:39], a[16:19], v[32:47]
ds_read_b128 a[56:59], v8 offset:36864
ds_read_b128 a[60:63], v8 offset:38912
v_mfma_f32_32x32x16_bf16 v[48:63], a[40:43], a[16:19], v[48:63]
ds_read_b64_tr_b16 a[64:65], v6 offset:40960
ds_read_b64_tr_b16 a[66:67], v6 offset:43008
v_mfma_f32_32x32x16_bf16 v[64:79], a[44:47], a[16:19], v[64:79]
ds_read_b64_tr_b16 a[68:69], v7 offset:40960
ds_read_b64_tr_b16 a[70:71], v7 offset:43008
v_mfma_f32_32x32x16_bf16 v[80:95], a[32:35], a[20:23], v[80:95]
ds_read_b64_tr_b16 a[72:73], v9 offset:40960
ds_read_b64_tr_b16 a[74:75], v9 offset:43008
v_mfma_f32_32x32x16_bf16 v[96:111], a[36:39], a[20:23], v[96:111]
ds_read_b64_tr_b16 a[76:77], v15 offset:40960
ds_read_b64_tr_b16 a[78:79], v15 offset:43008
v_mfma_f32_32x32x16_bf16 v[112:127], a[40:43], a[20:23], v[112:127]
v_mfma_f32_32x32x16_bf16 v[128:143], a[44:47], a[20:23], v[128:143]
v_mfma_f32_32x32x16_bf16 v[144:159], a[32:35], a[24:27], v[144:159]
v_mfma_f32_32x32x16_bf16 v[160:175], a[36:39], a[24:27], v[160:175]
v_mfma_f32_32x32x16_bf16 v[176:191], a[40:43], a[24:27], v[176:191]
v_mfma_f32_32x32x16_bf16 v[192:207], a[44:47], a[24:27], v[192:207]
v_mfma_f32_32x32x16_bf16 v[208:223], a[32:35], a[28:31], v[208:223]
v_mfma_f32_32x32x16_bf16 v[224:239], a[36:39], a[28:31], v[224:239]
v_mfma_f32_32x32x16_bf16 v[240:255], a[40:43], a[28:31], v[240:255]
v_mfma_f32_32x32x16_bf16 a[0:15], a[44:47], a[28:31], a[0:15]
s_waitcnt lgkmcnt(0)
s_waitcnt vmcnt(8)
s_barrier
v_mfma_f32_32x32x16_bf16 v[16:31], a[64:67], a[48:51], v[16:31]
ds_read_b128 a[16:19], v10
ds_read_b128 a[20:23], v10 offset:2048
v_mfma_f32_32x32x16_bf16 v[32:47], a[68:71], a[48:51], v[32:47]
ds_read_b128 a[24:27], v10 offset:4096
ds_read_b128 a[28:31], v10 offset:6144
v_mfma_f32_32x32x16_bf16 v[48:63], a[72:75], a[48:51], v[48:63]
ds_read_b64_tr_b16 a[32:33], v12
ds_read_b64_tr_b16 a[34:35], v12 offset:2048
v_mfma_f32_32x32x16_bf16 v[64:79], a[76:79], a[48:51], v[64:79]
ds_read_b64_tr_b16 a[36:37], v13
ds_read_b64_tr_b16 a[38:39], v13 offset:2048
v_mfma_f32_32x32x16_bf16 v[80:95], a[64:67], a[52:55], v[80:95]
ds_read_b64_tr_b16 a[40:41], v14
ds_read_b64_tr_b16 a[42:43], v14 offset:2048
v_mfma_f32_32x32x16_bf16 v[96:111], a[68:71], a[52:55], v[96:111]
ds_read_b64_tr_b16 a[44:45], v2
ds_read_b64_tr_b16 a[46:47], v2 offset:2048
v_mfma_f32_32x32x16_bf16 v[112:127], a[72:75], a[52:55], v[112:127]
s_add_u32 s32, s60, 256
s_add_u32 m0, s36, 0
s_nop 0
buffer_load_dwordx4 v1, s[52:55], s32 offen lds
v_mfma_f32_32x32x16_bf16 v[128:143], a[76:79], a[52:55], v[128:143]
s_add_u32 s32, s60, 73984
s_add_u32 m0, s36, 4096
s_nop 0
buffer_load_dwordx4 v1, s[52:55], s32 offen lds
v_mfma_f32_32x32x16_bf16 v[144:159], a[64:67], a[56:59], v[144:159]
s_add_u32 s32, s60, 147712
s_add_u32 m0, s36, 8192
s_nop 0
buffer_load_dwordx4 v1, s[52:55], s32 offen lds
v_mfma_f32_32x32x16_bf16 v[160:175], a[68:71], a[56:59], v[160:175]
s_add_u32 s32, s60, 221440
s_add_u32 m0, s36, 12288
s_nop 0
buffer_load_dwordx4 v1, s[52:55], s32 offen lds
v_mfma_f32_32x32x16_bf16 v[176:191], a[72:75], a[56:59], v[176:191]
s_add_u32 m0, s36, 16384
s_nop 0
buffer_load_dwordx4 v4, s[48:51], s61 offen lds
s_add_u32 s61, s61, s62
v_mfma_f32_32x32x16_bf16 v[192:207], a[76:79], a[56:59], v[192:207]
s_add_u32 m0, s36, 20480
s_nop 0
buffer_load_dwordx4 v4, s[48:51], s61 offen lds
s_add_u32 s61, s61, s62
v_mfma_f32_32x32x16_bf16 v[208:223], a[64:67], a[60:63], v[208:223]
s_add_u32 m0, s36, 24576
s_nop 0
buffer_load_dwordx4 v4, s[48:51], s61 offen lds
s_add_u32 s61, s61, s62
v_mfma_f32_32x32x16_bf16 v[224:239], a[68:71], a[60:63], v[224:239]
s_add_u32 m0, s36, 28672
s_nop 0
buffer_load_dwordx4 v4, s[48:51], s61 offen lds
s_add_u32 s61, s61, s62
v_mfma_f32_32x32x16_bf16 v[240:255], a[72:75], a[60:63], v[240:255]
v_mfma_f32_32x32x16_bf16 a[0:15], a[76:79], a[60:63], a[0:15]
s_waitcnt lgkmcnt(0)
v_mfma_f32_32x32x16_bf16 v[16:31], a[32:35], a[16:19], v[16:31]
ds_read_b128 a[48:51], v11
ds_read_b128 a[52:55], v11 offset:2048
v_mfma_f32_32x32x16_bf16 v[32:47], a[36:39], a[16:19], v[32:47]
ds_read_b128 a[56:59], v11 offset:4096
ds_read_b128 a[60:63], v11 offset:6144
v_mfma_f32_32x32x16_bf16 v[48:63], a[40:43], a[16:19], v[48:63]
ds_read_b64_tr_b16 a[64:65], v12 offset:8192
ds_read_b64_tr_b16 a[66:67], v12 offset:10240
v_mfma_f32_32x32x16_bf16 v[64:79], a[44:47], a[16:19], v[64:79]
ds_read_b64_tr_b16 a[68:69], v13 offset:8192
ds_read_b64_tr_b16 a[70:71], v13 offset:10240
v_mfma_f32_32x32x16_bf16 v[80:95], a[32:35], a[20:23], v[80:95]
ds_read_b64_tr_b16 a[72:73], v14 offset:8192
ds_read_b64_tr_b16 a[74:75], v14 offset:10240
v_mfma_f32_32x32x16_bf16 v[96:111], a[36:39], a[20:23], v[96:111]
ds_read_b64_tr_b16 a[76:77], v2 offset:8192
ds_read_b64_tr_b16 a[78:79], v2 offset:10240
v_mfma_f32_32x32x16_bf16 v[112:127], a[40:43], a[20:23], v[112:127]
v_mfma_f32_32x32x16_bf16 v[128:143], a[44:47], a[20:23], v[128:143]
v_mfma_f32_32x32x16_bf16 v[144:159], a[32:35], a[24:27], v[144:159]
v_mfma_f32_32x32x16_bf16 v[160:175], a[36:39], a[24:27], v[160:175]
v_mfma_f32_32x32x16_bf16 v[176:191], a[40:43], a[24:27], v[176:191]
v_mfma_f32_32x32x16_bf16 v[192:207], a[44:47], a[24:27], v[192:207]
v_mfma_f32_32x32x16_bf16 v[208:223], a[32:35], a[28:31], v[208:223]
v_mfma_f32_32x32x16_bf16 v[224:239], a[36:39], a[28:31], v[224:239]
v_mfma_f32_32x32x16_bf16 v[240:255], a[40:43], a[28:31], v[240:255]
v_mfma_f32_32x32x16_bf16 a[0:15], a[44:47], a[28:31], a[0:15]
s_waitcnt lgkmcnt(0)
s_waitcnt vmcnt(8)
s_barrier
v_mfma_f32_32x32x16_bf16 v[16:31], a[64:67], a[48:51], v[16:31]
ds_read_b128 a[16:19], v10 offset:32768
ds_read_b128 a[20:23], v10 offset:34816
v_mfma_f32_32x32x16_bf16 v[32:47], a[68:71], a[48:51], v[32:47]
ds_read_b128 a[24:27], v10 offset:36864
ds_read_b128 a[28:31], v10 offset:38912
v_mfma_f32_32x32x16_bf16 v[48:63], a[72:75], a[48:51], v[48:63]
ds_read_b64_tr_b16 a[32:33], v12 offset:32768
ds_read_b64_tr_b16 a[34:35], v12 offset:34816
v_mfma_f32_32x32x16_bf16 v[64:79], a[76:79], a[48:51], v[64:79]
ds_read_b64_tr_b16 a[36:37], v13 offset:32768
ds_read_b64_tr_b16 a[38:39], v13 offset:34816
v_mfma_f32_32x32x16_bf16 v[80:95], a[64:67], a[52:55], v[80:95]
ds_read_b64_tr_b16 a[40:41], v14 offset:32768
ds_read_b64_tr_b16 a[42:43], v14 offset:34816
v_mfma_f32_32x32x16_bf16 v[96:111], a[68:71], a[52:55], v[96:111]
ds_read_b64_tr_b16 a[44:45], v2 offset:32768
ds_read_b64_tr_b16 a[46:47], v2 offset:34816
v_mfma_f32_32x32x16_bf16 v[112:127], a[72:75], a[52:55], v[112:127]
s_add_u32 s32, s60, 320
s_add_u32 m0, s36, 32768
s_nop 0
buffer_load_dwordx4 v1, s[52:55], s32 offen lds
v_mfma_f32_32x32x16_bf16 v[128:143], a[76:79], a[52:55], v[128:143]
s_add_u32 s32, s60, 74048
s_add_u32 m0, s36, 36864
s_nop 0
buffer_load_dwordx4 v1, s[52:55], s32 offen lds
v_mfma_f32_32x32x16_bf16 v[144:159], a[64:67], a[56:59], v[144:159]
s_add_u32 s32, s60, 147776
s_add_u32 m0, s36, 40960
s_nop 0
buffer_load_dwordx4 v1, s[52:55], s32 offen lds
v_mfma_f32_32x32x16_bf16 v[160:175], a[68:71], a[56:59], v[160:175]
s_add_u32 s32, s60, 221504
s_add_u32 m0, s36, 45056
s_nop 0
buffer_load_dwordx4 v1, s[52:55], s32 offen lds
v_mfma_f32_32x32x16_bf16 v[176:191], a[72:75], a[56:59], v[176:191]
s_add_u32 m0, s36, 49152
s_nop 0
buffer_load_dwordx4 v4, s[48:51], s61 offen lds
s_add_u32 s61, s61, s62
v_mfma_f32_32x32x16_bf16 v[192:207], a[76:79], a[56:59], v[192:207]
s_add_u32 m0, s36, 53248
s_nop 0
buffer_load_dwordx4 v4, s[48:51], s61 offen lds
s_add_u32 s61, s61, s62
v_mfma_f32_32x32x16_bf16 v[208:223], a[64:67], a[60:63], v[208:223]
s_add_u32 m0, s36, 57344
s_nop 0
buffer_load_dwordx4 v4, s[48:51], s61 offen lds
s_add_u32 s61, s61, s62
v_mfma_f32_32x32x16_bf16 v[224:239], a[68:71], a[60:63], v[224:239]
s_add_u32 m0, s36, 61440
s_nop 0
buffer_load_dwordx4 v4, s[48:51], s61 offen lds
s_add_u32 s61, s61, s62
v_mfma_f32_32x32x16_bf16 v[240:255], a[72:75], a[60:63], v[240:255]
v_mfma_f32_32x32x16_bf16 a[0:15], a[76:79], a[60:63], a[0:15]
s_waitcnt lgkmcnt(0)
v_mfma_f32_32x32x16_bf16 v[16:31], a[32:35], a[16:19], v[16:31]
ds_read_b128 a[48:51], v11 offset:32768
ds_read_b128 a[52:55], v11 offset:34816
v_mfma_f32_32x32x16_bf16 v[32:47], a[36:39], a[16:19], v[32:47]
ds_read_b128 a[56:59], v11 offset:36864
ds_read_b128 a[60:63], v11 offset:38912
v_mfma_f32_32x32x16_bf16 v[48:63], a[40:43], a[16:19], v[48:63]
ds_read_b64_tr_b16 a[64:65], v12 offset:40960
ds_read_b64_tr_b16 a[66:67], v12 offset:43008
v_mfma_f32_32x32x16_bf16 v[64:79], a[44:47], a[16:19], v[64:79]
ds_read_b64_tr_b16 a[68:69], v13 offset:40960
ds_read_b64_tr_b16 a[70:71], v13 offset:43008
v_mfma_f32_32x32x16_bf16 v[80:95], a[32:35], a[20:23], v[80:95]
ds_read_b64_tr_b16 a[72:73], v14 offset:40960
ds_read_b64_tr_b16 a[74:75], v14 offset:43008
v_mfma_f32_32x32x16_bf16 v[96:111], a[36:39], a[20:23], v[96:111]
ds_read_b64_tr_b16 a[76:77], v2 offset:40960
ds_read_b64_tr_b16 a[78:79], v2 offset:43008
v_mfma_f32_32x32x16_bf16 v[112:127], a[40:43], a[20:23], v[112:127]
v_mfma_f32_32x32x16_bf16 v[128:143], a[44:47], a[20:23], v[128:143]
v_mfma_f32_32x32x16_bf16 v[144:159], a[32:35], a[24:27], v[144:159]
v_mfma_f32_32x32x16_bf16 v[160:175], a[36:39], a[24:27], v[160:175]
v_mfma_f32_32x32x16_bf16 v[176:191], a[40:43], a[24:27], v[176:191]
v_mfma_f32_32x32x16_bf16 v[192:207], a[44:47], a[24:27], v[192:207]
v_mfma_f32_32x32x16_bf16 v[208:223], a[32:35], a[28:31], v[208:223]
v_mfma_f32_32x32x16_bf16 v[224:239], a[36:39], a[28:31], v[224:239]
v_mfma_f32_32x32x16_bf16 v[240:255], a[40:43], a[28:31], v[240:255]
v_mfma_f32_32x32x16_bf16 a[0:15], a[44:47], a[28:31], a[0:15]
s_waitcnt lgkmcnt(0)
s_waitcnt vmcnt(8)
s_barrier
v_mfma_f32_32x32x16_bf16 v[16:31], a[64:67], a[48:51], v[16:31]
ds_read_b128 a[16:19], v5
ds_read_b128 a[20:23], v5 offset:2048
v_mfma_f32_32x32x16_bf16 v[32:47], a[68:71], a[48:51], v[32:47]
ds_read_b128 a[24:27], v5 offset:4096
ds_read_b128 a[28:31], v5 offset:6144
v_mfma_f32_32x32x16_bf16 v[48:63], a[72:75], a[48:51], v[48:63]
ds_read_b64_tr_b16 a[32:33], v6
ds_read_b64_tr_b16 a[34:35], v6 offset:2048
v_mfma_f32_32x32x16_bf16 v[64:79], a[76:79], a[48:51], v[64:79]
ds_read_b64_tr_b16 a[36:37], v7
ds_read_b64_tr_b16 a[38:39], v7 offset:2048
v_mfma_f32_32x32x16_bf16 v[80:95], a[64:67], a[52:55], v[80:95]
ds_read_b64_tr_b16 a[40:41], v9
ds_read_b64_tr_b16 a[42:43], v9 offset:2048
v_mfma_f32_32x32x16_bf16 v[96:111], a[68:71], a[52:55], v[96:111]
ds_read_b64_tr_b16 a[44:45], v15
ds_read_b64_tr_b16 a[46:47], v15 offset:2048
v_mfma_f32_32x32x16_bf16 v[112:127], a[72:75], a[52:55], v[112:127]
s_add_u32 s32, s60, 384
s_add_u32 m0, s36, 65536
s_nop 0
buffer_load_dwordx4 v1, s[52:55], s32 offen lds
v_mfma_f32_32x32x16_bf16 v[128:143], a[76:79], a[52:55], v[128:143]
s_add_u32 s32, s60, 74112
s_add_u32 m0, s36, 69632
s_nop 0
buffer_load_dwordx4 v1, s[52:55], s32 offen lds
v_mfma_f32_32x32x16_bf16 v[144:159], a[64:67], a[56:59], v[144:159]
s_add_u32 s32, s60, 147840
s_add_u32 m0, s36, 73728
s_nop 0
buffer_load_dwordx4 v1, s[52:55], s32 offen lds
v_mfma_f32_32x32x16_bf16 v[160:175], a[68:71], a[56:59], v[160:175]
s_add_u32 s32, s60, 221568
s_add_u32 m0, s36, 77824
s_nop 0
buffer_load_dwordx4 v1, s[52:55], s32 offen lds
v_mfma_f32_32x32x16_bf16 v[176:191], a[72:75], a[56:59], v[176:191]
s_add_u32 m0, s36, 81920
s_nop 0
buffer_load_dwordx4 v4, s[48:51], s61 offen lds
s_add_u32 s61, s61, s62
v_mfma_f32_32x32x16_bf16 v[192:207], a[76:79], a[56:59], v[192:207]
s_add_u32 m0, s36, 86016
s_nop 0
buffer_load_dwordx4 v4, s[48:51], s61 offen lds
s_add_u32 s61, s61, s62
v_mfma_f32_32x32x16_bf16 v[208:223], a[64:67], a[60:63], v[208:223]
s_add_u32 m0, s36, 90112
s_nop 0
buffer_load_dwordx4 v4, s[48:51], s61 offen lds
s_add_u32 s61, s61, s62
v_mfma_f32_32x32x16_bf16 v[224:239], a[68:71], a[60:63], v[224:239]
s_add_u32 m0, s36, 94208
s_nop 0
buffer_load_dwordx4 v4, s[48:51], s61 offen lds
s_add_u32 s61, s61, s62
v_mfma_f32_32x32x16_bf16 v[240:255], a[72:75], a[60:63], v[240:255]
v_mfma_f32_32x32x16_bf16 a[0:15], a[76:79], a[60:63], a[0:15]
s_waitcnt lgkmcnt(0)
v_mfma_f32_32x32x16_bf16 v[16:31], a[32:35], a[16:19], v[16:31]
ds_read_b128 a[48:51], v8
ds_read_b128 a[52:55], v8 offset:2048
v_mfma_f32_32x32x16_bf16 v[32:47], a[36:39], a[16:19], v[32:47]
ds_read_b128 a[56:59], v8 offset:4096
ds_read_b128 a[60:63], v8 offset:6144
v_mfma_f32_32x32x16_bf16 v[48:63], a[40:43], a[16:19], v[48:63]
ds_read_b64_tr_b16 a[64:65], v6 offset:8192
ds_read_b64_tr_b16 a[66:67], v6 offset:10240
v_mfma_f32_32x32x16_bf16 v[64:79], a[44:47], a[16:19], v[64:79]
ds_read_b64_tr_b16 a[68:69], v7 offset:8192
ds_read_b64_tr_b16 a[70:71], v7 offset:10240
v_mfma_f32_32x32x16_bf16 v[80:95], a[32:35], a[20:23], v[80:95]
ds_read_b64_tr_b16 a[72:73], v9 offset:8192
ds_read_b64_tr_b16 a[74:75], v9 offset:10240
v_mfma_f32_32x32x16_bf16 v[96:111], a[36:39], a[20:23], v[96:111]
ds_read_b64_tr_b16 a[76:77], v15 offset:8192
ds_read_b64_tr_b16 a[78:79], v15 offset:10240
v_mfma_f32_32x32x16_bf16 v[112:127], a[40:43], a[20:23], v[112:127]
v_mfma_f32_32x32x16_bf16 v[128:143], a[44:47], a[20:23], v[128:143]
v_mfma_f32_32x32x16_bf16 v[144:159], a[32:35], a[24:27], v[144:159]
v_mfma_f32_32x32x16_bf16 v[160:175], a[36:39], a[24:27], v[160:175]
v_mfma_f32_32x32x16_bf16 v[176:191], a[40:43], a[24:27], v[176:191]
v_mfma_f32_32x32x16_bf16 v[192:207], a[44:47], a[24:27], v[192:207]
v_mfma_f32_32x32x16_bf16 v[208:223], a[32:35], a[28:31], v[208:223]
v_mfma_f32_32x32x16_bf16 v[224:239], a[36:39], a[28:31], v[224:239]
v_mfma_f32_32x32x16_bf16 v[240:255], a[40:43], a[28:31], v[240:255]
v_mfma_f32_32x32x16_bf16 a[0:15], a[44:47], a[28:31], a[0:15]
s_waitcnt lgkmcnt(0)
s_waitcnt vmcnt(8)
s_barrier
v_mfma_f32_32x32x16_bf16 v[16:31], a[64:67], a[48:51], v[16:31]
ds_read_b128 a[16:19], v5 offset:32768
ds_read_b128 a[20:23], v5 offset:34816
v_mfma_f32_32x32x16_bf16 v[32:47], a[68:71], a[48:51], v[32:47]
ds_read_b128 a[24:27], v5 offset:36864
ds_read_b128 a[28:31], v5 offset:38912
v_mfma_f32_32x32x16_bf16 v[48:63], a[72:75], a[48:51], v[48:63]
ds_read_b64_tr_b16 a[32:33], v6 offset:32768
ds_read_b64_tr_b16 a[34:35], v6 offset:34816
v_mfma_f32_32x32x16_bf16 v[64:79], a[76:79], a[48:51], v[64:79]
ds_read_b64_tr_b16 a[36:37], v7 offset:32768
ds_read_b64_tr_b16 a[38:39], v7 offset:34816
v_mfma_f32_32x32x16_bf16 v[80:95], a[64:67], a[52:55], v[80:95]
ds_read_b64_tr_b16 a[40:41], v9 offset:32768
ds_read_b64_tr_b16 a[42:43], v9 offset:34816
v_mfma_f32_32x32x16_bf16 v[96:111], a[68:71], a[52:55], v[96:111]
ds_read_b64_tr_b16 a[44:45], v15 offset:32768
ds_read_b64_tr_b16 a[46:47], v15 offset:34816
v_mfma_f32_32x32x16_bf16 v[112:127], a[72:75], a[52:55], v[112:127]
s_add_u32 s32, s60, 448
s_add_u32 m0, s36, 98304
s_nop 0
buffer_load_dwordx4 v1, s[52:55], s32 offen lds
v_mfma_f32_32x32x16_bf16 v[128:143], a[76:79], a[52:55], v[128:143]
s_add_u32 s32, s60, 74176
s_add_u32 m0, s36, 102400
s_nop 0
buffer_load_dwordx4 v1, s[52:55], s32 offen lds
v_mfma_f32_32x32x16_bf16 v[144:159], a[64:67], a[56:59], v[144:159]
s_add_u32 s32, s60, 147904
s_add_u32 m0, s36, 106496
s_nop 0
buffer_load_dwordx4 v1, s[52:55], s32 offen lds
v_mfma_f32_32x32x16_bf16 v[160:175], a[68:71], a[56:59], v[160:175]
s_add_u32 s32, s60, 221632
s_add_u32 m0, s36, 110592
s_nop 0
buffer_load_dwordx4 v1, s[52:55], s32 offen lds
v_mfma_f32_32x32x16_bf16 v[176:191], a[72:75], a[56:59], v[176:191]
s_add_u32 m0, s36, 114688
s_nop 0
buffer_load_dwordx4 v4, s[48:51], s61 offen lds
s_add_u32 s61, s61, s62
v_mfma_f32_32x32x16_bf16 v[192:207], a[76:79], a[56:59], v[192:207]
s_add_u32 m0, s36, 118784
s_nop 0
buffer_load_dwordx4 v4, s[48:51], s61 offen lds
s_add_u32 s61, s61, s62
v_mfma_f32_32x32x16_bf16 v[208:223], a[64:67], a[60:63], v[208:223]
s_add_u32 m0, s36, 122880
s_nop 0
buffer_load_dwordx4 v4, s[48:51], s61 offen lds
s_add_u32 s61, s61, s62
v_mfma_f32_32x32x16_bf16 v[224:239], a[68:71], a[60:63], v[224:239]
s_add_u32 m0, s36, 126976
s_nop 0
buffer_load_dwordx4 v4, s[48:51], s61 offen lds
s_add_u32 s61, s61, s62
v_mfma_f32_32x32x16_bf16 v[240:255], a[72:75], a[60:63], v[240:255]
v_mfma_f32_32x32x16_bf16 a[0:15], a[76:79], a[60:63], a[0:15]
s_waitcnt lgkmcnt(0)
v_mfma_f32_32x32x16_bf16 v[16:31], a[32:35], a[16:19], v[16:31]
ds_read_b128 a[48:51], v8 offset:32768
ds_read_b128 a[52:55], v8 offset:34816
v_mfma_f32_32x32x16_bf16 v[32:47], a[36:39], a[16:19], v[32:47]
ds_read_b128 a[56:59], v8 offset:36864
ds_read_b128 a[60:63], v8 offset:38912
v_mfma_f32_32x32x16_bf16 v[48:63], a[40:43], a[16:19], v[48:63]
ds_read_b64_tr_b16 a[64:65], v6 offset:40960
ds_read_b64_tr_b16 a[66:67], v6 offset:43008
v_mfma_f32_32x32x16_bf16 v[64:79], a[44:47], a[16:19], v[64:79]
ds_read_b64_tr_b16 a[68:69], v7 offset:40960
ds_read_b64_tr_b16 a[70:71], v7 offset:43008
v_mfma_f32_32x32x16_bf16 v[80:95], a[32:35], a[20:23], v[80:95]
ds_read_b64_tr_b16 a[72:73], v9 offset:40960
ds_read_b64_tr_b16 a[74:75], v9 offset:43008
v_mfma_f32_32x32x16_bf16 v[96:111], a[36:39], a[20:23], v[96:111]
ds_read_b64_tr_b16 a[76:77], v15 offset:40960
ds_read_b64_tr_b16 a[78:79], v15 offset:43008
v_mfma_f32_32x32x16_bf16 v[112:127], a[40:43], a[20:23], v[112:127]
v_mfma_f32_32x32x16_bf16 v[128:143], a[44:47], a[20:23], v[128:143]
v_mfma_f32_32x32x16_bf16 v[144:159], a[32:35], a[24:27], v[144:159]
v_mfma_f32_32x32x16_bf16 v[160:175], a[36:39], a[24:27], v[160:175]
v_mfma_f32_32x32x16_bf16 v[176:191], a[40:43], a[24:27], v[176:191]
v_mfma_f32_32x32x16_bf16 v[192:207], a[44:47], a[24:27], v[192:207]
v_mfma_f32_32x32x16_bf16 v[208:223], a[32:35], a[28:31], v[208:223]
v_mfma_f32_32x32x16_bf16 v[224:239], a[36:39], a[28:31], v[224:239]
v_mfma_f32_32x32x16_bf16 v[240:255], a[40:43], a[28:31], v[240:255]
v_mfma_f32_32x32x16_bf16 a[0:15], a[44:47], a[28:31], a[0:15]
s_waitcnt lgkmcnt(0)
s_waitcnt vmcnt(8)
s_barrier
v_mfma_f32_32x32x16_bf16 v[16:31], a[64:67], a[48:51], v[16:31]
ds_read_b128 a[16:19], v10
ds_read_b128 a[20:23], v10 offset:2048
v_mfma_f32_32x32x16_bf16 v[32:47], a[68:71], a[48:51], v[32:47]
ds_read_b128 a[24:27], v10 offset:4096
ds_read_b128 a[28:31], v10 offset:6144
v_mfma_f32_32x32x16_bf16 v[48:63], a[72:75], a[48:51], v[48:63]
ds_read_b64_tr_b16 a[32:33], v12
ds_read_b64_tr_b16 a[34:35], v12 offset:2048
v_mfma_f32_32x32x16_bf16 v[64:79], a[76:79], a[48:51], v[64:79]
ds_read_b64_tr_b16 a[36:37], v13
ds_read_b64_tr_b16 a[38:39], v13 offset:2048
v_mfma_f32_32x32x16_bf16 v[80:95], a[64:67], a[52:55], v[80:95]
ds_read_b64_tr_b16 a[40:41], v14
ds_read_b64_tr_b16 a[42:43], v14 offset:2048
v_mfma_f32_32x32x16_bf16 v[96:111], a[68:71], a[52:55], v[96:111]
ds_read_b64_tr_b16 a[44:45], v2
ds_read_b64_tr_b16 a[46:47], v2 offset:2048
v_mfma_f32_32x32x16_bf16 v[112:127], a[72:75], a[52:55], v[112:127]
s_add_u32 s32, s60, 512
s_add_u32 m0, s36, 0
s_nop 0
buffer_load_dwordx4 v1, s[52:55], s32 offen lds
v_mfma_f32_32x32x16_bf16 v[128:143], a[76:79], a[52:55], v[128:143]
s_add_u32 s32, s60, 74240
s_add_u32 m0, s36, 4096
s_nop 0
buffer_load_dwordx4 v1, s[52:55], s32 offen lds
v_mfma_f32_32x32x16_bf16 v[144:159], a[64:67], a[56:59], v[144:159]
s_add_u32 s32, s60, 147968
s_add_u32 m0, s36, 8192
s_nop 0
buffer_load_dwordx4 v1, s[52:55], s32 offen lds
v_mfma_f32_32x32x16_bf16 v[160:175], a[68:71], a[56:59], v[160:175]
s_add_u32 s32, s60, 221696
s_add_u32 m0, s36, 12288
s_nop 0
buffer_load_dwordx4 v1, s[52:55], s32 offen lds
v_mfma_f32_32x32x16_bf16 v[176:191], a[72:75], a[56:59], v[176:191]
s_add_u32 m0, s36, 16384
s_nop 0
buffer_load_dwordx4 v4, s[48:51], s61 offen lds
s_add_u32 s61, s61, s62
v_mfma_f32_32x32x16_bf16 v[192:207], a[76:79], a[56:59], v[192:207]
s_add_u32 m0, s36, 20480
s_nop 0
buffer_load_dwordx4 v4, s[48:51], s61 offen lds
s_add_u32 s61, s61, s62
v_mfma_f32_32x32x16_bf16 v[208:223], a[64:67], a[60:63], v[208:223]
s_add_u32 m0, s36, 24576
s_nop 0
buffer_load_dwordx4 v4, s[48:51], s61 offen lds
s_add_u32 s61, s61, s62
v_mfma_f32_32x32x16_bf16 v[224:239], a[68:71], a[60:63], v[224:239]
s_add_u32 m0, s36, 28672
s_nop 0
buffer_load_dwordx4 v4, s[48:51], s61 offen lds
s_add_u32 s61, s61, s62
v_mfma_f32_32x32x16_bf16 v[240:255], a[72:75], a[60:63], v[240:255]
v_mfma_f32_32x32x16_bf16 a[0:15], a[76:79], a[60:63], a[0:15]
s_waitcnt lgkmcnt(0)
v_mfma_f32_32x32x16_bf16 v[16:31], a[32:35], a[16:19], v[16:31]
ds_read_b128 a[48:51], v11
ds_read_b128 a[52:55], v11 offset:2048
v_mfma_f32_32x32x16_bf16 v[32:47], a[36:39], a[16:19], v[32:47]
ds_read_b128 a[56:59], v11 offset:4096
ds_read_b128 a[60:63], v11 offset:6144
v_mfma_f32_32x32x16_bf16 v[48:63], a[40:43], a[16:19], v[48:63]
ds_read_b64_tr_b16 a[64:65], v12 offset:8192
ds_read_b64_tr_b16 a[66:67], v12 offset:10240
v_mfma_f32_32x32x16_bf16 v[64:79], a[44:47], a[16:19], v[64:79]
ds_read_b64_tr_b16 a[68:69], v13 offset:8192
ds_read_b64_tr_b16 a[70:71], v13 offset:10240
v_mfma_f32_32x32x16_bf16 v[80:95], a[32:35], a[20:23], v[80:95]
ds_read_b64_tr_b16 a[72:73], v14 offset:8192
ds_read_b64_tr_b16 a[74:75], v14 offset:10240
v_mfma_f32_32x32x16_bf16 v[96:111], a[36:39], a[20:23], v[96:111]
ds_read_b64_tr_b16 a[76:77], v2 offset:8192
ds_read_b64_tr_b16 a[78:79], v2 offset:10240
v_mfma_f32_32x32x16_bf16 v[112:127], a[40:43], a[20:23], v[112:127]
v_mfma_f32_32x32x16_bf16 v[128:143], a[44:47], a[20:23], v[128:143]
v_mfma_f32_32x32x16_bf16 v[144:159], a[32:35], a[24:27], v[144:159]
v_mfma_f32_32x32x16_bf16 v[160:175], a[36:39], a[24:27], v[160:175]
v_mfma_f32_32x32x16_bf16 v[176:191], a[40:43], a[24:27], v[176:191]
v_mfma_f32_32x32x16_bf16 v[192:207], a[44:47], a[24:27], v[192:207]
v_mfma_f32_32x32x16_bf16 v[208:223], a[32:35], a[28:31], v[208:223]
v_mfma_f32_32x32x16_bf16 v[224:239], a[36:39], a[28:31], v[224:239]
v_mfma_f32_32x32x16_bf16 v[240:255], a[40:43], a[28:31], v[240:255]
v_mfma_f32_32x32x16_bf16 a[0:15], a[44:47], a[28:31], a[0:15]
s_waitcnt lgkmcnt(0)
s_waitcnt vmcnt(8)
s_barrier
v_mfma_f32_32x32x16_bf16 v[16:31], a[64:67], a[48:51], v[16:31]
ds_read_b128 a[16:19], v10 offset:32768
ds_read_b128 a[20:23], v10 offset:34816
v_mfma_f32_32x32x16_bf16 v[32:47], a[68:71], a[48:51], v[32:47]
ds_read_b128 a[24:27], v10 offset:36864
ds_read_b128 a[28:31], v10 offset:38912
v_mfma_f32_32x32x16_bf16 v[48:63], a[72:75], a[48:51], v[48:63]
ds_read_b64_tr_b16 a[32:33], v12 offset:32768
ds_read_b64_tr_b16 a[34:35], v12 offset:34816
v_mfma_f32_32x32x16_bf16 v[64:79], a[76:79], a[48:51], v[64:79]
ds_read_b64_tr_b16 a[36:37], v13 offset:32768
ds_read_b64_tr_b16 a[38:39], v13 offset:34816
v_mfma_f32_32x32x16_bf16 v[80:95], a[64:67], a[52:55], v[80:95]
ds_read_b64_tr_b16 a[40:41], v14 offset:32768
ds_read_b64_tr_b16 a[42:43], v14 offset:34816
v_mfma_f32_32x32x16_bf16 v[96:111], a[68:71], a[52:55], v[96:111]
ds_read_b64_tr_b16 a[44:45], v2 offset:32768
ds_read_b64_tr_b16 a[46:47], v2 offset:34816
v_mfma_f32_32x32x16_bf16 v[112:127], a[72:75], a[52:55], v[112:127]
s_add_u32 s32, s60, 576
s_add_u32 m0, s36, 32768
s_nop 0
buffer_load_dwordx4 v1, s[52:55], s32 offen lds
v_mfma_f32_32x32x16_bf16 v[128:143], a[76:79], a[52:55], v[128:143]
s_add_u32 s32, s60, 74304
s_add_u32 m0, s36, 36864
s_nop 0
buffer_load_dwordx4 v1, s[52:55], s32 offen lds
v_mfma_f32_32x32x16_bf16 v[144:159], a[64:67], a[56:59], v[144:159]
s_add_u32 s32, s60, 148032
s_add_u32 m0, s36, 40960
s_nop 0
buffer_load_dwordx4 v1, s[52:55], s32 offen lds
v_mfma_f32_32x32x16_bf16 v[160:175], a[68:71], a[56:59], v[160:175]
s_add_u32 s32, s60, 221760
s_add_u32 m0, s36, 45056
s_nop 0
buffer_load_dwordx4 v1, s[52:55], s32 offen lds
v_mfma_f32_32x32x16_bf16 v[176:191], a[72:75], a[56:59], v[176:191]
s_add_u32 m0, s36, 49152
s_nop 0
buffer_load_dwordx4 v4, s[48:51], s61 offen lds
s_add_u32 s61, s61, s62
v_mfma_f32_32x32x16_bf16 v[192:207], a[76:79], a[56:59], v[192:207]
s_add_u32 m0, s36, 53248
s_nop 0
buffer_load_dwordx4 v4, s[48:51], s61 offen lds
s_add_u32 s61, s61, s62
v_mfma_f32_32x32x16_bf16 v[208:223], a[64:67], a[60:63], v[208:223]
s_add_u32 m0, s36, 57344
s_nop 0
buffer_load_dwordx4 v4, s[48:51], s61 offen lds
s_add_u32 s61, s61, s62
v_mfma_f32_32x32x16_bf16 v[224:239], a[68:71], a[60:63], v[224:239]
s_add_u32 m0, s36, 61440
s_nop 0
buffer_load_dwordx4 v4, s[48:51], s61 offen lds
s_add_u32 s61, s61, s62
v_mfma_f32_32x32x16_bf16 v[240:255], a[72:75], a[60:63], v[240:255]
v_mfma_f32_32x32x16_bf16 a[0:15], a[76:79], a[60:63], a[0:15]
s_waitcnt lgkmcnt(0)
v_mfma_f32_32x32x16_bf16 v[16:31], a[32:35], a[16:19], v[16:31]
ds_read_b128 a[48:51], v11 offset:32768
ds_read_b128 a[52:55], v11 offset:34816
v_mfma_f32_32x32x16_bf16 v[32:47], a[36:39], a[16:19], v[32:47]
ds_read_b128 a[56:59], v11 offset:36864
ds_read_b128 a[60:63], v11 offset:38912
v_mfma_f32_32x32x16_bf16 v[48:63], a[40:43], a[16:19], v[48:63]
ds_read_b64_tr_b16 a[64:65], v12 offset:40960
ds_read_b64_tr_b16 a[66:67], v12 offset:43008
v_mfma_f32_32x32x16_bf16 v[64:79], a[44:47], a[16:19], v[64:79]
ds_read_b64_tr_b16 a[68:69], v13 offset:40960
ds_read_b64_tr_b16 a[70:71], v13 offset:43008
v_mfma_f32_32x32x16_bf16 v[80:95], a[32:35], a[20:23], v[80:95]
ds_read_b64_tr_b16 a[72:73], v14 offset:40960
ds_read_b64_tr_b16 a[74:75], v14 offset:43008
v_mfma_f32_32x32x16_bf16 v[96:111], a[36:39], a[20:23], v[96:111]
ds_read_b64_tr_b16 a[76:77], v2 offset:40960
ds_read_b64_tr_b16 a[78:79], v2 offset:43008
v_mfma_f32_32x32x16_bf16 v[112:127], a[40:43], a[20:23], v[112:127]
v_mfma_f32_32x32x16_bf16 v[128:143], a[44:47], a[20:23], v[128:143]
v_mfma_f32_32x32x16_bf16 v[144:159], a[32:35], a[24:27], v[144:159]
v_mfma_f32_32x32x16_bf16 v[160:175], a[36:39], a[24:27], v[160:175]
v_mfma_f32_32x32x16_bf16 v[176:191], a[40:43], a[24:27], v[176:191]
v_mfma_f32_32x32x16_bf16 v[192:207], a[44:47], a[24:27], v[192:207]
v_mfma_f32_32x32x16_bf16 v[208:223], a[32:35], a[28:31], v[208:223]
v_mfma_f32_32x32x16_bf16 v[224:239], a[36:39], a[28:31], v[224:239]
v_mfma_f32_32x32x16_bf16 v[240:255], a[40:43], a[28:31], v[240:255]
v_mfma_f32_32x32x16_bf16 a[0:15], a[44:47], a[28:31], a[0:15]
s_waitcnt lgkmcnt(0)
s_waitcnt vmcnt(8)
s_barrier
v_mfma_f32_32x32x16_bf16 v[16:31], a[64:67], a[48:51], v[16:31]
ds_read_b128 a[16:19], v5
ds_read_b128 a[20:23], v5 offset:2048
v_mfma_f32_32x32x16_bf16 v[32:47], a[68:71], a[48:51], v[32:47]
ds_read_b128 a[24:27], v5 offset:4096
ds_read_b128 a[28:31], v5 offset:6144
v_mfma_f32_32x32x16_bf16 v[48:63], a[72:75], a[48:51], v[48:63]
ds_read_b64_tr_b16 a[32:33], v6
ds_read_b64_tr_b16 a[34:35], v6 offset:2048
v_mfma_f32_32x32x16_bf16 v[64:79], a[76:79], a[48:51], v[64:79]
ds_read_b64_tr_b16 a[36:37], v7
ds_read_b64_tr_b16 a[38:39], v7 offset:2048
v_mfma_f32_32x32x16_bf16 v[80:95], a[64:67], a[52:55], v[80:95]
ds_read_b64_tr_b16 a[40:41], v9
ds_read_b64_tr_b16 a[42:43], v9 offset:2048
v_mfma_f32_32x32x16_bf16 v[96:111], a[68:71], a[52:55], v[96:111]
ds_read_b64_tr_b16 a[44:45], v15
ds_read_b64_tr_b16 a[46:47], v15 offset:2048
v_mfma_f32_32x32x16_bf16 v[112:127], a[72:75], a[52:55], v[112:127]
s_add_u32 s32, s60, 640
s_add_u32 m0, s36, 65536
s_nop 0
buffer_load_dwordx4 v1, s[52:55], s32 offen lds
v_mfma_f32_32x32x16_bf16 v[128:143], a[76:79], a[52:55], v[128:143]
s_add_u32 s32, s60, 74368
s_add_u32 m0, s36, 69632
s_nop 0
buffer_load_dwordx4 v1, s[52:55], s32 offen lds
v_mfma_f32_32x32x16_bf16 v[144:159], a[64:67], a[56:59], v[144:159]
s_add_u32 s32, s60, 148096
s_add_u32 m0, s36, 73728
s_nop 0
buffer_load_dwordx4 v1, s[52:55], s32 offen lds
v_mfma_f32_32x32x16_bf16 v[160:175], a[68:71], a[56:59], v[160:175]
s_add_u32 s32, s60, 221824
s_add_u32 m0, s36, 77824
s_nop 0
buffer_load_dwordx4 v1, s[52:55], s32 offen lds
v_mfma_f32_32x32x16_bf16 v[176:191], a[72:75], a[56:59], v[176:191]
s_add_u32 m0, s36, 81920
s_nop 0
buffer_load_dwordx4 v4, s[48:51], s61 offen lds
s_add_u32 s61, s61, s62
v_mfma_f32_32x32x16_bf16 v[192:207], a[76:79], a[56:59], v[192:207]
s_add_u32 m0, s36, 86016
s_nop 0
buffer_load_dwordx4 v4, s[48:51], s61 offen lds
s_add_u32 s61, s61, s62
v_mfma_f32_32x32x16_bf16 v[208:223], a[64:67], a[60:63], v[208:223]
s_add_u32 m0, s36, 90112
s_nop 0
buffer_load_dwordx4 v4, s[48:51], s61 offen lds
s_add_u32 s61, s61, s62
v_mfma_f32_32x32x16_bf16 v[224:239], a[68:71], a[60:63], v[224:239]
s_add_u32 m0, s36, 94208
s_nop 0
buffer_load_dwordx4 v4, s[48:51], s61 offen lds
s_add_u32 s61, s61, s62
v_mfma_f32_32x32x16_bf16 v[240:255], a[72:75], a[60:63], v[240:255]
v_mfma_f32_32x32x16_bf16 a[0:15], a[76:79], a[60:63], a[0:15]
s_waitcnt lgkmcnt(0)
v_mfma_f32_32x32x16_bf16 v[16:31], a[32:35], a[16:19], v[16:31]
ds_read_b128 a[48:51], v8
ds_read_b128 a[52:55], v8 offset:2048
v_mfma_f32_32x32x16_bf16 v[32:47], a[36:39], a[16:19], v[32:47]
ds_read_b128 a[56:59], v8 offset:4096
ds_read_b128 a[60:63], v8 offset:6144
v_mfma_f32_32x32x16_bf16 v[48:63], a[40:43], a[16:19], v[48:63]
ds_read_b64_tr_b16 a[64:65], v6 offset:8192
ds_read_b64_tr_b16 a[66:67], v6 offset:10240
v_mfma_f32_32x32x16_bf16 v[64:79], a[44:47], a[16:19], v[64:79]
ds_read_b64_tr_b16 a[68:69], v7 offset:8192
ds_read_b64_tr_b16 a[70:71], v7 offset:10240
v_mfma_f32_32x32x16_bf16 v[80:95], a[32:35], a[20:23], v[80:95]
ds_read_b64_tr_b16 a[72:73], v9 offset:8192
ds_read_b64_tr_b16 a[74:75], v9 offset:10240
v_mfma_f32_32x32x16_bf16 v[96:111], a[36:39], a[20:23], v[96:111]
ds_read_b64_tr_b16 a[76:77], v15 offset:8192
ds_read_b64_tr_b16 a[78:79], v15 offset:10240
v_mfma_f32_32x32x16_bf16 v[112:127], a[40:43], a[20:23], v[112:127]
v_mfma_f32_32x32x16_bf16 v[128:143], a[44:47], a[20:23], v[128:143]
v_mfma_f32_32x32x16_bf16 v[144:159], a[32:35], a[24:27], v[144:159]
v_mfma_f32_32x32x16_bf16 v[160:175], a[36:39], a[24:27], v[160:175]
v_mfma_f32_32x32x16_bf16 v[176:191], a[40:43], a[24:27], v[176:191]
v_mfma_f32_32x32x16_bf16 v[192:207], a[44:47], a[24:27], v[192:207]
v_mfma_f32_32x32x16_bf16 v[208:223], a[32:35], a[28:31], v[208:223]
v_mfma_f32_32x32x16_bf16 v[224:239], a[36:39], a[28:31], v[224:239]
v_mfma_f32_32x32x16_bf16 v[240:255], a[40:43], a[28:31], v[240:255]
v_mfma_f32_32x32x16_bf16 a[0:15], a[44:47], a[28:31], a[0:15]
s_waitcnt lgkmcnt(0)
s_waitcnt vmcnt(8)
s_barrier
v_mfma_f32_32x32x16_bf16 v[16:31], a[64:67], a[48:51], v[16:31]
ds_read_b128 a[16:19], v5 offset:32768
ds_read_b128 a[20:23], v5 offset:34816
v_mfma_f32_32x32x16_bf16 v[32:47], a[68:71], a[48:51], v[32:47]
ds_read_b128 a[24:27], v5 offset:36864
ds_read_b128 a[28:31], v5 offset:38912
v_mfma_f32_32x32x16_bf16 v[48:63], a[72:75], a[48:51], v[48:63]
ds_read_b64_tr_b16 a[32:33], v6 offset:32768
ds_read_b64_tr_b16 a[34:35], v6 offset:34816
v_mfma_f32_32x32x16_bf16 v[64:79], a[76:79], a[48:51], v[64:79]
ds_read_b64_tr_b16 a[36:37], v7 offset:32768
ds_read_b64_tr_b16 a[38:39], v7 offset:34816
v_mfma_f32_32x32x16_bf16 v[80:95], a[64:67], a[52:55], v[80:95]
ds_read_b64_tr_b16 a[40:41], v9 offset:32768
ds_read_b64_tr_b16 a[42:43], v9 offset:34816
v_mfma_f32_32x32x16_bf16 v[96:111], a[68:71], a[52:55], v[96:111]
ds_read_b64_tr_b16 a[44:45], v15 offset:32768
ds_read_b64_tr_b16 a[46:47], v15 offset:34816
v_mfma_f32_32x32x16_bf16 v[112:127], a[72:75], a[52:55], v[112:127]
s_add_u32 s32, s60, 704
s_add_u32 m0, s36, 98304
s_nop 0
buffer_load_dwordx4 v1, s[52:55], s32 offen lds
v_mfma_f32_32x32x16_bf16 v[128:143], a[76:79], a[52:55], v[128:143]
s_add_u32 s32, s60, 74432
s_add_u32 m0, s36, 102400
s_nop 0
buffer_load_dwordx4 v1, s[52:55], s32 offen lds
v_mfma_f32_32x32x16_bf16 v[144:159], a[64:67], a[56:59], v[144:159]
s_add_u32 s32, s60, 148160
s_add_u32 m0, s36, 106496
s_nop 0
buffer_load_dwordx4 v1, s[52:55], s32 offen lds
v_mfma_f32_32x32x16_bf16 v[160:175], a[68:71], a[56:59], v[160:175]
s_add_u32 s32, s60, 221888
s_add_u32 m0, s36, 110592
s_nop 0
buffer_load_dwordx4 v1, s[52:55], s32 offen lds
v_mfma_f32_32x32x16_bf16 v[176:191], a[72:75], a[56:59], v[176:191]
s_add_u32 m0, s36, 114688
s_nop 0
buffer_load_dwordx4 v4, s[48:51], s61 offen lds
s_add_u32 s61, s61, s62
v_mfma_f32_32x32x16_bf16 v[192:207], a[76:79], a[56:59], v[192:207]
s_add_u32 m0, s36, 118784
s_nop 0
buffer_load_dwordx4 v4, s[48:51], s61 offen lds
s_add_u32 s61, s61, s62
v_mfma_f32_32x32x16_bf16 v[208:223], a[64:67], a[60:63], v[208:223]
s_add_u32 m0, s36, 122880
s_nop 0
buffer_load_dwordx4 v4, s[48:51], s61 offen lds
s_add_u32 s61, s61, s62
v_mfma_f32_32x32x16_bf16 v[224:239], a[68:71], a[60:63], v[224:239]
s_add_u32 m0, s36, 126976
s_nop 0
buffer_load_dwordx4 v4, s[48:51], s61 offen lds
s_add_u32 s61, s61, s62
v_mfma_f32_32x32x16_bf16 v[240:255], a[72:75], a[60:63], v[240:255]
v_mfma_f32_32x32x16_bf16 a[0:15], a[76:79], a[60:63], a[0:15]
s_waitcnt lgkmcnt(0)
v_mfma_f32_32x32x16_bf16 v[16:31], a[32:35], a[16:19], v[16:31]
ds_read_b128 a[48:51], v8 offset:32768
ds_read_b128 a[52:55], v8 offset:34816
v_mfma_f32_32x32x16_bf16 v[32:47], a[36:39], a[16:19], v[32:47]
ds_read_b128 a[56:59], v8 offset:36864
ds_read_b128 a[60:63], v8 offset:38912
v_mfma_f32_32x32x16_bf16 v[48:63], a[40:43], a[16:19], v[48:63]
ds_read_b64_tr_b16 a[64:65], v6 offset:40960
ds_read_b64_tr_b16 a[66:67], v6 offset:43008
v_mfma_f32_32x32x16_bf16 v[64:79], a[44:47], a[16:19], v[64:79]
ds_read_b64_tr_b16 a[68:69], v7 offset:40960
ds_read_b64_tr_b16 a[70:71], v7 offset:43008
v_mfma_f32_32x32x16_bf16 v[80:95], a[32:35], a[20:23], v[80:95]
ds_read_b64_tr_b16 a[72:73], v9 offset:40960
ds_read_b64_tr_b16 a[74:75], v9 offset:43008
v_mfma_f32_32x32x16_bf16 v[96:111], a[36:39], a[20:23], v[96:111]
ds_read_b64_tr_b16 a[76:77], v15 offset:40960
ds_read_b64_tr_b16 a[78:79], v15 offset:43008
v_mfma_f32_32x32x16_bf16 v[112:127], a[40:43], a[20:23], v[112:127]
v_mfma_f32_32x32x16_bf16 v[128:143], a[44:47], a[20:23], v[128:143]
v_mfma_f32_32x32x16_bf16 v[144:159], a[32:35], a[24:27], v[144:159]
v_mfma_f32_32x32x16_bf16 v[160:175], a[36:39], a[24:27], v[160:175]
v_mfma_f32_32x32x16_bf16 v[176:191], a[40:43], a[24:27], v[176:191]
v_mfma_f32_32x32x16_bf16 v[192:207], a[44:47], a[24:27], v[192:207]
v_mfma_f32_32x32x16_bf16 v[208:223], a[32:35], a[28:31], v[208:223]
v_mfma_f32_32x32x16_bf16 v[224:239], a[36:39], a[28:31], v[224:239]
v_mfma_f32_32x32x16_bf16 v[240:255], a[40:43], a[28:31], v[240:255]
v_mfma_f32_32x32x16_bf16 a[0:15], a[44:47], a[28:31], a[0:15]
s_waitcnt lgkmcnt(0)
s_waitcnt vmcnt(8)
s_barrier
v_mfma_f32_32x32x16_bf16 v[16:31], a[64:67], a[48:51], v[16:31]
ds_read_b128 a[16:19], v10
ds_read_b128 a[20:23], v10 offset:2048
v_mfma_f32_32x32x16_bf16 v[32:47], a[68:71], a[48:51], v[32:47]
ds_read_b128 a[24:27], v10 offset:4096
ds_read_b128 a[28:31], v10 offset:6144
v_mfma_f32_32x32x16_bf16 v[48:63], a[72:75], a[48:51], v[48:63]
ds_read_b64_tr_b16 a[32:33], v12
ds_read_b64_tr_b16 a[34:35], v12 offset:2048
v_mfma_f32_32x32x16_bf16 v[64:79], a[76:79], a[48:51], v[64:79]
ds_read_b64_tr_b16 a[36:37], v13
ds_read_b64_tr_b16 a[38:39], v13 offset:2048
v_mfma_f32_32x32x16_bf16 v[80:95], a[64:67], a[52:55], v[80:95]
ds_read_b64_tr_b16 a[40:41], v14
ds_read_b64_tr_b16 a[42:43], v14 offset:2048
v_mfma_f32_32x32x16_bf16 v[96:111], a[68:71], a[52:55], v[96:111]
ds_read_b64_tr_b16 a[44:45], v2
ds_read_b64_tr_b16 a[46:47], v2 offset:2048
v_mfma_f32_32x32x16_bf16 v[112:127], a[72:75], a[52:55], v[112:127]
s_add_u32 s32, s60, 768
s_add_u32 m0, s36, 0
s_nop 0
buffer_load_dwordx4 v1, s[52:55], s32 offen lds
v_mfma_f32_32x32x16_bf16 v[128:143], a[76:79], a[52:55], v[128:143]
s_add_u32 s32, s60, 74496
s_add_u32 m0, s36, 4096
s_nop 0
buffer_load_dwordx4 v1, s[52:55], s32 offen lds
v_mfma_f32_32x32x16_bf16 v[144:159], a[64:67], a[56:59], v[144:159]
s_add_u32 s32, s60, 148224
s_add_u32 m0, s36, 8192
s_nop 0
buffer_load_dwordx4 v1, s[52:55], s32 offen lds
v_mfma_f32_32x32x16_bf16 v[160:175], a[68:71], a[56:59], v[160:175]
s_add_u32 s32, s60, 221952
s_add_u32 m0, s36, 12288
s_nop 0
buffer_load_dwordx4 v1, s[52:55], s32 offen lds
v_mfma_f32_32x32x16_bf16 v[176:191], a[72:75], a[56:59], v[176:191]
s_add_u32 m0, s36, 16384
s_nop 0
buffer_load_dwordx4 v4, s[48:51], s61 offen lds
s_add_u32 s61, s61, s62
v_mfma_f32_32x32x16_bf16 v[192:207], a[76:79], a[56:59], v[192:207]
s_add_u32 m0, s36, 20480
s_nop 0
buffer_load_dwordx4 v4, s[48:51], s61 offen lds
s_add_u32 s61, s61, s62
v_mfma_f32_32x32x16_bf16 v[208:223], a[64:67], a[60:63], v[208:223]
s_add_u32 m0, s36, 24576
s_nop 0
buffer_load_dwordx4 v4, s[48:51], s61 offen lds
s_add_u32 s61, s61, s62
v_mfma_f32_32x32x16_bf16 v[224:239], a[68:71], a[60:63], v[224:239]
s_add_u32 m0, s36, 28672
s_nop 0
buffer_load_dwordx4 v4, s[48:51], s61 offen lds
s_add_u32 s61, s61, s62
v_mfma_f32_32x32x16_bf16 v[240:255], a[72:75], a[60:63], v[240:255]
v_mfma_f32_32x32x16_bf16 a[0:15], a[76:79], a[60:63], a[0:15]
s_waitcnt lgkmcnt(0)
v_mfma_f32_32x32x16_bf16 v[16:31], a[32:35], a[16:19], v[16:31]
ds_read_b128 a[48:51], v11
ds_read_b128 a[52:55], v11 offset:2048
v_mfma_f32_32x32x16_bf16 v[32:47], a[36:39], a[16:19], v[32:47]
ds_read_b128 a[56:59], v11 offset:4096
ds_read_b128 a[60:63], v11 offset:6144
v_mfma_f32_32x32x16_bf16 v[48:63], a[40:43], a[16:19], v[48:63]
ds_read_b64_tr_b16 a[64:65], v12 offset:8192
ds_read_b64_tr_b16 a[66:67], v12 offset:10240
v_mfma_f32_32x32x16_bf16 v[64:79], a[44:47], a[16:19], v[64:79]
ds_read_b64_tr_b16 a[68:69], v13 offset:8192
ds_read_b64_tr_b16 a[70:71], v13 offset:10240
v_mfma_f32_32x32x16_bf16 v[80:95], a[32:35], a[20:23], v[80:95]
ds_read_b64_tr_b16 a[72:73], v14 offset:8192
ds_read_b64_tr_b16 a[74:75], v14 offset:10240
v_mfma_f32_32x32x16_bf16 v[96:111], a[36:39], a[20:23], v[96:111]
ds_read_b64_tr_b16 a[76:77], v2 offset:8192
ds_read_b64_tr_b16 a[78:79], v2 offset:10240
v_mfma_f32_32x32x16_bf16 v[112:127], a[40:43], a[20:23], v[112:127]
v_mfma_f32_32x32x16_bf16 v[128:143], a[44:47], a[20:23], v[128:143]
v_mfma_f32_32x32x16_bf16 v[144:159], a[32:35], a[24:27], v[144:159]
v_mfma_f32_32x32x16_bf16 v[160:175], a[36:39], a[24:27], v[160:175]
v_mfma_f32_32x32x16_bf16 v[176:191], a[40:43], a[24:27], v[176:191]
v_mfma_f32_32x32x16_bf16 v[192:207], a[44:47], a[24:27], v[192:207]
v_mfma_f32_32x32x16_bf16 v[208:223], a[32:35], a[28:31], v[208:223]
v_mfma_f32_32x32x16_bf16 v[224:239], a[36:39], a[28:31], v[224:239]
v_mfma_f32_32x32x16_bf16 v[240:255], a[40:43], a[28:31], v[240:255]
v_mfma_f32_32x32x16_bf16 a[0:15], a[44:47], a[28:31], a[0:15]
s_waitcnt lgkmcnt(0)
s_waitcnt vmcnt(8)
s_barrier
v_mfma_f32_32x32x16_bf16 v[16:31], a[64:67], a[48:51], v[16:31]
ds_read_b128 a[16:19], v10 offset:32768
ds_read_b128 a[20:23], v10 offset:34816
v_mfma_f32_32x32x16_bf16 v[32:47], a[68:71], a[48:51], v[32:47]
ds_read_b128 a[24:27], v10 offset:36864
ds_read_b128 a[28:31], v10 offset:38912
v_mfma_f32_32x32x16_bf16 v[48:63], a[72:75], a[48:51], v[48:63]
ds_read_b64_tr_b16 a[32:33], v12 offset:32768
ds_read_b64_tr_b16 a[34:35], v12 offset:34816
v_mfma_f32_32x32x16_bf16 v[64:79], a[76:79], a[48:51], v[64:79]
ds_read_b64_tr_b16 a[36:37], v13 offset:32768
ds_read_b64_tr_b16 a[38:39], v13 offset:34816
v_mfma_f32_32x32x16_bf16 v[80:95], a[64:67], a[52:55], v[80:95]
ds_read_b64_tr_b16 a[40:41], v14 offset:32768
ds_read_b64_tr_b16 a[42:43], v14 offset:34816
v_mfma_f32_32x32x16_bf16 v[96:111], a[68:71], a[52:55], v[96:111]
ds_read_b64_tr_b16 a[44:45], v2 offset:32768
ds_read_b64_tr_b16 a[46:47], v2 offset:34816
v_mfma_f32_32x32x16_bf16 v[112:127], a[72:75], a[52:55], v[112:127]
s_add_u32 s32, s60, 832
s_add_u32 m0, s36, 32768
s_nop 0
buffer_load_dwordx4 v1, s[52:55], s32 offen lds
v_mfma_f32_32x32x16_bf16 v[128:143], a[76:79], a[52:55], v[128:143]
s_add_u32 s32, s60, 74560
s_add_u32 m0, s36, 36864
s_nop 0
buffer_load_dwordx4 v1, s[52:55], s32 offen lds
v_mfma_f32_32x32x16_bf16 v[144:159], a[64:67], a[56:59], v[144:159]
s_add_u32 s32, s60, 148288
s_add_u32 m0, s36, 40960
s_nop 0
buffer_load_dwordx4 v1, s[52:55], s32 offen lds
v_mfma_f32_32x32x16_bf16 v[160:175], a[68:71], a[56:59], v[160:175]
s_add_u32 s32, s60, 222016
s_add_u32 m0, s36, 45056
s_nop 0
buffer_load_dwordx4 v1, s[52:55], s32 offen lds
v_mfma_f32_32x32x16_bf16 v[176:191], a[72:75], a[56:59], v[176:191]
s_add_u32 m0, s36, 49152
s_nop 0
buffer_load_dwordx4 v4, s[48:51], s61 offen lds
s_add_u32 s61, s61, s62
v_mfma_f32_32x32x16_bf16 v[192:207], a[76:79], a[56:59], v[192:207]
s_add_u32 m0, s36, 53248
s_nop 0
buffer_load_dwordx4 v4, s[48:51], s61 offen lds
s_add_u32 s61, s61, s62
v_mfma_f32_32x32x16_bf16 v[208:223], a[64:67], a[60:63], v[208:223]
s_add_u32 m0, s36, 57344
s_nop 0
buffer_load_dwordx4 v4, s[48:51], s61 offen lds
s_add_u32 s61, s61, s62
v_mfma_f32_32x32x16_bf16 v[224:239], a[68:71], a[60:63], v[224:239]
s_add_u32 m0, s36, 61440
s_nop 0
buffer_load_dwordx4 v4, s[48:51], s61 offen lds
s_add_u32 s61, s61, s62
v_mfma_f32_32x32x16_bf16 v[240:255], a[72:75], a[60:63], v[240:255]
v_mfma_f32_32x32x16_bf16 a[0:15], a[76:79], a[60:63], a[0:15]
s_waitcnt lgkmcnt(0)
v_mfma_f32_32x32x16_bf16 v[16:31], a[32:35], a[16:19], v[16:31]
ds_read_b128 a[48:51], v11 offset:32768
ds_read_b128 a[52:55], v11 offset:34816
v_mfma_f32_32x32x16_bf16 v[32:47], a[36:39], a[16:19], v[32:47]
ds_read_b128 a[56:59], v11 offset:36864
ds_read_b128 a[60:63], v11 offset:38912
v_mfma_f32_32x32x16_bf16 v[48:63], a[40:43], a[16:19], v[48:63]
ds_read_b64_tr_b16 a[64:65], v12 offset:40960
ds_read_b64_tr_b16 a[66:67], v12 offset:43008
v_mfma_f32_32x32x16_bf16 v[64:79], a[44:47], a[16:19], v[64:79]
ds_read_b64_tr_b16 a[68:69], v13 offset:40960
ds_read_b64_tr_b16 a[70:71], v13 offset:43008
v_mfma_f32_32x32x16_bf16 v[80:95], a[32:35], a[20:23], v[80:95]
ds_read_b64_tr_b16 a[72:73], v14 offset:40960
ds_read_b64_tr_b16 a[74:75], v14 offset:43008
v_mfma_f32_32x32x16_bf16 v[96:111], a[36:39], a[20:23], v[96:111]
ds_read_b64_tr_b16 a[76:77], v2 offset:40960
ds_read_b64_tr_b16 a[78:79], v2 offset:43008
v_mfma_f32_32x32x16_bf16 v[112:127], a[40:43], a[20:23], v[112:127]
v_mfma_f32_32x32x16_bf16 v[128:143], a[44:47], a[20:23], v[128:143]
v_mfma_f32_32x32x16_bf16 v[144:159], a[32:35], a[24:27], v[144:159]
v_mfma_f32_32x32x16_bf16 v[160:175], a[36:39], a[24:27], v[160:175]
v_mfma_f32_32x32x16_bf16 v[176:191], a[40:43], a[24:27], v[176:191]
v_mfma_f32_32x32x16_bf16 v[192:207], a[44:47], a[24:27], v[192:207]
v_mfma_f32_32x32x16_bf16 v[208:223], a[32:35], a[28:31], v[208:223]
v_mfma_f32_32x32x16_bf16 v[224:239], a[36:39], a[28:31], v[224:239]
v_mfma_f32_32x32x16_bf16 v[240:255], a[40:43], a[28:31], v[240:255]
v_mfma_f32_32x32x16_bf16 a[0:15], a[44:47], a[28:31], a[0:15]
s_waitcnt lgkmcnt(0)
s_waitcnt vmcnt(8)
s_barrier
v_mfma_f32_32x32x16_bf16 v[16:31], a[64:67], a[48:51], v[16:31]
ds_read_b128 a[16:19], v5
ds_read_b128 a[20:23], v5 offset:2048
v_mfma_f32_32x32x16_bf16 v[32:47], a[68:71], a[48:51], v[32:47]
ds_read_b128 a[24:27], v5 offset:4096
ds_read_b128 a[28:31], v5 offset:6144
v_mfma_f32_32x32x16_bf16 v[48:63], a[72:75], a[48:51], v[48:63]
ds_read_b64_tr_b16 a[32:33], v6
ds_read_b64_tr_b16 a[34:35], v6 offset:2048
v_mfma_f32_32x32x16_bf16 v[64:79], a[76:79], a[48:51], v[64:79]
ds_read_b64_tr_b16 a[36:37], v7
ds_read_b64_tr_b16 a[38:39], v7 offset:2048
v_mfma_f32_32x32x16_bf16 v[80:95], a[64:67], a[52:55], v[80:95]
ds_read_b64_tr_b16 a[40:41], v9
ds_read_b64_tr_b16 a[42:43], v9 offset:2048
v_mfma_f32_32x32x16_bf16 v[96:111], a[68:71], a[52:55], v[96:111]
ds_read_b64_tr_b16 a[44:45], v15
ds_read_b64_tr_b16 a[46:47], v15 offset:2048
v_mfma_f32_32x32x16_bf16 v[112:127], a[72:75], a[52:55], v[112:127]
s_add_u32 s32, s60, 896
s_add_u32 m0, s36, 65536
s_nop 0
buffer_load_dwordx4 v1, s[52:55], s32 offen lds
v_mfma_f32_32x32x16_bf16 v[128:143], a[76:79], a[52:55], v[128:143]
s_add_u32 s32, s60, 74624
s_add_u32 m0, s36, 69632
s_nop 0
buffer_load_dwordx4 v1, s[52:55], s32 offen lds
v_mfma_f32_32x32x16_bf16 v[144:159], a[64:67], a[56:59], v[144:159]
s_add_u32 s32, s60, 148352
s_add_u32 m0, s36, 73728
s_nop 0
buffer_load_dwordx4 v1, s[52:55], s32 offen lds
v_mfma_f32_32x32x16_bf16 v[160:175], a[68:71], a[56:59], v[160:175]
s_add_u32 s32, s60, 222080
s_add_u32 m0, s36, 77824
s_nop 0
buffer_load_dwordx4 v1, s[52:55], s32 offen lds
v_mfma_f32_32x32x16_bf16 v[176:191], a[72:75], a[56:59], v[176:191]
s_add_u32 m0, s36, 81920
s_nop 0
buffer_load_dwordx4 v4, s[48:51], s61 offen lds
s_add_u32 s61, s61, s62
v_mfma_f32_32x32x16_bf16 v[192:207], a[76:79], a[56:59], v[192:207]
s_add_u32 m0, s36, 86016
s_nop 0
buffer_load_dwordx4 v4, s[48:51], s61 offen lds
s_add_u32 s61, s61, s62
v_mfma_f32_32x32x16_bf16 v[208:223], a[64:67], a[60:63], v[208:223]
s_add_u32 m0, s36, 90112
s_nop 0
buffer_load_dwordx4 v4, s[48:51], s61 offen lds
s_add_u32 s61, s61, s62
v_mfma_f32_32x32x16_bf16 v[224:239], a[68:71], a[60:63], v[224:239]
s_add_u32 m0, s36, 94208
s_nop 0
buffer_load_dwordx4 v4, s[48:51], s61 offen lds
s_add_u32 s61, s61, s62
v_mfma_f32_32x32x16_bf16 v[240:255], a[72:75], a[60:63], v[240:255]
v_mfma_f32_32x32x16_bf16 a[0:15], a[76:79], a[60:63], a[0:15]
s_waitcnt lgkmcnt(0)
v_mfma_f32_32x32x16_bf16 v[16:31], a[32:35], a[16:19], v[16:31]
ds_read_b128 a[48:51], v8
ds_read_b128 a[52:55], v8 offset:2048
v_mfma_f32_32x32x16_bf16 v[32:47], a[36:39], a[16:19], v[32:47]
ds_read_b128 a[56:59], v8 offset:4096
ds_read_b128 a[60:63], v8 offset:6144
v_mfma_f32_32x32x16_bf16 v[48:63], a[40:43], a[16:19], v[48:63]
ds_read_b64_tr_b16 a[64:65], v6 offset:8192
ds_read_b64_tr_b16 a[66:67], v6 offset:10240
v_mfma_f32_32x32x16_bf16 v[64:79], a[44:47], a[16:19], v[64:79]
ds_read_b64_tr_b16 a[68:69], v7 offset:8192
ds_read_b64_tr_b16 a[70:71], v7 offset:10240
v_mfma_f32_32x32x16_bf16 v[80:95], a[32:35], a[20:23], v[80:95]
ds_read_b64_tr_b16 a[72:73], v9 offset:8192
ds_read_b64_tr_b16 a[74:75], v9 offset:10240
v_mfma_f32_32x32x16_bf16 v[96:111], a[36:39], a[20:23], v[96:111]
ds_read_b64_tr_b16 a[76:77], v15 offset:8192
ds_read_b64_tr_b16 a[78:79], v15 offset:10240
v_mfma_f32_32x32x16_bf16 v[112:127], a[40:43], a[20:23], v[112:127]
v_mfma_f32_32x32x16_bf16 v[128:143], a[44:47], a[20:23], v[128:143]
v_mfma_f32_32x32x16_bf16 v[144:159], a[32:35], a[24:27], v[144:159]
v_mfma_f32_32x32x16_bf16 v[160:175], a[36:39], a[24:27], v[160:175]
v_mfma_f32_32x32x16_bf16 v[176:191], a[40:43], a[24:27], v[176:191]
v_mfma_f32_32x32x16_bf16 v[192:207], a[44:47], a[24:27], v[192:207]
v_mfma_f32_32x32x16_bf16 v[208:223], a[32:35], a[28:31], v[208:223]
v_mfma_f32_32x32x16_bf16 v[224:239], a[36:39], a[28:31], v[224:239]
v_mfma_f32_32x32x16_bf16 v[240:255], a[40:43], a[28:31], v[240:255]
v_mfma_f32_32x32x16_bf16 a[0:15], a[44:47], a[28:31], a[0:15]
s_waitcnt lgkmcnt(0)
s_waitcnt vmcnt(8)
s_barrier
v_mfma_f32_32x32x16_bf16 v[16:31], a[64:67], a[48:51], v[16:31]
ds_read_b128 a[16:19], v5 offset:32768
ds_read_b128 a[20:23], v5 offset:34816
v_mfma_f32_32x32x16_bf16 v[32:47], a[68:71], a[48:51], v[32:47]
ds_read_b128 a[24:27], v5 offset:36864
ds_read_b128 a[28:31], v5 offset:38912
v_mfma_f32_32x32x16_bf16 v[48:63], a[72:75], a[48:51], v[48:63]
ds_read_b64_tr_b16 a[32:33], v6 offset:32768
ds_read_b64_tr_b16 a[34:35], v6 offset:34816
v_mfma_f32_32x32x16_bf16 v[64:79], a[76:79], a[48:51], v[64:79]
ds_read_b64_tr_b16 a[36:37], v7 offset:32768
ds_read_b64_tr_b16 a[38:39], v7 offset:34816
v_mfma_f32_32x32x16_bf16 v[80:95], a[64:67], a[52:55], v[80:95]
ds_read_b64_tr_b16 a[40:41], v9 offset:32768
ds_read_b64_tr_b16 a[42:43], v9 offset:34816
v_mfma_f32_32x32x16_bf16 v[96:111], a[68:71], a[52:55], v[96:111]
ds_read_b64_tr_b16 a[44:45], v15 offset:32768
ds_read_b64_tr_b16 a[46:47], v15 offset:34816
v_mfma_f32_32x32x16_bf16 v[112:127], a[72:75], a[52:55], v[112:127]
s_add_u32 s32, s60, 960
s_add_u32 m0, s36, 98304
s_nop 0
buffer_load_dwordx4 v1, s[52:55], s32 offen lds
v_mfma_f32_32x32x16_bf16 v[128:143], a[76:79], a[52:55], v[128:143]
s_add_u32 s32, s60, 74688
s_add_u32 m0, s36, 102400
s_nop 0
buffer_load_dwordx4 v1, s[52:55], s32 offen lds
v_mfma_f32_32x32x16_bf16 v[144:159], a[64:67], a[56:59], v[144:159]
s_add_u32 s32, s60, 148416
s_add_u32 m0, s36, 106496
s_nop 0
buffer_load_dwordx4 v1, s[52:55], s32 offen lds
v_mfma_f32_32x32x16_bf16 v[160:175], a[68:71], a[56:59], v[160:175]
s_add_u32 s32, s60, 222144
s_add_u32 m0, s36, 110592
s_nop 0
buffer_load_dwordx4 v1, s[52:55], s32 offen lds
v_mfma_f32_32x32x16_bf16 v[176:191], a[72:75], a[56:59], v[176:191]
s_add_u32 m0, s36, 114688
s_nop 0
buffer_load_dwordx4 v4, s[48:51], s61 offen lds
s_add_u32 s61, s61, s62
v_mfma_f32_32x32x16_bf16 v[192:207], a[76:79], a[56:59], v[192:207]
s_add_u32 m0, s36, 118784
s_nop 0
buffer_load_dwordx4 v4, s[48:51], s61 offen lds
s_add_u32 s61, s61, s62
v_mfma_f32_32x32x16_bf16 v[208:223], a[64:67], a[60:63], v[208:223]
s_add_u32 m0, s36, 122880
s_nop 0
buffer_load_dwordx4 v4, s[48:51], s61 offen lds
s_add_u32 s61, s61, s62
v_mfma_f32_32x32x16_bf16 v[224:239], a[68:71], a[60:63], v[224:239]
s_add_u32 m0, s36, 126976
s_nop 0
buffer_load_dwordx4 v4, s[48:51], s61 offen lds
s_add_u32 s61, s61, s62
v_mfma_f32_32x32x16_bf16 v[240:255], a[72:75], a[60:63], v[240:255]
v_mfma_f32_32x32x16_bf16 a[0:15], a[76:79], a[60:63], a[0:15]
s_waitcnt lgkmcnt(0)
v_mfma_f32_32x32x16_bf16 v[16:31], a[32:35], a[16:19], v[16:31]
ds_read_b128 a[48:51], v8 offset:32768
ds_read_b128 a[52:55], v8 offset:34816
v_mfma_f32_32x32x16_bf16 v[32:47], a[36:39], a[16:19], v[32:47]
ds_read_b128 a[56:59], v8 offset:36864
ds_read_b128 a[60:63], v8 offset:38912
v_mfma_f32_32x32x16_bf16 v[48:63], a[40:43], a[16:19], v[48:63]
ds_read_b64_tr_b16 a[64:65], v6 offset:40960
ds_read_b64_tr_b16 a[66:67], v6 offset:43008
v_mfma_f32_32x32x16_bf16 v[64:79], a[44:47], a[16:19], v[64:79]
ds_read_b64_tr_b16 a[68:69], v7 offset:40960
ds_read_b64_tr_b16 a[70:71], v7 offset:43008
v_mfma_f32_32x32x16_bf16 v[80:95], a[32:35], a[20:23], v[80:95]
ds_read_b64_tr_b16 a[72:73], v9 offset:40960
ds_read_b64_tr_b16 a[74:75], v9 offset:43008
v_mfma_f32_32x32x16_bf16 v[96:111], a[36:39], a[20:23], v[96:111]
ds_read_b64_tr_b16 a[76:77], v15 offset:40960
ds_read_b64_tr_b16 a[78:79], v15 offset:43008
v_mfma_f32_32x32x16_bf16 v[112:127], a[40:43], a[20:23], v[112:127]
v_mfma_f32_32x32x16_bf16 v[128:143], a[44:47], a[20:23], v[128:143]
v_mfma_f32_32x32x16_bf16 v[144:159], a[32:35], a[24:27], v[144:159]
v_mfma_f32_32x32x16_bf16 v[160:175], a[36:39], a[24:27], v[160:175]
v_mfma_f32_32x32x16_bf16 v[176:191], a[40:43], a[24:27], v[176:191]
v_mfma_f32_32x32x16_bf16 v[192:207], a[44:47], a[24:27], v[192:207]
v_mfma_f32_32x32x16_bf16 v[208:223], a[32:35], a[28:31], v[208:223]
v_mfma_f32_32x32x16_bf16 v[224:239], a[36:39], a[28:31], v[224:239]
v_mfma_f32_32x32x16_bf16 v[240:255], a[40:43], a[28:31], v[240:255]
v_mfma_f32_32x32x16_bf16 a[0:15], a[44:47], a[28:31], a[0:15]
s_waitcnt lgkmcnt(0)
s_waitcnt vmcnt(8)
s_barrier
v_mfma_f32_32x32x16_bf16 v[16:31], a[64:67], a[48:51], v[16:31]
ds_read_b128 a[16:19], v10
ds_read_b128 a[20:23], v10 offset:2048
v_mfma_f32_32x32x16_bf16 v[32:47], a[68:71], a[48:51], v[32:47]
ds_read_b128 a[24:27], v10 offset:4096
ds_read_b128 a[28:31], v10 offset:6144
v_mfma_f32_32x32x16_bf16 v[48:63], a[72:75], a[48:51], v[48:63]
ds_read_b64_tr_b16 a[32:33], v12
ds_read_b64_tr_b16 a[34:35], v12 offset:2048
v_mfma_f32_32x32x16_bf16 v[64:79], a[76:79], a[48:51], v[64:79]
ds_read_b64_tr_b16 a[36:37], v13
ds_read_b64_tr_b16 a[38:39], v13 offset:2048
v_mfma_f32_32x32x16_bf16 v[80:95], a[64:67], a[52:55], v[80:95]
ds_read_b64_tr_b16 a[40:41], v14
ds_read_b64_tr_b16 a[42:43], v14 offset:2048
v_mfma_f32_32x32x16_bf16 v[96:111], a[68:71], a[52:55], v[96:111]
ds_read_b64_tr_b16 a[44:45], v2
ds_read_b64_tr_b16 a[46:47], v2 offset:2048
v_mfma_f32_32x32x16_bf16 v[112:127], a[72:75], a[52:55], v[112:127]
s_add_u32 s32, s60, 1024
s_add_u32 m0, s36, 0
s_nop 0
buffer_load_dwordx4 v1, s[52:55], s32 offen lds
v_mfma_f32_32x32x16_bf16 v[128:143], a[76:79], a[52:55], v[128:143]
s_add_u32 s32, s60, 74752
s_add_u32 m0, s36, 4096
s_nop 0
buffer_load_dwordx4 v1, s[52:55], s32 offen lds
v_mfma_f32_32x32x16_bf16 v[144:159], a[64:67], a[56:59], v[144:159]
s_add_u32 s32, s60, 148480
s_add_u32 m0, s36, 8192
s_nop 0
buffer_load_dwordx4 v1, s[52:55], s32 offen lds
v_mfma_f32_32x32x16_bf16 v[160:175], a[68:71], a[56:59], v[160:175]
s_add_u32 s32, s60, 222208
s_add_u32 m0, s36, 12288
s_nop 0
buffer_load_dwordx4 v1, s[52:55], s32 offen lds
v_mfma_f32_32x32x16_bf16 v[176:191], a[72:75], a[56:59], v[176:191]
s_add_u32 m0, s36, 16384
s_nop 0
buffer_load_dwordx4 v4, s[48:51], s61 offen lds
s_add_u32 s61, s61, s62
v_mfma_f32_32x32x16_bf16 v[192:207], a[76:79], a[56:59], v[192:207]
s_add_u32 m0, s36, 20480
s_nop 0
buffer_load_dwordx4 v4, s[48:51], s61 offen lds
s_add_u32 s61, s61, s62
v_mfma_f32_32x32x16_bf16 v[208:223], a[64:67], a[60:63], v[208:223]
s_add_u32 m0, s36, 24576
s_nop 0
buffer_load_dwordx4 v4, s[48:51], s61 offen lds
s_add_u32 s61, s61, s62
v_mfma_f32_32x32x16_bf16 v[224:239], a[68:71], a[60:63], v[224:239]
s_add_u32 m0, s36, 28672
s_nop 0
buffer_load_dwordx4 v4, s[48:51], s61 offen lds
s_add_u32 s61, s61, s62
v_mfma_f32_32x32x16_bf16 v[240:255], a[72:75], a[60:63], v[240:255]
v_mfma_f32_32x32x16_bf16 a[0:15], a[76:79], a[60:63], a[0:15]
s_waitcnt lgkmcnt(0)
v_mfma_f32_32x32x16_bf16 v[16:31], a[32:35], a[16:19], v[16:31]
ds_read_b128 a[48:51], v11
ds_read_b128 a[52:55], v11 offset:2048
v_mfma_f32_32x32x16_bf16 v[32:47], a[36:39], a[16:19], v[32:47]
ds_read_b128 a[56:59], v11 offset:4096
ds_read_b128 a[60:63], v11 offset:6144
v_mfma_f32_32x32x16_bf16 v[48:63], a[40:43], a[16:19], v[48:63]
ds_read_b64_tr_b16 a[64:65], v12 offset:8192
ds_read_b64_tr_b16 a[66:67], v12 offset:10240
v_mfma_f32_32x32x16_bf16 v[64:79], a[44:47], a[16:19], v[64:79]
ds_read_b64_tr_b16 a[68:69], v13 offset:8192
ds_read_b64_tr_b16 a[70:71], v13 offset:10240
v_mfma_f32_32x32x16_bf16 v[80:95], a[32:35], a[20:23], v[80:95]
ds_read_b64_tr_b16 a[72:73], v14 offset:8192
ds_read_b64_tr_b16 a[74:75], v14 offset:10240
v_mfma_f32_32x32x16_bf16 v[96:111], a[36:39], a[20:23], v[96:111]
ds_read_b64_tr_b16 a[76:77], v2 offset:8192
ds_read_b64_tr_b16 a[78:79], v2 offset:10240
v_mfma_f32_32x32x16_bf16 v[112:127], a[40:43], a[20:23], v[112:127]
v_mfma_f32_32x32x16_bf16 v[128:143], a[44:47], a[20:23], v[128:143]
v_mfma_f32_32x32x16_bf16 v[144:159], a[32:35], a[24:27], v[144:159]
v_mfma_f32_32x32x16_bf16 v[160:175], a[36:39], a[24:27], v[160:175]
v_mfma_f32_32x32x16_bf16 v[176:191], a[40:43], a[24:27], v[176:191]
v_mfma_f32_32x32x16_bf16 v[192:207], a[44:47], a[24:27], v[192:207]
v_mfma_f32_32x32x16_bf16 v[208:223], a[32:35], a[28:31], v[208:223]
v_mfma_f32_32x32x16_bf16 v[224:239], a[36:39], a[28:31], v[224:239]
v_mfma_f32_32x32x16_bf16 v[240:255], a[40:43], a[28:31], v[240:255]
v_mfma_f32_32x32x16_bf16 a[0:15], a[44:47], a[28:31], a[0:15]
s_waitcnt lgkmcnt(0)
s_waitcnt vmcnt(8)
s_barrier
v_mfma_f32_32x32x16_bf16 v[16:31], a[64:67], a[48:51], v[16:31]
ds_read_b128 a[16:19], v10 offset:32768
ds_read_b128 a[20:23], v10 offset:34816
v_mfma_f32_32x32x16_bf16 v[32:47], a[68:71], a[48:51], v[32:47]
ds_read_b128 a[24:27], v10 offset:36864
ds_read_b128 a[28:31], v10 offset:38912
v_mfma_f32_32x32x16_bf16 v[48:63], a[72:75], a[48:51], v[48:63]
ds_read_b64_tr_b16 a[32:33], v12 offset:32768
ds_read_b64_tr_b16 a[34:35], v12 offset:34816
v_mfma_f32_32x32x16_bf16 v[64:79], a[76:79], a[48:51], v[64:79]
ds_read_b64_tr_b16 a[36:37], v13 offset:32768
ds_read_b64_tr_b16 a[38:39], v13 offset:34816
v_mfma_f32_32x32x16_bf16 v[80:95], a[64:67], a[52:55], v[80:95]
ds_read_b64_tr_b16 a[40:41], v14 offset:32768
ds_read_b64_tr_b16 a[42:43], v14 offset:34816
v_mfma_f32_32x32x16_bf16 v[96:111], a[68:71], a[52:55], v[96:111]
ds_read_b64_tr_b16 a[44:45], v2 offset:32768
ds_read_b64_tr_b16 a[46:47], v2 offset:34816
v_mfma_f32_32x32x16_bf16 v[112:127], a[72:75], a[52:55], v[112:127]
s_add_u32 s32, s60, 1088
s_add_u32 m0, s36, 32768
s_nop 0
buffer_load_dwordx4 v1, s[52:55], s32 offen lds
v_mfma_f32_32x32x16_bf16 v[128:143], a[76:79], a[52:55], v[128:143]
s_add_u32 s32, s60, 74816
s_add_u32 m0, s36, 36864
s_nop 0
buffer_load_dwordx4 v1, s[52:55], s32 offen lds
v_mfma_f32_32x32x16_bf16 v[144:159], a[64:67], a[56:59], v[144:159]
s_add_u32 s32, s60, 148544
s_add_u32 m0, s36, 40960
s_nop 0
buffer_load_dwordx4 v1, s[52:55], s32 offen lds
v_mfma_f32_32x32x16_bf16 v[160:175], a[68:71], a[56:59], v[160:175]
s_add_u32 s32, s60, 222272
s_add_u32 m0, s36, 45056
s_nop 0
buffer_load_dwordx4 v1, s[52:55], s32 offen lds
v_mfma_f32_32x32x16_bf16 v[176:191], a[72:75], a[56:59], v[176:191]
s_add_u32 m0, s36, 49152
s_nop 0
buffer_load_dwordx4 v4, s[48:51], s61 offen lds
s_add_u32 s61, s61, s62
v_mfma_f32_32x32x16_bf16 v[192:207], a[76:79], a[56:59], v[192:207]
s_add_u32 m0, s36, 53248
s_nop 0
buffer_load_dwordx4 v4, s[48:51], s61 offen lds
s_add_u32 s61, s61, s62
v_mfma_f32_32x32x16_bf16 v[208:223], a[64:67], a[60:63], v[208:223]
s_add_u32 m0, s36, 57344
s_nop 0
buffer_load_dwordx4 v4, s[48:51], s61 offen lds
s_add_u32 s61, s61, s62
v_mfma_f32_32x32x16_bf16 v[224:239], a[68:71], a[60:63], v[224:239]
s_add_u32 m0, s36, 61440
s_nop 0
buffer_load_dwordx4 v4, s[48:51], s61 offen lds
s_add_u32 s61, s61, s62
v_mfma_f32_32x32x16_bf16 v[240:255], a[72:75], a[60:63], v[240:255]
v_mfma_f32_32x32x16_bf16 a[0:15], a[76:79], a[60:63], a[0:15]
s_waitcnt lgkmcnt(0)
v_mfma_f32_32x32x16_bf16 v[16:31], a[32:35], a[16:19], v[16:31]
ds_read_b128 a[48:51], v11 offset:32768
ds_read_b128 a[52:55], v11 offset:34816
v_mfma_f32_32x32x16_bf16 v[32:47], a[36:39], a[16:19], v[32:47]
ds_read_b128 a[56:59], v11 offset:36864
ds_read_b128 a[60:63], v11 offset:38912
v_mfma_f32_32x32x16_bf16 v[48:63], a[40:43], a[16:19], v[48:63]
ds_read_b64_tr_b16 a[64:65], v12 offset:40960
ds_read_b64_tr_b16 a[66:67], v12 offset:43008
v_mfma_f32_32x32x16_bf16 v[64:79], a[44:47], a[16:19], v[64:79]
ds_read_b64_tr_b16 a[68:69], v13 offset:40960
ds_read_b64_tr_b16 a[70:71], v13 offset:43008
v_mfma_f32_32x32x16_bf16 v[80:95], a[32:35], a[20:23], v[80:95]
ds_read_b64_tr_b16 a[72:73], v14 offset:40960
ds_read_b64_tr_b16 a[74:75], v14 offset:43008
v_mfma_f32_32x32x16_bf16 v[96:111], a[36:39], a[20:23], v[96:111]
ds_read_b64_tr_b16 a[76:77], v2 offset:40960
ds_read_b64_tr_b16 a[78:79], v2 offset:43008
v_mfma_f32_32x32x16_bf16 v[112:127], a[40:43], a[20:23], v[112:127]
v_mfma_f32_32x32x16_bf16 v[128:143], a[44:47], a[20:23], v[128:143]
v_mfma_f32_32x32x16_bf16 v[144:159], a[32:35], a[24:27], v[144:159]
v_mfma_f32_32x32x16_bf16 v[160:175], a[36:39], a[24:27], v[160:175]
v_mfma_f32_32x32x16_bf16 v[176:191], a[40:43], a[24:27], v[176:191]
v_mfma_f32_32x32x16_bf16 v[192:207], a[44:47], a[24:27], v[192:207]
v_mfma_f32_32x32x16_bf16 v[208:223], a[32:35], a[28:31], v[208:223]
v_mfma_f32_32x32x16_bf16 v[224:239], a[36:39], a[28:31], v[224:239]
v_mfma_f32_32x32x16_bf16 v[240:255], a[40:43], a[28:31], v[240:255]
v_mfma_f32_32x32x16_bf16 a[0:15], a[44:47], a[28:31], a[0:15]
s_waitcnt lgkmcnt(0)
s_waitcnt vmcnt(8)
s_barrier
v_mfma_f32_32x32x16_bf16 v[16:31], a[64:67], a[48:51], v[16:31]
ds_read_b128 a[16:19], v5
ds_read_b128 a[20:23], v5 offset:2048
v_mfma_f32_32x32x16_bf16 v[32:47], a[68:71], a[48:51], v[32:47]
ds_read_b128 a[24:27], v5 offset:4096
ds_read_b128 a[28:31], v5 offset:6144
v_mfma_f32_32x32x16_bf16 v[48:63], a[72:75], a[48:51], v[48:63]
ds_read_b64_tr_b16 a[32:33], v6
ds_read_b64_tr_b16 a[34:35], v6 offset:2048
v_mfma_f32_32x32x16_bf16 v[64:79], a[76:79], a[48:51], v[64:79]
ds_read_b64_tr_b16 a[36:37], v7
ds_read_b64_tr_b16 a[38:39], v7 offset:2048
v_mfma_f32_32x32x16_bf16 v[80:95], a[64:67], a[52:55], v[80:95]
ds_read_b64_tr_b16 a[40:41], v9
ds_read_b64_tr_b16 a[42:43], v9 offset:2048
v_mfma_f32_32x32x16_bf16 v[96:111], a[68:71], a[52:55], v[96:111]
ds_read_b64_tr_b16 a[44:45], v15
ds_read_b64_tr_b16 a[46:47], v15 offset:2048
v_mfma_f32_32x32x16_bf16 v[112:127], a[72:75], a[52:55], v[112:127]
v_mfma_f32_32x32x16_bf16 v[128:143], a[76:79], a[52:55], v[128:143]
v_mfma_f32_32x32x16_bf16 v[144:159], a[64:67], a[56:59], v[144:159]
v_mfma_f32_32x32x16_bf16 v[160:175], a[68:71], a[56:59], v[160:175]
v_mfma_f32_32x32x16_bf16 v[176:191], a[72:75], a[56:59], v[176:191]
v_mfma_f32_32x32x16_bf16 v[192:207], a[76:79], a[56:59], v[192:207]
v_mfma_f32_32x32x16_bf16 v[208:223], a[64:67], a[60:63], v[208:223]
v_mfma_f32_32x32x16_bf16 v[224:239], a[68:71], a[60:63], v[224:239]
v_mfma_f32_32x32x16_bf16 v[240:255], a[72:75], a[60:63], v[240:255]
v_mfma_f32_32x32x16_bf16 a[0:15], a[76:79], a[60:63], a[0:15]
s_waitcnt lgkmcnt(0)
v_mfma_f32_32x32x16_bf16 v[16:31], a[32:35], a[16:19], v[16:31]
ds_read_b128 a[48:51], v8
ds_read_b128 a[52:55], v8 offset:2048
v_mfma_f32_32x32x16_bf16 v[32:47], a[36:39], a[16:19], v[32:47]
ds_read_b128 a[56:59], v8 offset:4096
ds_read_b128 a[60:63], v8 offset:6144
v_mfma_f32_32x32x16_bf16 v[48:63], a[40:43], a[16:19], v[48:63]
ds_read_b64_tr_b16 a[64:65], v6 offset:8192
ds_read_b64_tr_b16 a[66:67], v6 offset:10240
v_mfma_f32_32x32x16_bf16 v[64:79], a[44:47], a[16:19], v[64:79]
ds_read_b64_tr_b16 a[68:69], v7 offset:8192
ds_read_b64_tr_b16 a[70:71], v7 offset:10240
v_mfma_f32_32x32x16_bf16 v[80:95], a[32:35], a[20:23], v[80:95]
ds_read_b64_tr_b16 a[72:73], v9 offset:8192
ds_read_b64_tr_b16 a[74:75], v9 offset:10240
v_mfma_f32_32x32x16_bf16 v[96:111], a[36:39], a[20:23], v[96:111]
ds_read_b64_tr_b16 a[76:77], v15 offset:8192
ds_read_b64_tr_b16 a[78:79], v15 offset:10240
v_mfma_f32_32x32x16_bf16 v[112:127], a[40:43], a[20:23], v[112:127]
v_mfma_f32_32x32x16_bf16 v[128:143], a[44:47], a[20:23], v[128:143]
v_mfma_f32_32x32x16_bf16 v[144:159], a[32:35], a[24:27], v[144:159]
v_mfma_f32_32x32x16_bf16 v[160:175], a[36:39], a[24:27], v[160:175]
v_mfma_f32_32x32x16_bf16 v[176:191], a[40:43], a[24:27], v[176:191]
v_mfma_f32_32x32x16_bf16 v[192:207], a[44:47], a[24:27], v[192:207]
v_mfma_f32_32x32x16_bf16 v[208:223], a[32:35], a[28:31], v[208:223]
v_mfma_f32_32x32x16_bf16 v[224:239], a[36:39], a[28:31], v[224:239]
v_mfma_f32_32x32x16_bf16 v[240:255], a[40:43], a[28:31], v[240:255]
v_mfma_f32_32x32x16_bf16 a[0:15], a[44:47], a[28:31], a[0:15]
s_waitcnt lgkmcnt(0)
s_waitcnt vmcnt(0)
s_barrier
v_mfma_f32_32x32x16_bf16 v[16:31], a[64:67], a[48:51], v[16:31]
ds_read_b128 a[16:19], v5 offset:32768
ds_read_b128 a[20:23], v5 offset:34816
v_mfma_f32_32x32x16_bf16 v[32:47], a[68:71], a[48:51], v[32:47]
ds_read_b128 a[24:27], v5 offset:36864
ds_read_b128 a[28:31], v5 offset:38912
v_mfma_f32_32x32x16_bf16 v[48:63], a[72:75], a[48:51], v[48:63]
ds_read_b64_tr_b16 a[32:33], v6 offset:32768
ds_read_b64_tr_b16 a[34:35], v6 offset:34816
v_mfma_f32_32x32x16_bf16 v[64:79], a[76:79], a[48:51], v[64:79]
ds_read_b64_tr_b16 a[36:37], v7 offset:32768
ds_read_b64_tr_b16 a[38:39], v7 offset:34816
v_mfma_f32_32x32x16_bf16 v[80:95], a[64:67], a[52:55], v[80:95]
ds_read_b64_tr_b16 a[40:41], v9 offset:32768
ds_read_b64_tr_b16 a[42:43], v9 offset:34816
v_mfma_f32_32x32x16_bf16 v[96:111], a[68:71], a[52:55], v[96:111]
ds_read_b64_tr_b16 a[44:45], v15 offset:32768
ds_read_b64_tr_b16 a[46:47], v15 offset:34816
v_mfma_f32_32x32x16_bf16 v[112:127], a[72:75], a[52:55], v[112:127]
v_mfma_f32_32x32x16_bf16 v[128:143], a[76:79], a[52:55], v[128:143]
v_mfma_f32_32x32x16_bf16 v[144:159], a[64:67], a[56:59], v[144:159]
v_mfma_f32_32x32x16_bf16 v[160:175], a[68:71], a[56:59], v[160:175]
v_mfma_f32_32x32x16_bf16 v[176:191], a[72:75], a[56:59], v[176:191]
v_mfma_f32_32x32x16_bf16 v[192:207], a[76:79], a[56:59], v[192:207]
v_mfma_f32_32x32x16_bf16 v[208:223], a[64:67], a[60:63], v[208:223]
v_mfma_f32_32x32x16_bf16 v[224:239], a[68:71], a[60:63], v[224:239]
v_mfma_f32_32x32x16_bf16 v[240:255], a[72:75], a[60:63], v[240:255]
v_mfma_f32_32x32x16_bf16 a[0:15], a[76:79], a[60:63], a[0:15]
s_waitcnt lgkmcnt(0)
v_mfma_f32_32x32x16_bf16 v[16:31], a[32:35], a[16:19], v[16:31]
ds_read_b128 a[48:51], v8 offset:32768
ds_read_b128 a[52:55], v8 offset:34816
v_mfma_f32_32x32x16_bf16 v[32:47], a[36:39], a[16:19], v[32:47]
ds_read_b128 a[56:59], v8 offset:36864
ds_read_b128 a[60:63], v8 offset:38912
v_mfma_f32_32x32x16_bf16 v[48:63], a[40:43], a[16:19], v[48:63]
ds_read_b64_tr_b16 a[64:65], v6 offset:40960
ds_read_b64_tr_b16 a[66:67], v6 offset:43008
v_mfma_f32_32x32x16_bf16 v[64:79], a[44:47], a[16:19], v[64:79]
ds_read_b64_tr_b16 a[68:69], v7 offset:40960
ds_read_b64_tr_b16 a[70:71], v7 offset:43008
v_mfma_f32_32x32x16_bf16 v[80:95], a[32:35], a[20:23], v[80:95]
ds_read_b64_tr_b16 a[72:73], v9 offset:40960
ds_read_b64_tr_b16 a[74:75], v9 offset:43008
v_mfma_f32_32x32x16_bf16 v[96:111], a[36:39], a[20:23], v[96:111]
ds_read_b64_tr_b16 a[76:77], v15 offset:40960
ds_read_b64_tr_b16 a[78:79], v15 offset:43008
v_mfma_f32_32x32x16_bf16 v[112:127], a[40:43], a[20:23], v[112:127]
v_mfma_f32_32x32x16_bf16 v[128:143], a[44:47], a[20:23], v[128:143]
v_mfma_f32_32x32x16_bf16 v[144:159], a[32:35], a[24:27], v[144:159]
v_mfma_f32_32x32x16_bf16 v[160:175], a[36:39], a[24:27], v[160:175]
v_mfma_f32_32x32x16_bf16 v[176:191], a[40:43], a[24:27], v[176:191]
v_mfma_f32_32x32x16_bf16 v[192:207], a[44:47], a[24:27], v[192:207]
v_mfma_f32_32x32x16_bf16 v[208:223], a[32:35], a[28:31], v[208:223]
v_mfma_f32_32x32x16_bf16 v[224:239], a[36:39], a[28:31], v[224:239]
v_mfma_f32_32x32x16_bf16 v[240:255], a[40:43], a[28:31], v[240:255]
v_mfma_f32_32x32x16_bf16 a[0:15], a[44:47], a[28:31], a[0:15]
s_waitcnt lgkmcnt(0)
v_mfma_f32_32x32x16_bf16 v[16:31], a[64:67], a[48:51], v[16:31]
v_mfma_f32_32x32x16_bf16 v[32:47], a[68:71], a[48:51], v[32:47]
v_mfma_f32_32x32x16_bf16 v[48:63], a[72:75], a[48:51], v[48:63]
v_mfma_f32_32x32x16_bf16 v[64:79], a[76:79], a[48:51], v[64:79]
v_mfma_f32_32x32x16_bf16 v[80:95], a[64:67], a[52:55], v[80:95]
v_mfma_f32_32x32x16_bf16 v[96:111], a[68:71], a[52:55], v[96:111]
v_mfma_f32_32x32x16_bf16 v[112:127], a[72:75], a[52:55], v[112:127]
v_mfma_f32_32x32x16_bf16 v[128:143], a[76:79], a[52:55], v[128:143]
v_mfma_f32_32x32x16_bf16 v[144:159], a[64:67], a[56:59], v[144:159]
v_mfma_f32_32x32x16_bf16 v[160:175], a[68:71], a[56:59], v[160:175]
v_mfma_f32_32x32x16_bf16 v[176:191], a[72:75], a[56:59], v[176:191]
v_mfma_f32_32x32x16_bf16 v[192:207], a[76:79], a[56:59], v[192:207]
v_mfma_f32_32x32x16_bf16 v[208:223], a[64:67], a[60:63], v[208:223]
v_mfma_f32_32x32x16_bf16 v[224:239], a[68:71], a[60:63], v[224:239]
v_mfma_f32_32x32x16_bf16 v[240:255], a[72:75], a[60:63], v[240:255]
v_mfma_f32_32x32x16_bf16 a[0:15], a[76:79], a[60:63], a[0:15]
s_branch GE_16
GX_15:
s_waitcnt vmcnt(9)
s_barrier
ds_read_b128 a[16:19], v5
ds_read_b128 a[20:23], v5 offset:2048
ds_read_b128 a[24:27], v5 offset:4096
ds_read_b128 a[28:31], v5 offset:6144
ds_read_b64_tr_b16 a[32:33], v6
ds_read_b64_tr_b16 a[34:35], v6 offset:2048
ds_read_b64_tr_b16 a[36:37], v7
ds_read_b64_tr_b16 a[38:39], v7 offset:2048
ds_read_b64_tr_b16 a[40:41], v9
ds_read_b64_tr_b16 a[42:43], v9 offset:2048
ds_read_b64_tr_b16 a[44:45], v15
ds_read_b64_tr_b16 a[46:47], v15 offset:2048
s_add_u32 s32, s60, 128
s_add_u32 m0, s36, 65536
s_nop 0
buffer_load_dwordx4 v1, s[52:55], s32 offen lds
s_add_u32 s32, s60, 73856
s_add_u32 m0, s36, 69632
s_nop 0
buffer_load_dwordx4 v1, s[52:55], s32 offen lds
s_add_u32 s32, s60, 147584
s_add_u32 m0, s36, 73728
s_nop 0
buffer_load_dwordx4 v1, s[52:55], s32 offen lds
s_add_u32 s32, s60, 221312
s_add_u32 m0, s36, 77824
s_nop 0
buffer_load_dwordx4 v1, s[52:55], s32 offen lds
s_add_u32 m0, s36, 81920
s_nop 0
buffer_load_dwordx4 v4, s[48:51], s61 offen lds
s_add_u32 s61, s61, s62
s_add_u32 m0, s36, 86016
s_nop 0
buffer_load_dwordx4 v4, s[48:51], s61 offen lds
s_add_u32 s61, s61, s62
s_add_u32 m0, s36, 90112
s_nop 0
buffer_load_dwordx4 v4, s[48:51], s61 offen lds
s_add_u32 s61, s61, s62
s_add_u32 m0, s36, 94208
s_nop 0
buffer_load_dwordx4 v4, s[48:51], s61 offen lds
s_add_u32 s61, s61, s62
s_waitcnt lgkmcnt(0)
v_mfma_f32_32x32x16_bf16 v[16:31], a[16:19], a[32:35], 0
ds_read_b128 a[48:51], v8
ds_read_b128 a[52:55], v8 offset:2048
v_mfma_f32_32x32x16_bf16 v[32:47], a[16:19], a[36:39], 0
ds_read_b128 a[56:59], v8 offset:4096
ds_read_b128 a[60:63], v8 offset:6144
v_mfma_f32_32x32x16_bf16 v[48:63], a[16:19], a[40:43], 0
ds_read_b64_tr_b16 a[64:65], v6 offset:8192
ds_read_b64_tr_b16 a[66:67], v6 offset:10240
v_mfma_f32_32x32x16_bf16 v[64:79], a[16:19], a[44:47], 0
ds_read_b64_tr_b16 a[68:69], v7 offset:8192
ds_read_b64_tr_b16 a[70:71], v7 offset:10240
v_mfma_f32_32x32x16_bf16 v[80:95], a[20:23], a[32:35], 0
ds_read_b64_tr_b16 a[72:73], v9 offset:8192
ds_read_b64_tr_b16 a[74:75], v9 offset:10240
v_mfma_f32_32x32x16_bf16 v[96:111], a[20:23], a[36:39], 0
ds_read_b64_tr_b16 a[76:77], v15 offset:8192
ds_read_b64_tr_b16 a[78:79], v15 offset:10240
v_mfma_f32_32x32x16_bf16 v[112:127], a[20:23], a[40:43], 0
v_mfma_f32_32x32x16_bf16 v[128:143], a[20:23], a[44:47], 0
v_mfma_f32_32x32x16_bf16 v[144:159], a[24:27], a[32:35], 0
v_mfma_f32_32x32x16_bf16 v[160:175], a[24:27], a[36:39], 0
v_mfma_f32_32x32x16_bf16 v[176:191], a[24:27], a[40:43], 0
v_mfma_f32_32x32x16_bf16 v[192:207], a[24:27], a[44:47], 0
v_mfma_f32_32x32x16_bf16 v[208:223], a[28:31], a[32:35], 0
v_mfma_f32_32x32x16_bf16 v[224:239], a[28:31], a[36:39], 0
v_mfma_f32_32x32x16_bf16 v[240:255], a[28:31], a[40:43], 0
v_mfma_f32_32x32x16_bf16 a[0:15], a[28:31], a[44:47], 0
s_waitcnt lgkmcnt(0)
s_waitcnt vmcnt(9)
s_barrier
v_mfma_f32_32x32x16_bf16 v[16:31], a[48:51], a[64:67], v[16:31]
ds_read_b128 a[16:19], v5 offset:32768
ds_read_b128 a[20:23], v5 offset:34816
v_mfma_f32_32x32x16_bf16 v[32:47], a[48:51], a[68:71], v[32:47]
ds_read_b128 a[24:27], v5 offset:36864
ds_read_b128 a[28:31], v5 offset:38912
v_mfma_f32_32x32x16_bf16 v[48:63], a[48:51], a[72:75], v[48:63]
ds_read_b64_tr_b16 a[32:33], v6 offset:32768
ds_read_b64_tr_b16 a[34:35], v6 offset:34816
v_mfma_f32_32x32x16_bf16 v[64:79], a[48:51], a[76:79], v[64:79]
ds_read_b64_tr_b16 a[36:37], v7 offset:32768
ds_read_b64_tr_b16 a[38:39], v7 offset:34816
v_mfma_f32_32x32x16_bf16 v[80:95], a[52:55], a[64:67], v[80:95]
ds_read_b64_tr_b16 a[40:41], v9 offset:32768
ds_read_b64_tr_b16 a[42:43], v9 offset:34816
v_mfma_f32_32x32x16_bf16 v[96:111], a[52:55], a[68:71], v[96:111]
ds_read_b64_tr_b16 a[44:45], v15 offset:32768
ds_read_b64_tr_b16 a[46:47], v15 offset:34816
v_mfma_f32_32x32x16_bf16 v[112:127], a[52:55], a[72:75], v[112:127]
s_add_u32 s32, s60, 192
s_add_u32 m0, s36, 98304
s_nop 0
buffer_load_dwordx4 v1, s[52:55], s32 offen lds
v_mfma_f32_32x32x16_bf16 v[128:143], a[52:55], a[76:79], v[128:143]
s_add_u32 s32, s60, 73920
s_add_u32 m0, s36, 102400
s_nop 0
buffer_load_dwordx4 v1, s[52:55], s32 offen lds
v_mfma_f32_32x32x16_bf16 v[144:159], a[56:59], a[64:67], v[144:159]
s_add_u32 s32, s60, 147648
s_add_u32 m0, s36, 106496
s_nop 0
buffer_load_dwordx4 v1, s[52:55], s32 offen lds
v_mfma_f32_32x32x16_bf16 v[160:175], a[56:59], a[68:71], v[160:175]
s_add_u32 s32, s60, 221376
s_add_u32 m0, s36, 110592
s_nop 0
buffer_load_dwordx4 v1, s[52:55], s32 offen lds
v_mfma_f32_32x32x16_bf16 v[176:191], a[56:59], a[72:75], v[176:191]
s_add_u32 m0, s36, 114688
s_nop 0
buffer_load_dwordx4 v4, s[48:51], s61 offen lds
s_add_u32 s61, s61, s62
v_mfma_f32_32x32x16_bf16 v[192:207], a[56:59], a[76:79], v[192:207]
s_add_u32 m0, s36, 118784
s_nop 0
buffer_load_dwordx4 v4, s[48:51], s61 offen lds
s_add_u32 s61, s61, s62
v_mfma_f32_32x32x16_bf16 v[208:223], a[60:63], a[64:67], v[208:223]
s_add_u32 m0, s36, 122880
s_nop 0
buffer_load_dwordx4 v4, s[48:51], s61 offen lds
s_add_u32 s61, s61, s62
v_mfma_f32_32x32x16_bf16 v[224:239], a[60:63], a[68:71], v[224:239]
s_add_u32 m0, s36, 126976
s_nop 0
buffer_load_dwordx4 v4, s[48:51], s61 offen lds
s_add_u32 s61, s61, s62
v_mfma_f32_32x32x16_bf16 v[240:255], a[60:63], a[72:75], v[240:255]
v_mfma_f32_32x32x16_bf16 a[0:15], a[60:63], a[76:79], a[0:15]
s_waitcnt lgkmcnt(0)
v_mfma_f32_32x32x16_bf16 v[16:31], a[16:19], a[32:35], v[16:31]
ds_read_b128 a[48:51], v8 offset:32768
ds_read_b128 a[52:55], v8 offset:34816
v_mfma_f32_32x32x16_bf16 v[32:47], a[16:19], a[36:39], v[32:47]
ds_read_b128 a[56:59], v8 offset:36864
ds_read_b128 a[60:63], v8 offset:38912
v_mfma_f32_32x32x16_bf16 v[48:63], a[16:19], a[40:43], v[48:63]
ds_read_b64_tr_b16 a[64:65], v6 offset:40960
ds_read_b64_tr_b16 a[66:67], v6 offset:43008
v_mfma_f32_32x32x16_bf16 v[64:79], a[16:19], a[44:47], v[64:79]
ds_read_b64_tr_b16 a[68:69], v7 offset:40960
ds_read_b64_tr_b16 a[70:71], v7 offset:43008
v_mfma_f32_32x32x16_bf16 v[80:95], a[20:23], a[32:35], v[80:95]
ds_read_b64_tr_b16 a[72:73], v9 offset:40960
ds_read_b64_tr_b16 a[74:75], v9 offset:43008
v_mfma_f32_32x32x16_bf16 v[96:111], a[20:23], a[36:39], v[96:111]
ds_read_b64_tr_b16 a[76:77], v15 offset:40960
ds_read_b64_tr_b16 a[78:79], v15 offset:43008
v_mfma_f32_32x32x16_bf16 v[112:127], a[20:23], a[40:43], v[112:127]
v_mfma_f32_32x32x16_bf16 v[128:143], a[20:23], a[44:47], v[128:143]
v_mfma_f32_32x32x16_bf16 v[144:159], a[24:27], a[32:35], v[144:159]
v_mfma_f32_32x32x16_bf16 v[160:175], a[24:27], a[36:39], v[160:175]
v_mfma_f32_32x32x16_bf16 v[176:191], a[24:27], a[40:43], v[176:191]
v_mfma_f32_32x32x16_bf16 v[192:207], a[24:27], a[44:47], v[192:207]
v_mfma_f32_32x32x16_bf16 v[208:223], a[28:31], a[32:35], v[208:223]
v_mfma_f32_32x32x16_bf16 v[224:239], a[28:31], a[36:39], v[224:239]
v_mfma_f32_32x32x16_bf16 v[240:255], a[28:31], a[40:43], v[240:255]
v_mfma_f32_32x32x16_bf16 a[0:15], a[28:31], a[44:47], a[0:15]
s_waitcnt lgkmcnt(0)
s_waitcnt vmcnt(8)
s_barrier
v_mfma_f32_32x32x16_bf16 v[16:31], a[48:51], a[64:67], v[16:31]
ds_read_b128 a[16:19], v10
ds_read_b128 a[20:23], v10 offset:2048
v_mfma_f32_32x32x16_bf16 v[32:47], a[48:51], a[68:71], v[32:47]
ds_read_b128 a[24:27], v10 offset:4096
ds_read_b128 a[28:31], v10 offset:6144
v_mfma_f32_32x32x16_bf16 v[48:63], a[48:51], a[72:75], v[48:63]
ds_read_b64_tr_b16 a[32:33], v12
ds_read_b64_tr_b16 a[34:35], v12 offset:2048
v_mfma_f32_32x32x16_bf16 v[64:79], a[48:51], a[76:79], v[64:79]
ds_read_b64_tr_b16 a[36:37], v13
ds_read_b64_tr_b16 a[38:39], v13 offset:2048
v_mfma_f32_32x32x16_bf16 v[80:95], a[52:55], a[64:67], v[80:95]
ds_read_b64_tr_b16 a[40:41], v14
ds_read_b64_tr_b16 a[42:43], v14 offset:2048
v_mfma_f32_32x32x16_bf16 v[96:111], a[52:55], a[68:71], v[96:111]
ds_read_b64_tr_b16 a[44:45], v2
ds_read_b64_tr_b16 a[46:47], v2 offset:2048
v_mfma_f32_32x32x16_bf16 v[112:127], a[52:55], a[72:75], v[112:127]
s_add_u32 s32, s60, 256
s_add_u32 m0, s36, 0
s_nop 0
buffer_load_dwordx4 v1, s[52:55], s32 offen lds
v_mfma_f32_32x32x16_bf16 v[128:143], a[52:55], a[76:79], v[128:143]
s_add_u32 s32, s60, 73984
s_add_u32 m0, s36, 4096
s_nop 0
buffer_load_dwordx4 v1, s[52:55], s32 offen lds
v_mfma_f32_32x32x16_bf16 v[144:159], a[56:59], a[64:67], v[144:159]
s_add_u32 s32, s60, 147712
s_add_u32 m0, s36, 8192
s_nop 0
buffer_load_dwordx4 v1, s[52:55], s32 offen lds
v_mfma_f32_32x32x16_bf16 v[160:175], a[56:59], a[68:71], v[160:175]
s_add_u32 s32, s60, 221440
s_add_u32 m0, s36, 12288
s_nop 0
buffer_load_dwordx4 v1, s[52:55], s32 offen lds
v_mfma_f32_32x32x16_bf16 v[176:191], a[56:59], a[72:75], v[176:191]
s_add_u32 m0, s36, 16384
s_nop 0
buffer_load_dwordx4 v4, s[48:51], s61 offen lds
s_add_u32 s61, s61, s62
v_mfma_f32_32x32x16_bf16 v[192:207], a[56:59], a[76:79], v[192:207]
s_add_u32 m0, s36, 20480
s_nop 0
buffer_load_dwordx4 v4, s[48:51], s61 offen lds
s_add_u32 s61, s61, s62
v_mfma_f32_32x32x16_bf16 v[208:223], a[60:63], a[64:67], v[208:223]
s_add_u32 m0, s36, 24576
s_nop 0
buffer_load_dwordx4 v4, s[48:51], s61 offen lds
s_add_u32 s61, s61, s62
v_mfma_f32_32x32x16_bf16 v[224:239], a[60:63], a[68:71], v[224:239]
s_add_u32 m0, s36, 28672
s_nop 0
buffer_load_dwordx4 v4, s[48:51], s61 offen lds
s_add_u32 s61, s61, s62
v_mfma_f32_32x32x16_bf16 v[240:255], a[60:63], a[72:75], v[240:255]
v_mfma_f32_32x32x16_bf16 a[0:15], a[60:63], a[76:79], a[0:15]
s_waitcnt lgkmcnt(0)
v_mfma_f32_32x32x16_bf16 v[16:31], a[16:19], a[32:35], v[16:31]
ds_read_b128 a[48:51], v11
ds_read_b128 a[52:55], v11 offset:2048
v_mfma_f32_32x32x16_bf16 v[32:47], a[16:19], a[36:39], v[32:47]
ds_read_b128 a[56:59], v11 offset:4096
ds_read_b128 a[60:63], v11 offset:6144
v_mfma_f32_32x32x16_bf16 v[48:63], a[16:19], a[40:43], v[48:63]
ds_read_b64_tr_b16 a[64:65], v12 offset:8192
ds_read_b64_tr_b16 a[66:67], v12 offset:10240
v_mfma_f32_32x32x16_bf16 v[64:79], a[16:19], a[44:47], v[64:79]
ds_read_b64_tr_b16 a[68:69], v13 offset:8192
ds_read_b64_tr_b16 a[70:71], v13 offset:10240
v_mfma_f32_32x32x16_bf16 v[80:95], a[20:23], a[32:35], v[80:95]
ds_read_b64_tr_b16 a[72:73], v14 offset:8192
ds_read_b64_tr_b16 a[74:75], v14 offset:10240
v_mfma_f32_32x32x16_bf16 v[96:111], a[20:23], a[36:39], v[96:111]
ds_read_b64_tr_b16 a[76:77], v2 offset:8192
ds_read_b64_tr_b16 a[78:79], v2 offset:10240
v_mfma_f32_32x32x16_bf16 v[112:127], a[20:23], a[40:43], v[112:127]
v_mfma_f32_32x32x16_bf16 v[128:143], a[20:23], a[44:47], v[128:143]
v_mfma_f32_32x32x16_bf16 v[144:159], a[24:27], a[32:35], v[144:159]
v_mfma_f32_32x32x16_bf16 v[160:175], a[24:27], a[36:39], v[160:175]
v_mfma_f32_32x32x16_bf16 v[176:191], a[24:27], a[40:43], v[176:191]
v_mfma_f32_32x32x16_bf16 v[192:207], a[24:27], a[44:47], v[192:207]
v_mfma_f32_32x32x16_bf16 v[208:223], a[28:31], a[32:35], v[208:223]
v_mfma_f32_32x32x16_bf16 v[224:239], a[28:31], a[36:39], v[224:239]
v_mfma_f32_32x32x16_bf16 v[240:255], a[28:31], a[40:43], v[240:255]
v_mfma_f32_32x32x16_bf16 a[0:15], a[28:31], a[44:47], a[0:15]
s_waitcnt lgkmcnt(0)
s_waitcnt vmcnt(8)
s_barrier
v_mfma_f32_32x32x16_bf16 v[16:31], a[48:51], a[64:67], v[16:31]
ds_read_b128 a[16:19], v10 offset:32768
ds_read_b128 a[20:23], v10 offset:34816
v_mfma_f32_32x32x16_bf16 v[32:47], a[48:51], a[68:71], v[32:47]
ds_read_b128 a[24:27], v10 offset:36864
ds_read_b128 a[28:31], v10 offset:38912
v_mfma_f32_32x32x16_bf16 v[48:63], a[48:51], a[72:75], v[48:63]
ds_read_b64_tr_b16 a[32:33], v12 offset:32768
ds_read_b64_tr_b16 a[34:35], v12 offset:34816
v_mfma_f32_32x32x16_bf16 v[64:79], a[48:51], a[76:79], v[64:79]
ds_read_b64_tr_b16 a[36:37], v13 offset:32768
ds_read_b64_tr_b16 a[38:39], v13 offset:34816
v_mfma_f32_32x32x16_bf16 v[80:95], a[52:55], a[64:67], v[80:95]
ds_read_b64_tr_b16 a[40:41], v14 offset:32768
ds_read_b64_tr_b16 a[42:43], v14 offset:34816
v_mfma_f32_32x32x16_bf16 v[96:111], a[52:55], a[68:71], v[96:111]
ds_read_b64_tr_b16 a[44:45], v2 offset:32768
ds_read_b64_tr_b16 a[46:47], v2 offset:34816
v_mfma_f32_32x32x16_bf16 v[112:127], a[52:55], a[72:75], v[112:127]
s_add_u32 s32, s60, 320
s_add_u32 m0, s36, 32768
s_nop 0
buffer_load_dwordx4 v1, s[52:55], s32 offen lds
v_mfma_f32_32x32x16_bf16 v[128:143], a[52:55], a[76:79], v[128:143]
s_add_u32 s32, s60, 74048
s_add_u32 m0, s36, 36864
s_nop 0
buffer_load_dwordx4 v1, s[52:55], s32 offen lds
v_mfma_f32_32x32x16_bf16 v[144:159], a[56:59], a[64:67], v[144:159]
s_add_u32 s32, s60, 147776
s_add_u32 m0, s36, 40960
s_nop 0
buffer_load_dwordx4 v1, s[52:55], s32 offen lds
v_mfma_f32_32x32x16_bf16 v[160:175], a[56:59], a[68:71], v[160:175]
s_add_u32 s32, s60, 221504
s_add_u32 m0, s36, 45056
s_nop 0
buffer_load_dwordx4 v1, s[52:55], s32 offen lds
v_mfma_f32_32x32x16_bf16 v[176:191], a[56:59], a[72:75], v[176:191]
s_add_u32 m0, s36, 49152
s_nop 0
buffer_load_dwordx4 v4, s[48:51], s61 offen lds
s_add_u32 s61, s61, s62
v_mfma_f32_32x32x16_bf16 v[192:207], a[56:59], a[76:79], v[192:207]
s_add_u32 m0, s36, 53248
s_nop 0
buffer_load_dwordx4 v4, s[48:51], s61 offen lds
s_add_u32 s61, s61, s62
v_mfma_f32_32x32x16_bf16 v[208:223], a[60:63], a[64:67], v[208:223]
s_add_u32 m0, s36, 57344
s_nop 0
buffer_load_dwordx4 v4, s[48:51], s61 offen lds
s_add_u32 s61, s61, s62
v_mfma_f32_32x32x16_bf16 v[224:239], a[60:63], a[68:71], v[224:239]
s_add_u32 m0, s36, 61440
s_nop 0
buffer_load_dwordx4 v4, s[48:51], s61 offen lds
s_add_u32 s61, s61, s62
v_mfma_f32_32x32x16_bf16 v[240:255], a[60:63], a[72:75], v[240:255]
v_mfma_f32_32x32x16_bf16 a[0:15], a[60:63], a[76:79], a[0:15]
s_waitcnt lgkmcnt(0)
v_mfma_f32_32x32x16_bf16 v[16:31], a[16:19], a[32:35], v[16:31]
ds_read_b128 a[48:51], v11 offset:32768
ds_read_b128 a[52:55], v11 offset:34816
v_mfma_f32_32x32x16_bf16 v[32:47], a[16:19], a[36:39], v[32:47]
ds_read_b128 a[56:59], v11 offset:36864
ds_read_b128 a[60:63], v11 offset:38912
v_mfma_f32_32x32x16_bf16 v[48:63], a[16:19], a[40:43], v[48:63]
ds_read_b64_tr_b16 a[64:65], v12 offset:40960
ds_read_b64_tr_b16 a[66:67], v12 offset:43008
v_mfma_f32_32x32x16_bf16 v[64:79], a[16:19], a[44:47], v[64:79]
ds_read_b64_tr_b16 a[68:69], v13 offset:40960
ds_read_b64_tr_b16 a[70:71], v13 offset:43008
v_mfma_f32_32x32x16_bf16 v[80:95], a[20:23], a[32:35], v[80:95]
ds_read_b64_tr_b16 a[72:73], v14 offset:40960
ds_read_b64_tr_b16 a[74:75], v14 offset:43008
v_mfma_f32_32x32x16_bf16 v[96:111], a[20:23], a[36:39], v[96:111]
ds_read_b64_tr_b16 a[76:77], v2 offset:40960
ds_read_b64_tr_b16 a[78:79], v2 offset:43008
v_mfma_f32_32x32x16_bf16 v[112:127], a[20:23], a[40:43], v[112:127]
v_mfma_f32_32x32x16_bf16 v[128:143], a[20:23], a[44:47], v[128:143]
v_mfma_f32_32x32x16_bf16 v[144:159], a[24:27], a[32:35], v[144:159]
v_mfma_f32_32x32x16_bf16 v[160:175], a[24:27], a[36:39], v[160:175]
v_mfma_f32_32x32x16_bf16 v[176:191], a[24:27], a[40:43], v[176:191]
v_mfma_f32_32x32x16_bf16 v[192:207], a[24:27], a[44:47], v[192:207]
v_mfma_f32_32x32x16_bf16 v[208:223], a[28:31], a[32:35], v[208:223]
v_mfma_f32_32x32x16_bf16 v[224:239], a[28:31], a[36:39], v[224:239]
v_mfma_f32_32x32x16_bf16 v[240:255], a[28:31], a[40:43], v[240:255]
v_mfma_f32_32x32x16_bf16 a[0:15], a[28:31], a[44:47], a[0:15]
s_waitcnt lgkmcnt(0)
s_waitcnt vmcnt(8)
s_barrier
v_mfma_f32_32x32x16_bf16 v[16:31], a[48:51], a[64:67], v[16:31]
ds_read_b128 a[16:19], v5
ds_read_b128 a[20:23], v5 offset:2048
v_mfma_f32_32x32x16_bf16 v[32:47], a[48:51], a[68:71], v[32:47]
ds_read_b128 a[24:27], v5 offset:4096
ds_read_b128 a[28:31], v5 offset:6144
v_mfma_f32_32x32x16_bf16 v[48:63], a[48:51], a[72:75], v[48:63]
ds_read_b64_tr_b16 a[32:33], v6
ds_read_b64_tr_b16 a[34:35], v6 offset:2048
v_mfma_f32_32x32x16_bf16 v[64:79], a[48:51], a[76:79], v[64:79]
ds_read_b64_tr_b16 a[36:37], v7
ds_read_b64_tr_b16 a[38:39], v7 offset:2048
v_mfma_f32_32x32x16_bf16 v[80:95], a[52:55], a[64:67], v[80:95]
ds_read_b64_tr_b16 a[40:41], v9
ds_read_b64_tr_b16 a[42:43], v9 offset:2048
v_mfma_f32_32x32x16_bf16 v[96:111], a[52:55], a[68:71], v[96:111]
ds_read_b64_tr_b16 a[44:45], v15
ds_read_b64_tr_b16 a[46:47], v15 offset:2048
v_mfma_f32_32x32x16_bf16 v[112:127], a[52:55], a[72:75], v[112:127]
s_add_u32 s32, s60, 384
s_add_u32 m0, s36, 65536
s_nop 0
buffer_load_dwordx4 v1, s[52:55], s32 offen lds
v_mfma_f32_32x32x16_bf16 v[128:143], a[52:55], a[76:79], v[128:143]
s_add_u32 s32, s60, 74112
s_add_u32 m0, s36, 69632
s_nop 0
buffer_load_dwordx4 v1, s[52:55], s32 offen lds
v_mfma_f32_32x32x16_bf16 v[144:159], a[56:59], a[64:67], v[144:159]
s_add_u32 s32, s60, 147840
s_add_u32 m0, s36, 73728
s_nop 0
buffer_load_dwordx4 v1, s[52:55], s32 offen lds
v_mfma_f32_32x32x16_bf16 v[160:175], a[56:59], a[68:71], v[160:175]
s_add_u32 s32, s60, 221568
s_add_u32 m0, s36, 77824
s_nop 0
buffer_load_dwordx4 v1, s[52:55], s32 offen lds
v_mfma_f32_32x32x16_bf16 v[176:191], a[56:59], a[72:75], v[176:191]
s_add_u32 m0, s36, 81920
s_nop 0
buffer_load_dwordx4 v4, s[48:51], s61 offen lds
s_add_u32 s61, s61, s62
v_mfma_f32_32x32x16_bf16 v[192:207], a[56:59], a[76:79], v[192:207]
s_add_u32 m0, s36, 86016
s_nop 0
buffer_load_dwordx4 v4, s[48:51], s61 offen lds
s_add_u32 s61, s61, s62
v_mfma_f32_32x32x16_bf16 v[208:223], a[60:63], a[64:67], v[208:223]
s_add_u32 m0, s36, 90112
s_nop 0
buffer_load_dwordx4 v4, s[48:51], s61 offen lds
s_add_u32 s61, s61, s62
v_mfma_f32_32x32x16_bf16 v[224:239], a[60:63], a[68:71], v[224:239]
s_add_u32 m0, s36, 94208
s_nop 0
buffer_load_dwordx4 v4, s[48:51], s61 offen lds
s_add_u32 s61, s61, s62
v_mfma_f32_32x32x16_bf16 v[240:255], a[60:63], a[72:75], v[240:255]
v_mfma_f32_32x32x16_bf16 a[0:15], a[60:63], a[76:79], a[0:15]
s_waitcnt lgkmcnt(0)
v_mfma_f32_32x32x16_bf16 v[16:31], a[16:19], a[32:35], v[16:31]
ds_read_b128 a[48:51], v8
ds_read_b128 a[52:55], v8 offset:2048
v_mfma_f32_32x32x16_bf16 v[32:47], a[16:19], a[36:39], v[32:47]
ds_read_b128 a[56:59], v8 offset:4096
ds_read_b128 a[60:63], v8 offset:6144
v_mfma_f32_32x32x16_bf16 v[48:63], a[16:19], a[40:43], v[48:63]
ds_read_b64_tr_b16 a[64:65], v6 offset:8192
ds_read_b64_tr_b16 a[66:67], v6 offset:10240
v_mfma_f32_32x32x16_bf16 v[64:79], a[16:19], a[44:47], v[64:79]
ds_read_b64_tr_b16 a[68:69], v7 offset:8192
ds_read_b64_tr_b16 a[70:71], v7 offset:10240
v_mfma_f32_32x32x16_bf16 v[80:95], a[20:23], a[32:35], v[80:95]
ds_read_b64_tr_b16 a[72:73], v9 offset:8192
ds_read_b64_tr_b16 a[74:75], v9 offset:10240
v_mfma_f32_32x32x16_bf16 v[96:111], a[20:23], a[36:39], v[96:111]
ds_read_b64_tr_b16 a[76:77], v15 offset:8192
ds_read_b64_tr_b16 a[78:79], v15 offset:10240
v_mfma_f32_32x32x16_bf16 v[112:127], a[20:23], a[40:43], v[112:127]
v_mfma_f32_32x32x16_bf16 v[128:143], a[20:23], a[44:47], v[128:143]
v_mfma_f32_32x32x16_bf16 v[144:159], a[24:27], a[32:35], v[144:159]
v_mfma_f32_32x32x16_bf16 v[160:175], a[24:27], a[36:39], v[160:175]
v_mfma_f32_32x32x16_bf16 v[176:191], a[24:27], a[40:43], v[176:191]
v_mfma_f32_32x32x16_bf16 v[192:207], a[24:27], a[44:47], v[192:207]
v_mfma_f32_32x32x16_bf16 v[208:223], a[28:31], a[32:35], v[208:223]
v_mfma_f32_32x32x16_bf16 v[224:239], a[28:31], a[36:39], v[224:239]
v_mfma_f32_32x32x16_bf16 v[240:255], a[28:31], a[40:43], v[240:255]
v_mfma_f32_32x32x16_bf16 a[0:15], a[28:31], a[44:47], a[0:15]
s_waitcnt lgkmcnt(0)
s_waitcnt vmcnt(8)
s_barrier
v_mfma_f32_32x32x16_bf16 v[16:31], a[48:51], a[64:67], v[16:31]
ds_read_b128 a[16:19], v5 offset:32768
ds_read_b128 a[20:23], v5 offset:34816
v_mfma_f32_32x32x16_bf16 v[32:47], a[48:51], a[68:71], v[32:47]
ds_read_b128 a[24:27], v5 offset:36864
ds_read_b128 a[28:31], v5 offset:38912
v_mfma_f32_32x32x16_bf16 v[48:63], a[48:51], a[72:75], v[48:63]
ds_read_b64_tr_b16 a[32:33], v6 offset:32768
ds_read_b64_tr_b16 a[34:35], v6 offset:34816
v_mfma_f32_32x32x16_bf16 v[64:79], a[48:51], a[76:79], v[64:79]
ds_read_b64_tr_b16 a[36:37], v7 offset:32768
ds_read_b64_tr_b16 a[38:39], v7 offset:34816
v_mfma_f32_32x32x16_bf16 v[80:95], a[52:55], a[64:67], v[80:95]
ds_read_b64_tr_b16 a[40:41], v9 offset:32768
ds_read_b64_tr_b16 a[42:43], v9 offset:34816
v_mfma_f32_32x32x16_bf16 v[96:111], a[52:55], a[68:71], v[96:111]
ds_read_b64_tr_b16 a[44:45], v15 offset:32768
ds_read_b64_tr_b16 a[46:47], v15 offset:34816
v_mfma_f32_32x32x16_bf16 v[112:127], a[52:55], a[72:75], v[112:127]
s_add_u32 s32, s60, 448
s_add_u32 m0, s36, 98304
s_nop 0
buffer_load_dwordx4 v1, s[52:55], s32 offen lds
v_mfma_f32_32x32x16_bf16 v[128:143], a[52:55], a[76:79], v[128:143]
s_add_u32 s32, s60, 74176
s_add_u32 m0, s36, 102400
s_nop 0
buffer_load_dwordx4 v1, s[52:55], s32 offen lds
v_mfma_f32_32x32x16_bf16 v[144:159], a[56:59], a[64:67], v[144:159]
s_add_u32 s32, s60, 147904
s_add_u32 m0, s36, 106496
s_nop 0
buffer_load_dwordx4 v1, s[52:55], s32 offen lds
v_mfma_f32_32x32x16_bf16 v[160:175], a[56:59], a[68:71], v[160:175]
s_add_u32 s32, s60, 221632
s_add_u32 m0, s36, 110592
s_nop 0
buffer_load_dwordx4 v1, s[52:55], s32 offen lds
v_mfma_f32_32x32x16_bf16 v[176:191], a[56:59], a[72:75], v[176:191]
s_add_u32 m0, s36, 114688
s_nop 0
buffer_load_dwordx4 v4, s[48:51], s61 offen lds
s_add_u32 s61, s61, s62
v_mfma_f32_32x32x16_bf16 v[192:207], a[56:59], a[76:79], v[192:207]
s_add_u32 m0, s36, 118784
s_nop 0
buffer_load_dwordx4 v4, s[48:51], s61 offen lds
s_add_u32 s61, s61, s62
v_mfma_f32_32x32x16_bf16 v[208:223], a[60:63], a[64:67], v[208:223]
s_add_u32 m0, s36, 122880
s_nop 0
buffer_load_dwordx4 v4, s[48:51], s61 offen lds
s_add_u32 s61, s61, s62
v_mfma_f32_32x32x16_bf16 v[224:239], a[60:63], a[68:71], v[224:239]
s_add_u32 m0, s36, 126976
s_nop 0
buffer_load_dwordx4 v4, s[48:51], s61 offen lds
s_add_u32 s61, s61, s62
v_mfma_f32_32x32x16_bf16 v[240:255], a[60:63], a[72:75], v[240:255]
v_mfma_f32_32x32x16_bf16 a[0:15], a[60:63], a[76:79], a[0:15]
s_waitcnt lgkmcnt(0)
v_mfma_f32_32x32x16_bf16 v[16:31], a[16:19], a[32:35], v[16:31]
ds_read_b128 a[48:51], v8 offset:32768
ds_read_b128 a[52:55], v8 offset:34816
v_mfma_f32_32x32x16_bf16 v[32:47], a[16:19], a[36:39], v[32:47]
ds_read_b128 a[56:59], v8 offset:36864
ds_read_b128 a[60:63], v8 offset:38912
v_mfma_f32_32x32x16_bf16 v[48:63], a[16:19], a[40:43], v[48:63]
ds_read_b64_tr_b16 a[64:65], v6 offset:40960
ds_read_b64_tr_b16 a[66:67], v6 offset:43008
v_mfma_f32_32x32x16_bf16 v[64:79], a[16:19], a[44:47], v[64:79]
ds_read_b64_tr_b16 a[68:69], v7 offset:40960
ds_read_b64_tr_b16 a[70:71], v7 offset:43008
v_mfma_f32_32x32x16_bf16 v[80:95], a[20:23], a[32:35], v[80:95]
ds_read_b64_tr_b16 a[72:73], v9 offset:40960
ds_read_b64_tr_b16 a[74:75], v9 offset:43008
v_mfma_f32_32x32x16_bf16 v[96:111], a[20:23], a[36:39], v[96:111]
ds_read_b64_tr_b16 a[76:77], v15 offset:40960
ds_read_b64_tr_b16 a[78:79], v15 offset:43008
v_mfma_f32_32x32x16_bf16 v[112:127], a[20:23], a[40:43], v[112:127]
v_mfma_f32_32x32x16_bf16 v[128:143], a[20:23], a[44:47], v[128:143]
v_mfma_f32_32x32x16_bf16 v[144:159], a[24:27], a[32:35], v[144:159]
v_mfma_f32_32x32x16_bf16 v[160:175], a[24:27], a[36:39], v[160:175]
v_mfma_f32_32x32x16_bf16 v[176:191], a[24:27], a[40:43], v[176:191]
v_mfma_f32_32x32x16_bf16 v[192:207], a[24:27], a[44:47], v[192:207]
v_mfma_f32_32x32x16_bf16 v[208:223], a[28:31], a[32:35], v[208:223]
v_mfma_f32_32x32x16_bf16 v[224:239], a[28:31], a[36:39], v[224:239]
v_mfma_f32_32x32x16_bf16 v[240:255], a[28:31], a[40:43], v[240:255]
v_mfma_f32_32x32x16_bf16 a[0:15], a[28:31], a[44:47], a[0:15]
s_waitcnt lgkmcnt(0)
s_waitcnt vmcnt(8)
s_barrier
v_mfma_f32_32x32x16_bf16 v[16:31], a[48:51], a[64:67], v[16:31]
ds_read_b128 a[16:19], v10
ds_read_b128 a[20:23], v10 offset:2048
v_mfma_f32_32x32x16_bf16 v[32:47], a[48:51], a[68:71], v[32:47]
ds_read_b128 a[24:27], v10 offset:4096
ds_read_b128 a[28:31], v10 offset:6144
v_mfma_f32_32x32x16_bf16 v[48:63], a[48:51], a[72:75], v[48:63]
ds_read_b64_tr_b16 a[32:33], v12
ds_read_b64_tr_b16 a[34:35], v12 offset:2048
v_mfma_f32_32x32x16_bf16 v[64:79], a[48:51], a[76:79], v[64:79]
ds_read_b64_tr_b16 a[36:37], v13
ds_read_b64_tr_b16 a[38:39], v13 offset:2048
v_mfma_f32_32x32x16_bf16 v[80:95], a[52:55], a[64:67], v[80:95]
ds_read_b64_tr_b16 a[40:41], v14
ds_read_b64_tr_b16 a[42:43], v14 offset:2048
v_mfma_f32_32x32x16_bf16 v[96:111], a[52:55], a[68:71], v[96:111]
ds_read_b64_tr_b16 a[44:45], v2
ds_read_b64_tr_b16 a[46:47], v2 offset:2048
v_mfma_f32_32x32x16_bf16 v[112:127], a[52:55], a[72:75], v[112:127]
s_add_u32 s32, s60, 512
s_add_u32 m0, s36, 0
s_nop 0
buffer_load_dwordx4 v1, s[52:55], s32 offen lds
v_mfma_f32_32x32x16_bf16 v[128:143], a[52:55], a[76:79], v[128:143]
s_add_u32 s32, s60, 74240
s_add_u32 m0, s36, 4096
s_nop 0
buffer_load_dwordx4 v1, s[52:55], s32 offen lds
v_mfma_f32_32x32x16_bf16 v[144:159], a[56:59], a[64:67], v[144:159]
s_add_u32 s32, s60, 147968
s_add_u32 m0, s36, 8192
s_nop 0
buffer_load_dwordx4 v1, s[52:55], s32 offen lds
v_mfma_f32_32x32x16_bf16 v[160:175], a[56:59], a[68:71], v[160:175]
s_add_u32 s32, s60, 221696
s_add_u32 m0, s36, 12288
s_nop 0
buffer_load_dwordx4 v1, s[52:55], s32 offen lds
v_mfma_f32_32x32x16_bf16 v[176:191], a[56:59], a[72:75], v[176:191]
s_add_u32 m0, s36, 16384
s_nop 0
buffer_load_dwordx4 v4, s[48:51], s61 offen lds
s_add_u32 s61, s61, s62
v_mfma_f32_32x32x16_bf16 v[192:207], a[56:59], a[76:79], v[192:207]
s_add_u32 m0, s36, 20480
s_nop 0
buffer_load_dwordx4 v4, s[48:51], s61 offen lds
s_add_u32 s61, s61, s62
v_mfma_f32_32x32x16_bf16 v[208:223], a[60:63], a[64:67], v[208:223]
s_add_u32 m0, s36, 24576
s_nop 0
buffer_load_dwordx4 v4, s[48:51], s61 offen lds
s_add_u32 s61, s61, s62
v_mfma_f32_32x32x16_bf16 v[224:239], a[60:63], a[68:71], v[224:239]
s_add_u32 m0, s36, 28672
s_nop 0
buffer_load_dwordx4 v4, s[48:51], s61 offen lds
s_add_u32 s61, s61, s62
v_mfma_f32_32x32x16_bf16 v[240:255], a[60:63], a[72:75], v[240:255]
v_mfma_f32_32x32x16_bf16 a[0:15], a[60:63], a[76:79], a[0:15]
s_waitcnt lgkmcnt(0)
v_mfma_f32_32x32x16_bf16 v[16:31], a[16:19], a[32:35], v[16:31]
ds_read_b128 a[48:51], v11
ds_read_b128 a[52:55], v11 offset:2048
v_mfma_f32_32x32x16_bf16 v[32:47], a[16:19], a[36:39], v[32:47]
ds_read_b128 a[56:59], v11 offset:4096
ds_read_b128 a[60:63], v11 offset:6144
v_mfma_f32_32x32x16_bf16 v[48:63], a[16:19], a[40:43], v[48:63]
ds_read_b64_tr_b16 a[64:65], v12 offset:8192
ds_read_b64_tr_b16 a[66:67], v12 offset:10240
v_mfma_f32_32x32x16_bf16 v[64:79], a[16:19], a[44:47], v[64:79]
ds_read_b64_tr_b16 a[68:69], v13 offset:8192
ds_read_b64_tr_b16 a[70:71], v13 offset:10240
v_mfma_f32_32x32x16_bf16 v[80:95], a[20:23], a[32:35], v[80:95]
ds_read_b64_tr_b16 a[72:73], v14 offset:8192
ds_read_b64_tr_b16 a[74:75], v14 offset:10240
v_mfma_f32_32x32x16_bf16 v[96:111], a[20:23], a[36:39], v[96:111]
ds_read_b64_tr_b16 a[76:77], v2 offset:8192
ds_read_b64_tr_b16 a[78:79], v2 offset:10240
v_mfma_f32_32x32x16_bf16 v[112:127], a[20:23], a[40:43], v[112:127]
v_mfma_f32_32x32x16_bf16 v[128:143], a[20:23], a[44:47], v[128:143]
v_mfma_f32_32x32x16_bf16 v[144:159], a[24:27], a[32:35], v[144:159]
v_mfma_f32_32x32x16_bf16 v[160:175], a[24:27], a[36:39], v[160:175]
v_mfma_f32_32x32x16_bf16 v[176:191], a[24:27], a[40:43], v[176:191]
v_mfma_f32_32x32x16_bf16 v[192:207], a[24:27], a[44:47], v[192:207]
v_mfma_f32_32x32x16_bf16 v[208:223], a[28:31], a[32:35], v[208:223]
v_mfma_f32_32x32x16_bf16 v[224:239], a[28:31], a[36:39], v[224:239]
v_mfma_f32_32x32x16_bf16 v[240:255], a[28:31], a[40:43], v[240:255]
v_mfma_f32_32x32x16_bf16 a[0:15], a[28:31], a[44:47], a[0:15]
s_waitcnt lgkmcnt(0)
s_waitcnt vmcnt(8)
s_barrier
v_mfma_f32_32x32x16_bf16 v[16:31], a[48:51], a[64:67], v[16:31]
ds_read_b128 a[16:19], v10 offset:32768
ds_read_b128 a[20:23], v10 offset:34816
v_mfma_f32_32x32x16_bf16 v[32:47], a[48:51], a[68:71], v[32:47]
ds_read_b128 a[24:27], v10 offset:36864
ds_read_b128 a[28:31], v10 offset:38912
v_mfma_f32_32x32x16_bf16 v[48:63], a[48:51], a[72:75], v[48:63]
ds_read_b64_tr_b16 a[32:33], v12 offset:32768
ds_read_b64_tr_b16 a[34:35], v12 offset:34816
v_mfma_f32_32x32x16_bf16 v[64:79], a[48:51], a[76:79], v[64:79]
ds_read_b64_tr_b16 a[36:37], v13 offset:32768
ds_read_b64_tr_b16 a[38:39], v13 offset:34816
v_mfma_f32_32x32x16_bf16 v[80:95], a[52:55], a[64:67], v[80:95]
ds_read_b64_tr_b16 a[40:41], v14 offset:32768
ds_read_b64_tr_b16 a[42:43], v14 offset:34816
v_mfma_f32_32x32x16_bf16 v[96:111], a[52:55], a[68:71], v[96:111]
ds_read_b64_tr_b16 a[44:45], v2 offset:32768
ds_read_b64_tr_b16 a[46:47], v2 offset:34816
v_mfma_f32_32x32x16_bf16 v[112:127], a[52:55], a[72:75], v[112:127]
s_add_u32 s32, s60, 576
s_add_u32 m0, s36, 32768
s_nop 0
buffer_load_dwordx4 v1, s[52:55], s32 offen lds
v_mfma_f32_32x32x16_bf16 v[128:143], a[52:55], a[76:79], v[128:143]
s_add_u32 s32, s60, 74304
s_add_u32 m0, s36, 36864
s_nop 0
buffer_load_dwordx4 v1, s[52:55], s32 offen lds
v_mfma_f32_32x32x16_bf16 v[144:159], a[56:59], a[64:67], v[144:159]
s_add_u32 s32, s60, 148032
s_add_u32 m0, s36, 40960
s_nop 0
buffer_load_dwordx4 v1, s[52:55], s32 offen lds
v_mfma_f32_32x32x16_bf16 v[160:175], a[56:59], a[68:71], v[160:175]
s_add_u32 s32, s60, 221760
s_add_u32 m0, s36, 45056
s_nop 0
buffer_load_dwordx4 v1, s[52:55], s32 offen lds
v_mfma_f32_32x32x16_bf16 v[176:191], a[56:59], a[72:75], v[176:191]
s_add_u32 m0, s36, 49152
s_nop 0
buffer_load_dwordx4 v4, s[48:51], s61 offen lds
s_add_u32 s61, s61, s62
v_mfma_f32_32x32x16_bf16 v[192:207], a[56:59], a[76:79], v[192:207]
s_add_u32 m0, s36, 53248
s_nop 0
buffer_load_dwordx4 v4, s[48:51], s61 offen lds
s_add_u32 s61, s61, s62
v_mfma_f32_32x32x16_bf16 v[208:223], a[60:63], a[64:67], v[208:223]
s_add_u32 m0, s36, 57344
s_nop 0
buffer_load_dwordx4 v4, s[48:51], s61 offen lds
s_add_u32 s61, s61, s62
v_mfma_f32_32x32x16_bf16 v[224:239], a[60:63], a[68:71], v[224:239]
s_add_u32 m0, s36, 61440
s_nop 0
buffer_load_dwordx4 v4, s[48:51], s61 offen lds
s_add_u32 s61, s61, s62
v_mfma_f32_32x32x16_bf16 v[240:255], a[60:63], a[72:75], v[240:255]
v_mfma_f32_32x32x16_bf16 a[0:15], a[60:63], a[76:79], a[0:15]
s_waitcnt lgkmcnt(0)
v_mfma_f32_32x32x16_bf16 v[16:31], a[16:19], a[32:35], v[16:31]
ds_read_b128 a[48:51], v11 offset:32768
ds_read_b128 a[52:55], v11 offset:34816
v_mfma_f32_32x32x16_bf16 v[32:47], a[16:19], a[36:39], v[32:47]
ds_read_b128 a[56:59], v11 offset:36864
ds_read_b128 a[60:63], v11 offset:38912
v_mfma_f32_32x32x16_bf16 v[48:63], a[16:19], a[40:43], v[48:63]
ds_read_b64_tr_b16 a[64:65], v12 offset:40960
ds_read_b64_tr_b16 a[66:67], v12 offset:43008
v_mfma_f32_32x32x16_bf16 v[64:79], a[16:19], a[44:47], v[64:79]
ds_read_b64_tr_b16 a[68:69], v13 offset:40960
ds_read_b64_tr_b16 a[70:71], v13 offset:43008
v_mfma_f32_32x32x16_bf16 v[80:95], a[20:23], a[32:35], v[80:95]
ds_read_b64_tr_b16 a[72:73], v14 offset:40960
ds_read_b64_tr_b16 a[74:75], v14 offset:43008
v_mfma_f32_32x32x16_bf16 v[96:111], a[20:23], a[36:39], v[96:111]
ds_read_b64_tr_b16 a[76:77], v2 offset:40960
ds_read_b64_tr_b16 a[78:79], v2 offset:43008
v_mfma_f32_32x32x16_bf16 v[112:127], a[20:23], a[40:43], v[112:127]
v_mfma_f32_32x32x16_bf16 v[128:143], a[20:23], a[44:47], v[128:143]
v_mfma_f32_32x32x16_bf16 v[144:159], a[24:27], a[32:35], v[144:159]
v_mfma_f32_32x32x16_bf16 v[160:175], a[24:27], a[36:39], v[160:175]
v_mfma_f32_32x32x16_bf16 v[176:191], a[24:27], a[40:43], v[176:191]
v_mfma_f32_32x32x16_bf16 v[192:207], a[24:27], a[44:47], v[192:207]
v_mfma_f32_32x32x16_bf16 v[208:223], a[28:31], a[32:35], v[208:223]
v_mfma_f32_32x32x16_bf16 v[224:239], a[28:31], a[36:39], v[224:239]
v_mfma_f32_32x32x16_bf16 v[240:255], a[28:31], a[40:43], v[240:255]
v_mfma_f32_32x32x16_bf16 a[0:15], a[28:31], a[44:47], a[0:15]
s_waitcnt lgkmcnt(0)
s_waitcnt vmcnt(8)
s_barrier
v_mfma_f32_32x32x16_bf16 v[16:31], a[48:51], a[64:67], v[16:31]
ds_read_b128 a[16:19], v5
ds_read_b128 a[20:23], v5 offset:2048
v_mfma_f32_32x32x16_bf16 v[32:47], a[48:51], a[68:71], v[32:47]
ds_read_b128 a[24:27], v5 offset:4096
ds_read_b128 a[28:31], v5 offset:6144
v_mfma_f32_32x32x16_bf16 v[48:63], a[48:51], a[72:75], v[48:63]
ds_read_b64_tr_b16 a[32:33], v6
ds_read_b64_tr_b16 a[34:35], v6 offset:2048
v_mfma_f32_32x32x16_bf16 v[64:79], a[48:51], a[76:79], v[64:79]
ds_read_b64_tr_b16 a[36:37], v7
ds_read_b64_tr_b16 a[38:39], v7 offset:2048
v_mfma_f32_32x32x16_bf16 v[80:95], a[52:55], a[64:67], v[80:95]
ds_read_b64_tr_b16 a[40:41], v9
ds_read_b64_tr_b16 a[42:43], v9 offset:2048
v_mfma_f32_32x32x16_bf16 v[96:111], a[52:55], a[68:71], v[96:111]
ds_read_b64_tr_b16 a[44:45], v15
ds_read_b64_tr_b16 a[46:47], v15 offset:2048
v_mfma_f32_32x32x16_bf16 v[112:127], a[52:55], a[72:75], v[112:127]
s_add_u32 s32, s60, 640
s_add_u32 m0, s36, 65536
s_nop 0
buffer_load_dwordx4 v1, s[52:55], s32 offen lds
v_mfma_f32_32x32x16_bf16 v[128:143], a[52:55], a[76:79], v[128:143]
s_add_u32 s32, s60, 74368
s_add_u32 m0, s36, 69632
s_nop 0
buffer_load_dwordx4 v1, s[52:55], s32 offen lds
v_mfma_f32_32x32x16_bf16 v[144:159], a[56:59], a[64:67], v[144:159]
s_add_u32 s32, s60, 148096
s_add_u32 m0, s36, 73728
s_nop 0
buffer_load_dwordx4 v1, s[52:55], s32 offen lds
v_mfma_f32_32x32x16_bf16 v[160:175], a[56:59], a[68:71], v[160:175]
s_add_u32 s32, s60, 221824
s_add_u32 m0, s36, 77824
s_nop 0
buffer_load_dwordx4 v1, s[52:55], s32 offen lds
v_mfma_f32_32x32x16_bf16 v[176:191], a[56:59], a[72:75], v[176:191]
s_add_u32 m0, s36, 81920
s_nop 0
buffer_load_dwordx4 v4, s[48:51], s61 offen lds
s_add_u32 s61, s61, s62
v_mfma_f32_32x32x16_bf16 v[192:207], a[56:59], a[76:79], v[192:207]
s_add_u32 m0, s36, 86016
s_nop 0
buffer_load_dwordx4 v4, s[48:51], s61 offen lds
s_add_u32 s61, s61, s62
v_mfma_f32_32x32x16_bf16 v[208:223], a[60:63], a[64:67], v[208:223]
s_add_u32 m0, s36, 90112
s_nop 0
buffer_load_dwordx4 v4, s[48:51], s61 offen lds
s_add_u32 s61, s61, s62
v_mfma_f32_32x32x16_bf16 v[224:239], a[60:63], a[68:71], v[224:239]
s_add_u32 m0, s36, 94208
s_nop 0
buffer_load_dwordx4 v4, s[48:51], s61 offen lds
s_add_u32 s61, s61, s62
v_mfma_f32_32x32x16_bf16 v[240:255], a[60:63], a[72:75], v[240:255]
v_mfma_f32_32x32x16_bf16 a[0:15], a[60:63], a[76:79], a[0:15]
s_waitcnt lgkmcnt(0)
v_mfma_f32_32x32x16_bf16 v[16:31], a[16:19], a[32:35], v[16:31]
ds_read_b128 a[48:51], v8
ds_read_b128 a[52:55], v8 offset:2048
v_mfma_f32_32x32x16_bf16 v[32:47], a[16:19], a[36:39], v[32:47]
ds_read_b128 a[56:59], v8 offset:4096
ds_read_b128 a[60:63], v8 offset:6144
v_mfma_f32_32x32x16_bf16 v[48:63], a[16:19], a[40:43], v[48:63]
ds_read_b64_tr_b16 a[64:65], v6 offset:8192
ds_read_b64_tr_b16 a[66:67], v6 offset:10240
v_mfma_f32_32x32x16_bf16 v[64:79], a[16:19], a[44:47], v[64:79]
ds_read_b64_tr_b16 a[68:69], v7 offset:8192
ds_read_b64_tr_b16 a[70:71], v7 offset:10240
v_mfma_f32_32x32x16_bf16 v[80:95], a[20:23], a[32:35], v[80:95]
ds_read_b64_tr_b16 a[72:73], v9 offset:8192
ds_read_b64_tr_b16 a[74:75], v9 offset:10240
v_mfma_f32_32x32x16_bf16 v[96:111], a[20:23], a[36:39], v[96:111]
ds_read_b64_tr_b16 a[76:77], v15 offset:8192
ds_read_b64_tr_b16 a[78:79], v15 offset:10240
v_mfma_f32_32x32x16_bf16 v[112:127], a[20:23], a[40:43], v[112:127]
v_mfma_f32_32x32x16_bf16 v[128:143], a[20:23], a[44:47], v[128:143]
v_mfma_f32_32x32x16_bf16 v[144:159], a[24:27], a[32:35], v[144:159]
v_mfma_f32_32x32x16_bf16 v[160:175], a[24:27], a[36:39], v[160:175]
v_mfma_f32_32x32x16_bf16 v[176:191], a[24:27], a[40:43], v[176:191]
v_mfma_f32_32x32x16_bf16 v[192:207], a[24:27], a[44:47], v[192:207]
v_mfma_f32_32x32x16_bf16 v[208:223], a[28:31], a[32:35], v[208:223]
v_mfma_f32_32x32x16_bf16 v[224:239], a[28:31], a[36:39], v[224:239]
v_mfma_f32_32x32x16_bf16 v[240:255], a[28:31], a[40:43], v[240:255]
v_mfma_f32_32x32x16_bf16 a[0:15], a[28:31], a[44:47], a[0:15]
s_waitcnt lgkmcnt(0)
s_waitcnt vmcnt(8)
s_barrier
v_mfma_f32_32x32x16_bf16 v[16:31], a[48:51], a[64:67], v[16:31]
ds_read_b128 a[16:19], v5 offset:32768
ds_read_b128 a[20:23], v5 offset:34816
v_mfma_f32_32x32x16_bf16 v[32:47], a[48:51], a[68:71], v[32:47]
ds_read_b128 a[24:27], v5 offset:36864
ds_read_b128 a[28:31], v5 offset:38912
v_mfma_f32_32x32x16_bf16 v[48:63], a[48:51], a[72:75], v[48:63]
ds_read_b64_tr_b16 a[32:33], v6 offset:32768
ds_read_b64_tr_b16 a[34:35], v6 offset:34816
v_mfma_f32_32x32x16_bf16 v[64:79], a[48:51], a[76:79], v[64:79]
ds_read_b64_tr_b16 a[36:37], v7 offset:32768
ds_read_b64_tr_b16 a[38:39], v7 offset:34816
v_mfma_f32_32x32x16_bf16 v[80:95], a[52:55], a[64:67], v[80:95]
ds_read_b64_tr_b16 a[40:41], v9 offset:32768
ds_read_b64_tr_b16 a[42:43], v9 offset:34816
v_mfma_f32_32x32x16_bf16 v[96:111], a[52:55], a[68:71], v[96:111]
ds_read_b64_tr_b16 a[44:45], v15 offset:32768
ds_read_b64_tr_b16 a[46:47], v15 offset:34816
v_mfma_f32_32x32x16_bf16 v[112:127], a[52:55], a[72:75], v[112:127]
s_add_u32 s32, s60, 704
s_add_u32 m0, s36, 98304
s_nop 0
buffer_load_dwordx4 v1, s[52:55], s32 offen lds
v_mfma_f32_32x32x16_bf16 v[128:143], a[52:55], a[76:79], v[128:143]
s_add_u32 s32, s60, 74432
s_add_u32 m0, s36, 102400
s_nop 0
buffer_load_dwordx4 v1, s[52:55], s32 offen lds
v_mfma_f32_32x32x16_bf16 v[144:159], a[56:59], a[64:67], v[144:159]
s_add_u32 s32, s60, 148160
s_add_u32 m0, s36, 106496
s_nop 0
buffer_load_dwordx4 v1, s[52:55], s32 offen lds
v_mfma_f32_32x32x16_bf16 v[160:175], a[56:59], a[68:71], v[160:175]
s_add_u32 s32, s60, 221888
s_add_u32 m0, s36, 110592
s_nop 0
buffer_load_dwordx4 v1, s[52:55], s32 offen lds
v_mfma_f32_32x32x16_bf16 v[176:191], a[56:59], a[72:75], v[176:191]
s_add_u32 m0, s36, 114688
s_nop 0
buffer_load_dwordx4 v4, s[48:51], s61 offen lds
s_add_u32 s61, s61, s62
v_mfma_f32_32x32x16_bf16 v[192:207], a[56:59], a[76:79], v[192:207]
s_add_u32 m0, s36, 118784
s_nop 0
buffer_load_dwordx4 v4, s[48:51], s61 offen lds
s_add_u32 s61, s61, s62
v_mfma_f32_32x32x16_bf16 v[208:223], a[60:63], a[64:67], v[208:223]
s_add_u32 m0, s36, 122880
s_nop 0
buffer_load_dwordx4 v4, s[48:51], s61 offen lds
s_add_u32 s61, s61, s62
v_mfma_f32_32x32x16_bf16 v[224:239], a[60:63], a[68:71], v[224:239]
s_add_u32 m0, s36, 126976
s_nop 0
buffer_load_dwordx4 v4, s[48:51], s61 offen lds
s_add_u32 s61, s61, s62
v_mfma_f32_32x32x16_bf16 v[240:255], a[60:63], a[72:75], v[240:255]
v_mfma_f32_32x32x16_bf16 a[0:15], a[60:63], a[76:79], a[0:15]
s_waitcnt lgkmcnt(0)
v_mfma_f32_32x32x16_bf16 v[16:31], a[16:19], a[32:35], v[16:31]
ds_read_b128 a[48:51], v8 offset:32768
ds_read_b128 a[52:55], v8 offset:34816
v_mfma_f32_32x32x16_bf16 v[32:47], a[16:19], a[36:39], v[32:47]
ds_read_b128 a[56:59], v8 offset:36864
ds_read_b128 a[60:63], v8 offset:38912
v_mfma_f32_32x32x16_bf16 v[48:63], a[16:19], a[40:43], v[48:63]
ds_read_b64_tr_b16 a[64:65], v6 offset:40960
ds_read_b64_tr_b16 a[66:67], v6 offset:43008
v_mfma_f32_32x32x16_bf16 v[64:79], a[16:19], a[44:47], v[64:79]
ds_read_b64_tr_b16 a[68:69], v7 offset:40960
ds_read_b64_tr_b16 a[70:71], v7 offset:43008
v_mfma_f32_32x32x16_bf16 v[80:95], a[20:23], a[32:35], v[80:95]
ds_read_b64_tr_b16 a[72:73], v9 offset:40960
ds_read_b64_tr_b16 a[74:75], v9 offset:43008
v_mfma_f32_32x32x16_bf16 v[96:111], a[20:23], a[36:39], v[96:111]
ds_read_b64_tr_b16 a[76:77], v15 offset:40960
ds_read_b64_tr_b16 a[78:79], v15 offset:43008
v_mfma_f32_32x32x16_bf16 v[112:127], a[20:23], a[40:43], v[112:127]
v_mfma_f32_32x32x16_bf16 v[128:143], a[20:23], a[44:47], v[128:143]
v_mfma_f32_32x32x16_bf16 v[144:159], a[24:27], a[32:35], v[144:159]
v_mfma_f32_32x32x16_bf16 v[160:175], a[24:27], a[36:39], v[160:175]
v_mfma_f32_32x32x16_bf16 v[176:191], a[24:27], a[40:43], v[176:191]
v_mfma_f32_32x32x16_bf16 v[192:207], a[24:27], a[44:47], v[192:207]
v_mfma_f32_32x32x16_bf16 v[208:223], a[28:31], a[32:35], v[208:223]
v_mfma_f32_32x32x16_bf16 v[224:239], a[28:31], a[36:39], v[224:239]
v_mfma_f32_32x32x16_bf16 v[240:255], a[28:31], a[40:43], v[240:255]
v_mfma_f32_32x32x16_bf16 a[0:15], a[28:31], a[44:47], a[0:15]
s_waitcnt lgkmcnt(0)
s_waitcnt vmcnt(8)
s_barrier
v_mfma_f32_32x32x16_bf16 v[16:31], a[48:51], a[64:67], v[16:31]
ds_read_b128 a[16:19], v10
ds_read_b128 a[20:23], v10 offset:2048
v_mfma_f32_32x32x16_bf16 v[32:47], a[48:51], a[68:71], v[32:47]
ds_read_b128 a[24:27], v10 offset:4096
ds_read_b128 a[28:31], v10 offset:6144
v_mfma_f32_32x32x16_bf16 v[48:63], a[48:51], a[72:75], v[48:63]
ds_read_b64_tr_b16 a[32:33], v12
ds_read_b64_tr_b16 a[34:35], v12 offset:2048
v_mfma_f32_32x32x16_bf16 v[64:79], a[48:51], a[76:79], v[64:79]
ds_read_b64_tr_b16 a[36:37], v13
ds_read_b64_tr_b16 a[38:39], v13 offset:2048
v_mfma_f32_32x32x16_bf16 v[80:95], a[52:55], a[64:67], v[80:95]
ds_read_b64_tr_b16 a[40:41], v14
ds_read_b64_tr_b16 a[42:43], v14 offset:2048
v_mfma_f32_32x32x16_bf16 v[96:111], a[52:55], a[68:71], v[96:111]
ds_read_b64_tr_b16 a[44:45], v2
ds_read_b64_tr_b16 a[46:47], v2 offset:2048
v_mfma_f32_32x32x16_bf16 v[112:127], a[52:55], a[72:75], v[112:127]
s_add_u32 s32, s60, 768
s_add_u32 m0, s36, 0
s_nop 0
buffer_load_dwordx4 v1, s[52:55], s32 offen lds
v_mfma_f32_32x32x16_bf16 v[128:143], a[52:55], a[76:79], v[128:143]
s_add_u32 s32, s60, 74496
s_add_u32 m0, s36, 4096
s_nop 0
buffer_load_dwordx4 v1, s[52:55], s32 offen lds
v_mfma_f32_32x32x16_bf16 v[144:159], a[56:59], a[64:67], v[144:159]
s_add_u32 s32, s60, 148224
s_add_u32 m0, s36, 8192
s_nop 0
buffer_load_dwordx4 v1, s[52:55], s32 offen lds
v_mfma_f32_32x32x16_bf16 v[160:175], a[56:59], a[68:71], v[160:175]
s_add_u32 s32, s60, 221952
s_add_u32 m0, s36, 12288
s_nop 0
buffer_load_dwordx4 v1, s[52:55], s32 offen lds
v_mfma_f32_32x32x16_bf16 v[176:191], a[56:59], a[72:75], v[176:191]
s_add_u32 m0, s36, 16384
s_nop 0
buffer_load_dwordx4 v4, s[48:51], s61 offen lds
s_add_u32 s61, s61, s62
v_mfma_f32_32x32x16_bf16 v[192:207], a[56:59], a[76:79], v[192:207]
s_add_u32 m0, s36, 20480
s_nop 0
buffer_load_dwordx4 v4, s[48:51], s61 offen lds
s_add_u32 s61, s61, s62
v_mfma_f32_32x32x16_bf16 v[208:223], a[60:63], a[64:67], v[208:223]
s_add_u32 m0, s36, 24576
s_nop 0
buffer_load_dwordx4 v4, s[48:51], s61 offen lds
s_add_u32 s61, s61, s62
v_mfma_f32_32x32x16_bf16 v[224:239], a[60:63], a[68:71], v[224:239]
s_add_u32 m0, s36, 28672
s_nop 0
buffer_load_dwordx4 v4, s[48:51], s61 offen lds
s_add_u32 s61, s61, s62
v_mfma_f32_32x32x16_bf16 v[240:255], a[60:63], a[72:75], v[240:255]
v_mfma_f32_32x32x16_bf16 a[0:15], a[60:63], a[76:79], a[0:15]
s_waitcnt lgkmcnt(0)
v_mfma_f32_32x32x16_bf16 v[16:31], a[16:19], a[32:35], v[16:31]
ds_read_b128 a[48:51], v11
ds_read_b128 a[52:55], v11 offset:2048
v_mfma_f32_32x32x16_bf16 v[32:47], a[16:19], a[36:39], v[32:47]
ds_read_b128 a[56:59], v11 offset:4096
ds_read_b128 a[60:63], v11 offset:6144
v_mfma_f32_32x32x16_bf16 v[48:63], a[16:19], a[40:43], v[48:63]
ds_read_b64_tr_b16 a[64:65], v12 offset:8192
ds_read_b64_tr_b16 a[66:67], v12 offset:10240
v_mfma_f32_32x32x16_bf16 v[64:79], a[16:19], a[44:47], v[64:79]
ds_read_b64_tr_b16 a[68:69], v13 offset:8192
ds_read_b64_tr_b16 a[70:71], v13 offset:10240
v_mfma_f32_32x32x16_bf16 v[80:95], a[20:23], a[32:35], v[80:95]
ds_read_b64_tr_b16 a[72:73], v14 offset:8192
ds_read_b64_tr_b16 a[74:75], v14 offset:10240
v_mfma_f32_32x32x16_bf16 v[96:111], a[20:23], a[36:39], v[96:111]
ds_read_b64_tr_b16 a[76:77], v2 offset:8192
ds_read_b64_tr_b16 a[78:79], v2 offset:10240
v_mfma_f32_32x32x16_bf16 v[112:127], a[20:23], a[40:43], v[112:127]
v_mfma_f32_32x32x16_bf16 v[128:143], a[20:23], a[44:47], v[128:143]
v_mfma_f32_32x32x16_bf16 v[144:159], a[24:27], a[32:35], v[144:159]
v_mfma_f32_32x32x16_bf16 v[160:175], a[24:27], a[36:39], v[160:175]
v_mfma_f32_32x32x16_bf16 v[176:191], a[24:27], a[40:43], v[176:191]
v_mfma_f32_32x32x16_bf16 v[192:207], a[24:27], a[44:47], v[192:207]
v_mfma_f32_32x32x16_bf16 v[208:223], a[28:31], a[32:35], v[208:223]
v_mfma_f32_32x32x16_bf16 v[224:239], a[28:31], a[36:39], v[224:239]
v_mfma_f32_32x32x16_bf16 v[240:255], a[28:31], a[40:43], v[240:255]
v_mfma_f32_32x32x16_bf16 a[0:15], a[28:31], a[44:47], a[0:15]
s_waitcnt lgkmcnt(0)
s_waitcnt vmcnt(8)
s_barrier
v_mfma_f32_32x32x16_bf16 v[16:31], a[48:51], a[64:67], v[16:31]
ds_read_b128 a[16:19], v10 offset:32768
ds_read_b128 a[20:23], v10 offset:34816
v_mfma_f32_32x32x16_bf16 v[32:47], a[48:51], a[68:71], v[32:47]
ds_read_b128 a[24:27], v10 offset:36864
ds_read_b128 a[28:31], v10 offset:38912
v_mfma_f32_32x32x16_bf16 v[48:63], a[48:51], a[72:75], v[48:63]
ds_read_b64_tr_b16 a[32:33], v12 offset:32768
ds_read_b64_tr_b16 a[34:35], v12 offset:34816
v_mfma_f32_32x32x16_bf16 v[64:79], a[48:51], a[76:79], v[64:79]
ds_read_b64_tr_b16 a[36:37], v13 offset:32768
ds_read_b64_tr_b16 a[38:39], v13 offset:34816
v_mfma_f32_32x32x16_bf16 v[80:95], a[52:55], a[64:67], v[80:95]
ds_read_b64_tr_b16 a[40:41], v14 offset:32768
ds_read_b64_tr_b16 a[42:43], v14 offset:34816
v_mfma_f32_32x32x16_bf16 v[96:111], a[52:55], a[68:71], v[96:111]
ds_read_b64_tr_b16 a[44:45], v2 offset:32768
ds_read_b64_tr_b16 a[46:47], v2 offset:34816
v_mfma_f32_32x32x16_bf16 v[112:127], a[52:55], a[72:75], v[112:127]
s_add_u32 s32, s60, 832
s_add_u32 m0, s36, 32768
s_nop 0
buffer_load_dwordx4 v1, s[52:55], s32 offen lds
v_mfma_f32_32x32x16_bf16 v[128:143], a[52:55], a[76:79], v[128:143]
s_add_u32 s32, s60, 74560
s_add_u32 m0, s36, 36864
s_nop 0
buffer_load_dwordx4 v1, s[52:55], s32 offen lds
v_mfma_f32_32x32x16_bf16 v[144:159], a[56:59], a[64:67], v[144:159]
s_add_u32 s32, s60, 148288
s_add_u32 m0, s36, 40960
s_nop 0
buffer_load_dwordx4 v1, s[52:55], s32 offen lds
v_mfma_f32_32x32x16_bf16 v[160:175], a[56:59], a[68:71], v[160:175]
s_add_u32 s32, s60, 222016
s_add_u32 m0, s36, 45056
s_nop 0
buffer_load_dwordx4 v1, s[52:55], s32 offen lds
v_mfma_f32_32x32x16_bf16 v[176:191], a[56:59], a[72:75], v[176:191]
s_add_u32 m0, s36, 49152
s_nop 0
buffer_load_dwordx4 v4, s[48:51], s61 offen lds
s_add_u32 s61, s61, s62
v_mfma_f32_32x32x16_bf16 v[192:207], a[56:59], a[76:79], v[192:207]
s_add_u32 m0, s36, 53248
s_nop 0
buffer_load_dwordx4 v4, s[48:51], s61 offen lds
s_add_u32 s61, s61, s62
v_mfma_f32_32x32x16_bf16 v[208:223], a[60:63], a[64:67], v[208:223]
s_add_u32 m0, s36, 57344
s_nop 0
buffer_load_dwordx4 v4, s[48:51], s61 offen lds
s_add_u32 s61, s61, s62
v_mfma_f32_32x32x16_bf16 v[224:239], a[60:63], a[68:71], v[224:239]
s_add_u32 m0, s36, 61440
s_nop 0
buffer_load_dwordx4 v4, s[48:51], s61 offen lds
s_add_u32 s61, s61, s62
v_mfma_f32_32x32x16_bf16 v[240:255], a[60:63], a[72:75], v[240:255]
v_mfma_f32_32x32x16_bf16 a[0:15], a[60:63], a[76:79], a[0:15]
s_waitcnt lgkmcnt(0)
v_mfma_f32_32x32x16_bf16 v[16:31], a[16:19], a[32:35], v[16:31]
ds_read_b128 a[48:51], v11 offset:32768
ds_read_b128 a[52:55], v11 offset:34816
v_mfma_f32_32x32x16_bf16 v[32:47], a[16:19], a[36:39], v[32:47]
ds_read_b128 a[56:59], v11 offset:36864
ds_read_b128 a[60:63], v11 offset:38912
v_mfma_f32_32x32x16_bf16 v[48:63], a[16:19], a[40:43], v[48:63]
ds_read_b64_tr_b16 a[64:65], v12 offset:40960
ds_read_b64_tr_b16 a[66:67], v12 offset:43008
v_mfma_f32_32x32x16_bf16 v[64:79], a[16:19], a[44:47], v[64:79]
ds_read_b64_tr_b16 a[68:69], v13 offset:40960
ds_read_b64_tr_b16 a[70:71], v13 offset:43008
v_mfma_f32_32x32x16_bf16 v[80:95], a[20:23], a[32:35], v[80:95]
ds_read_b64_tr_b16 a[72:73], v14 offset:40960
ds_read_b64_tr_b16 a[74:75], v14 offset:43008
v_mfma_f32_32x32x16_bf16 v[96:111], a[20:23], a[36:39], v[96:111]
ds_read_b64_tr_b16 a[76:77], v2 offset:40960
ds_read_b64_tr_b16 a[78:79], v2 offset:43008
v_mfma_f32_32x32x16_bf16 v[112:127], a[20:23], a[40:43], v[112:127]
v_mfma_f32_32x32x16_bf16 v[128:143], a[20:23], a[44:47], v[128:143]
v_mfma_f32_32x32x16_bf16 v[144:159], a[24:27], a[32:35], v[144:159]
v_mfma_f32_32x32x16_bf16 v[160:175], a[24:27], a[36:39], v[160:175]
v_mfma_f32_32x32x16_bf16 v[176:191], a[24:27], a[40:43], v[176:191]
v_mfma_f32_32x32x16_bf16 v[192:207], a[24:27], a[44:47], v[192:207]
v_mfma_f32_32x32x16_bf16 v[208:223], a[28:31], a[32:35], v[208:223]
v_mfma_f32_32x32x16_bf16 v[224:239], a[28:31], a[36:39], v[224:239]
v_mfma_f32_32x32x16_bf16 v[240:255], a[28:31], a[40:43], v[240:255]
v_mfma_f32_32x32x16_bf16 a[0:15], a[28:31], a[44:47], a[0:15]
s_waitcnt lgkmcnt(0)
s_waitcnt vmcnt(8)
s_barrier
v_mfma_f32_32x32x16_bf16 v[16:31], a[48:51], a[64:67], v[16:31]
ds_read_b128 a[16:19], v5
ds_read_b128 a[20:23], v5 offset:2048
v_mfma_f32_32x32x16_bf16 v[32:47], a[48:51], a[68:71], v[32:47]
ds_read_b128 a[24:27], v5 offset:4096
ds_read_b128 a[28:31], v5 offset:6144
v_mfma_f32_32x32x16_bf16 v[48:63], a[48:51], a[72:75], v[48:63]
ds_read_b64_tr_b16 a[32:33], v6
ds_read_b64_tr_b16 a[34:35], v6 offset:2048
v_mfma_f32_32x32x16_bf16 v[64:79], a[48:51], a[76:79], v[64:79]
ds_read_b64_tr_b16 a[36:37], v7
ds_read_b64_tr_b16 a[38:39], v7 offset:2048
v_mfma_f32_32x32x16_bf16 v[80:95], a[52:55], a[64:67], v[80:95]
ds_read_b64_tr_b16 a[40:41], v9
ds_read_b64_tr_b16 a[42:43], v9 offset:2048
v_mfma_f32_32x32x16_bf16 v[96:111], a[52:55], a[68:71], v[96:111]
ds_read_b64_tr_b16 a[44:45], v15
ds_read_b64_tr_b16 a[46:47], v15 offset:2048
v_mfma_f32_32x32x16_bf16 v[112:127], a[52:55], a[72:75], v[112:127]
s_add_u32 s32, s60, 896
s_add_u32 m0, s36, 65536
s_nop 0
buffer_load_dwordx4 v1, s[52:55], s32 offen lds
v_mfma_f32_32x32x16_bf16 v[128:143], a[52:55], a[76:79], v[128:143]
s_add_u32 s32, s60, 74624
s_add_u32 m0, s36, 69632
s_nop 0
buffer_load_dwordx4 v1, s[52:55], s32 offen lds
v_mfma_f32_32x32x16_bf16 v[144:159], a[56:59], a[64:67], v[144:159]
s_add_u32 s32, s60, 148352
s_add_u32 m0, s36, 73728
s_nop 0
buffer_load_dwordx4 v1, s[52:55], s32 offen lds
v_mfma_f32_32x32x16_bf16 v[160:175], a[56:59], a[68:71], v[160:175]
s_add_u32 s32, s60, 222080
s_add_u32 m0, s36, 77824
s_nop 0
buffer_load_dwordx4 v1, s[52:55], s32 offen lds
v_mfma_f32_32x32x16_bf16 v[176:191], a[56:59], a[72:75], v[176:191]
s_add_u32 m0, s36, 81920
s_nop 0
buffer_load_dwordx4 v4, s[48:51], s61 offen lds
s_add_u32 s61, s61, s62
v_mfma_f32_32x32x16_bf16 v[192:207], a[56:59], a[76:79], v[192:207]
s_add_u32 m0, s36, 86016
s_nop 0
buffer_load_dwordx4 v4, s[48:51], s61 offen lds
s_add_u32 s61, s61, s62
v_mfma_f32_32x32x16_bf16 v[208:223], a[60:63], a[64:67], v[208:223]
s_add_u32 m0, s36, 90112
s_nop 0
buffer_load_dwordx4 v4, s[48:51], s61 offen lds
s_add_u32 s61, s61, s62
v_mfma_f32_32x32x16_bf16 v[224:239], a[60:63], a[68:71], v[224:239]
s_add_u32 m0, s36, 94208
s_nop 0
buffer_load_dwordx4 v4, s[48:51], s61 offen lds
s_add_u32 s61, s61, s62
v_mfma_f32_32x32x16_bf16 v[240:255], a[60:63], a[72:75], v[240:255]
v_mfma_f32_32x32x16_bf16 a[0:15], a[60:63], a[76:79], a[0:15]
s_waitcnt lgkmcnt(0)
v_mfma_f32_32x32x16_bf16 v[16:31], a[16:19], a[32:35], v[16:31]
ds_read_b128 a[48:51], v8
ds_read_b128 a[52:55], v8 offset:2048
v_mfma_f32_32x32x16_bf16 v[32:47], a[16:19], a[36:39], v[32:47]
ds_read_b128 a[56:59], v8 offset:4096
ds_read_b128 a[60:63], v8 offset:6144
v_mfma_f32_32x32x16_bf16 v[48:63], a[16:19], a[40:43], v[48:63]
ds_read_b64_tr_b16 a[64:65], v6 offset:8192
ds_read_b64_tr_b16 a[66:67], v6 offset:10240
v_mfma_f32_32x32x16_bf16 v[64:79], a[16:19], a[44:47], v[64:79]
ds_read_b64_tr_b16 a[68:69], v7 offset:8192
ds_read_b64_tr_b16 a[70:71], v7 offset:10240
v_mfma_f32_32x32x16_bf16 v[80:95], a[20:23], a[32:35], v[80:95]
ds_read_b64_tr_b16 a[72:73], v9 offset:8192
ds_read_b64_tr_b16 a[74:75], v9 offset:10240
v_mfma_f32_32x32x16_bf16 v[96:111], a[20:23], a[36:39], v[96:111]
ds_read_b64_tr_b16 a[76:77], v15 offset:8192
ds_read_b64_tr_b16 a[78:79], v15 offset:10240
v_mfma_f32_32x32x16_bf16 v[112:127], a[20:23], a[40:43], v[112:127]
v_mfma_f32_32x32x16_bf16 v[128:143], a[20:23], a[44:47], v[128:143]
v_mfma_f32_32x32x16_bf16 v[144:159], a[24:27], a[32:35], v[144:159]
v_mfma_f32_32x32x16_bf16 v[160:175], a[24:27], a[36:39], v[160:175]
v_mfma_f32_32x32x16_bf16 v[176:191], a[24:27], a[40:43], v[176:191]
v_mfma_f32_32x32x16_bf16 v[192:207], a[24:27], a[44:47], v[192:207]
v_mfma_f32_32x32x16_bf16 v[208:223], a[28:31], a[32:35], v[208:223]
v_mfma_f32_32x32x16_bf16 v[224:239], a[28:31], a[36:39], v[224:239]
v_mfma_f32_32x32x16_bf16 v[240:255], a[28:31], a[40:43], v[240:255]
v_mfma_f32_32x32x16_bf16 a[0:15], a[28:31], a[44:47], a[0:15]
s_waitcnt lgkmcnt(0)
s_waitcnt vmcnt(8)
s_barrier
v_mfma_f32_32x32x16_bf16 v[16:31], a[48:51], a[64:67], v[16:31]
ds_read_b128 a[16:19], v5 offset:32768
ds_read_b128 a[20:23], v5 offset:34816
v_mfma_f32_32x32x16_bf16 v[32:47], a[48:51], a[68:71], v[32:47]
ds_read_b128 a[24:27], v5 offset:36864
ds_read_b128 a[28:31], v5 offset:38912
v_mfma_f32_32x32x16_bf16 v[48:63], a[48:51], a[72:75], v[48:63]
ds_read_b64_tr_b16 a[32:33], v6 offset:32768
ds_read_b64_tr_b16 a[34:35], v6 offset:34816
v_mfma_f32_32x32x16_bf16 v[64:79], a[48:51], a[76:79], v[64:79]
ds_read_b64_tr_b16 a[36:37], v7 offset:32768
ds_read_b64_tr_b16 a[38:39], v7 offset:34816
v_mfma_f32_32x32x16_bf16 v[80:95], a[52:55], a[64:67], v[80:95]
ds_read_b64_tr_b16 a[40:41], v9 offset:32768
ds_read_b64_tr_b16 a[42:43], v9 offset:34816
v_mfma_f32_32x32x16_bf16 v[96:111], a[52:55], a[68:71], v[96:111]
ds_read_b64_tr_b16 a[44:45], v15 offset:32768
ds_read_b64_tr_b16 a[46:47], v15 offset:34816
v_mfma_f32_32x32x16_bf16 v[112:127], a[52:55], a[72:75], v[112:127]
s_add_u32 s32, s60, 960
s_add_u32 m0, s36, 98304
s_nop 0
buffer_load_dwordx4 v1, s[52:55], s32 offen lds
v_mfma_f32_32x32x16_bf16 v[128:143], a[52:55], a[76:79], v[128:143]
s_add_u32 s32, s60, 74688
s_add_u32 m0, s36, 102400
s_nop 0
buffer_load_dwordx4 v1, s[52:55], s32 offen lds
v_mfma_f32_32x32x16_bf16 v[144:159], a[56:59], a[64:67], v[144:159]
s_add_u32 s32, s60, 148416
s_add_u32 m0, s36, 106496
s_nop 0
buffer_load_dwordx4 v1, s[52:55], s32 offen lds
v_mfma_f32_32x32x16_bf16 v[160:175], a[56:59], a[68:71], v[160:175]
s_add_u32 s32, s60, 222144
s_add_u32 m0, s36, 110592
s_nop 0
buffer_load_dwordx4 v1, s[52:55], s32 offen lds
v_mfma_f32_32x32x16_bf16 v[176:191], a[56:59], a[72:75], v[176:191]
s_add_u32 m0, s36, 114688
s_nop 0
buffer_load_dwordx4 v4, s[48:51], s61 offen lds
s_add_u32 s61, s61, s62
v_mfma_f32_32x32x16_bf16 v[192:207], a[56:59], a[76:79], v[192:207]
s_add_u32 m0, s36, 118784
s_nop 0
buffer_load_dwordx4 v4, s[48:51], s61 offen lds
s_add_u32 s61, s61, s62
v_mfma_f32_32x32x16_bf16 v[208:223], a[60:63], a[64:67], v[208:223]
s_add_u32 m0, s36, 122880
s_nop 0
buffer_load_dwordx4 v4, s[48:51], s61 offen lds
s_add_u32 s61, s61, s62
v_mfma_f32_32x32x16_bf16 v[224:239], a[60:63], a[68:71], v[224:239]
s_add_u32 m0, s36, 126976
s_nop 0
buffer_load_dwordx4 v4, s[48:51], s61 offen lds
s_add_u32 s61, s61, s62
v_mfma_f32_32x32x16_bf16 v[240:255], a[60:63], a[72:75], v[240:255]
v_mfma_f32_32x32x16_bf16 a[0:15], a[60:63], a[76:79], a[0:15]
s_waitcnt lgkmcnt(0)
v_mfma_f32_32x32x16_bf16 v[16:31], a[16:19], a[32:35], v[16:31]
ds_read_b128 a[48:51], v8 offset:32768
ds_read_b128 a[52:55], v8 offset:34816
v_mfma_f32_32x32x16_bf16 v[32:47], a[16:19], a[36:39], v[32:47]
ds_read_b128 a[56:59], v8 offset:36864
ds_read_b128 a[60:63], v8 offset:38912
v_mfma_f32_32x32x16_bf16 v[48:63], a[16:19], a[40:43], v[48:63]
ds_read_b64_tr_b16 a[64:65], v6 offset:40960
ds_read_b64_tr_b16 a[66:67], v6 offset:43008
v_mfma_f32_32x32x16_bf16 v[64:79], a[16:19], a[44:47], v[64:79]
ds_read_b64_tr_b16 a[68:69], v7 offset:40960
ds_read_b64_tr_b16 a[70:71], v7 offset:43008
v_mfma_f32_32x32x16_bf16 v[80:95], a[20:23], a[32:35], v[80:95]
ds_read_b64_tr_b16 a[72:73], v9 offset:40960
ds_read_b64_tr_b16 a[74:75], v9 offset:43008
v_mfma_f32_32x32x16_bf16 v[96:111], a[20:23], a[36:39], v[96:111]
ds_read_b64_tr_b16 a[76:77], v15 offset:40960
ds_read_b64_tr_b16 a[78:79], v15 offset:43008
v_mfma_f32_32x32x16_bf16 v[112:127], a[20:23], a[40:43], v[112:127]
v_mfma_f32_32x32x16_bf16 v[128:143], a[20:23], a[44:47], v[128:143]
v_mfma_f32_32x32x16_bf16 v[144:159], a[24:27], a[32:35], v[144:159]
v_mfma_f32_32x32x16_bf16 v[160:175], a[24:27], a[36:39], v[160:175]
v_mfma_f32_32x32x16_bf16 v[176:191], a[24:27], a[40:43], v[176:191]
v_mfma_f32_32x32x16_bf16 v[192:207], a[24:27], a[44:47], v[192:207]
v_mfma_f32_32x32x16_bf16 v[208:223], a[28:31], a[32:35], v[208:223]
v_mfma_f32_32x32x16_bf16 v[224:239], a[28:31], a[36:39], v[224:239]
v_mfma_f32_32x32x16_bf16 v[240:255], a[28:31], a[40:43], v[240:255]
v_mfma_f32_32x32x16_bf16 a[0:15], a[28:31], a[44:47], a[0:15]
s_waitcnt lgkmcnt(0)
s_waitcnt vmcnt(8)
s_barrier
v_mfma_f32_32x32x16_bf16 v[16:31], a[48:51], a[64:67], v[16:31]
ds_read_b128 a[16:19], v10
ds_read_b128 a[20:23], v10 offset:2048
v_mfma_f32_32x32x16_bf16 v[32:47], a[48:51], a[68:71], v[32:47]
ds_read_b128 a[24:27], v10 offset:4096
ds_read_b128 a[28:31], v10 offset:6144
v_mfma_f32_32x32x16_bf16 v[48:63], a[48:51], a[72:75], v[48:63]
ds_read_b64_tr_b16 a[32:33], v12
ds_read_b64_tr_b16 a[34:35], v12 offset:2048
v_mfma_f32_32x32x16_bf16 v[64:79], a[48:51], a[76:79], v[64:79]
ds_read_b64_tr_b16 a[36:37], v13
ds_read_b64_tr_b16 a[38:39], v13 offset:2048
v_mfma_f32_32x32x16_bf16 v[80:95], a[52:55], a[64:67], v[80:95]
ds_read_b64_tr_b16 a[40:41], v14
ds_read_b64_tr_b16 a[42:43], v14 offset:2048
v_mfma_f32_32x32x16_bf16 v[96:111], a[52:55], a[68:71], v[96:111]
ds_read_b64_tr_b16 a[44:45], v2
ds_read_b64_tr_b16 a[46:47], v2 offset:2048
v_mfma_f32_32x32x16_bf16 v[112:127], a[52:55], a[72:75], v[112:127]
s_add_u32 s32, s60, 1024
s_add_u32 m0, s36, 0
s_nop 0
buffer_load_dwordx4 v1, s[52:55], s32 offen lds
v_mfma_f32_32x32x16_bf16 v[128:143], a[52:55], a[76:79], v[128:143]
s_add_u32 s32, s60, 74752
s_add_u32 m0, s36, 4096
s_nop 0
buffer_load_dwordx4 v1, s[52:55], s32 offen lds
v_mfma_f32_32x32x16_bf16 v[144:159], a[56:59], a[64:67], v[144:159]
s_add_u32 s32, s60, 148480
s_add_u32 m0, s36, 8192
s_nop 0
buffer_load_dwordx4 v1, s[52:55], s32 offen lds
v_mfma_f32_32x32x16_bf16 v[160:175], a[56:59], a[68:71], v[160:175]
s_add_u32 s32, s60, 222208
s_add_u32 m0, s36, 12288
s_nop 0
buffer_load_dwordx4 v1, s[52:55], s32 offen lds
v_mfma_f32_32x32x16_bf16 v[176:191], a[56:59], a[72:75], v[176:191]
s_add_u32 m0, s36, 16384
s_nop 0
buffer_load_dwordx4 v4, s[48:51], s61 offen lds
s_add_u32 s61, s61, s62
v_mfma_f32_32x32x16_bf16 v[192:207], a[56:59], a[76:79], v[192:207]
s_add_u32 m0, s36, 20480
s_nop 0
buffer_load_dwordx4 v4, s[48:51], s61 offen lds
s_add_u32 s61, s61, s62
v_mfma_f32_32x32x16_bf16 v[208:223], a[60:63], a[64:67], v[208:223]
s_add_u32 m0, s36, 24576
s_nop 0
buffer_load_dwordx4 v4, s[48:51], s61 offen lds
s_add_u32 s61, s61, s62
v_mfma_f32_32x32x16_bf16 v[224:239], a[60:63], a[68:71], v[224:239]
s_add_u32 m0, s36, 28672
s_nop 0
buffer_load_dwordx4 v4, s[48:51], s61 offen lds
s_add_u32 s61, s61, s62
v_mfma_f32_32x32x16_bf16 v[240:255], a[60:63], a[72:75], v[240:255]
v_mfma_f32_32x32x16_bf16 a[0:15], a[60:63], a[76:79], a[0:15]
s_waitcnt lgkmcnt(0)
v_mfma_f32_32x32x16_bf16 v[16:31], a[16:19], a[32:35], v[16:31]
ds_read_b128 a[48:51], v11
ds_read_b128 a[52:55], v11 offset:2048
v_mfma_f32_32x32x16_bf16 v[32:47], a[16:19], a[36:39], v[32:47]
ds_read_b128 a[56:59], v11 offset:4096
ds_read_b128 a[60:63], v11 offset:6144
v_mfma_f32_32x32x16_bf16 v[48:63], a[16:19], a[40:43], v[48:63]
ds_read_b64_tr_b16 a[64:65], v12 offset:8192
ds_read_b64_tr_b16 a[66:67], v12 offset:10240
v_mfma_f32_32x32x16_bf16 v[64:79], a[16:19], a[44:47], v[64:79]
ds_read_b64_tr_b16 a[68:69], v13 offset:8192
ds_read_b64_tr_b16 a[70:71], v13 offset:10240
v_mfma_f32_32x32x16_bf16 v[80:95], a[20:23], a[32:35], v[80:95]
ds_read_b64_tr_b16 a[72:73], v14 offset:8192
ds_read_b64_tr_b16 a[74:75], v14 offset:10240
v_mfma_f32_32x32x16_bf16 v[96:111], a[20:23], a[36:39], v[96:111]
ds_read_b64_tr_b16 a[76:77], v2 offset:8192
ds_read_b64_tr_b16 a[78:79], v2 offset:10240
v_mfma_f32_32x32x16_bf16 v[112:127], a[20:23], a[40:43], v[112:127]
v_mfma_f32_32x32x16_bf16 v[128:143], a[20:23], a[44:47], v[128:143]
v_mfma_f32_32x32x16_bf16 v[144:159], a[24:27], a[32:35], v[144:159]
v_mfma_f32_32x32x16_bf16 v[160:175], a[24:27], a[36:39], v[160:175]
v_mfma_f32_32x32x16_bf16 v[176:191], a[24:27], a[40:43], v[176:191]
v_mfma_f32_32x32x16_bf16 v[192:207], a[24:27], a[44:47], v[192:207]
v_mfma_f32_32x32x16_bf16 v[208:223], a[28:31], a[32:35], v[208:223]
v_mfma_f32_32x32x16_bf16 v[224:239], a[28:31], a[36:39], v[224:239]
v_mfma_f32_32x32x16_bf16 v[240:255], a[28:31], a[40:43], v[240:255]
v_mfma_f32_32x32x16_bf16 a[0:15], a[28:31], a[44:47], a[0:15]
s_waitcnt lgkmcnt(0)
s_waitcnt vmcnt(8)
s_barrier
v_mfma_f32_32x32x16_bf16 v[16:31], a[48:51], a[64:67], v[16:31]
ds_read_b128 a[16:19], v10 offset:32768
ds_read_b128 a[20:23], v10 offset:34816
v_mfma_f32_32x32x16_bf16 v[32:47], a[48:51], a[68:71], v[32:47]
ds_read_b128 a[24:27], v10 offset:36864
ds_read_b128 a[28:31], v10 offset:38912
v_mfma_f32_32x32x16_bf16 v[48:63], a[48:51], a[72:75], v[48:63]
ds_read_b64_tr_b16 a[32:33], v12 offset:32768
ds_read_b64_tr_b16 a[34:35], v12 offset:34816
v_mfma_f32_32x32x16_bf16 v[64:79], a[48:51], a[76:79], v[64:79]
ds_read_b64_tr_b16 a[36:37], v13 offset:32768
ds_read_b64_tr_b16 a[38:39], v13 offset:34816
v_mfma_f32_32x32x16_bf16 v[80:95], a[52:55], a[64:67], v[80:95]
ds_read_b64_tr_b16 a[40:41], v14 offset:32768
ds_read_b64_tr_b16 a[42:43], v14 offset:34816
v_mfma_f32_32x32x16_bf16 v[96:111], a[52:55], a[68:71], v[96:111]
ds_read_b64_tr_b16 a[44:45], v2 offset:32768
ds_read_b64_tr_b16 a[46:47], v2 offset:34816
v_mfma_f32_32x32x16_bf16 v[112:127], a[52:55], a[72:75], v[112:127]
s_add_u32 s32, s60, 1088
s_add_u32 m0, s36, 32768
s_nop 0
buffer_load_dwordx4 v1, s[52:55], s32 offen lds
v_mfma_f32_32x32x16_bf16 v[128:143], a[52:55], a[76:79], v[128:143]
s_add_u32 s32, s60, 74816
s_add_u32 m0, s36, 36864
s_nop 0
buffer_load_dwordx4 v1, s[52:55], s32 offen lds
v_mfma_f32_32x32x16_bf16 v[144:159], a[56:59], a[64:67], v[144:159]
s_add_u32 s32, s60, 148544
s_add_u32 m0, s36, 40960
s_nop 0
buffer_load_dwordx4 v1, s[52:55], s32 offen lds
v_mfma_f32_32x32x16_bf16 v[160:175], a[56:59], a[68:71], v[160:175]
s_add_u32 s32, s60, 222272
s_add_u32 m0, s36, 45056
s_nop 0
buffer_load_dwordx4 v1, s[52:55], s32 offen lds
v_mfma_f32_32x32x16_bf16 v[176:191], a[56:59], a[72:75], v[176:191]
s_add_u32 m0, s36, 49152
s_nop 0
buffer_load_dwordx4 v4, s[48:51], s61 offen lds
s_add_u32 s61, s61, s62
v_mfma_f32_32x32x16_bf16 v[192:207], a[56:59], a[76:79], v[192:207]
s_add_u32 m0, s36, 53248
s_nop 0
buffer_load_dwordx4 v4, s[48:51], s61 offen lds
s_add_u32 s61, s61, s62
v_mfma_f32_32x32x16_bf16 v[208:223], a[60:63], a[64:67], v[208:223]
s_add_u32 m0, s36, 57344
s_nop 0
buffer_load_dwordx4 v4, s[48:51], s61 offen lds
s_add_u32 s61, s61, s62
v_mfma_f32_32x32x16_bf16 v[224:239], a[60:63], a[68:71], v[224:239]
s_add_u32 m0, s36, 61440
s_nop 0
buffer_load_dwordx4 v4, s[48:51], s61 offen lds
s_add_u32 s61, s61, s62
v_mfma_f32_32x32x16_bf16 v[240:255], a[60:63], a[72:75], v[240:255]
v_mfma_f32_32x32x16_bf16 a[0:15], a[60:63], a[76:79], a[0:15]
s_waitcnt lgkmcnt(0)
v_mfma_f32_32x32x16_bf16 v[16:31], a[16:19], a[32:35], v[16:31]
ds_read_b128 a[48:51], v11 offset:32768
ds_read_b128 a[52:55], v11 offset:34816
v_mfma_f32_32x32x16_bf16 v[32:47], a[16:19], a[36:39], v[32:47]
ds_read_b128 a[56:59], v11 offset:36864
ds_read_b128 a[60:63], v11 offset:38912
v_mfma_f32_32x32x16_bf16 v[48:63], a[16:19], a[40:43], v[48:63]
ds_read_b64_tr_b16 a[64:65], v12 offset:40960
ds_read_b64_tr_b16 a[66:67], v12 offset:43008
v_mfma_f32_32x32x16_bf16 v[64:79], a[16:19], a[44:47], v[64:79]
ds_read_b64_tr_b16 a[68:69], v13 offset:40960
ds_read_b64_tr_b16 a[70:71], v13 offset:43008
v_mfma_f32_32x32x16_bf16 v[80:95], a[20:23], a[32:35], v[80:95]
ds_read_b64_tr_b16 a[72:73], v14 offset:40960
ds_read_b64_tr_b16 a[74:75], v14 offset:43008
v_mfma_f32_32x32x16_bf16 v[96:111], a[20:23], a[36:39], v[96:111]
ds_read_b64_tr_b16 a[76:77], v2 offset:40960
ds_read_b64_tr_b16 a[78:79], v2 offset:43008
v_mfma_f32_32x32x16_bf16 v[112:127], a[20:23], a[40:43], v[112:127]
v_mfma_f32_32x32x16_bf16 v[128:143], a[20:23], a[44:47], v[128:143]
v_mfma_f32_32x32x16_bf16 v[144:159], a[24:27], a[32:35], v[144:159]
v_mfma_f32_32x32x16_bf16 v[160:175], a[24:27], a[36:39], v[160:175]
v_mfma_f32_32x32x16_bf16 v[176:191], a[24:27], a[40:43], v[176:191]
v_mfma_f32_32x32x16_bf16 v[192:207], a[24:27], a[44:47], v[192:207]
v_mfma_f32_32x32x16_bf16 v[208:223], a[28:31], a[32:35], v[208:223]
v_mfma_f32_32x32x16_bf16 v[224:239], a[28:31], a[36:39], v[224:239]
v_mfma_f32_32x32x16_bf16 v[240:255], a[28:31], a[40:43], v[240:255]
v_mfma_f32_32x32x16_bf16 a[0:15], a[28:31], a[44:47], a[0:15]
s_waitcnt lgkmcnt(0)
s_waitcnt vmcnt(8)
s_barrier
v_mfma_f32_32x32x16_bf16 v[16:31], a[48:51], a[64:67], v[16:31]
ds_read_b128 a[16:19], v5
ds_read_b128 a[20:23], v5 offset:2048
v_mfma_f32_32x32x16_bf16 v[32:47], a[48:51], a[68:71], v[32:47]
ds_read_b128 a[24:27], v5 offset:4096
ds_read_b128 a[28:31], v5 offset:6144
v_mfma_f32_32x32x16_bf16 v[48:63], a[48:51], a[72:75], v[48:63]
ds_read_b64_tr_b16 a[32:33], v6
ds_read_b64_tr_b16 a[34:35], v6 offset:2048
v_mfma_f32_32x32x16_bf16 v[64:79], a[48:51], a[76:79], v[64:79]
ds_read_b64_tr_b16 a[36:37], v7
ds_read_b64_tr_b16 a[38:39], v7 offset:2048
v_mfma_f32_32x32x16_bf16 v[80:95], a[52:55], a[64:67], v[80:95]
ds_read_b64_tr_b16 a[40:41], v9
ds_read_b64_tr_b16 a[42:43], v9 offset:2048
v_mfma_f32_32x32x16_bf16 v[96:111], a[52:55], a[68:71], v[96:111]
ds_read_b64_tr_b16 a[44:45], v15
ds_read_b64_tr_b16 a[46:47], v15 offset:2048
v_mfma_f32_32x32x16_bf16 v[112:127], a[52:55], a[72:75], v[112:127]
v_mfma_f32_32x32x16_bf16 v[128:143], a[52:55], a[76:79], v[128:143]
v_mfma_f32_32x32x16_bf16 v[144:159], a[56:59], a[64:67], v[144:159]
v_mfma_f32_32x32x16_bf16 v[160:175], a[56:59], a[68:71], v[160:175]
v_mfma_f32_32x32x16_bf16 v[176:191], a[56:59], a[72:75], v[176:191]
v_mfma_f32_32x32x16_bf16 v[192:207], a[56:59], a[76:79], v[192:207]
v_mfma_f32_32x32x16_bf16 v[208:223], a[60:63], a[64:67], v[208:223]
v_mfma_f32_32x32x16_bf16 v[224:239], a[60:63], a[68:71], v[224:239]
v_mfma_f32_32x32x16_bf16 v[240:255], a[60:63], a[72:75], v[240:255]
v_mfma_f32_32x32x16_bf16 a[0:15], a[60:63], a[76:79], a[0:15]
s_waitcnt lgkmcnt(0)
v_mfma_f32_32x32x16_bf16 v[16:31], a[16:19], a[32:35], v[16:31]
ds_read_b128 a[48:51], v8
ds_read_b128 a[52:55], v8 offset:2048
v_mfma_f32_32x32x16_bf16 v[32:47], a[16:19], a[36:39], v[32:47]
ds_read_b128 a[56:59], v8 offset:4096
ds_read_b128 a[60:63], v8 offset:6144
v_mfma_f32_32x32x16_bf16 v[48:63], a[16:19], a[40:43], v[48:63]
ds_read_b64_tr_b16 a[64:65], v6 offset:8192
ds_read_b64_tr_b16 a[66:67], v6 offset:10240
v_mfma_f32_32x32x16_bf16 v[64:79], a[16:19], a[44:47], v[64:79]
ds_read_b64_tr_b16 a[68:69], v7 offset:8192
ds_read_b64_tr_b16 a[70:71], v7 offset:10240
v_mfma_f32_32x32x16_bf16 v[80:95], a[20:23], a[32:35], v[80:95]
ds_read_b64_tr_b16 a[72:73], v9 offset:8192
ds_read_b64_tr_b16 a[74:75], v9 offset:10240
v_mfma_f32_32x32x16_bf16 v[96:111], a[20:23], a[36:39], v[96:111]
ds_read_b64_tr_b16 a[76:77], v15 offset:8192
ds_read_b64_tr_b16 a[78:79], v15 offset:10240
v_mfma_f32_32x32x16_bf16 v[112:127], a[20:23], a[40:43], v[112:127]
v_mfma_f32_32x32x16_bf16 v[128:143], a[20:23], a[44:47], v[128:143]
v_mfma_f32_32x32x16_bf16 v[144:159], a[24:27], a[32:35], v[144:159]
v_mfma_f32_32x32x16_bf16 v[160:175], a[24:27], a[36:39], v[160:175]
v_mfma_f32_32x32x16_bf16 v[176:191], a[24:27], a[40:43], v[176:191]
v_mfma_f32_32x32x16_bf16 v[192:207], a[24:27], a[44:47], v[192:207]
v_mfma_f32_32x32x16_bf16 v[208:223], a[28:31], a[32:35], v[208:223]
v_mfma_f32_32x32x16_bf16 v[224:239], a[28:31], a[36:39], v[224:239]
v_mfma_f32_32x32x16_bf16 v[240:255], a[28:31], a[40:43], v[240:255]
v_mfma_f32_32x32x16_bf16 a[0:15], a[28:31], a[44:47], a[0:15]
s_waitcnt lgkmcnt(0)
s_waitcnt vmcnt(0)
s_barrier
v_mfma_f32_32x32x16_bf16 v[16:31], a[48:51], a[64:67], v[16:31]
ds_read_b128 a[16:19], v5 offset:32768
ds_read_b128 a[20:23], v5 offset:34816
v_mfma_f32_32x32x16_bf16 v[32:47], a[48:51], a[68:71], v[32:47]
ds_read_b128 a[24:27], v5 offset:36864
ds_read_b128 a[28:31], v5 offset:38912
v_mfma_f32_32x32x16_bf16 v[48:63], a[48:51], a[72:75], v[48:63]
ds_read_b64_tr_b16 a[32:33], v6 offset:32768
ds_read_b64_tr_b16 a[34:35], v6 offset:34816
v_mfma_f32_32x32x16_bf16 v[64:79], a[48:51], a[76:79], v[64:79]
ds_read_b64_tr_b16 a[36:37], v7 offset:32768
ds_read_b64_tr_b16 a[38:39], v7 offset:34816
v_mfma_f32_32x32x16_bf16 v[80:95], a[52:55], a[64:67], v[80:95]
ds_read_b64_tr_b16 a[40:41], v9 offset:32768
ds_read_b64_tr_b16 a[42:43], v9 offset:34816
v_mfma_f32_32x32x16_bf16 v[96:111], a[52:55], a[68:71], v[96:111]
ds_read_b64_tr_b16 a[44:45], v15 offset:32768
ds_read_b64_tr_b16 a[46:47], v15 offset:34816
v_mfma_f32_32x32x16_bf16 v[112:127], a[52:55], a[72:75], v[112:127]
v_mfma_f32_32x32x16_bf16 v[128:143], a[52:55], a[76:79], v[128:143]
v_mfma_f32_32x32x16_bf16 v[144:159], a[56:59], a[64:67], v[144:159]
v_mfma_f32_32x32x16_bf16 v[160:175], a[56:59], a[68:71], v[160:175]
v_mfma_f32_32x32x16_bf16 v[176:191], a[56:59], a[72:75], v[176:191]
v_mfma_f32_32x32x16_bf16 v[192:207], a[56:59], a[76:79], v[192:207]
v_mfma_f32_32x32x16_bf16 v[208:223], a[60:63], a[64:67], v[208:223]
v_mfma_f32_32x32x16_bf16 v[224:239], a[60:63], a[68:71], v[224:239]
v_mfma_f32_32x32x16_bf16 v[240:255], a[60:63], a[72:75], v[240:255]
v_mfma_f32_32x32x16_bf16 a[0:15], a[60:63], a[76:79], a[0:15]
s_waitcnt lgkmcnt(0)
v_mfma_f32_32x32x16_bf16 v[16:31], a[16:19], a[32:35], v[16:31]
ds_read_b128 a[48:51], v8 offset:32768
ds_read_b128 a[52:55], v8 offset:34816
v_mfma_f32_32x32x16_bf16 v[32:47], a[16:19], a[36:39], v[32:47]
ds_read_b128 a[56:59], v8 offset:36864
ds_read_b128 a[60:63], v8 offset:38912
v_mfma_f32_32x32x16_bf16 v[48:63], a[16:19], a[40:43], v[48:63]
ds_read_b64_tr_b16 a[64:65], v6 offset:40960
ds_read_b64_tr_b16 a[66:67], v6 offset:43008
v_mfma_f32_32x32x16_bf16 v[64:79], a[16:19], a[44:47], v[64:79]
ds_read_b64_tr_b16 a[68:69], v7 offset:40960
ds_read_b64_tr_b16 a[70:71], v7 offset:43008
v_mfma_f32_32x32x16_bf16 v[80:95], a[20:23], a[32:35], v[80:95]
ds_read_b64_tr_b16 a[72:73], v9 offset:40960
ds_read_b64_tr_b16 a[74:75], v9 offset:43008
v_mfma_f32_32x32x16_bf16 v[96:111], a[20:23], a[36:39], v[96:111]
ds_read_b64_tr_b16 a[76:77], v15 offset:40960
ds_read_b64_tr_b16 a[78:79], v15 offset:43008
v_mfma_f32_32x32x16_bf16 v[112:127], a[20:23], a[40:43], v[112:127]
v_mfma_f32_32x32x16_bf16 v[128:143], a[20:23], a[44:47], v[128:143]
v_mfma_f32_32x32x16_bf16 v[144:159], a[24:27], a[32:35], v[144:159]
v_mfma_f32_32x32x16_bf16 v[160:175], a[24:27], a[36:39], v[160:175]
v_mfma_f32_32x32x16_bf16 v[176:191], a[24:27], a[40:43], v[176:191]
v_mfma_f32_32x32x16_bf16 v[192:207], a[24:27], a[44:47], v[192:207]
v_mfma_f32_32x32x16_bf16 v[208:223], a[28:31], a[32:35], v[208:223]
v_mfma_f32_32x32x16_bf16 v[224:239], a[28:31], a[36:39], v[224:239]
v_mfma_f32_32x32x16_bf16 v[240:255], a[28:31], a[40:43], v[240:255]
v_mfma_f32_32x32x16_bf16 a[0:15], a[28:31], a[44:47], a[0:15]
s_waitcnt lgkmcnt(0)
v_mfma_f32_32x32x16_bf16 v[16:31], a[48:51], a[64:67], v[16:31]
v_mfma_f32_32x32x16_bf16 v[32:47], a[48:51], a[68:71], v[32:47]
v_mfma_f32_32x32x16_bf16 v[48:63], a[48:51], a[72:75], v[48:63]
v_mfma_f32_32x32x16_bf16 v[64:79], a[48:51], a[76:79], v[64:79]
v_mfma_f32_32x32x16_bf16 v[80:95], a[52:55], a[64:67], v[80:95]
v_mfma_f32_32x32x16_bf16 v[96:111], a[52:55], a[68:71], v[96:111]
v_mfma_f32_32x32x16_bf16 v[112:127], a[52:55], a[72:75], v[112:127]
v_mfma_f32_32x32x16_bf16 v[128:143], a[52:55], a[76:79], v[128:143]
v_mfma_f32_32x32x16_bf16 v[144:159], a[56:59], a[64:67], v[144:159]
v_mfma_f32_32x32x16_bf16 v[160:175], a[56:59], a[68:71], v[160:175]
v_mfma_f32_32x32x16_bf16 v[176:191], a[56:59], a[72:75], v[176:191]
v_mfma_f32_32x32x16_bf16 v[192:207], a[56:59], a[76:79], v[192:207]
v_mfma_f32_32x32x16_bf16 v[208:223], a[60:63], a[64:67], v[208:223]
v_mfma_f32_32x32x16_bf16 v[224:239], a[60:63], a[68:71], v[224:239]
v_mfma_f32_32x32x16_bf16 v[240:255], a[60:63], a[72:75], v[240:255]
v_mfma_f32_32x32x16_bf16 a[0:15], a[60:63], a[76:79], a[0:15]
s_branch GE_16
GY_17:
s_cmp_eq_u32 s59, 1
s_cbranch_scc1 GZ_18
s_waitcnt vmcnt(7)
s_barrier
ds_read_b128 a[16:19], v5
ds_read_b128 a[20:23], v5 offset:2048
ds_read_b64_tr_b16 a[32:33], v6
ds_read_b64_tr_b16 a[34:35], v6 offset:2048
ds_read_b64_tr_b16 a[36:37], v7
ds_read_b64_tr_b16 a[38:39], v7 offset:2048
ds_read_b64_tr_b16 a[40:41], v9
ds_read_b64_tr_b16 a[42:43], v9 offset:2048
ds_read_b64_tr_b16 a[44:45], v15
ds_read_b64_tr_b16 a[46:47], v15 offset:2048
s_add_u32 s32, s60, 128
s_add_u32 m0, s36, 65536
s_nop 0
buffer_load_dwordx4 v1, s[52:55], s32 offen lds
s_add_u32 s32, s60, 73856
s_add_u32 m0, s36, 69632
s_nop 0
buffer_load_dwordx4 v1, s[52:55], s32 offen lds
s_add_u32 m0, s36, 81920
s_nop 0
buffer_load_dwordx4 v4, s[48:51], s61 offen lds
s_add_u32 s61, s61, s62
s_add_u32 m0, s36, 86016
s_nop 0
buffer_load_dwordx4 v4, s[48:51], s61 offen lds
s_add_u32 s61, s61, s62
s_add_u32 m0, s36, 90112
s_nop 0
buffer_load_dwordx4 v4, s[48:51], s61 offen lds
s_add_u32 s61, s61, s62
s_add_u32 m0, s36, 94208
s_nop 0
buffer_load_dwordx4 v4, s[48:51], s61 offen lds
s_add_u32 s61, s61, s62
s_waitcnt lgkmcnt(0)
v_mfma_f32_32x32x16_bf16 v[16:31], a[32:35], a[16:19], 0
ds_read_b128 a[48:51], v8
ds_read_b128 a[52:55], v8 offset:2048
v_mfma_f32_32x32x16_bf16 v[32:47], a[36:39], a[16:19], 0
ds_read_b64_tr_b16 a[64:65], v6 offset:8192
ds_read_b64_tr_b16 a[66:67], v6 offset:10240
v_mfma_f32_32x32x16_bf16 v[48:63], a[40:43], a[16:19], 0
ds_read_b64_tr_b16 a[68:69], v7 offset:8192
ds_read_b64_tr_b16 a[70:71], v7 offset:10240
v_mfma_f32_32x32x16_bf16 v[64:79], a[44:47], a[16:19], 0
ds_read_b64_tr_b16 a[72:73], v9 offset:8192
ds_read_b64_tr_b16 a[74:75], v9 offset:10240
v_mfma_f32_32x32x16_bf16 v[80:95], a[32:35], a[20:23], 0
ds_read_b64_tr_b16 a[76:77], v15 offset:8192
ds_read_b64_tr_b16 a[78:79], v15 offset:10240
v_mfma_f32_32x32x16_bf16 v[96:111], a[36:39], a[20:23], 0
v_mfma_f32_32x32x16_bf16 v[112:127], a[40:43], a[20:23], 0
v_mfma_f32_32x32x16_bf16 v[128:143], a[44:47], a[20:23], 0
s_waitcnt lgkmcnt(0)
s_waitcnt vmcnt(7)
s_barrier
v_mfma_f32_32x32x16_bf16 v[16:31], a[64:67], a[48:51], v[16:31]
ds_read_b128 a[16:19], v5 offset:32768
ds_read_b128 a[20:23], v5 offset:34816
ds_read_b64_tr_b16 a[32:33], v6 offset:32768
ds_read_b64_tr_b16 a[34:35], v6 offset:34816
v_mfma_f32_32x32x16_bf16 v[32:47], a[68:71], a[48:51], v[32:47]
ds_read_b64_tr_b16 a[36:37], v7 offset:32768
ds_read_b64_tr_b16 a[38:39], v7 offset:34816
ds_read_b64_tr_b16 a[40:41], v9 offset:32768
ds_read_b64_tr_b16 a[42:43], v9 offset:34816
v_mfma_f32_32x32x16_bf16 v[48:63], a[72:75], a[48:51], v[48:63]
ds_read_b64_tr_b16 a[44:45], v15 offset:32768
ds_read_b64_tr_b16 a[46:47], v15 offset:34816
s_add_u32 s32, s60, 192
s_add_u32 m0, s36, 98304
s_nop 0
buffer_load_dwordx4 v1, s[52:55], s32 offen lds
v_mfma_f32_32x32x16_bf16 v[64:79], a[76:79], a[48:51], v[64:79]
s_add_u32 s32, s60, 73920
s_add_u32 m0, s36, 102400
s_nop 0
buffer_load_dwordx4 v1, s[52:55], s32 offen lds
s_add_u32 m0, s36, 114688
s_nop 0
buffer_load_dwordx4 v4, s[48:51], s61 offen lds
s_add_u32 s61, s61, s62
v_mfma_f32_32x32x16_bf16 v[80:95], a[64:67], a[52:55], v[80:95]
s_add_u32 m0, s36, 118784
s_nop 0
buffer_load_dwordx4 v4, s[48:51], s61 offen lds
s_add_u32 s61, s61, s62
s_add_u32 m0, s36, 122880
s_nop 0
buffer_load_dwordx4 v4, s[48:51], s61 offen lds
s_add_u32 s61, s61, s62
v_mfma_f32_32x32x16_bf16 v[96:111], a[68:71], a[52:55], v[96:111]
s_add_u32 m0, s36, 126976
s_nop 0
buffer_load_dwordx4 v4, s[48:51], s61 offen lds
s_add_u32 s61, s61, s62
v_mfma_f32_32x32x16_bf16 v[112:127], a[72:75], a[52:55], v[112:127]
v_mfma_f32_32x32x16_bf16 v[128:143], a[76:79], a[52:55], v[128:143]
s_waitcnt lgkmcnt(0)
v_mfma_f32_32x32x16_bf16 v[16:31], a[32:35], a[16:19], v[16:31]
ds_read_b128 a[48:51], v8 offset:32768
ds_read_b128 a[52:55], v8 offset:34816
v_mfma_f32_32x32x16_bf16 v[32:47], a[36:39], a[16:19], v[32:47]
ds_read_b64_tr_b16 a[64:65], v6 offset:40960
ds_read_b64_tr_b16 a[66:67], v6 offset:43008
v_mfma_f32_32x32x16_bf16 v[48:63], a[40:43], a[16:19], v[48:63]
ds_read_b64_tr_b16 a[68:69], v7 offset:40960
ds_read_b64_tr_b16 a[70:71], v7 offset:43008
v_mfma_f32_32x32x16_bf16 v[64:79], a[44:47], a[16:19], v[64:79]
ds_read_b64_tr_b16 a[72:73], v9 offset:40960
ds_read_b64_tr_b16 a[74:75], v9 offset:43008
v_mfma_f32_32x32x16_bf16 v[80:95], a[32:35], a[20:23], v[80:95]
ds_read_b64_tr_b16 a[76:77], v15 offset:40960
ds_read_b64_tr_b16 a[78:79], v15 offset:43008
v_mfma_f32_32x32x16_bf16 v[96:111], a[36:39], a[20:23], v[96:111]
v_mfma_f32_32x32x16_bf16 v[112:127], a[40:43], a[20:23], v[112:127]
v_mfma_f32_32x32x16_bf16 v[128:143], a[44:47], a[20:23], v[128:143]
s_waitcnt lgkmcnt(0)
s_waitcnt vmcnt(6)
s_barrier
v_mfma_f32_32x32x16_bf16 v[16:31], a[64:67], a[48:51], v[16:31]
ds_read_b128 a[16:19], v10
ds_read_b128 a[20:23], v10 offset:2048
ds_read_b64_tr_b16 a[32:33], v12
ds_read_b64_tr_b16 a[34:35], v12 offset:2048
v_mfma_f32_32x32x16_bf16 v[32:47], a[68:71], a[48:51], v[32:47]
ds_read_b64_tr_b16 a[36:37], v13
ds_read_b64_tr_b16 a[38:39], v13 offset:2048
ds_read_b64_tr_b16 a[40:41], v14
ds_read_b64_tr_b16 a[42:43], v14 offset:2048
v_mfma_f32_32x32x16_bf16 v[48:63], a[72:75], a[48:51], v[48:63]
ds_read_b64_tr_b16 a[44:45], v2
ds_read_b64_tr_b16 a[46:47], v2 offset:2048
s_add_u32 s32, s60, 256
s_add_u32 m0, s36, 0
s_nop 0
buffer_load_dwordx4 v1, s[52:55], s32 offen lds
v_mfma_f32_32x32x16_bf16 v[64:79], a[76:79], a[48:51], v[64:79]
s_add_u32 s32, s60, 73984
s_add_u32 m0, s36, 4096
s_nop 0
buffer_load_dwordx4 v1, s[52:55], s32 offen lds
s_add_u32 m0, s36, 16384
s_nop 0
buffer_load_dwordx4 v4, s[48:51], s61 offen lds
s_add_u32 s61, s61, s62
v_mfma_f32_32x32x16_bf16 v[80:95], a[64:67], a[52:55], v[80:95]
s_add_u32 m0, s36, 20480
s_nop 0
buffer_load_dwordx4 v4, s[48:51], s61 offen lds
s_add_u32 s61, s61, s62
s_add_u32 m0, s36, 24576
s_nop 0
buffer_load_dwordx4 v4, s[48:51], s61 offen lds
s_add_u32 s61, s61, s62
v_mfma_f32_32x32x16_bf16 v[96:111], a[68:71], a[52:55], v[96:111]
s_add_u32 m0, s36, 28672
s_nop 0
buffer_load_dwordx4 v4, s[48:51], s61 offen lds
s_add_u32 s61, s61, s62
v_mfma_f32_32x32x16_bf16 v[112:127], a[72:75], a[52:55], v[112:127]
v_mfma_f32_32x32x16_bf16 v[128:143], a[76:79], a[52:55], v[128:143]
s_waitcnt lgkmcnt(0)
v_mfma_f32_32x32x16_bf16 v[16:31], a[32:35], a[16:19], v[16:31]
ds_read_b128 a[48:51], v11
ds_read_b128 a[52:55], v11 offset:2048
v_mfma_f32_32x32x16_bf16 v[32:47], a[36:39], a[16:19], v[32:47]
ds_read_b64_tr_b16 a[64:65], v12 offset:8192
ds_read_b64_tr_b16 a[66:67], v12 offset:10240
v_mfma_f32_32x32x16_bf16 v[48:63], a[40:43], a[16:19], v[48:63]
ds_read_b64_tr_b16 a[68:69], v13 offset:8192
ds_read_b64_tr_b16 a[70:71], v13 offset:10240
v_mfma_f32_32x32x16_bf16 v[64:79], a[44:47], a[16:19], v[64:79]
ds_read_b64_tr_b16 a[72:73], v14 offset:8192
ds_read_b64_tr_b16 a[74:75], v14 offset:10240
v_mfma_f32_32x32x16_bf16 v[80:95], a[32:35], a[20:23], v[80:95]
ds_read_b64_tr_b16 a[76:77], v2 offset:8192
ds_read_b64_tr_b16 a[78:79], v2 offset:10240
v_mfma_f32_32x32x16_bf16 v[96:111], a[36:39], a[20:23], v[96:111]
v_mfma_f32_32x32x16_bf16 v[112:127], a[40:43], a[20:23], v[112:127]
v_mfma_f32_32x32x16_bf16 v[128:143], a[44:47], a[20:23], v[128:143]
s_waitcnt lgkmcnt(0)
s_waitcnt vmcnt(6)
s_barrier
v_mfma_f32_32x32x16_bf16 v[16:31], a[64:67], a[48:51], v[16:31]
ds_read_b128 a[16:19], v10 offset:32768
ds_read_b128 a[20:23], v10 offset:34816
ds_read_b64_tr_b16 a[32:33], v12 offset:32768
ds_read_b64_tr_b16 a[34:35], v12 offset:34816
v_mfma_f32_32x32x16_bf16 v[32:47], a[68:71], a[48:51], v[32:47]
ds_read_b64_tr_b16 a[36:37], v13 offset:32768
ds_read_b64_tr_b16 a[38:39], v13 offset:34816
ds_read_b64_tr_b16 a[40:41], v14 offset:32768
ds_read_b64_tr_b16 a[42:43], v14 offset:34816
v_mfma_f32_32x32x16_bf16 v[48:63], a[72:75], a[48:51], v[48:63]
ds_read_b64_tr_b16 a[44:45], v2 offset:32768
ds_read_b64_tr_b16 a[46:47], v2 offset:34816
s_add_u32 s32, s60, 320
s_add_u32 m0, s36, 32768
s_nop 0
buffer_load_dwordx4 v1, s[52:55], s32 offen lds
v_mfma_f32_32x32x16_bf16 v[64:79], a[76:79], a[48:51], v[64:79]
s_add_u32 s32, s60, 74048
s_add_u32 m0, s36, 36864
s_nop 0
buffer_load_dwordx4 v1, s[52:55], s32 offen lds
s_add_u32 m0, s36, 49152
s_nop 0
buffer_load_dwordx4 v4, s[48:51], s61 offen lds
s_add_u32 s61, s61, s62
v_mfma_f32_32x32x16_bf16 v[80:95], a[64:67], a[52:55], v[80:95]
s_add_u32 m0, s36, 53248
s_nop 0
buffer_load_dwordx4 v4, s[48:51], s61 offen lds
s_add_u32 s61, s61, s62
s_add_u32 m0, s36, 57344
s_nop 0
buffer_load_dwordx4 v4, s[48:51], s61 offen lds
s_add_u32 s61, s61, s62
v_mfma_f32_32x32x16_bf16 v[96:111], a[68:71], a[52:55], v[96:111]
s_add_u32 m0, s36, 61440
s_nop 0
buffer_load_dwordx4 v4, s[48:51], s61 offen lds
s_add_u32 s61, s61, s62
v_mfma_f32_32x32x16_bf16 v[112:127], a[72:75], a[52:55], v[112:127]
v_mfma_f32_32x32x16_bf16 v[128:143], a[76:79], a[52:55], v[128:143]
s_waitcnt lgkmcnt(0)
v_mfma_f32_32x32x16_bf16 v[16:31], a[32:35], a[16:19], v[16:31]
ds_read_b128 a[48:51], v11 offset:32768
ds_read_b128 a[52:55], v11 offset:34816
v_mfma_f32_32x32x16_bf16 v[32:47], a[36:39], a[16:19], v[32:47]
ds_read_b64_tr_b16 a[64:65], v12 offset:40960
ds_read_b64_tr_b16 a[66:67], v12 offset:43008
v_mfma_f32_32x32x16_bf16 v[48:63], a[40:43], a[16:19], v[48:63]
ds_read_b64_tr_b16 a[68:69], v13 offset:40960
ds_read_b64_tr_b16 a[70:71], v13 offset:43008
v_mfma_f32_32x32x16_bf16 v[64:79], a[44:47], a[16:19], v[64:79]
ds_read_b64_tr_b16 a[72:73], v14 offset:40960
ds_read_b64_tr_b16 a[74:75], v14 offset:43008
v_mfma_f32_32x32x16_bf16 v[80:95], a[32:35], a[20:23], v[80:95]
ds_read_b64_tr_b16 a[76:77], v2 offset:40960
ds_read_b64_tr_b16 a[78:79], v2 offset:43008
v_mfma_f32_32x32x16_bf16 v[96:111], a[36:39], a[20:23], v[96:111]
v_mfma_f32_32x32x16_bf16 v[112:127], a[40:43], a[20:23], v[112:127]
v_mfma_f32_32x32x16_bf16 v[128:143], a[44:47], a[20:23], v[128:143]
s_waitcnt lgkmcnt(0)
s_waitcnt vmcnt(6)
s_barrier
v_mfma_f32_32x32x16_bf16 v[16:31], a[64:67], a[48:51], v[16:31]
ds_read_b128 a[16:19], v5
ds_read_b128 a[20:23], v5 offset:2048
ds_read_b64_tr_b16 a[32:33], v6
ds_read_b64_tr_b16 a[34:35], v6 offset:2048
v_mfma_f32_32x32x16_bf16 v[32:47], a[68:71], a[48:51], v[32:47]
ds_read_b64_tr_b16 a[36:37], v7
ds_read_b64_tr_b16 a[38:39], v7 offset:2048
ds_read_b64_tr_b16 a[40:41], v9
ds_read_b64_tr_b16 a[42:43], v9 offset:2048
v_mfma_f32_32x32x16_bf16 v[48:63], a[72:75], a[48:51], v[48:63]
ds_read_b64_tr_b16 a[44:45], v15
ds_read_b64_tr_b16 a[46:47], v15 offset:2048
s_add_u32 s32, s60, 384
s_add_u32 m0, s36, 65536
s_nop 0
buffer_load_dwordx4 v1, s[52:55], s32 offen lds
v_mfma_f32_32x32x16_bf16 v[64:79], a[76:79], a[48:51], v[64:79]
s_add_u32 s32, s60, 74112
s_add_u32 m0, s36, 69632
s_nop 0
buffer_load_dwordx4 v1, s[52:55], s32 offen lds
s_add_u32 m0, s36, 81920
s_nop 0
buffer_load_dwordx4 v4, s[48:51], s61 offen lds
s_add_u32 s61, s61, s62
v_mfma_f32_32x32x16_bf16 v[80:95], a[64:67], a[52:55], v[80:95]
s_add_u32 m0, s36, 86016
s_nop 0
buffer_load_dwordx4 v4, s[48:51], s61 offen lds
s_add_u32 s61, s61, s62
s_add_u32 m0, s36, 90112
s_nop 0
buffer_load_dwordx4 v4, s[48:51], s61 offen lds
s_add_u32 s61, s61, s62
v_mfma_f32_32x32x16_bf16 v[96:111], a[68:71], a[52:55], v[96:111]
s_add_u32 m0, s36, 94208
s_nop 0
buffer_load_dwordx4 v4, s[48:51], s61 offen lds
s_add_u32 s61, s61, s62
v_mfma_f32_32x32x16_bf16 v[112:127], a[72:75], a[52:55], v[112:127]
v_mfma_f32_32x32x16_bf16 v[128:143], a[76:79], a[52:55], v[128:143]
s_waitcnt lgkmcnt(0)
v_mfma_f32_32x32x16_bf16 v[16:31], a[32:35], a[16:19], v[16:31]
ds_read_b128 a[48:51], v8
ds_read_b128 a[52:55], v8 offset:2048
v_mfma_f32_32x32x16_bf16 v[32:47], a[36:39], a[16:19], v[32:47]
ds_read_b64_tr_b16 a[64:65], v6 offset:8192
ds_read_b64_tr_b16 a[66:67], v6 offset:10240
v_mfma_f32_32x32x16_bf16 v[48:63], a[40:43], a[16:19], v[48:63]
ds_read_b64_tr_b16 a[68:69], v7 offset:8192
ds_read_b64_tr_b16 a[70:71], v7 offset:10240
v_mfma_f32_32x32x16_bf16 v[64:79], a[44:47], a[16:19], v[64:79]
ds_read_b64_tr_b16 a[72:73], v9 offset:8192
ds_read_b64_tr_b16 a[74:75], v9 offset:10240
v_mfma_f32_32x32x16_bf16 v[80:95], a[32:35], a[20:23], v[80:95]
ds_read_b64_tr_b16 a[76:77], v15 offset:8192
ds_read_b64_tr_b16 a[78:79], v15 offset:10240
v_mfma_f32_32x32x16_bf16 v[96:111], a[36:39], a[20:23], v[96:111]
v_mfma_f32_32x32x16_bf16 v[112:127], a[40:43], a[20:23], v[112:127]
v_mfma_f32_32x32x16_bf16 v[128:143], a[44:47], a[20:23], v[128:143]
s_waitcnt lgkmcnt(0)
s_waitcnt vmcnt(6)
s_barrier
v_mfma_f32_32x32x16_bf16 v[16:31], a[64:67], a[48:51], v[16:31]
ds_read_b128 a[16:19], v5 offset:32768
ds_read_b128 a[20:23], v5 offset:34816
ds_read_b64_tr_b16 a[32:33], v6 offset:32768
ds_read_b64_tr_b16 a[34:35], v6 offset:34816
v_mfma_f32_32x32x16_bf16 v[32:47], a[68:71], a[48:51], v[32:47]
ds_read_b64_tr_b16 a[36:37], v7 offset:32768
ds_read_b64_tr_b16 a[38:39], v7 offset:34816
ds_read_b64_tr_b16 a[40:41], v9 offset:32768
ds_read_b64_tr_b16 a[42:43], v9 offset:34816
v_mfma_f32_32x32x16_bf16 v[48:63], a[72:75], a[48:51], v[48:63]
ds_read_b64_tr_b16 a[44:45], v15 offset:32768
ds_read_b64_tr_b16 a[46:47], v15 offset:34816
s_add_u32 s32, s60, 448
s_add_u32 m0, s36, 98304
s_nop 0
buffer_load_dwordx4 v1, s[52:55], s32 offen lds
v_mfma_f32_32x32x16_bf16 v[64:79], a[76:79], a[48:51], v[64:79]
s_add_u32 s32, s60, 74176
s_add_u32 m0, s36, 102400
s_nop 0
buffer_load_dwordx4 v1, s[52:55], s32 offen lds
s_add_u32 m0, s36, 114688
s_nop 0
buffer_load_dwordx4 v4, s[48:51], s61 offen lds
s_add_u32 s61, s61, s62
v_mfma_f32_32x32x16_bf16 v[80:95], a[64:67], a[52:55], v[80:95]
s_add_u32 m0, s36, 118784
s_nop 0
buffer_load_dwordx4 v4, s[48:51], s61 offen lds
s_add_u32 s61, s61, s62
s_add_u32 m0, s36, 122880
s_nop 0
buffer_load_dwordx4 v4, s[48:51], s61 offen lds
s_add_u32 s61, s61, s62
v_mfma_f32_32x32x16_bf16 v[96:111], a[68:71], a[52:55], v[96:111]
s_add_u32 m0, s36, 126976
s_nop 0
buffer_load_dwordx4 v4, s[48:51], s61 offen lds
s_add_u32 s61, s61, s62
v_mfma_f32_32x32x16_bf16 v[112:127], a[72:75], a[52:55], v[112:127]
v_mfma_f32_32x32x16_bf16 v[128:143], a[76:79], a[52:55], v[128:143]
s_waitcnt lgkmcnt(0)
v_mfma_f32_32x32x16_bf16 v[16:31], a[32:35], a[16:19], v[16:31]
ds_read_b128 a[48:51], v8 offset:32768
ds_read_b128 a[52:55], v8 offset:34816
v_mfma_f32_32x32x16_bf16 v[32:47], a[36:39], a[16:19], v[32:47]
ds_read_b64_tr_b16 a[64:65], v6 offset:40960
ds_read_b64_tr_b16 a[66:67], v6 offset:43008
v_mfma_f32_32x32x16_bf16 v[48:63], a[40:43], a[16:19], v[48:63]
ds_read_b64_tr_b16 a[68:69], v7 offset:40960
ds_read_b64_tr_b16 a[70:71], v7 offset:43008
v_mfma_f32_32x32x16_bf16 v[64:79], a[44:47], a[16:19], v[64:79]
ds_read_b64_tr_b16 a[72:73], v9 offset:40960
ds_read_b64_tr_b16 a[74:75], v9 offset:43008
v_mfma_f32_32x32x16_bf16 v[80:95], a[32:35], a[20:23], v[80:95]
ds_read_b64_tr_b16 a[76:77], v15 offset:40960
ds_read_b64_tr_b16 a[78:79], v15 offset:43008
v_mfma_f32_32x32x16_bf16 v[96:111], a[36:39], a[20:23], v[96:111]
v_mfma_f32_32x32x16_bf16 v[112:127], a[40:43], a[20:23], v[112:127]
v_mfma_f32_32x32x16_bf16 v[128:143], a[44:47], a[20:23], v[128:143]
s_waitcnt lgkmcnt(0)
s_waitcnt vmcnt(6)
s_barrier
v_mfma_f32_32x32x16_bf16 v[16:31], a[64:67], a[48:51], v[16:31]
ds_read_b128 a[16:19], v10
ds_read_b128 a[20:23], v10 offset:2048
ds_read_b64_tr_b16 a[32:33], v12
ds_read_b64_tr_b16 a[34:35], v12 offset:2048
v_mfma_f32_32x32x16_bf16 v[32:47], a[68:71], a[48:51], v[32:47]
ds_read_b64_tr_b16 a[36:37], v13
ds_read_b64_tr_b16 a[38:39], v13 offset:2048
ds_read_b64_tr_b16 a[40:41], v14
ds_read_b64_tr_b16 a[42:43], v14 offset:2048
v_mfma_f32_32x32x16_bf16 v[48:63], a[72:75], a[48:51], v[48:63]
ds_read_b64_tr_b16 a[44:45], v2
ds_read_b64_tr_b16 a[46:47], v2 offset:2048
s_add_u32 s32, s60, 512
s_add_u32 m0, s36, 0
s_nop 0
buffer_load_dwordx4 v1, s[52:55], s32 offen lds
v_mfma_f32_32x32x16_bf16 v[64:79], a[76:79], a[48:51], v[64:79]
s_add_u32 s32, s60, 74240
s_add_u32 m0, s36, 4096
s_nop 0
buffer_load_dwordx4 v1, s[52:55], s32 offen lds
s_add_u32 m0, s36, 16384
s_nop 0
buffer_load_dwordx4 v4, s[48:51], s61 offen lds
s_add_u32 s61, s61, s62
v_mfma_f32_32x32x16_bf16 v[80:95], a[64:67], a[52:55], v[80:95]
s_add_u32 m0, s36, 20480
s_nop 0
buffer_load_dwordx4 v4, s[48:51], s61 offen lds
s_add_u32 s61, s61, s62
s_add_u32 m0, s36, 24576
s_nop 0
buffer_load_dwordx4 v4, s[48:51], s61 offen lds
s_add_u32 s61, s61, s62
v_mfma_f32_32x32x16_bf16 v[96:111], a[68:71], a[52:55], v[96:111]
s_add_u32 m0, s36, 28672
s_nop 0
buffer_load_dwordx4 v4, s[48:51], s61 offen lds
s_add_u32 s61, s61, s62
v_mfma_f32_32x32x16_bf16 v[112:127], a[72:75], a[52:55], v[112:127]
v_mfma_f32_32x32x16_bf16 v[128:143], a[76:79], a[52:55], v[128:143]
s_waitcnt lgkmcnt(0)
v_mfma_f32_32x32x16_bf16 v[16:31], a[32:35], a[16:19], v[16:31]
ds_read_b128 a[48:51], v11
ds_read_b128 a[52:55], v11 offset:2048
v_mfma_f32_32x32x16_bf16 v[32:47], a[36:39], a[16:19], v[32:47]
ds_read_b64_tr_b16 a[64:65], v12 offset:8192
ds_read_b64_tr_b16 a[66:67], v12 offset:10240
v_mfma_f32_32x32x16_bf16 v[48:63], a[40:43], a[16:19], v[48:63]
ds_read_b64_tr_b16 a[68:69], v13 offset:8192
ds_read_b64_tr_b16 a[70:71], v13 offset:10240
v_mfma_f32_32x32x16_bf16 v[64:79], a[44:47], a[16:19], v[64:79]
ds_read_b64_tr_b16 a[72:73], v14 offset:8192
ds_read_b64_tr_b16 a[74:75], v14 offset:10240
v_mfma_f32_32x32x16_bf16 v[80:95], a[32:35], a[20:23], v[80:95]
ds_read_b64_tr_b16 a[76:77], v2 offset:8192
ds_read_b64_tr_b16 a[78:79], v2 offset:10240
v_mfma_f32_32x32x16_bf16 v[96:111], a[36:39], a[20:23], v[96:111]
v_mfma_f32_32x32x16_bf16 v[112:127], a[40:43], a[20:23], v[112:127]
v_mfma_f32_32x32x16_bf16 v[128:143], a[44:47], a[20:23], v[128:143]
s_waitcnt lgkmcnt(0)
s_waitcnt vmcnt(6)
s_barrier
v_mfma_f32_32x32x16_bf16 v[16:31], a[64:67], a[48:51], v[16:31]
ds_read_b128 a[16:19], v10 offset:32768
ds_read_b128 a[20:23], v10 offset:34816
ds_read_b64_tr_b16 a[32:33], v12 offset:32768
ds_read_b64_tr_b16 a[34:35], v12 offset:34816
v_mfma_f32_32x32x16_bf16 v[32:47], a[68:71], a[48:51], v[32:47]
ds_read_b64_tr_b16 a[36:37], v13 offset:32768
ds_read_b64_tr_b16 a[38:39], v13 offset:34816
ds_read_b64_tr_b16 a[40:41], v14 offset:32768
ds_read_b64_tr_b16 a[42:43], v14 offset:34816
v_mfma_f32_32x32x16_bf16 v[48:63], a[72:75], a[48:51], v[48:63]
ds_read_b64_tr_b16 a[44:45], v2 offset:32768
ds_read_b64_tr_b16 a[46:47], v2 offset:34816
s_add_u32 s32, s60, 576
s_add_u32 m0, s36, 32768
s_nop 0
buffer_load_dwordx4 v1, s[52:55], s32 offen lds
v_mfma_f32_32x32x16_bf16 v[64:79], a[76:79], a[48:51], v[64:79]
s_add_u32 s32, s60, 74304
s_add_u32 m0, s36, 36864
s_nop 0
buffer_load_dwordx4 v1, s[52:55], s32 offen lds
s_add_u32 m0, s36, 49152
s_nop 0
buffer_load_dwordx4 v4, s[48:51], s61 offen lds
s_add_u32 s61, s61, s62
v_mfma_f32_32x32x16_bf16 v[80:95], a[64:67], a[52:55], v[80:95]
s_add_u32 m0, s36, 53248
s_nop 0
buffer_load_dwordx4 v4, s[48:51], s61 offen lds
s_add_u32 s61, s61, s62
s_add_u32 m0, s36, 57344
s_nop 0
buffer_load_dwordx4 v4, s[48:51], s61 offen lds
s_add_u32 s61, s61, s62
v_mfma_f32_32x32x16_bf16 v[96:111], a[68:71], a[52:55], v[96:111]
s_add_u32 m0, s36, 61440
s_nop 0
buffer_load_dwordx4 v4, s[48:51], s61 offen lds
s_add_u32 s61, s61, s62
v_mfma_f32_32x32x16_bf16 v[112:127], a[72:75], a[52:55], v[112:127]
v_mfma_f32_32x32x16_bf16 v[128:143], a[76:79], a[52:55], v[128:143]
s_waitcnt lgkmcnt(0)
v_mfma_f32_32x32x16_bf16 v[16:31], a[32:35], a[16:19], v[16:31]
ds_read_b128 a[48:51], v11 offset:32768
ds_read_b128 a[52:55], v11 offset:34816
v_mfma_f32_32x32x16_bf16 v[32:47], a[36:39], a[16:19], v[32:47]
ds_read_b64_tr_b16 a[64:65], v12 offset:40960
ds_read_b64_tr_b16 a[66:67], v12 offset:43008
v_mfma_f32_32x32x16_bf16 v[48:63], a[40:43], a[16:19], v[48:63]
ds_read_b64_tr_b16 a[68:69], v13 offset:40960
ds_read_b64_tr_b16 a[70:71], v13 offset:43008
v_mfma_f32_32x32x16_bf16 v[64:79], a[44:47], a[16:19], v[64:79]
ds_read_b64_tr_b16 a[72:73], v14 offset:40960
ds_read_b64_tr_b16 a[74:75], v14 offset:43008
v_mfma_f32_32x32x16_bf16 v[80:95], a[32:35], a[20:23], v[80:95]
ds_read_b64_tr_b16 a[76:77], v2 offset:40960
ds_read_b64_tr_b16 a[78:79], v2 offset:43008
v_mfma_f32_32x32x16_bf16 v[96:111], a[36:39], a[20:23], v[96:111]
v_mfma_f32_32x32x16_bf16 v[112:127], a[40:43], a[20:23], v[112:127]
v_mfma_f32_32x32x16_bf16 v[128:143], a[44:47], a[20:23], v[128:143]
s_waitcnt lgkmcnt(0)
s_waitcnt vmcnt(6)
s_barrier
v_mfma_f32_32x32x16_bf16 v[16:31], a[64:67], a[48:51], v[16:31]
ds_read_b128 a[16:19], v5
ds_read_b128 a[20:23], v5 offset:2048
ds_read_b64_tr_b16 a[32:33], v6
ds_read_b64_tr_b16 a[34:35], v6 offset:2048
v_mfma_f32_32x32x16_bf16 v[32:47], a[68:71], a[48:51], v[32:47]
ds_read_b64_tr_b16 a[36:37], v7
ds_read_b64_tr_b16 a[38:39], v7 offset:2048
ds_read_b64_tr_b16 a[40:41], v9
ds_read_b64_tr_b16 a[42:43], v9 offset:2048
v_mfma_f32_32x32x16_bf16 v[48:63], a[72:75], a[48:51], v[48:63]
ds_read_b64_tr_b16 a[44:45], v15
ds_read_b64_tr_b16 a[46:47], v15 offset:2048
s_add_u32 s32, s60, 640
s_add_u32 m0, s36, 65536
s_nop 0
buffer_load_dwordx4 v1, s[52:55], s32 offen lds
v_mfma_f32_32x32x16_bf16 v[64:79], a[76:79], a[48:51], v[64:79]
s_add_u32 s32, s60, 74368
s_add_u32 m0, s36, 69632
s_nop 0
buffer_load_dwordx4 v1, s[52:55], s32 offen lds
s_add_u32 m0, s36, 81920
s_nop 0
buffer_load_dwordx4 v4, s[48:51], s61 offen lds
s_add_u32 s61, s61, s62
v_mfma_f32_32x32x16_bf16 v[80:95], a[64:67], a[52:55], v[80:95]
s_add_u32 m0, s36, 86016
s_nop 0
buffer_load_dwordx4 v4, s[48:51], s61 offen lds
s_add_u32 s61, s61, s62
s_add_u32 m0, s36, 90112
s_nop 0
buffer_load_dwordx4 v4, s[48:51], s61 offen lds
s_add_u32 s61, s61, s62
v_mfma_f32_32x32x16_bf16 v[96:111], a[68:71], a[52:55], v[96:111]
s_add_u32 m0, s36, 94208
s_nop 0
buffer_load_dwordx4 v4, s[48:51], s61 offen lds
s_add_u32 s61, s61, s62
v_mfma_f32_32x32x16_bf16 v[112:127], a[72:75], a[52:55], v[112:127]
v_mfma_f32_32x32x16_bf16 v[128:143], a[76:79], a[52:55], v[128:143]
s_waitcnt lgkmcnt(0)
v_mfma_f32_32x32x16_bf16 v[16:31], a[32:35], a[16:19], v[16:31]
ds_read_b128 a[48:51], v8
ds_read_b128 a[52:55], v8 offset:2048
v_mfma_f32_32x32x16_bf16 v[32:47], a[36:39], a[16:19], v[32:47]
ds_read_b64_tr_b16 a[64:65], v6 offset:8192
ds_read_b64_tr_b16 a[66:67], v6 offset:10240
v_mfma_f32_32x32x16_bf16 v[48:63], a[40:43], a[16:19], v[48:63]
ds_read_b64_tr_b16 a[68:69], v7 offset:8192
ds_read_b64_tr_b16 a[70:71], v7 offset:10240
v_mfma_f32_32x32x16_bf16 v[64:79], a[44:47], a[16:19], v[64:79]
ds_read_b64_tr_b16 a[72:73], v9 offset:8192
ds_read_b64_tr_b16 a[74:75], v9 offset:10240
v_mfma_f32_32x32x16_bf16 v[80:95], a[32:35], a[20:23], v[80:95]
ds_read_b64_tr_b16 a[76:77], v15 offset:8192
ds_read_b64_tr_b16 a[78:79], v15 offset:10240
v_mfma_f32_32x32x16_bf16 v[96:111], a[36:39], a[20:23], v[96:111]
v_mfma_f32_32x32x16_bf16 v[112:127], a[40:43], a[20:23], v[112:127]
v_mfma_f32_32x32x16_bf16 v[128:143], a[44:47], a[20:23], v[128:143]
s_waitcnt lgkmcnt(0)
s_waitcnt vmcnt(6)
s_barrier
v_mfma_f32_32x32x16_bf16 v[16:31], a[64:67], a[48:51], v[16:31]
ds_read_b128 a[16:19], v5 offset:32768
ds_read_b128 a[20:23], v5 offset:34816
ds_read_b64_tr_b16 a[32:33], v6 offset:32768
ds_read_b64_tr_b16 a[34:35], v6 offset:34816
v_mfma_f32_32x32x16_bf16 v[32:47], a[68:71], a[48:51], v[32:47]
ds_read_b64_tr_b16 a[36:37], v7 offset:32768
ds_read_b64_tr_b16 a[38:39], v7 offset:34816
ds_read_b64_tr_b16 a[40:41], v9 offset:32768
ds_read_b64_tr_b16 a[42:43], v9 offset:34816
v_mfma_f32_32x32x16_bf16 v[48:63], a[72:75], a[48:51], v[48:63]
ds_read_b64_tr_b16 a[44:45], v15 offset:32768
ds_read_b64_tr_b16 a[46:47], v15 offset:34816
s_add_u32 s32, s60, 704
s_add_u32 m0, s36, 98304
s_nop 0
buffer_load_dwordx4 v1, s[52:55], s32 offen lds
v_mfma_f32_32x32x16_bf16 v[64:79], a[76:79], a[48:51], v[64:79]
s_add_u32 s32, s60, 74432
s_add_u32 m0, s36, 102400
s_nop 0
buffer_load_dwordx4 v1, s[52:55], s32 offen lds
s_add_u32 m0, s36, 114688
s_nop 0
buffer_load_dwordx4 v4, s[48:51], s61 offen lds
s_add_u32 s61, s61, s62
v_mfma_f32_32x32x16_bf16 v[80:95], a[64:67], a[52:55], v[80:95]
s_add_u32 m0, s36, 118784
s_nop 0
buffer_load_dwordx4 v4, s[48:51], s61 offen lds
s_add_u32 s61, s61, s62
s_add_u32 m0, s36, 122880
s_nop 0
buffer_load_dwordx4 v4, s[48:51], s61 offen lds
s_add_u32 s61, s61, s62
v_mfma_f32_32x32x16_bf16 v[96:111], a[68:71], a[52:55], v[96:111]
s_add_u32 m0, s36, 126976
s_nop 0
buffer_load_dwordx4 v4, s[48:51], s61 offen lds
s_add_u32 s61, s61, s62
v_mfma_f32_32x32x16_bf16 v[112:127], a[72:75], a[52:55], v[112:127]
v_mfma_f32_32x32x16_bf16 v[128:143], a[76:79], a[52:55], v[128:143]
s_waitcnt lgkmcnt(0)
v_mfma_f32_32x32x16_bf16 v[16:31], a[32:35], a[16:19], v[16:31]
ds_read_b128 a[48:51], v8 offset:32768
ds_read_b128 a[52:55], v8 offset:34816
v_mfma_f32_32x32x16_bf16 v[32:47], a[36:39], a[16:19], v[32:47]
ds_read_b64_tr_b16 a[64:65], v6 offset:40960
ds_read_b64_tr_b16 a[66:67], v6 offset:43008
v_mfma_f32_32x32x16_bf16 v[48:63], a[40:43], a[16:19], v[48:63]
ds_read_b64_tr_b16 a[68:69], v7 offset:40960
ds_read_b64_tr_b16 a[70:71], v7 offset:43008
v_mfma_f32_32x32x16_bf16 v[64:79], a[44:47], a[16:19], v[64:79]
ds_read_b64_tr_b16 a[72:73], v9 offset:40960
ds_read_b64_tr_b16 a[74:75], v9 offset:43008
v_mfma_f32_32x32x16_bf16 v[80:95], a[32:35], a[20:23], v[80:95]
ds_read_b64_tr_b16 a[76:77], v15 offset:40960
ds_read_b64_tr_b16 a[78:79], v15 offset:43008
v_mfma_f32_32x32x16_bf16 v[96:111], a[36:39], a[20:23], v[96:111]
v_mfma_f32_32x32x16_bf16 v[112:127], a[40:43], a[20:23], v[112:127]
v_mfma_f32_32x32x16_bf16 v[128:143], a[44:47], a[20:23], v[128:143]
s_waitcnt lgkmcnt(0)
s_waitcnt vmcnt(6)
s_barrier
v_mfma_f32_32x32x16_bf16 v[16:31], a[64:67], a[48:51], v[16:31]
ds_read_b128 a[16:19], v10
ds_read_b128 a[20:23], v10 offset:2048
ds_read_b64_tr_b16 a[32:33], v12
ds_read_b64_tr_b16 a[34:35], v12 offset:2048
v_mfma_f32_32x32x16_bf16 v[32:47], a[68:71], a[48:51], v[32:47]
ds_read_b64_tr_b16 a[36:37], v13
ds_read_b64_tr_b16 a[38:39], v13 offset:2048
ds_read_b64_tr_b16 a[40:41], v14
ds_read_b64_tr_b16 a[42:43], v14 offset:2048
v_mfma_f32_32x32x16_bf16 v[48:63], a[72:75], a[48:51], v[48:63]
ds_read_b64_tr_b16 a[44:45], v2
ds_read_b64_tr_b16 a[46:47], v2 offset:2048
s_add_u32 s32, s60, 768
s_add_u32 m0, s36, 0
s_nop 0
buffer_load_dwordx4 v1, s[52:55], s32 offen lds
v_mfma_f32_32x32x16_bf16 v[64:79], a[76:79], a[48:51], v[64:79]
s_add_u32 s32, s60, 74496
s_add_u32 m0, s36, 4096
s_nop 0
buffer_load_dwordx4 v1, s[52:55], s32 offen lds
s_add_u32 m0, s36, 16384
s_nop 0
buffer_load_dwordx4 v4, s[48:51], s61 offen lds
s_add_u32 s61, s61, s62
v_mfma_f32_32x32x16_bf16 v[80:95], a[64:67], a[52:55], v[80:95]
s_add_u32 m0, s36, 20480
s_nop 0
buffer_load_dwordx4 v4, s[48:51], s61 offen lds
s_add_u32 s61, s61, s62
s_add_u32 m0, s36, 24576
s_nop 0
buffer_load_dwordx4 v4, s[48:51], s61 offen lds
s_add_u32 s61, s61, s62
v_mfma_f32_32x32x16_bf16 v[96:111], a[68:71], a[52:55], v[96:111]
s_add_u32 m0, s36, 28672
s_nop 0
buffer_load_dwordx4 v4, s[48:51], s61 offen lds
s_add_u32 s61, s61, s62
v_mfma_f32_32x32x16_bf16 v[112:127], a[72:75], a[52:55], v[112:127]
v_mfma_f32_32x32x16_bf16 v[128:143], a[76:79], a[52:55], v[128:143]
s_waitcnt lgkmcnt(0)
v_mfma_f32_32x32x16_bf16 v[16:31], a[32:35], a[16:19], v[16:31]
ds_read_b128 a[48:51], v11
ds_read_b128 a[52:55], v11 offset:2048
v_mfma_f32_32x32x16_bf16 v[32:47], a[36:39], a[16:19], v[32:47]
ds_read_b64_tr_b16 a[64:65], v12 offset:8192
ds_read_b64_tr_b16 a[66:67], v12 offset:10240
v_mfma_f32_32x32x16_bf16 v[48:63], a[40:43], a[16:19], v[48:63]
ds_read_b64_tr_b16 a[68:69], v13 offset:8192
ds_read_b64_tr_b16 a[70:71], v13 offset:10240
v_mfma_f32_32x32x16_bf16 v[64:79], a[44:47], a[16:19], v[64:79]
ds_read_b64_tr_b16 a[72:73], v14 offset:8192
ds_read_b64_tr_b16 a[74:75], v14 offset:10240
v_mfma_f32_32x32x16_bf16 v[80:95], a[32:35], a[20:23], v[80:95]
ds_read_b64_tr_b16 a[76:77], v2 offset:8192
ds_read_b64_tr_b16 a[78:79], v2 offset:10240
v_mfma_f32_32x32x16_bf16 v[96:111], a[36:39], a[20:23], v[96:111]
v_mfma_f32_32x32x16_bf16 v[112:127], a[40:43], a[20:23], v[112:127]
v_mfma_f32_32x32x16_bf16 v[128:143], a[44:47], a[20:23], v[128:143]
s_waitcnt lgkmcnt(0)
s_waitcnt vmcnt(6)
s_barrier
v_mfma_f32_32x32x16_bf16 v[16:31], a[64:67], a[48:51], v[16:31]
ds_read_b128 a[16:19], v10 offset:32768
ds_read_b128 a[20:23], v10 offset:34816
ds_read_b64_tr_b16 a[32:33], v12 offset:32768
ds_read_b64_tr_b16 a[34:35], v12 offset:34816
v_mfma_f32_32x32x16_bf16 v[32:47], a[68:71], a[48:51], v[32:47]
ds_read_b64_tr_b16 a[36:37], v13 offset:32768
ds_read_b64_tr_b16 a[38:39], v13 offset:34816
ds_read_b64_tr_b16 a[40:41], v14 offset:32768
ds_read_b64_tr_b16 a[42:43], v14 offset:34816
v_mfma_f32_32x32x16_bf16 v[48:63], a[72:75], a[48:51], v[48:63]
ds_read_b64_tr_b16 a[44:45], v2 offset:32768
ds_read_b64_tr_b16 a[46:47], v2 offset:34816
s_add_u32 s32, s60, 832
s_add_u32 m0, s36, 32768
s_nop 0
buffer_load_dwordx4 v1, s[52:55], s32 offen lds
v_mfma_f32_32x32x16_bf16 v[64:79], a[76:79], a[48:51], v[64:79]
s_add_u32 s32, s60, 74560
s_add_u32 m0, s36, 36864
s_nop 0
buffer_load_dwordx4 v1, s[52:55], s32 offen lds
s_add_u32 m0, s36, 49152
s_nop 0
buffer_load_dwordx4 v4, s[48:51], s61 offen lds
s_add_u32 s61, s61, s62
v_mfma_f32_32x32x16_bf16 v[80:95], a[64:67], a[52:55], v[80:95]
s_add_u32 m0, s36, 53248
s_nop 0
buffer_load_dwordx4 v4, s[48:51], s61 offen lds
s_add_u32 s61, s61, s62
s_add_u32 m0, s36, 57344
s_nop 0
buffer_load_dwordx4 v4, s[48:51], s61 offen lds
s_add_u32 s61, s61, s62
v_mfma_f32_32x32x16_bf16 v[96:111], a[68:71], a[52:55], v[96:111]
s_add_u32 m0, s36, 61440
s_nop 0
buffer_load_dwordx4 v4, s[48:51], s61 offen lds
s_add_u32 s61, s61, s62
v_mfma_f32_32x32x16_bf16 v[112:127], a[72:75], a[52:55], v[112:127]
v_mfma_f32_32x32x16_bf16 v[128:143], a[76:79], a[52:55], v[128:143]
s_waitcnt lgkmcnt(0)
v_mfma_f32_32x32x16_bf16 v[16:31], a[32:35], a[16:19], v[16:31]
ds_read_b128 a[48:51], v11 offset:32768
ds_read_b128 a[52:55], v11 offset:34816
v_mfma_f32_32x32x16_bf16 v[32:47], a[36:39], a[16:19], v[32:47]
ds_read_b64_tr_b16 a[64:65], v12 offset:40960
ds_read_b64_tr_b16 a[66:67], v12 offset:43008
v_mfma_f32_32x32x16_bf16 v[48:63], a[40:43], a[16:19], v[48:63]
ds_read_b64_tr_b16 a[68:69], v13 offset:40960
ds_read_b64_tr_b16 a[70:71], v13 offset:43008
v_mfma_f32_32x32x16_bf16 v[64:79], a[44:47], a[16:19], v[64:79]
ds_read_b64_tr_b16 a[72:73], v14 offset:40960
ds_read_b64_tr_b16 a[74:75], v14 offset:43008
v_mfma_f32_32x32x16_bf16 v[80:95], a[32:35], a[20:23], v[80:95]
ds_read_b64_tr_b16 a[76:77], v2 offset:40960
ds_read_b64_tr_b16 a[78:79], v2 offset:43008
v_mfma_f32_32x32x16_bf16 v[96:111], a[36:39], a[20:23], v[96:111]
v_mfma_f32_32x32x16_bf16 v[112:127], a[40:43], a[20:23], v[112:127]
v_mfma_f32_32x32x16_bf16 v[128:143], a[44:47], a[20:23], v[128:143]
s_waitcnt lgkmcnt(0)
s_waitcnt vmcnt(6)
s_barrier
v_mfma_f32_32x32x16_bf16 v[16:31], a[64:67], a[48:51], v[16:31]
ds_read_b128 a[16:19], v5
ds_read_b128 a[20:23], v5 offset:2048
ds_read_b64_tr_b16 a[32:33], v6
ds_read_b64_tr_b16 a[34:35], v6 offset:2048
v_mfma_f32_32x32x16_bf16 v[32:47], a[68:71], a[48:51], v[32:47]
ds_read_b64_tr_b16 a[36:37], v7
ds_read_b64_tr_b16 a[38:39], v7 offset:2048
ds_read_b64_tr_b16 a[40:41], v9
ds_read_b64_tr_b16 a[42:43], v9 offset:2048
v_mfma_f32_32x32x16_bf16 v[48:63], a[72:75], a[48:51], v[48:63]
ds_read_b64_tr_b16 a[44:45], v15
ds_read_b64_tr_b16 a[46:47], v15 offset:2048
s_add_u32 s32, s60, 896
s_add_u32 m0, s36, 65536
s_nop 0
buffer_load_dwordx4 v1, s[52:55], s32 offen lds
v_mfma_f32_32x32x16_bf16 v[64:79], a[76:79], a[48:51], v[64:79]
s_add_u32 s32, s60, 74624
s_add_u32 m0, s36, 69632
s_nop 0
buffer_load_dwordx4 v1, s[52:55], s32 offen lds
s_add_u32 m0, s36, 81920
s_nop 0
buffer_load_dwordx4 v4, s[48:51], s61 offen lds
s_add_u32 s61, s61, s62
v_mfma_f32_32x32x16_bf16 v[80:95], a[64:67], a[52:55], v[80:95]
s_add_u32 m0, s36, 86016
s_nop 0
buffer_load_dwordx4 v4, s[48:51], s61 offen lds
s_add_u32 s61, s61, s62
s_add_u32 m0, s36, 90112
s_nop 0
buffer_load_dwordx4 v4, s[48:51], s61 offen lds
s_add_u32 s61, s61, s62
v_mfma_f32_32x32x16_bf16 v[96:111], a[68:71], a[52:55], v[96:111]
s_add_u32 m0, s36, 94208
s_nop 0
buffer_load_dwordx4 v4, s[48:51], s61 offen lds
s_add_u32 s61, s61, s62
v_mfma_f32_32x32x16_bf16 v[112:127], a[72:75], a[52:55], v[112:127]
v_mfma_f32_32x32x16_bf16 v[128:143], a[76:79], a[52:55], v[128:143]
s_waitcnt lgkmcnt(0)
v_mfma_f32_32x32x16_bf16 v[16:31], a[32:35], a[16:19], v[16:31]
ds_read_b128 a[48:51], v8
ds_read_b128 a[52:55], v8 offset:2048
v_mfma_f32_32x32x16_bf16 v[32:47], a[36:39], a[16:19], v[32:47]
ds_read_b64_tr_b16 a[64:65], v6 offset:8192
ds_read_b64_tr_b16 a[66:67], v6 offset:10240
v_mfma_f32_32x32x16_bf16 v[48:63], a[40:43], a[16:19], v[48:63]
ds_read_b64_tr_b16 a[68:69], v7 offset:8192
ds_read_b64_tr_b16 a[70:71], v7 offset:10240
v_mfma_f32_32x32x16_bf16 v[64:79], a[44:47], a[16:19], v[64:79]
ds_read_b64_tr_b16 a[72:73], v9 offset:8192
ds_read_b64_tr_b16 a[74:75], v9 offset:10240
v_mfma_f32_32x32x16_bf16 v[80:95], a[32:35], a[20:23], v[80:95]
ds_read_b64_tr_b16 a[76:77], v15 offset:8192
ds_read_b64_tr_b16 a[78:79], v15 offset:10240
v_mfma_f32_32x32x16_bf16 v[96:111], a[36:39], a[20:23], v[96:111]
v_mfma_f32_32x32x16_bf16 v[112:127], a[40:43], a[20:23], v[112:127]
v_mfma_f32_32x32x16_bf16 v[128:143], a[44:47], a[20:23], v[128:143]
s_waitcnt lgkmcnt(0)
s_waitcnt vmcnt(6)
s_barrier
v_mfma_f32_32x32x16_bf16 v[16:31], a[64:67], a[48:51], v[16:31]
ds_read_b128 a[16:19], v5 offset:32768
ds_read_b128 a[20:23], v5 offset:34816
ds_read_b64_tr_b16 a[32:33], v6 offset:32768
ds_read_b64_tr_b16 a[34:35], v6 offset:34816
v_mfma_f32_32x32x16_bf16 v[32:47], a[68:71], a[48:51], v[32:47]
ds_read_b64_tr_b16 a[36:37], v7 offset:32768
ds_read_b64_tr_b16 a[38:39], v7 offset:34816
ds_read_b64_tr_b16 a[40:41], v9 offset:32768
ds_read_b64_tr_b16 a[42:43], v9 offset:34816
v_mfma_f32_32x32x16_bf16 v[48:63], a[72:75], a[48:51], v[48:63]
ds_read_b64_tr_b16 a[44:45], v15 offset:32768
ds_read_b64_tr_b16 a[46:47], v15 offset:34816
s_add_u32 s32, s60, 960
s_add_u32 m0, s36, 98304
s_nop 0
buffer_load_dwordx4 v1, s[52:55], s32 offen lds
v_mfma_f32_32x32x16_bf16 v[64:79], a[76:79], a[48:51], v[64:79]
s_add_u32 s32, s60, 74688
s_add_u32 m0, s36, 102400
s_nop 0
buffer_load_dwordx4 v1, s[52:55], s32 offen lds
s_add_u32 m0, s36, 114688
s_nop 0
buffer_load_dwordx4 v4, s[48:51], s61 offen lds
s_add_u32 s61, s61, s62
v_mfma_f32_32x32x16_bf16 v[80:95], a[64:67], a[52:55], v[80:95]
s_add_u32 m0, s36, 118784
s_nop 0
buffer_load_dwordx4 v4, s[48:51], s61 offen lds
s_add_u32 s61, s61, s62
s_add_u32 m0, s36, 122880
s_nop 0
buffer_load_dwordx4 v4, s[48:51], s61 offen lds
s_add_u32 s61, s61, s62
v_mfma_f32_32x32x16_bf16 v[96:111], a[68:71], a[52:55], v[96:111]
s_add_u32 m0, s36, 126976
s_nop 0
buffer_load_dwordx4 v4, s[48:51], s61 offen lds
s_add_u32 s61, s61, s62
v_mfma_f32_32x32x16_bf16 v[112:127], a[72:75], a[52:55], v[112:127]
v_mfma_f32_32x32x16_bf16 v[128:143], a[76:79], a[52:55], v[128:143]
s_waitcnt lgkmcnt(0)
v_mfma_f32_32x32x16_bf16 v[16:31], a[32:35], a[16:19], v[16:31]
ds_read_b128 a[48:51], v8 offset:32768
ds_read_b128 a[52:55], v8 offset:34816
v_mfma_f32_32x32x16_bf16 v[32:47], a[36:39], a[16:19], v[32:47]
ds_read_b64_tr_b16 a[64:65], v6 offset:40960
ds_read_b64_tr_b16 a[66:67], v6 offset:43008
v_mfma_f32_32x32x16_bf16 v[48:63], a[40:43], a[16:19], v[48:63]
ds_read_b64_tr_b16 a[68:69], v7 offset:40960
ds_read_b64_tr_b16 a[70:71], v7 offset:43008
v_mfma_f32_32x32x16_bf16 v[64:79], a[44:47], a[16:19], v[64:79]
ds_read_b64_tr_b16 a[72:73], v9 offset:40960
ds_read_b64_tr_b16 a[74:75], v9 offset:43008
v_mfma_f32_32x32x16_bf16 v[80:95], a[32:35], a[20:23], v[80:95]
ds_read_b64_tr_b16 a[76:77], v15 offset:40960
ds_read_b64_tr_b16 a[78:79], v15 offset:43008
v_mfma_f32_32x32x16_bf16 v[96:111], a[36:39], a[20:23], v[96:111]
v_mfma_f32_32x32x16_bf16 v[112:127], a[40:43], a[20:23], v[112:127]
v_mfma_f32_32x32x16_bf16 v[128:143], a[44:47], a[20:23], v[128:143]
s_waitcnt lgkmcnt(0)
s_waitcnt vmcnt(6)
s_barrier
v_mfma_f32_32x32x16_bf16 v[16:31], a[64:67], a[48:51], v[16:31]
ds_read_b128 a[16:19], v10
ds_read_b128 a[20:23], v10 offset:2048
ds_read_b64_tr_b16 a[32:33], v12
ds_read_b64_tr_b16 a[34:35], v12 offset:2048
v_mfma_f32_32x32x16_bf16 v[32:47], a[68:71], a[48:51], v[32:47]
ds_read_b64_tr_b16 a[36:37], v13
ds_read_b64_tr_b16 a[38:39], v13 offset:2048
ds_read_b64_tr_b16 a[40:41], v14
ds_read_b64_tr_b16 a[42:43], v14 offset:2048
v_mfma_f32_32x32x16_bf16 v[48:63], a[72:75], a[48:51], v[48:63]
ds_read_b64_tr_b16 a[44:45], v2
ds_read_b64_tr_b16 a[46:47], v2 offset:2048
s_add_u32 s32, s60, 1024
s_add_u32 m0, s36, 0
s_nop 0
buffer_load_dwordx4 v1, s[52:55], s32 offen lds
v_mfma_f32_32x32x16_bf16 v[64:79], a[76:79], a[48:51], v[64:79]
s_add_u32 s32, s60, 74752
s_add_u32 m0, s36, 4096
s_nop 0
buffer_load_dwordx4 v1, s[52:55], s32 offen lds
s_add_u32 m0, s36, 16384
s_nop 0
buffer_load_dwordx4 v4, s[48:51], s61 offen lds
s_add_u32 s61, s61, s62
v_mfma_f32_32x32x16_bf16 v[80:95], a[64:67], a[52:55], v[80:95]
s_add_u32 m0, s36, 20480
s_nop 0
buffer_load_dwordx4 v4, s[48:51], s61 offen lds
s_add_u32 s61, s61, s62
s_add_u32 m0, s36, 24576
s_nop 0
buffer_load_dwordx4 v4, s[48:51], s61 offen lds
s_add_u32 s61, s61, s62
v_mfma_f32_32x32x16_bf16 v[96:111], a[68:71], a[52:55], v[96:111]
s_add_u32 m0, s36, 28672
s_nop 0
buffer_load_dwordx4 v4, s[48:51], s61 offen lds
s_add_u32 s61, s61, s62
v_mfma_f32_32x32x16_bf16 v[112:127], a[72:75], a[52:55], v[112:127]
v_mfma_f32_32x32x16_bf16 v[128:143], a[76:79], a[52:55], v[128:143]
s_waitcnt lgkmcnt(0)
v_mfma_f32_32x32x16_bf16 v[16:31], a[32:35], a[16:19], v[16:31]
ds_read_b128 a[48:51], v11
ds_read_b128 a[52:55], v11 offset:2048
v_mfma_f32_32x32x16_bf16 v[32:47], a[36:39], a[16:19], v[32:47]
ds_read_b64_tr_b16 a[64:65], v12 offset:8192
ds_read_b64_tr_b16 a[66:67], v12 offset:10240
v_mfma_f32_32x32x16_bf16 v[48:63], a[40:43], a[16:19], v[48:63]
ds_read_b64_tr_b16 a[68:69], v13 offset:8192
ds_read_b64_tr_b16 a[70:71], v13 offset:10240
v_mfma_f32_32x32x16_bf16 v[64:79], a[44:47], a[16:19], v[64:79]
ds_read_b64_tr_b16 a[72:73], v14 offset:8192
ds_read_b64_tr_b16 a[74:75], v14 offset:10240
v_mfma_f32_32x32x16_bf16 v[80:95], a[32:35], a[20:23], v[80:95]
ds_read_b64_tr_b16 a[76:77], v2 offset:8192
ds_read_b64_tr_b16 a[78:79], v2 offset:10240
v_mfma_f32_32x32x16_bf16 v[96:111], a[36:39], a[20:23], v[96:111]
v_mfma_f32_32x32x16_bf16 v[112:127], a[40:43], a[20:23], v[112:127]
v_mfma_f32_32x32x16_bf16 v[128:143], a[44:47], a[20:23], v[128:143]
s_waitcnt lgkmcnt(0)
s_waitcnt vmcnt(6)
s_barrier
v_mfma_f32_32x32x16_bf16 v[16:31], a[64:67], a[48:51], v[16:31]
ds_read_b128 a[16:19], v10 offset:32768
ds_read_b128 a[20:23], v10 offset:34816
ds_read_b64_tr_b16 a[32:33], v12 offset:32768
ds_read_b64_tr_b16 a[34:35], v12 offset:34816
v_mfma_f32_32x32x16_bf16 v[32:47], a[68:71], a[48:51], v[32:47]
ds_read_b64_tr_b16 a[36:37], v13 offset:32768
ds_read_b64_tr_b16 a[38:39], v13 offset:34816
ds_read_b64_tr_b16 a[40:41], v14 offset:32768
ds_read_b64_tr_b16 a[42:43], v14 offset:34816
v_mfma_f32_32x32x16_bf16 v[48:63], a[72:75], a[48:51], v[48:63]
ds_read_b64_tr_b16 a[44:45], v2 offset:32768
ds_read_b64_tr_b16 a[46:47], v2 offset:34816
s_add_u32 s32, s60, 1088
s_add_u32 m0, s36, 32768
s_nop 0
buffer_load_dwordx4 v1, s[52:55], s32 offen lds
v_mfma_f32_32x32x16_bf16 v[64:79], a[76:79], a[48:51], v[64:79]
s_add_u32 s32, s60, 74816
s_add_u32 m0, s36, 36864
s_nop 0
buffer_load_dwordx4 v1, s[52:55], s32 offen lds
s_add_u32 m0, s36, 49152
s_nop 0
buffer_load_dwordx4 v4, s[48:51], s61 offen lds
s_add_u32 s61, s61, s62
v_mfma_f32_32x32x16_bf16 v[80:95], a[64:67], a[52:55], v[80:95]
s_add_u32 m0, s36, 53248
s_nop 0
buffer_load_dwordx4 v4, s[48:51], s61 offen lds
s_add_u32 s61, s61, s62
s_add_u32 m0, s36, 57344
s_nop 0
buffer_load_dwordx4 v4, s[48:51], s61 offen lds
s_add_u32 s61, s61, s62
v_mfma_f32_32x32x16_bf16 v[96:111], a[68:71], a[52:55], v[96:111]
s_add_u32 m0, s36, 61440
s_nop 0
buffer_load_dwordx4 v4, s[48:51], s61 offen lds
s_add_u32 s61, s61, s62
v_mfma_f32_32x32x16_bf16 v[112:127], a[72:75], a[52:55], v[112:127]
v_mfma_f32_32x32x16_bf16 v[128:143], a[76:79], a[52:55], v[128:143]
s_waitcnt lgkmcnt(0)
v_mfma_f32_32x32x16_bf16 v[16:31], a[32:35], a[16:19], v[16:31]
ds_read_b128 a[48:51], v11 offset:32768
ds_read_b128 a[52:55], v11 offset:34816
v_mfma_f32_32x32x16_bf16 v[32:47], a[36:39], a[16:19], v[32:47]
ds_read_b64_tr_b16 a[64:65], v12 offset:40960
ds_read_b64_tr_b16 a[66:67], v12 offset:43008
v_mfma_f32_32x32x16_bf16 v[48:63], a[40:43], a[16:19], v[48:63]
ds_read_b64_tr_b16 a[68:69], v13 offset:40960
ds_read_b64_tr_b16 a[70:71], v13 offset:43008
v_mfma_f32_32x32x16_bf16 v[64:79], a[44:47], a[16:19], v[64:79]
ds_read_b64_tr_b16 a[72:73], v14 offset:40960
ds_read_b64_tr_b16 a[74:75], v14 offset:43008
v_mfma_f32_32x32x16_bf16 v[80:95], a[32:35], a[20:23], v[80:95]
ds_read_b64_tr_b16 a[76:77], v2 offset:40960
ds_read_b64_tr_b16 a[78:79], v2 offset:43008
v_mfma_f32_32x32x16_bf16 v[96:111], a[36:39], a[20:23], v[96:111]
v_mfma_f32_32x32x16_bf16 v[112:127], a[40:43], a[20:23], v[112:127]
v_mfma_f32_32x32x16_bf16 v[128:143], a[44:47], a[20:23], v[128:143]
s_waitcnt lgkmcnt(0)
s_waitcnt vmcnt(6)
s_barrier
v_mfma_f32_32x32x16_bf16 v[16:31], a[64:67], a[48:51], v[16:31]
ds_read_b128 a[16:19], v5
ds_read_b128 a[20:23], v5 offset:2048
v_mfma_f32_32x32x16_bf16 v[32:47], a[68:71], a[48:51], v[32:47]
ds_read_b64_tr_b16 a[32:33], v6
ds_read_b64_tr_b16 a[34:35], v6 offset:2048
v_mfma_f32_32x32x16_bf16 v[48:63], a[72:75], a[48:51], v[48:63]
ds_read_b64_tr_b16 a[36:37], v7
ds_read_b64_tr_b16 a[38:39], v7 offset:2048
v_mfma_f32_32x32x16_bf16 v[64:79], a[76:79], a[48:51], v[64:79]
ds_read_b64_tr_b16 a[40:41], v9
ds_read_b64_tr_b16 a[42:43], v9 offset:2048
v_mfma_f32_32x32x16_bf16 v[80:95], a[64:67], a[52:55], v[80:95]
ds_read_b64_tr_b16 a[44:45], v15
ds_read_b64_tr_b16 a[46:47], v15 offset:2048
v_mfma_f32_32x32x16_bf16 v[96:111], a[68:71], a[52:55], v[96:111]
v_mfma_f32_32x32x16_bf16 v[112:127], a[72:75], a[52:55], v[112:127]
v_mfma_f32_32x32x16_bf16 v[128:143], a[76:79], a[52:55], v[128:143]
s_waitcnt lgkmcnt(0)
v_mfma_f32_32x32x16_bf16 v[16:31], a[32:35], a[16:19], v[16:31]
ds_read_b128 a[48:51], v8
ds_read_b128 a[52:55], v8 offset:2048
v_mfma_f32_32x32x16_bf16 v[32:47], a[36:39], a[16:19], v[32:47]
ds_read_b64_tr_b16 a[64:65], v6 offset:8192
ds_read_b64_tr_b16 a[66:67], v6 offset:10240
v_mfma_f32_32x32x16_bf16 v[48:63], a[40:43], a[16:19], v[48:63]
ds_read_b64_tr_b16 a[68:69], v7 offset:8192
ds_read_b64_tr_b16 a[70:71], v7 offset:10240
v_mfma_f32_32x32x16_bf16 v[64:79], a[44:47], a[16:19], v[64:79]
ds_read_b64_tr_b16 a[72:73], v9 offset:8192
ds_read_b64_tr_b16 a[74:75], v9 offset:10240
v_mfma_f32_32x32x16_bf16 v[80:95], a[32:35], a[20:23], v[80:95]
ds_read_b64_tr_b16 a[76:77], v15 offset:8192
ds_read_b64_tr_b16 a[78:79], v15 offset:10240
v_mfma_f32_32x32x16_bf16 v[96:111], a[36:39], a[20:23], v[96:111]
v_mfma_f32_32x32x16_bf16 v[112:127], a[40:43], a[20:23], v[112:127]
v_mfma_f32_32x32x16_bf16 v[128:143], a[44:47], a[20:23], v[128:143]
s_waitcnt lgkmcnt(0)
s_waitcnt vmcnt(0)
s_barrier
v_mfma_f32_32x32x16_bf16 v[16:31], a[64:67], a[48:51], v[16:31]
ds_read_b128 a[16:19], v5 offset:32768
ds_read_b128 a[20:23], v5 offset:34816
v_mfma_f32_32x32x16_bf16 v[32:47], a[68:71], a[48:51], v[32:47]
ds_read_b64_tr_b16 a[32:33], v6 offset:32768
ds_read_b64_tr_b16 a[34:35], v6 offset:34816
v_mfma_f32_32x32x16_bf16 v[48:63], a[72:75], a[48:51], v[48:63]
ds_read_b64_tr_b16 a[36:37], v7 offset:32768
ds_read_b64_tr_b16 a[38:39], v7 offset:34816
v_mfma_f32_32x32x16_bf16 v[64:79], a[76:79], a[48:51], v[64:79]
ds_read_b64_tr_b16 a[40:41], v9 offset:32768
ds_read_b64_tr_b16 a[42:43], v9 offset:34816
v_mfma_f32_32x32x16_bf16 v[80:95], a[64:67], a[52:55], v[80:95]
ds_read_b64_tr_b16 a[44:45], v15 offset:32768
ds_read_b64_tr_b16 a[46:47], v15 offset:34816
v_mfma_f32_32x32x16_bf16 v[96:111], a[68:71], a[52:55], v[96:111]
v_mfma_f32_32x32x16_bf16 v[112:127], a[72:75], a[52:55], v[112:127]
v_mfma_f32_32x32x16_bf16 v[128:143], a[76:79], a[52:55], v[128:143]
s_waitcnt lgkmcnt(0)
v_mfma_f32_32x32x16_bf16 v[16:31], a[32:35], a[16:19], v[16:31]
ds_read_b128 a[48:51], v8 offset:32768
ds_read_b128 a[52:55], v8 offset:34816
v_mfma_f32_32x32x16_bf16 v[32:47], a[36:39], a[16:19], v[32:47]
ds_read_b64_tr_b16 a[64:65], v6 offset:40960
ds_read_b64_tr_b16 a[66:67], v6 offset:43008
v_mfma_f32_32x32x16_bf16 v[48:63], a[40:43], a[16:19], v[48:63]
ds_read_b64_tr_b16 a[68:69], v7 offset:40960
ds_read_b64_tr_b16 a[70:71], v7 offset:43008
v_mfma_f32_32x32x16_bf16 v[64:79], a[44:47], a[16:19], v[64:79]
ds_read_b64_tr_b16 a[72:73], v9 offset:40960
ds_read_b64_tr_b16 a[74:75], v9 offset:43008
v_mfma_f32_32x32x16_bf16 v[80:95], a[32:35], a[20:23], v[80:95]
ds_read_b64_tr_b16 a[76:77], v15 offset:40960
ds_read_b64_tr_b16 a[78:79], v15 offset:43008
v_mfma_f32_32x32x16_bf16 v[96:111], a[36:39], a[20:23], v[96:111]
v_mfma_f32_32x32x16_bf16 v[112:127], a[40:43], a[20:23], v[112:127]
v_mfma_f32_32x32x16_bf16 v[128:143], a[44:47], a[20:23], v[128:143]
s_waitcnt lgkmcnt(0)
v_mfma_f32_32x32x16_bf16 v[16:31], a[64:67], a[48:51], v[16:31]
v_mfma_f32_32x32x16_bf16 v[32:47], a[68:71], a[48:51], v[32:47]
v_mfma_f32_32x32x16_bf16 v[48:63], a[72:75], a[48:51], v[48:63]
v_mfma_f32_32x32x16_bf16 v[64:79], a[76:79], a[48:51], v[64:79]
v_mfma_f32_32x32x16_bf16 v[80:95], a[64:67], a[52:55], v[80:95]
v_mfma_f32_32x32x16_bf16 v[96:111], a[68:71], a[52:55], v[96:111]
v_mfma_f32_32x32x16_bf16 v[112:127], a[72:75], a[52:55], v[112:127]
v_mfma_f32_32x32x16_bf16 v[128:143], a[76:79], a[52:55], v[128:143]
s_branch GE_16
GZ_18:
s_waitcnt vmcnt(7)
s_barrier
ds_read_b128 a[16:19], v5
ds_read_b128 a[20:23], v5 offset:2048
ds_read_b64_tr_b16 a[32:33], v6
ds_read_b64_tr_b16 a[34:35], v6 offset:2048
ds_read_b64_tr_b16 a[36:37], v7
ds_read_b64_tr_b16 a[38:39], v7 offset:2048
ds_read_b64_tr_b16 a[40:41], v9
ds_read_b64_tr_b16 a[42:43], v9 offset:2048
ds_read_b64_tr_b16 a[44:45], v15
ds_read_b64_tr_b16 a[46:47], v15 offset:2048
s_add_u32 s32, s60, 128
s_add_u32 m0, s36, 65536
s_nop 0
buffer_load_dwordx4 v1, s[52:55], s32 offen lds
s_add_u32 s32, s60, 73856
s_add_u32 m0, s36, 69632
s_nop 0
buffer_load_dwordx4 v1, s[52:55], s32 offen lds
s_add_u32 m0, s36, 81920
s_nop 0
buffer_load_dwordx4 v4, s[48:51], s61 offen lds
s_add_u32 s61, s61, s62
s_add_u32 m0, s36, 86016
s_nop 0
buffer_load_dwordx4 v4, s[48:51], s61 offen lds
s_add_u32 s61, s61, s62
s_add_u32 m0, s36, 90112
s_nop 0
buffer_load_dwordx4 v4, s[48:51], s61 offen lds
s_add_u32 s61, s61, s62
s_add_u32 m0, s36, 94208
s_nop 0
buffer_load_dwordx4 v4, s[48:51], s61 offen lds
s_add_u32 s61, s61, s62
s_waitcnt lgkmcnt(0)
v_mfma_f32_32x32x16_bf16 v[16:31], a[16:19], a[32:35], 0
ds_read_b128 a[48:51], v8
ds_read_b128 a[52:55], v8 offset:2048
v_mfma_f32_32x32x16_bf16 v[32:47], a[16:19], a[36:39], 0
ds_read_b64_tr_b16 a[64:65], v6 offset:8192
ds_read_b64_tr_b16 a[66:67], v6 offset:10240
v_mfma_f32_32x32x16_bf16 v[48:63], a[16:19], a[40:43], 0
ds_read_b64_tr_b16 a[68:69], v7 offset:8192
ds_read_b64_tr_b16 a[70:71], v7 offset:10240
v_mfma_f32_32x32x16_bf16 v[64:79], a[16:19], a[44:47], 0
ds_read_b64_tr_b16 a[72:73], v9 offset:8192
ds_read_b64_tr_b16 a[74:75], v9 offset:10240
v_mfma_f32_32x32x16_bf16 v[80:95], a[20:23], a[32:35], 0
ds_read_b64_tr_b16 a[76:77], v15 offset:8192
ds_read_b64_tr_b16 a[78:79], v15 offset:10240
v_mfma_f32_32x32x16_bf16 v[96:111], a[20:23], a[36:39], 0
v_mfma_f32_32x32x16_bf16 v[112:127], a[20:23], a[40:43], 0
v_mfma_f32_32x32x16_bf16 v[128:143], a[20:23], a[44:47], 0
s_waitcnt lgkmcnt(0)
s_waitcnt vmcnt(7)
s_barrier
v_mfma_f32_32x32x16_bf16 v[16:31], a[48:51], a[64:67], v[16:31]
ds_read_b128 a[16:19], v5 offset:32768
ds_read_b128 a[20:23], v5 offset:34816
ds_read_b64_tr_b16 a[32:33], v6 offset:32768
ds_read_b64_tr_b16 a[34:35], v6 offset:34816
v_mfma_f32_32x32x16_bf16 v[32:47], a[48:51], a[68:71], v[32:47]
ds_read_b64_tr_b16 a[36:37], v7 offset:32768
ds_read_b64_tr_b16 a[38:39], v7 offset:34816
ds_read_b64_tr_b16 a[40:41], v9 offset:32768
ds_read_b64_tr_b16 a[42:43], v9 offset:34816
v_mfma_f32_32x32x16_bf16 v[48:63], a[48:51], a[72:75], v[48:63]
ds_read_b64_tr_b16 a[44:45], v15 offset:32768
ds_read_b64_tr_b16 a[46:47], v15 offset:34816
s_add_u32 s32, s60, 192
s_add_u32 m0, s36, 98304
s_nop 0
buffer_load_dwordx4 v1, s[52:55], s32 offen lds
v_mfma_f32_32x32x16_bf16 v[64:79], a[48:51], a[76:79], v[64:79]
s_add_u32 s32, s60, 73920
s_add_u32 m0, s36, 102400
s_nop 0
buffer_load_dwordx4 v1, s[52:55], s32 offen lds
s_add_u32 m0, s36, 114688
s_nop 0
buffer_load_dwordx4 v4, s[48:51], s61 offen lds
s_add_u32 s61, s61, s62
v_mfma_f32_32x32x16_bf16 v[80:95], a[52:55], a[64:67], v[80:95]
s_add_u32 m0, s36, 118784
s_nop 0
buffer_load_dwordx4 v4, s[48:51], s61 offen lds
s_add_u32 s61, s61, s62
s_add_u32 m0, s36, 122880
s_nop 0
buffer_load_dwordx4 v4, s[48:51], s61 offen lds
s_add_u32 s61, s61, s62
v_mfma_f32_32x32x16_bf16 v[96:111], a[52:55], a[68:71], v[96:111]
s_add_u32 m0, s36, 126976
s_nop 0
buffer_load_dwordx4 v4, s[48:51], s61 offen lds
s_add_u32 s61, s61, s62
v_mfma_f32_32x32x16_bf16 v[112:127], a[52:55], a[72:75], v[112:127]
v_mfma_f32_32x32x16_bf16 v[128:143], a[52:55], a[76:79], v[128:143]
s_waitcnt lgkmcnt(0)
v_mfma_f32_32x32x16_bf16 v[16:31], a[16:19], a[32:35], v[16:31]
ds_read_b128 a[48:51], v8 offset:32768
ds_read_b128 a[52:55], v8 offset:34816
v_mfma_f32_32x32x16_bf16 v[32:47], a[16:19], a[36:39], v[32:47]
ds_read_b64_tr_b16 a[64:65], v6 offset:40960
ds_read_b64_tr_b16 a[66:67], v6 offset:43008
v_mfma_f32_32x32x16_bf16 v[48:63], a[16:19], a[40:43], v[48:63]
ds_read_b64_tr_b16 a[68:69], v7 offset:40960
ds_read_b64_tr_b16 a[70:71], v7 offset:43008
v_mfma_f32_32x32x16_bf16 v[64:79], a[16:19], a[44:47], v[64:79]
ds_read_b64_tr_b16 a[72:73], v9 offset:40960
ds_read_b64_tr_b16 a[74:75], v9 offset:43008
v_mfma_f32_32x32x16_bf16 v[80:95], a[20:23], a[32:35], v[80:95]
ds_read_b64_tr_b16 a[76:77], v15 offset:40960
ds_read_b64_tr_b16 a[78:79], v15 offset:43008
v_mfma_f32_32x32x16_bf16 v[96:111], a[20:23], a[36:39], v[96:111]
v_mfma_f32_32x32x16_bf16 v[112:127], a[20:23], a[40:43], v[112:127]
v_mfma_f32_32x32x16_bf16 v[128:143], a[20:23], a[44:47], v[128:143]
s_waitcnt lgkmcnt(0)
s_waitcnt vmcnt(6)
s_barrier
v_mfma_f32_32x32x16_bf16 v[16:31], a[48:51], a[64:67], v[16:31]
ds_read_b128 a[16:19], v10
ds_read_b128 a[20:23], v10 offset:2048
ds_read_b64_tr_b16 a[32:33], v12
ds_read_b64_tr_b16 a[34:35], v12 offset:2048
v_mfma_f32_32x32x16_bf16 v[32:47], a[48:51], a[68:71], v[32:47]
ds_read_b64_tr_b16 a[36:37], v13
ds_read_b64_tr_b16 a[38:39], v13 offset:2048
ds_read_b64_tr_b16 a[40:41], v14
ds_read_b64_tr_b16 a[42:43], v14 offset:2048
v_mfma_f32_32x32x16_bf16 v[48:63], a[48:51], a[72:75], v[48:63]
ds_read_b64_tr_b16 a[44:45], v2
ds_read_b64_tr_b16 a[46:47], v2 offset:2048
s_add_u32 s32, s60, 256
s_add_u32 m0, s36, 0
s_nop 0
buffer_load_dwordx4 v1, s[52:55], s32 offen lds
v_mfma_f32_32x32x16_bf16 v[64:79], a[48:51], a[76:79], v[64:79]
s_add_u32 s32, s60, 73984
s_add_u32 m0, s36, 4096
s_nop 0
buffer_load_dwordx4 v1, s[52:55], s32 offen lds
s_add_u32 m0, s36, 16384
s_nop 0
buffer_load_dwordx4 v4, s[48:51], s61 offen lds
s_add_u32 s61, s61, s62
v_mfma_f32_32x32x16_bf16 v[80:95], a[52:55], a[64:67], v[80:95]
s_add_u32 m0, s36, 20480
s_nop 0
buffer_load_dwordx4 v4, s[48:51], s61 offen lds
s_add_u32 s61, s61, s62
s_add_u32 m0, s36, 24576
s_nop 0
buffer_load_dwordx4 v4, s[48:51], s61 offen lds
s_add_u32 s61, s61, s62
v_mfma_f32_32x32x16_bf16 v[96:111], a[52:55], a[68:71], v[96:111]
s_add_u32 m0, s36, 28672
s_nop 0
buffer_load_dwordx4 v4, s[48:51], s61 offen lds
s_add_u32 s61, s61, s62
v_mfma_f32_32x32x16_bf16 v[112:127], a[52:55], a[72:75], v[112:127]
v_mfma_f32_32x32x16_bf16 v[128:143], a[52:55], a[76:79], v[128:143]
s_waitcnt lgkmcnt(0)
v_mfma_f32_32x32x16_bf16 v[16:31], a[16:19], a[32:35], v[16:31]
ds_read_b128 a[48:51], v11
ds_read_b128 a[52:55], v11 offset:2048
v_mfma_f32_32x32x16_bf16 v[32:47], a[16:19], a[36:39], v[32:47]
ds_read_b64_tr_b16 a[64:65], v12 offset:8192
ds_read_b64_tr_b16 a[66:67], v12 offset:10240
v_mfma_f32_32x32x16_bf16 v[48:63], a[16:19], a[40:43], v[48:63]
ds_read_b64_tr_b16 a[68:69], v13 offset:8192
ds_read_b64_tr_b16 a[70:71], v13 offset:10240
v_mfma_f32_32x32x16_bf16 v[64:79], a[16:19], a[44:47], v[64:79]
ds_read_b64_tr_b16 a[72:73], v14 offset:8192
ds_read_b64_tr_b16 a[74:75], v14 offset:10240
v_mfma_f32_32x32x16_bf16 v[80:95], a[20:23], a[32:35], v[80:95]
ds_read_b64_tr_b16 a[76:77], v2 offset:8192
ds_read_b64_tr_b16 a[78:79], v2 offset:10240
v_mfma_f32_32x32x16_bf16 v[96:111], a[20:23], a[36:39], v[96:111]
v_mfma_f32_32x32x16_bf16 v[112:127], a[20:23], a[40:43], v[112:127]
v_mfma_f32_32x32x16_bf16 v[128:143], a[20:23], a[44:47], v[128:143]
s_waitcnt lgkmcnt(0)
s_waitcnt vmcnt(6)
s_barrier
v_mfma_f32_32x32x16_bf16 v[16:31], a[48:51], a[64:67], v[16:31]
ds_read_b128 a[16:19], v10 offset:32768
ds_read_b128 a[20:23], v10 offset:34816
ds_read_b64_tr_b16 a[32:33], v12 offset:32768
ds_read_b64_tr_b16 a[34:35], v12 offset:34816
v_mfma_f32_32x32x16_bf16 v[32:47], a[48:51], a[68:71], v[32:47]
ds_read_b64_tr_b16 a[36:37], v13 offset:32768
ds_read_b64_tr_b16 a[38:39], v13 offset:34816
ds_read_b64_tr_b16 a[40:41], v14 offset:32768
ds_read_b64_tr_b16 a[42:43], v14 offset:34816
v_mfma_f32_32x32x16_bf16 v[48:63], a[48:51], a[72:75], v[48:63]
ds_read_b64_tr_b16 a[44:45], v2 offset:32768
ds_read_b64_tr_b16 a[46:47], v2 offset:34816
s_add_u32 s32, s60, 320
s_add_u32 m0, s36, 32768
s_nop 0
buffer_load_dwordx4 v1, s[52:55], s32 offen lds
v_mfma_f32_32x32x16_bf16 v[64:79], a[48:51], a[76:79], v[64:79]
s_add_u32 s32, s60, 74048
s_add_u32 m0, s36, 36864
s_nop 0
buffer_load_dwordx4 v1, s[52:55], s32 offen lds
s_add_u32 m0, s36, 49152
s_nop 0
buffer_load_dwordx4 v4, s[48:51], s61 offen lds
s_add_u32 s61, s61, s62
v_mfma_f32_32x32x16_bf16 v[80:95], a[52:55], a[64:67], v[80:95]
s_add_u32 m0, s36, 53248
s_nop 0
buffer_load_dwordx4 v4, s[48:51], s61 offen lds
s_add_u32 s61, s61, s62
s_add_u32 m0, s36, 57344
s_nop 0
buffer_load_dwordx4 v4, s[48:51], s61 offen lds
s_add_u32 s61, s61, s62
v_mfma_f32_32x32x16_bf16 v[96:111], a[52:55], a[68:71], v[96:111]
s_add_u32 m0, s36, 61440
s_nop 0
buffer_load_dwordx4 v4, s[48:51], s61 offen lds
s_add_u32 s61, s61, s62
v_mfma_f32_32x32x16_bf16 v[112:127], a[52:55], a[72:75], v[112:127]
v_mfma_f32_32x32x16_bf16 v[128:143], a[52:55], a[76:79], v[128:143]
s_waitcnt lgkmcnt(0)
v_mfma_f32_32x32x16_bf16 v[16:31], a[16:19], a[32:35], v[16:31]
ds_read_b128 a[48:51], v11 offset:32768
ds_read_b128 a[52:55], v11 offset:34816
v_mfma_f32_32x32x16_bf16 v[32:47], a[16:19], a[36:39], v[32:47]
ds_read_b64_tr_b16 a[64:65], v12 offset:40960
ds_read_b64_tr_b16 a[66:67], v12 offset:43008
v_mfma_f32_32x32x16_bf16 v[48:63], a[16:19], a[40:43], v[48:63]
ds_read_b64_tr_b16 a[68:69], v13 offset:40960
ds_read_b64_tr_b16 a[70:71], v13 offset:43008
v_mfma_f32_32x32x16_bf16 v[64:79], a[16:19], a[44:47], v[64:79]
ds_read_b64_tr_b16 a[72:73], v14 offset:40960
ds_read_b64_tr_b16 a[74:75], v14 offset:43008
v_mfma_f32_32x32x16_bf16 v[80:95], a[20:23], a[32:35], v[80:95]
ds_read_b64_tr_b16 a[76:77], v2 offset:40960
ds_read_b64_tr_b16 a[78:79], v2 offset:43008
v_mfma_f32_32x32x16_bf16 v[96:111], a[20:23], a[36:39], v[96:111]
v_mfma_f32_32x32x16_bf16 v[112:127], a[20:23], a[40:43], v[112:127]
v_mfma_f32_32x32x16_bf16 v[128:143], a[20:23], a[44:47], v[128:143]
s_waitcnt lgkmcnt(0)
s_waitcnt vmcnt(6)
s_barrier
v_mfma_f32_32x32x16_bf16 v[16:31], a[48:51], a[64:67], v[16:31]
ds_read_b128 a[16:19], v5
ds_read_b128 a[20:23], v5 offset:2048
ds_read_b64_tr_b16 a[32:33], v6
ds_read_b64_tr_b16 a[34:35], v6 offset:2048
v_mfma_f32_32x32x16_bf16 v[32:47], a[48:51], a[68:71], v[32:47]
ds_read_b64_tr_b16 a[36:37], v7
ds_read_b64_tr_b16 a[38:39], v7 offset:2048
ds_read_b64_tr_b16 a[40:41], v9
ds_read_b64_tr_b16 a[42:43], v9 offset:2048
v_mfma_f32_32x32x16_bf16 v[48:63], a[48:51], a[72:75], v[48:63]
ds_read_b64_tr_b16 a[44:45], v15
ds_read_b64_tr_b16 a[46:47], v15 offset:2048
s_add_u32 s32, s60, 384
s_add_u32 m0, s36, 65536
s_nop 0
buffer_load_dwordx4 v1, s[52:55], s32 offen lds
v_mfma_f32_32x32x16_bf16 v[64:79], a[48:51], a[76:79], v[64:79]
s_add_u32 s32, s60, 74112
s_add_u32 m0, s36, 69632
s_nop 0
buffer_load_dwordx4 v1, s[52:55], s32 offen lds
s_add_u32 m0, s36, 81920
s_nop 0
buffer_load_dwordx4 v4, s[48:51], s61 offen lds
s_add_u32 s61, s61, s62
v_mfma_f32_32x32x16_bf16 v[80:95], a[52:55], a[64:67], v[80:95]
s_add_u32 m0, s36, 86016
s_nop 0
buffer_load_dwordx4 v4, s[48:51], s61 offen lds
s_add_u32 s61, s61, s62
s_add_u32 m0, s36, 90112
s_nop 0
buffer_load_dwordx4 v4, s[48:51], s61 offen lds
s_add_u32 s61, s61, s62
v_mfma_f32_32x32x16_bf16 v[96:111], a[52:55], a[68:71], v[96:111]
s_add_u32 m0, s36, 94208
s_nop 0
buffer_load_dwordx4 v4, s[48:51], s61 offen lds
s_add_u32 s61, s61, s62
v_mfma_f32_32x32x16_bf16 v[112:127], a[52:55], a[72:75], v[112:127]
v_mfma_f32_32x32x16_bf16 v[128:143], a[52:55], a[76:79], v[128:143]
s_waitcnt lgkmcnt(0)
v_mfma_f32_32x32x16_bf16 v[16:31], a[16:19], a[32:35], v[16:31]
ds_read_b128 a[48:51], v8
ds_read_b128 a[52:55], v8 offset:2048
v_mfma_f32_32x32x16_bf16 v[32:47], a[16:19], a[36:39], v[32:47]
ds_read_b64_tr_b16 a[64:65], v6 offset:8192
ds_read_b64_tr_b16 a[66:67], v6 offset:10240
v_mfma_f32_32x32x16_bf16 v[48:63], a[16:19], a[40:43], v[48:63]
ds_read_b64_tr_b16 a[68:69], v7 offset:8192
ds_read_b64_tr_b16 a[70:71], v7 offset:10240
v_mfma_f32_32x32x16_bf16 v[64:79], a[16:19], a[44:47], v[64:79]
ds_read_b64_tr_b16 a[72:73], v9 offset:8192
ds_read_b64_tr_b16 a[74:75], v9 offset:10240
v_mfma_f32_32x32x16_bf16 v[80:95], a[20:23], a[32:35], v[80:95]
ds_read_b64_tr_b16 a[76:77], v15 offset:8192
ds_read_b64_tr_b16 a[78:79], v15 offset:10240
v_mfma_f32_32x32x16_bf16 v[96:111], a[20:23], a[36:39], v[96:111]
v_mfma_f32_32x32x16_bf16 v[112:127], a[20:23], a[40:43], v[112:127]
v_mfma_f32_32x32x16_bf16 v[128:143], a[20:23], a[44:47], v[128:143]
s_waitcnt lgkmcnt(0)
s_waitcnt vmcnt(6)
s_barrier
v_mfma_f32_32x32x16_bf16 v[16:31], a[48:51], a[64:67], v[16:31]
ds_read_b128 a[16:19], v5 offset:32768
ds_read_b128 a[20:23], v5 offset:34816
ds_read_b64_tr_b16 a[32:33], v6 offset:32768
ds_read_b64_tr_b16 a[34:35], v6 offset:34816
v_mfma_f32_32x32x16_bf16 v[32:47], a[48:51], a[68:71], v[32:47]
ds_read_b64_tr_b16 a[36:37], v7 offset:32768
ds_read_b64_tr_b16 a[38:39], v7 offset:34816
ds_read_b64_tr_b16 a[40:41], v9 offset:32768
ds_read_b64_tr_b16 a[42:43], v9 offset:34816
v_mfma_f32_32x32x16_bf16 v[48:63], a[48:51], a[72:75], v[48:63]
ds_read_b64_tr_b16 a[44:45], v15 offset:32768
ds_read_b64_tr_b16 a[46:47], v15 offset:34816
s_add_u32 s32, s60, 448
s_add_u32 m0, s36, 98304
s_nop 0
buffer_load_dwordx4 v1, s[52:55], s32 offen lds
v_mfma_f32_32x32x16_bf16 v[64:79], a[48:51], a[76:79], v[64:79]
s_add_u32 s32, s60, 74176
s_add_u32 m0, s36, 102400
s_nop 0
buffer_load_dwordx4 v1, s[52:55], s32 offen lds
s_add_u32 m0, s36, 114688
s_nop 0
buffer_load_dwordx4 v4, s[48:51], s61 offen lds
s_add_u32 s61, s61, s62
v_mfma_f32_32x32x16_bf16 v[80:95], a[52:55], a[64:67], v[80:95]
s_add_u32 m0, s36, 118784
s_nop 0
buffer_load_dwordx4 v4, s[48:51], s61 offen lds
s_add_u32 s61, s61, s62
s_add_u32 m0, s36, 122880
s_nop 0
buffer_load_dwordx4 v4, s[48:51], s61 offen lds
s_add_u32 s61, s61, s62
v_mfma_f32_32x32x16_bf16 v[96:111], a[52:55], a[68:71], v[96:111]
s_add_u32 m0, s36, 126976
s_nop 0
buffer_load_dwordx4 v4, s[48:51], s61 offen lds
s_add_u32 s61, s61, s62
v_mfma_f32_32x32x16_bf16 v[112:127], a[52:55], a[72:75], v[112:127]
v_mfma_f32_32x32x16_bf16 v[128:143], a[52:55], a[76:79], v[128:143]
s_waitcnt lgkmcnt(0)
v_mfma_f32_32x32x16_bf16 v[16:31], a[16:19], a[32:35], v[16:31]
ds_read_b128 a[48:51], v8 offset:32768
ds_read_b128 a[52:55], v8 offset:34816
v_mfma_f32_32x32x16_bf16 v[32:47], a[16:19], a[36:39], v[32:47]
ds_read_b64_tr_b16 a[64:65], v6 offset:40960
ds_read_b64_tr_b16 a[66:67], v6 offset:43008
v_mfma_f32_32x32x16_bf16 v[48:63], a[16:19], a[40:43], v[48:63]
ds_read_b64_tr_b16 a[68:69], v7 offset:40960
ds_read_b64_tr_b16 a[70:71], v7 offset:43008
v_mfma_f32_32x32x16_bf16 v[64:79], a[16:19], a[44:47], v[64:79]
ds_read_b64_tr_b16 a[72:73], v9 offset:40960
ds_read_b64_tr_b16 a[74:75], v9 offset:43008
v_mfma_f32_32x32x16_bf16 v[80:95], a[20:23], a[32:35], v[80:95]
ds_read_b64_tr_b16 a[76:77], v15 offset:40960
ds_read_b64_tr_b16 a[78:79], v15 offset:43008
v_mfma_f32_32x32x16_bf16 v[96:111], a[20:23], a[36:39], v[96:111]
v_mfma_f32_32x32x16_bf16 v[112:127], a[20:23], a[40:43], v[112:127]
v_mfma_f32_32x32x16_bf16 v[128:143], a[20:23], a[44:47], v[128:143]
s_waitcnt lgkmcnt(0)
s_waitcnt vmcnt(6)
s_barrier
v_mfma_f32_32x32x16_bf16 v[16:31], a[48:51], a[64:67], v[16:31]
ds_read_b128 a[16:19], v10
ds_read_b128 a[20:23], v10 offset:2048
ds_read_b64_tr_b16 a[32:33], v12
ds_read_b64_tr_b16 a[34:35], v12 offset:2048
v_mfma_f32_32x32x16_bf16 v[32:47], a[48:51], a[68:71], v[32:47]
ds_read_b64_tr_b16 a[36:37], v13
ds_read_b64_tr_b16 a[38:39], v13 offset:2048
ds_read_b64_tr_b16 a[40:41], v14
ds_read_b64_tr_b16 a[42:43], v14 offset:2048
v_mfma_f32_32x32x16_bf16 v[48:63], a[48:51], a[72:75], v[48:63]
ds_read_b64_tr_b16 a[44:45], v2
ds_read_b64_tr_b16 a[46:47], v2 offset:2048
s_add_u32 s32, s60, 512
s_add_u32 m0, s36, 0
s_nop 0
buffer_load_dwordx4 v1, s[52:55], s32 offen lds
v_mfma_f32_32x32x16_bf16 v[64:79], a[48:51], a[76:79], v[64:79]
s_add_u32 s32, s60, 74240
s_add_u32 m0, s36, 4096
s_nop 0
buffer_load_dwordx4 v1, s[52:55], s32 offen lds
s_add_u32 m0, s36, 16384
s_nop 0
buffer_load_dwordx4 v4, s[48:51], s61 offen lds
s_add_u32 s61, s61, s62
v_mfma_f32_32x32x16_bf16 v[80:95], a[52:55], a[64:67], v[80:95]
s_add_u32 m0, s36, 20480
s_nop 0
buffer_load_dwordx4 v4, s[48:51], s61 offen lds
s_add_u32 s61, s61, s62
s_add_u32 m0, s36, 24576
s_nop 0
buffer_load_dwordx4 v4, s[48:51], s61 offen lds
s_add_u32 s61, s61, s62
v_mfma_f32_32x32x16_bf16 v[96:111], a[52:55], a[68:71], v[96:111]
s_add_u32 m0, s36, 28672
s_nop 0
buffer_load_dwordx4 v4, s[48:51], s61 offen lds
s_add_u32 s61, s61, s62
v_mfma_f32_32x32x16_bf16 v[112:127], a[52:55], a[72:75], v[112:127]
v_mfma_f32_32x32x16_bf16 v[128:143], a[52:55], a[76:79], v[128:143]
s_waitcnt lgkmcnt(0)
v_mfma_f32_32x32x16_bf16 v[16:31], a[16:19], a[32:35], v[16:31]
ds_read_b128 a[48:51], v11
ds_read_b128 a[52:55], v11 offset:2048
v_mfma_f32_32x32x16_bf16 v[32:47], a[16:19], a[36:39], v[32:47]
ds_read_b64_tr_b16 a[64:65], v12 offset:8192
ds_read_b64_tr_b16 a[66:67], v12 offset:10240
v_mfma_f32_32x32x16_bf16 v[48:63], a[16:19], a[40:43], v[48:63]
ds_read_b64_tr_b16 a[68:69], v13 offset:8192
ds_read_b64_tr_b16 a[70:71], v13 offset:10240
v_mfma_f32_32x32x16_bf16 v[64:79], a[16:19], a[44:47], v[64:79]
ds_read_b64_tr_b16 a[72:73], v14 offset:8192
ds_read_b64_tr_b16 a[74:75], v14 offset:10240
v_mfma_f32_32x32x16_bf16 v[80:95], a[20:23], a[32:35], v[80:95]
ds_read_b64_tr_b16 a[76:77], v2 offset:8192
ds_read_b64_tr_b16 a[78:79], v2 offset:10240
v_mfma_f32_32x32x16_bf16 v[96:111], a[20:23], a[36:39], v[96:111]
v_mfma_f32_32x32x16_bf16 v[112:127], a[20:23], a[40:43], v[112:127]
v_mfma_f32_32x32x16_bf16 v[128:143], a[20:23], a[44:47], v[128:143]
s_waitcnt lgkmcnt(0)
s_waitcnt vmcnt(6)
s_barrier
v_mfma_f32_32x32x16_bf16 v[16:31], a[48:51], a[64:67], v[16:31]
ds_read_b128 a[16:19], v10 offset:32768
ds_read_b128 a[20:23], v10 offset:34816
ds_read_b64_tr_b16 a[32:33], v12 offset:32768
ds_read_b64_tr_b16 a[34:35], v12 offset:34816
v_mfma_f32_32x32x16_bf16 v[32:47], a[48:51], a[68:71], v[32:47]
ds_read_b64_tr_b16 a[36:37], v13 offset:32768
ds_read_b64_tr_b16 a[38:39], v13 offset:34816
ds_read_b64_tr_b16 a[40:41], v14 offset:32768
ds_read_b64_tr_b16 a[42:43], v14 offset:34816
v_mfma_f32_32x32x16_bf16 v[48:63], a[48:51], a[72:75], v[48:63]
ds_read_b64_tr_b16 a[44:45], v2 offset:32768
ds_read_b64_tr_b16 a[46:47], v2 offset:34816
s_add_u32 s32, s60, 576
s_add_u32 m0, s36, 32768
s_nop 0
buffer_load_dwordx4 v1, s[52:55], s32 offen lds
v_mfma_f32_32x32x16_bf16 v[64:79], a[48:51], a[76:79], v[64:79]
s_add_u32 s32, s60, 74304
s_add_u32 m0, s36, 36864
s_nop 0
buffer_load_dwordx4 v1, s[52:55], s32 offen lds
s_add_u32 m0, s36, 49152
s_nop 0
buffer_load_dwordx4 v4, s[48:51], s61 offen lds
s_add_u32 s61, s61, s62
v_mfma_f32_32x32x16_bf16 v[80:95], a[52:55], a[64:67], v[80:95]
s_add_u32 m0, s36, 53248
s_nop 0
buffer_load_dwordx4 v4, s[48:51], s61 offen lds
s_add_u32 s61, s61, s62
s_add_u32 m0, s36, 57344
s_nop 0
buffer_load_dwordx4 v4, s[48:51], s61 offen lds
s_add_u32 s61, s61, s62
v_mfma_f32_32x32x16_bf16 v[96:111], a[52:55], a[68:71], v[96:111]
s_add_u32 m0, s36, 61440
s_nop 0
buffer_load_dwordx4 v4, s[48:51], s61 offen lds
s_add_u32 s61, s61, s62
v_mfma_f32_32x32x16_bf16 v[112:127], a[52:55], a[72:75], v[112:127]
v_mfma_f32_32x32x16_bf16 v[128:143], a[52:55], a[76:79], v[128:143]
s_waitcnt lgkmcnt(0)
v_mfma_f32_32x32x16_bf16 v[16:31], a[16:19], a[32:35], v[16:31]
ds_read_b128 a[48:51], v11 offset:32768
ds_read_b128 a[52:55], v11 offset:34816
v_mfma_f32_32x32x16_bf16 v[32:47], a[16:19], a[36:39], v[32:47]
ds_read_b64_tr_b16 a[64:65], v12 offset:40960
ds_read_b64_tr_b16 a[66:67], v12 offset:43008
v_mfma_f32_32x32x16_bf16 v[48:63], a[16:19], a[40:43], v[48:63]
ds_read_b64_tr_b16 a[68:69], v13 offset:40960
ds_read_b64_tr_b16 a[70:71], v13 offset:43008
v_mfma_f32_32x32x16_bf16 v[64:79], a[16:19], a[44:47], v[64:79]
ds_read_b64_tr_b16 a[72:73], v14 offset:40960
ds_read_b64_tr_b16 a[74:75], v14 offset:43008
v_mfma_f32_32x32x16_bf16 v[80:95], a[20:23], a[32:35], v[80:95]
ds_read_b64_tr_b16 a[76:77], v2 offset:40960
ds_read_b64_tr_b16 a[78:79], v2 offset:43008
v_mfma_f32_32x32x16_bf16 v[96:111], a[20:23], a[36:39], v[96:111]
v_mfma_f32_32x32x16_bf16 v[112:127], a[20:23], a[40:43], v[112:127]
v_mfma_f32_32x32x16_bf16 v[128:143], a[20:23], a[44:47], v[128:143]
s_waitcnt lgkmcnt(0)
s_waitcnt vmcnt(6)
s_barrier
v_mfma_f32_32x32x16_bf16 v[16:31], a[48:51], a[64:67], v[16:31]
ds_read_b128 a[16:19], v5
ds_read_b128 a[20:23], v5 offset:2048
ds_read_b64_tr_b16 a[32:33], v6
ds_read_b64_tr_b16 a[34:35], v6 offset:2048
v_mfma_f32_32x32x16_bf16 v[32:47], a[48:51], a[68:71], v[32:47]
ds_read_b64_tr_b16 a[36:37], v7
ds_read_b64_tr_b16 a[38:39], v7 offset:2048
ds_read_b64_tr_b16 a[40:41], v9
ds_read_b64_tr_b16 a[42:43], v9 offset:2048
v_mfma_f32_32x32x16_bf16 v[48:63], a[48:51], a[72:75], v[48:63]
ds_read_b64_tr_b16 a[44:45], v15
ds_read_b64_tr_b16 a[46:47], v15 offset:2048
s_add_u32 s32, s60, 640
s_add_u32 m0, s36, 65536
s_nop 0
buffer_load_dwordx4 v1, s[52:55], s32 offen lds
v_mfma_f32_32x32x16_bf16 v[64:79], a[48:51], a[76:79], v[64:79]
s_add_u32 s32, s60, 74368
s_add_u32 m0, s36, 69632
s_nop 0
buffer_load_dwordx4 v1, s[52:55], s32 offen lds
s_add_u32 m0, s36, 81920
s_nop 0
buffer_load_dwordx4 v4, s[48:51], s61 offen lds
s_add_u32 s61, s61, s62
v_mfma_f32_32x32x16_bf16 v[80:95], a[52:55], a[64:67], v[80:95]
s_add_u32 m0, s36, 86016
s_nop 0
buffer_load_dwordx4 v4, s[48:51], s61 offen lds
s_add_u32 s61, s61, s62
s_add_u32 m0, s36, 90112
s_nop 0
buffer_load_dwordx4 v4, s[48:51], s61 offen lds
s_add_u32 s61, s61, s62
v_mfma_f32_32x32x16_bf16 v[96:111], a[52:55], a[68:71], v[96:111]
s_add_u32 m0, s36, 94208
s_nop 0
buffer_load_dwordx4 v4, s[48:51], s61 offen lds
s_add_u32 s61, s61, s62
v_mfma_f32_32x32x16_bf16 v[112:127], a[52:55], a[72:75], v[112:127]
v_mfma_f32_32x32x16_bf16 v[128:143], a[52:55], a[76:79], v[128:143]
s_waitcnt lgkmcnt(0)
v_mfma_f32_32x32x16_bf16 v[16:31], a[16:19], a[32:35], v[16:31]
ds_read_b128 a[48:51], v8
ds_read_b128 a[52:55], v8 offset:2048
v_mfma_f32_32x32x16_bf16 v[32:47], a[16:19], a[36:39], v[32:47]
ds_read_b64_tr_b16 a[64:65], v6 offset:8192
ds_read_b64_tr_b16 a[66:67], v6 offset:10240
v_mfma_f32_32x32x16_bf16 v[48:63], a[16:19], a[40:43], v[48:63]
ds_read_b64_tr_b16 a[68:69], v7 offset:8192
ds_read_b64_tr_b16 a[70:71], v7 offset:10240
v_mfma_f32_32x32x16_bf16 v[64:79], a[16:19], a[44:47], v[64:79]
ds_read_b64_tr_b16 a[72:73], v9 offset:8192
ds_read_b64_tr_b16 a[74:75], v9 offset:10240
v_mfma_f32_32x32x16_bf16 v[80:95], a[20:23], a[32:35], v[80:95]
ds_read_b64_tr_b16 a[76:77], v15 offset:8192
ds_read_b64_tr_b16 a[78:79], v15 offset:10240
v_mfma_f32_32x32x16_bf16 v[96:111], a[20:23], a[36:39], v[96:111]
v_mfma_f32_32x32x16_bf16 v[112:127], a[20:23], a[40:43], v[112:127]
v_mfma_f32_32x32x16_bf16 v[128:143], a[20:23], a[44:47], v[128:143]
s_waitcnt lgkmcnt(0)
s_waitcnt vmcnt(6)
s_barrier
v_mfma_f32_32x32x16_bf16 v[16:31], a[48:51], a[64:67], v[16:31]
ds_read_b128 a[16:19], v5 offset:32768
ds_read_b128 a[20:23], v5 offset:34816
ds_read_b64_tr_b16 a[32:33], v6 offset:32768
ds_read_b64_tr_b16 a[34:35], v6 offset:34816
v_mfma_f32_32x32x16_bf16 v[32:47], a[48:51], a[68:71], v[32:47]
ds_read_b64_tr_b16 a[36:37], v7 offset:32768
ds_read_b64_tr_b16 a[38:39], v7 offset:34816
ds_read_b64_tr_b16 a[40:41], v9 offset:32768
ds_read_b64_tr_b16 a[42:43], v9 offset:34816
v_mfma_f32_32x32x16_bf16 v[48:63], a[48:51], a[72:75], v[48:63]
ds_read_b64_tr_b16 a[44:45], v15 offset:32768
ds_read_b64_tr_b16 a[46:47], v15 offset:34816
s_add_u32 s32, s60, 704
s_add_u32 m0, s36, 98304
s_nop 0
buffer_load_dwordx4 v1, s[52:55], s32 offen lds
v_mfma_f32_32x32x16_bf16 v[64:79], a[48:51], a[76:79], v[64:79]
s_add_u32 s32, s60, 74432
s_add_u32 m0, s36, 102400
s_nop 0
buffer_load_dwordx4 v1, s[52:55], s32 offen lds
s_add_u32 m0, s36, 114688
s_nop 0
buffer_load_dwordx4 v4, s[48:51], s61 offen lds
s_add_u32 s61, s61, s62
v_mfma_f32_32x32x16_bf16 v[80:95], a[52:55], a[64:67], v[80:95]
s_add_u32 m0, s36, 118784
s_nop 0
buffer_load_dwordx4 v4, s[48:51], s61 offen lds
s_add_u32 s61, s61, s62
s_add_u32 m0, s36, 122880
s_nop 0
buffer_load_dwordx4 v4, s[48:51], s61 offen lds
s_add_u32 s61, s61, s62
v_mfma_f32_32x32x16_bf16 v[96:111], a[52:55], a[68:71], v[96:111]
s_add_u32 m0, s36, 126976
s_nop 0
buffer_load_dwordx4 v4, s[48:51], s61 offen lds
s_add_u32 s61, s61, s62
v_mfma_f32_32x32x16_bf16 v[112:127], a[52:55], a[72:75], v[112:127]
v_mfma_f32_32x32x16_bf16 v[128:143], a[52:55], a[76:79], v[128:143]
s_waitcnt lgkmcnt(0)
v_mfma_f32_32x32x16_bf16 v[16:31], a[16:19], a[32:35], v[16:31]
ds_read_b128 a[48:51], v8 offset:32768
ds_read_b128 a[52:55], v8 offset:34816
v_mfma_f32_32x32x16_bf16 v[32:47], a[16:19], a[36:39], v[32:47]
ds_read_b64_tr_b16 a[64:65], v6 offset:40960
ds_read_b64_tr_b16 a[66:67], v6 offset:43008
v_mfma_f32_32x32x16_bf16 v[48:63], a[16:19], a[40:43], v[48:63]
ds_read_b64_tr_b16 a[68:69], v7 offset:40960
ds_read_b64_tr_b16 a[70:71], v7 offset:43008
v_mfma_f32_32x32x16_bf16 v[64:79], a[16:19], a[44:47], v[64:79]
ds_read_b64_tr_b16 a[72:73], v9 offset:40960
ds_read_b64_tr_b16 a[74:75], v9 offset:43008
v_mfma_f32_32x32x16_bf16 v[80:95], a[20:23], a[32:35], v[80:95]
ds_read_b64_tr_b16 a[76:77], v15 offset:40960
ds_read_b64_tr_b16 a[78:79], v15 offset:43008
v_mfma_f32_32x32x16_bf16 v[96:111], a[20:23], a[36:39], v[96:111]
v_mfma_f32_32x32x16_bf16 v[112:127], a[20:23], a[40:43], v[112:127]
v_mfma_f32_32x32x16_bf16 v[128:143], a[20:23], a[44:47], v[128:143]
s_waitcnt lgkmcnt(0)
s_waitcnt vmcnt(6)
s_barrier
v_mfma_f32_32x32x16_bf16 v[16:31], a[48:51], a[64:67], v[16:31]
ds_read_b128 a[16:19], v10
ds_read_b128 a[20:23], v10 offset:2048
ds_read_b64_tr_b16 a[32:33], v12
ds_read_b64_tr_b16 a[34:35], v12 offset:2048
v_mfma_f32_32x32x16_bf16 v[32:47], a[48:51], a[68:71], v[32:47]
ds_read_b64_tr_b16 a[36:37], v13
ds_read_b64_tr_b16 a[38:39], v13 offset:2048
ds_read_b64_tr_b16 a[40:41], v14
ds_read_b64_tr_b16 a[42:43], v14 offset:2048
v_mfma_f32_32x32x16_bf16 v[48:63], a[48:51], a[72:75], v[48:63]
ds_read_b64_tr_b16 a[44:45], v2
ds_read_b64_tr_b16 a[46:47], v2 offset:2048
s_add_u32 s32, s60, 768
s_add_u32 m0, s36, 0
s_nop 0
buffer_load_dwordx4 v1, s[52:55], s32 offen lds
v_mfma_f32_32x32x16_bf16 v[64:79], a[48:51], a[76:79], v[64:79]
s_add_u32 s32, s60, 74496
s_add_u32 m0, s36, 4096
s_nop 0
buffer_load_dwordx4 v1, s[52:55], s32 offen lds
s_add_u32 m0, s36, 16384
s_nop 0
buffer_load_dwordx4 v4, s[48:51], s61 offen lds
s_add_u32 s61, s61, s62
v_mfma_f32_32x32x16_bf16 v[80:95], a[52:55], a[64:67], v[80:95]
s_add_u32 m0, s36, 20480
s_nop 0
buffer_load_dwordx4 v4, s[48:51], s61 offen lds
s_add_u32 s61, s61, s62
s_add_u32 m0, s36, 24576
s_nop 0
buffer_load_dwordx4 v4, s[48:51], s61 offen lds
s_add_u32 s61, s61, s62
v_mfma_f32_32x32x16_bf16 v[96:111], a[52:55], a[68:71], v[96:111]
s_add_u32 m0, s36, 28672
s_nop 0
buffer_load_dwordx4 v4, s[48:51], s61 offen lds
s_add_u32 s61, s61, s62
v_mfma_f32_32x32x16_bf16 v[112:127], a[52:55], a[72:75], v[112:127]
v_mfma_f32_32x32x16_bf16 v[128:143], a[52:55], a[76:79], v[128:143]
s_waitcnt lgkmcnt(0)
v_mfma_f32_32x32x16_bf16 v[16:31], a[16:19], a[32:35], v[16:31]
ds_read_b128 a[48:51], v11
ds_read_b128 a[52:55], v11 offset:2048
v_mfma_f32_32x32x16_bf16 v[32:47], a[16:19], a[36:39], v[32:47]
ds_read_b64_tr_b16 a[64:65], v12 offset:8192
ds_read_b64_tr_b16 a[66:67], v12 offset:10240
v_mfma_f32_32x32x16_bf16 v[48:63], a[16:19], a[40:43], v[48:63]
ds_read_b64_tr_b16 a[68:69], v13 offset:8192
ds_read_b64_tr_b16 a[70:71], v13 offset:10240
v_mfma_f32_32x32x16_bf16 v[64:79], a[16:19], a[44:47], v[64:79]
ds_read_b64_tr_b16 a[72:73], v14 offset:8192
ds_read_b64_tr_b16 a[74:75], v14 offset:10240
v_mfma_f32_32x32x16_bf16 v[80:95], a[20:23], a[32:35], v[80:95]
ds_read_b64_tr_b16 a[76:77], v2 offset:8192
ds_read_b64_tr_b16 a[78:79], v2 offset:10240
v_mfma_f32_32x32x16_bf16 v[96:111], a[20:23], a[36:39], v[96:111]
v_mfma_f32_32x32x16_bf16 v[112:127], a[20:23], a[40:43], v[112:127]
v_mfma_f32_32x32x16_bf16 v[128:143], a[20:23], a[44:47], v[128:143]
s_waitcnt lgkmcnt(0)
s_waitcnt vmcnt(6)
s_barrier
v_mfma_f32_32x32x16_bf16 v[16:31], a[48:51], a[64:67], v[16:31]
ds_read_b128 a[16:19], v10 offset:32768
ds_read_b128 a[20:23], v10 offset:34816
ds_read_b64_tr_b16 a[32:33], v12 offset:32768
ds_read_b64_tr_b16 a[34:35], v12 offset:34816
v_mfma_f32_32x32x16_bf16 v[32:47], a[48:51], a[68:71], v[32:47]
ds_read_b64_tr_b16 a[36:37], v13 offset:32768
ds_read_b64_tr_b16 a[38:39], v13 offset:34816
ds_read_b64_tr_b16 a[40:41], v14 offset:32768
ds_read_b64_tr_b16 a[42:43], v14 offset:34816
v_mfma_f32_32x32x16_bf16 v[48:63], a[48:51], a[72:75], v[48:63]
ds_read_b64_tr_b16 a[44:45], v2 offset:32768
ds_read_b64_tr_b16 a[46:47], v2 offset:34816
s_add_u32 s32, s60, 832
s_add_u32 m0, s36, 32768
s_nop 0
buffer_load_dwordx4 v1, s[52:55], s32 offen lds
v_mfma_f32_32x32x16_bf16 v[64:79], a[48:51], a[76:79], v[64:79]
s_add_u32 s32, s60, 74560
s_add_u32 m0, s36, 36864
s_nop 0
buffer_load_dwordx4 v1, s[52:55], s32 offen lds
s_add_u32 m0, s36, 49152
s_nop 0
buffer_load_dwordx4 v4, s[48:51], s61 offen lds
s_add_u32 s61, s61, s62
v_mfma_f32_32x32x16_bf16 v[80:95], a[52:55], a[64:67], v[80:95]
s_add_u32 m0, s36, 53248
s_nop 0
buffer_load_dwordx4 v4, s[48:51], s61 offen lds
s_add_u32 s61, s61, s62
s_add_u32 m0, s36, 57344
s_nop 0
buffer_load_dwordx4 v4, s[48:51], s61 offen lds
s_add_u32 s61, s61, s62
v_mfma_f32_32x32x16_bf16 v[96:111], a[52:55], a[68:71], v[96:111]
s_add_u32 m0, s36, 61440
s_nop 0
buffer_load_dwordx4 v4, s[48:51], s61 offen lds
s_add_u32 s61, s61, s62
v_mfma_f32_32x32x16_bf16 v[112:127], a[52:55], a[72:75], v[112:127]
v_mfma_f32_32x32x16_bf16 v[128:143], a[52:55], a[76:79], v[128:143]
s_waitcnt lgkmcnt(0)
v_mfma_f32_32x32x16_bf16 v[16:31], a[16:19], a[32:35], v[16:31]
ds_read_b128 a[48:51], v11 offset:32768
ds_read_b128 a[52:55], v11 offset:34816
v_mfma_f32_32x32x16_bf16 v[32:47], a[16:19], a[36:39], v[32:47]
ds_read_b64_tr_b16 a[64:65], v12 offset:40960
ds_read_b64_tr_b16 a[66:67], v12 offset:43008
v_mfma_f32_32x32x16_bf16 v[48:63], a[16:19], a[40:43], v[48:63]
ds_read_b64_tr_b16 a[68:69], v13 offset:40960
ds_read_b64_tr_b16 a[70:71], v13 offset:43008
v_mfma_f32_32x32x16_bf16 v[64:79], a[16:19], a[44:47], v[64:79]
ds_read_b64_tr_b16 a[72:73], v14 offset:40960
ds_read_b64_tr_b16 a[74:75], v14 offset:43008
v_mfma_f32_32x32x16_bf16 v[80:95], a[20:23], a[32:35], v[80:95]
ds_read_b64_tr_b16 a[76:77], v2 offset:40960
ds_read_b64_tr_b16 a[78:79], v2 offset:43008
v_mfma_f32_32x32x16_bf16 v[96:111], a[20:23], a[36:39], v[96:111]
v_mfma_f32_32x32x16_bf16 v[112:127], a[20:23], a[40:43], v[112:127]
v_mfma_f32_32x32x16_bf16 v[128:143], a[20:23], a[44:47], v[128:143]
s_waitcnt lgkmcnt(0)
s_waitcnt vmcnt(6)
s_barrier
v_mfma_f32_32x32x16_bf16 v[16:31], a[48:51], a[64:67], v[16:31]
ds_read_b128 a[16:19], v5
ds_read_b128 a[20:23], v5 offset:2048
ds_read_b64_tr_b16 a[32:33], v6
ds_read_b64_tr_b16 a[34:35], v6 offset:2048
v_mfma_f32_32x32x16_bf16 v[32:47], a[48:51], a[68:71], v[32:47]
ds_read_b64_tr_b16 a[36:37], v7
ds_read_b64_tr_b16 a[38:39], v7 offset:2048
ds_read_b64_tr_b16 a[40:41], v9
ds_read_b64_tr_b16 a[42:43], v9 offset:2048
v_mfma_f32_32x32x16_bf16 v[48:63], a[48:51], a[72:75], v[48:63]
ds_read_b64_tr_b16 a[44:45], v15
ds_read_b64_tr_b16 a[46:47], v15 offset:2048
s_add_u32 s32, s60, 896
s_add_u32 m0, s36, 65536
s_nop 0
buffer_load_dwordx4 v1, s[52:55], s32 offen lds
v_mfma_f32_32x32x16_bf16 v[64:79], a[48:51], a[76:79], v[64:79]
s_add_u32 s32, s60, 74624
s_add_u32 m0, s36, 69632
s_nop 0
buffer_load_dwordx4 v1, s[52:55], s32 offen lds
s_add_u32 m0, s36, 81920
s_nop 0
buffer_load_dwordx4 v4, s[48:51], s61 offen lds
s_add_u32 s61, s61, s62
v_mfma_f32_32x32x16_bf16 v[80:95], a[52:55], a[64:67], v[80:95]
s_add_u32 m0, s36, 86016
s_nop 0
buffer_load_dwordx4 v4, s[48:51], s61 offen lds
s_add_u32 s61, s61, s62
s_add_u32 m0, s36, 90112
s_nop 0
buffer_load_dwordx4 v4, s[48:51], s61 offen lds
s_add_u32 s61, s61, s62
v_mfma_f32_32x32x16_bf16 v[96:111], a[52:55], a[68:71], v[96:111]
s_add_u32 m0, s36, 94208
s_nop 0
buffer_load_dwordx4 v4, s[48:51], s61 offen lds
s_add_u32 s61, s61, s62
v_mfma_f32_32x32x16_bf16 v[112:127], a[52:55], a[72:75], v[112:127]
v_mfma_f32_32x32x16_bf16 v[128:143], a[52:55], a[76:79], v[128:143]
s_waitcnt lgkmcnt(0)
v_mfma_f32_32x32x16_bf16 v[16:31], a[16:19], a[32:35], v[16:31]
ds_read_b128 a[48:51], v8
ds_read_b128 a[52:55], v8 offset:2048
v_mfma_f32_32x32x16_bf16 v[32:47], a[16:19], a[36:39], v[32:47]
ds_read_b64_tr_b16 a[64:65], v6 offset:8192
ds_read_b64_tr_b16 a[66:67], v6 offset:10240
v_mfma_f32_32x32x16_bf16 v[48:63], a[16:19], a[40:43], v[48:63]
ds_read_b64_tr_b16 a[68:69], v7 offset:8192
ds_read_b64_tr_b16 a[70:71], v7 offset:10240
v_mfma_f32_32x32x16_bf16 v[64:79], a[16:19], a[44:47], v[64:79]
ds_read_b64_tr_b16 a[72:73], v9 offset:8192
ds_read_b64_tr_b16 a[74:75], v9 offset:10240
v_mfma_f32_32x32x16_bf16 v[80:95], a[20:23], a[32:35], v[80:95]
ds_read_b64_tr_b16 a[76:77], v15 offset:8192
ds_read_b64_tr_b16 a[78:79], v15 offset:10240
v_mfma_f32_32x32x16_bf16 v[96:111], a[20:23], a[36:39], v[96:111]
v_mfma_f32_32x32x16_bf16 v[112:127], a[20:23], a[40:43], v[112:127]
v_mfma_f32_32x32x16_bf16 v[128:143], a[20:23], a[44:47], v[128:143]
s_waitcnt lgkmcnt(0)
s_waitcnt vmcnt(6)
s_barrier
v_mfma_f32_32x32x16_bf16 v[16:31], a[48:51], a[64:67], v[16:31]
ds_read_b128 a[16:19], v5 offset:32768
ds_read_b128 a[20:23], v5 offset:34816
ds_read_b64_tr_b16 a[32:33], v6 offset:32768
ds_read_b64_tr_b16 a[34:35], v6 offset:34816
v_mfma_f32_32x32x16_bf16 v[32:47], a[48:51], a[68:71], v[32:47]
ds_read_b64_tr_b16 a[36:37], v7 offset:32768
ds_read_b64_tr_b16 a[38:39], v7 offset:34816
ds_read_b64_tr_b16 a[40:41], v9 offset:32768
ds_read_b64_tr_b16 a[42:43], v9 offset:34816
v_mfma_f32_32x32x16_bf16 v[48:63], a[48:51], a[72:75], v[48:63]
ds_read_b64_tr_b16 a[44:45], v15 offset:32768
ds_read_b64_tr_b16 a[46:47], v15 offset:34816
s_add_u32 s32, s60, 960
s_add_u32 m0, s36, 98304
s_nop 0
buffer_load_dwordx4 v1, s[52:55], s32 offen lds
v_mfma_f32_32x32x16_bf16 v[64:79], a[48:51], a[76:79], v[64:79]
s_add_u32 s32, s60, 74688
s_add_u32 m0, s36, 102400
s_nop 0
buffer_load_dwordx4 v1, s[52:55], s32 offen lds
s_add_u32 m0, s36, 114688
s_nop 0
buffer_load_dwordx4 v4, s[48:51], s61 offen lds
s_add_u32 s61, s61, s62
v_mfma_f32_32x32x16_bf16 v[80:95], a[52:55], a[64:67], v[80:95]
s_add_u32 m0, s36, 118784
s_nop 0
buffer_load_dwordx4 v4, s[48:51], s61 offen lds
s_add_u32 s61, s61, s62
s_add_u32 m0, s36, 122880
s_nop 0
buffer_load_dwordx4 v4, s[48:51], s61 offen lds
s_add_u32 s61, s61, s62
v_mfma_f32_32x32x16_bf16 v[96:111], a[52:55], a[68:71], v[96:111]
s_add_u32 m0, s36, 126976
s_nop 0
buffer_load_dwordx4 v4, s[48:51], s61 offen lds
s_add_u32 s61, s61, s62
v_mfma_f32_32x32x16_bf16 v[112:127], a[52:55], a[72:75], v[112:127]
v_mfma_f32_32x32x16_bf16 v[128:143], a[52:55], a[76:79], v[128:143]
s_waitcnt lgkmcnt(0)
v_mfma_f32_32x32x16_bf16 v[16:31], a[16:19], a[32:35], v[16:31]
ds_read_b128 a[48:51], v8 offset:32768
ds_read_b128 a[52:55], v8 offset:34816
v_mfma_f32_32x32x16_bf16 v[32:47], a[16:19], a[36:39], v[32:47]
ds_read_b64_tr_b16 a[64:65], v6 offset:40960
ds_read_b64_tr_b16 a[66:67], v6 offset:43008
v_mfma_f32_32x32x16_bf16 v[48:63], a[16:19], a[40:43], v[48:63]
ds_read_b64_tr_b16 a[68:69], v7 offset:40960
ds_read_b64_tr_b16 a[70:71], v7 offset:43008
v_mfma_f32_32x32x16_bf16 v[64:79], a[16:19], a[44:47], v[64:79]
ds_read_b64_tr_b16 a[72:73], v9 offset:40960
ds_read_b64_tr_b16 a[74:75], v9 offset:43008
v_mfma_f32_32x32x16_bf16 v[80:95], a[20:23], a[32:35], v[80:95]
ds_read_b64_tr_b16 a[76:77], v15 offset:40960
ds_read_b64_tr_b16 a[78:79], v15 offset:43008
v_mfma_f32_32x32x16_bf16 v[96:111], a[20:23], a[36:39], v[96:111]
v_mfma_f32_32x32x16_bf16 v[112:127], a[20:23], a[40:43], v[112:127]
v_mfma_f32_32x32x16_bf16 v[128:143], a[20:23], a[44:47], v[128:143]
s_waitcnt lgkmcnt(0)
s_waitcnt vmcnt(6)
s_barrier
v_mfma_f32_32x32x16_bf16 v[16:31], a[48:51], a[64:67], v[16:31]
ds_read_b128 a[16:19], v10
ds_read_b128 a[20:23], v10 offset:2048
ds_read_b64_tr_b16 a[32:33], v12
ds_read_b64_tr_b16 a[34:35], v12 offset:2048
v_mfma_f32_32x32x16_bf16 v[32:47], a[48:51], a[68:71], v[32:47]
ds_read_b64_tr_b16 a[36:37], v13
ds_read_b64_tr_b16 a[38:39], v13 offset:2048
ds_read_b64_tr_b16 a[40:41], v14
ds_read_b64_tr_b16 a[42:43], v14 offset:2048
v_mfma_f32_32x32x16_bf16 v[48:63], a[48:51], a[72:75], v[48:63]
ds_read_b64_tr_b16 a[44:45], v2
ds_read_b64_tr_b16 a[46:47], v2 offset:2048
s_add_u32 s32, s60, 1024
s_add_u32 m0, s36, 0
s_nop 0
buffer_load_dwordx4 v1, s[52:55], s32 offen lds
v_mfma_f32_32x32x16_bf16 v[64:79], a[48:51], a[76:79], v[64:79]
s_add_u32 s32, s60, 74752
s_add_u32 m0, s36, 4096
s_nop 0
buffer_load_dwordx4 v1, s[52:55], s32 offen lds
s_add_u32 m0, s36, 16384
s_nop 0
buffer_load_dwordx4 v4, s[48:51], s61 offen lds
s_add_u32 s61, s61, s62
v_mfma_f32_32x32x16_bf16 v[80:95], a[52:55], a[64:67], v[80:95]
s_add_u32 m0, s36, 20480
s_nop 0
buffer_load_dwordx4 v4, s[48:51], s61 offen lds
s_add_u32 s61, s61, s62
s_add_u32 m0, s36, 24576
s_nop 0
buffer_load_dwordx4 v4, s[48:51], s61 offen lds
s_add_u32 s61, s61, s62
v_mfma_f32_32x32x16_bf16 v[96:111], a[52:55], a[68:71], v[96:111]
s_add_u32 m0, s36, 28672
s_nop 0
buffer_load_dwordx4 v4, s[48:51], s61 offen lds
s_add_u32 s61, s61, s62
v_mfma_f32_32x32x16_bf16 v[112:127], a[52:55], a[72:75], v[112:127]
v_mfma_f32_32x32x16_bf16 v[128:143], a[52:55], a[76:79], v[128:143]
s_waitcnt lgkmcnt(0)
v_mfma_f32_32x32x16_bf16 v[16:31], a[16:19], a[32:35], v[16:31]
ds_read_b128 a[48:51], v11
ds_read_b128 a[52:55], v11 offset:2048
v_mfma_f32_32x32x16_bf16 v[32:47], a[16:19], a[36:39], v[32:47]
ds_read_b64_tr_b16 a[64:65], v12 offset:8192
ds_read_b64_tr_b16 a[66:67], v12 offset:10240
v_mfma_f32_32x32x16_bf16 v[48:63], a[16:19], a[40:43], v[48:63]
ds_read_b64_tr_b16 a[68:69], v13 offset:8192
ds_read_b64_tr_b16 a[70:71], v13 offset:10240
v_mfma_f32_32x32x16_bf16 v[64:79], a[16:19], a[44:47], v[64:79]
ds_read_b64_tr_b16 a[72:73], v14 offset:8192
ds_read_b64_tr_b16 a[74:75], v14 offset:10240
v_mfma_f32_32x32x16_bf16 v[80:95], a[20:23], a[32:35], v[80:95]
ds_read_b64_tr_b16 a[76:77], v2 offset:8192
ds_read_b64_tr_b16 a[78:79], v2 offset:10240
v_mfma_f32_32x32x16_bf16 v[96:111], a[20:23], a[36:39], v[96:111]
v_mfma_f32_32x32x16_bf16 v[112:127], a[20:23], a[40:43], v[112:127]
v_mfma_f32_32x32x16_bf16 v[128:143], a[20:23], a[44:47], v[128:143]
s_waitcnt lgkmcnt(0)
s_waitcnt vmcnt(6)
s_barrier
v_mfma_f32_32x32x16_bf16 v[16:31], a[48:51], a[64:67], v[16:31]
ds_read_b128 a[16:19], v10 offset:32768
ds_read_b128 a[20:23], v10 offset:34816
ds_read_b64_tr_b16 a[32:33], v12 offset:32768
ds_read_b64_tr_b16 a[34:35], v12 offset:34816
v_mfma_f32_32x32x16_bf16 v[32:47], a[48:51], a[68:71], v[32:47]
ds_read_b64_tr_b16 a[36:37], v13 offset:32768
ds_read_b64_tr_b16 a[38:39], v13 offset:34816
ds_read_b64_tr_b16 a[40:41], v14 offset:32768
ds_read_b64_tr_b16 a[42:43], v14 offset:34816
v_mfma_f32_32x32x16_bf16 v[48:63], a[48:51], a[72:75], v[48:63]
ds_read_b64_tr_b16 a[44:45], v2 offset:32768
ds_read_b64_tr_b16 a[46:47], v2 offset:34816
s_add_u32 s32, s60, 1088
s_add_u32 m0, s36, 32768
s_nop 0
buffer_load_dwordx4 v1, s[52:55], s32 offen lds
v_mfma_f32_32x32x16_bf16 v[64:79], a[48:51], a[76:79], v[64:79]
s_add_u32 s32, s60, 74816
s_add_u32 m0, s36, 36864
s_nop 0
buffer_load_dwordx4 v1, s[52:55], s32 offen lds
s_add_u32 m0, s36, 49152
s_nop 0
buffer_load_dwordx4 v4, s[48:51], s61 offen lds
s_add_u32 s61, s61, s62
v_mfma_f32_32x32x16_bf16 v[80:95], a[52:55], a[64:67], v[80:95]
s_add_u32 m0, s36, 53248
s_nop 0
buffer_load_dwordx4 v4, s[48:51], s61 offen lds
s_add_u32 s61, s61, s62
s_add_u32 m0, s36, 57344
s_nop 0
buffer_load_dwordx4 v4, s[48:51], s61 offen lds
s_add_u32 s61, s61, s62
v_mfma_f32_32x32x16_bf16 v[96:111], a[52:55], a[68:71], v[96:111]
s_add_u32 m0, s36, 61440
s_nop 0
buffer_load_dwordx4 v4, s[48:51], s61 offen lds
s_add_u32 s61, s61, s62
v_mfma_f32_32x32x16_bf16 v[112:127], a[52:55], a[72:75], v[112:127]
v_mfma_f32_32x32x16_bf16 v[128:143], a[52:55], a[76:79], v[128:143]
s_waitcnt lgkmcnt(0)
v_mfma_f32_32x32x16_bf16 v[16:31], a[16:19], a[32:35], v[16:31]
ds_read_b128 a[48:51], v11 offset:32768
ds_read_b128 a[52:55], v11 offset:34816
v_mfma_f32_32x32x16_bf16 v[32:47], a[16:19], a[36:39], v[32:47]
ds_read_b64_tr_b16 a[64:65], v12 offset:40960
ds_read_b64_tr_b16 a[66:67], v12 offset:43008
v_mfma_f32_32x32x16_bf16 v[48:63], a[16:19], a[40:43], v[48:63]
ds_read_b64_tr_b16 a[68:69], v13 offset:40960
ds_read_b64_tr_b16 a[70:71], v13 offset:43008
v_mfma_f32_32x32x16_bf16 v[64:79], a[16:19], a[44:47], v[64:79]
ds_read_b64_tr_b16 a[72:73], v14 offset:40960
ds_read_b64_tr_b16 a[74:75], v14 offset:43008
v_mfma_f32_32x32x16_bf16 v[80:95], a[20:23], a[32:35], v[80:95]
ds_read_b64_tr_b16 a[76:77], v2 offset:40960
ds_read_b64_tr_b16 a[78:79], v2 offset:43008
v_mfma_f32_32x32x16_bf16 v[96:111], a[20:23], a[36:39], v[96:111]
v_mfma_f32_32x32x16_bf16 v[112:127], a[20:23], a[40:43], v[112:127]
v_mfma_f32_32x32x16_bf16 v[128:143], a[20:23], a[44:47], v[128:143]
s_waitcnt lgkmcnt(0)
s_waitcnt vmcnt(6)
s_barrier
v_mfma_f32_32x32x16_bf16 v[16:31], a[48:51], a[64:67], v[16:31]
ds_read_b128 a[16:19], v5
ds_read_b128 a[20:23], v5 offset:2048
v_mfma_f32_32x32x16_bf16 v[32:47], a[48:51], a[68:71], v[32:47]
ds_read_b64_tr_b16 a[32:33], v6
ds_read_b64_tr_b16 a[34:35], v6 offset:2048
v_mfma_f32_32x32x16_bf16 v[48:63], a[48:51], a[72:75], v[48:63]
ds_read_b64_tr_b16 a[36:37], v7
ds_read_b64_tr_b16 a[38:39], v7 offset:2048
v_mfma_f32_32x32x16_bf16 v[64:79], a[48:51], a[76:79], v[64:79]
ds_read_b64_tr_b16 a[40:41], v9
ds_read_b64_tr_b16 a[42:43], v9 offset:2048
v_mfma_f32_32x32x16_bf16 v[80:95], a[52:55], a[64:67], v[80:95]
ds_read_b64_tr_b16 a[44:45], v15
ds_read_b64_tr_b16 a[46:47], v15 offset:2048
v_mfma_f32_32x32x16_bf16 v[96:111], a[52:55], a[68:71], v[96:111]
v_mfma_f32_32x32x16_bf16 v[112:127], a[52:55], a[72:75], v[112:127]
v_mfma_f32_32x32x16_bf16 v[128:143], a[52:55], a[76:79], v[128:143]
s_waitcnt lgkmcnt(0)
v_mfma_f32_32x32x16_bf16 v[16:31], a[16:19], a[32:35], v[16:31]
ds_read_b128 a[48:51], v8
ds_read_b128 a[52:55], v8 offset:2048
v_mfma_f32_32x32x16_bf16 v[32:47], a[16:19], a[36:39], v[32:47]
ds_read_b64_tr_b16 a[64:65], v6 offset:8192
ds_read_b64_tr_b16 a[66:67], v6 offset:10240
v_mfma_f32_32x32x16_bf16 v[48:63], a[16:19], a[40:43], v[48:63]
ds_read_b64_tr_b16 a[68:69], v7 offset:8192
ds_read_b64_tr_b16 a[70:71], v7 offset:10240
v_mfma_f32_32x32x16_bf16 v[64:79], a[16:19], a[44:47], v[64:79]
ds_read_b64_tr_b16 a[72:73], v9 offset:8192
ds_read_b64_tr_b16 a[74:75], v9 offset:10240
v_mfma_f32_32x32x16_bf16 v[80:95], a[20:23], a[32:35], v[80:95]
ds_read_b64_tr_b16 a[76:77], v15 offset:8192
ds_read_b64_tr_b16 a[78:79], v15 offset:10240
v_mfma_f32_32x32x16_bf16 v[96:111], a[20:23], a[36:39], v[96:111]
v_mfma_f32_32x32x16_bf16 v[112:127], a[20:23], a[40:43], v[112:127]
v_mfma_f32_32x32x16_bf16 v[128:143], a[20:23], a[44:47], v[128:143]
s_waitcnt lgkmcnt(0)
s_waitcnt vmcnt(0)
s_barrier
v_mfma_f32_32x32x16_bf16 v[16:31], a[48:51], a[64:67], v[16:31]
ds_read_b128 a[16:19], v5 offset:32768
ds_read_b128 a[20:23], v5 offset:34816
v_mfma_f32_32x32x16_bf16 v[32:47], a[48:51], a[68:71], v[32:47]
ds_read_b64_tr_b16 a[32:33], v6 offset:32768
ds_read_b64_tr_b16 a[34:35], v6 offset:34816
v_mfma_f32_32x32x16_bf16 v[48:63], a[48:51], a[72:75], v[48:63]
ds_read_b64_tr_b16 a[36:37], v7 offset:32768
ds_read_b64_tr_b16 a[38:39], v7 offset:34816
v_mfma_f32_32x32x16_bf16 v[64:79], a[48:51], a[76:79], v[64:79]
ds_read_b64_tr_b16 a[40:41], v9 offset:32768
ds_read_b64_tr_b16 a[42:43], v9 offset:34816
v_mfma_f32_32x32x16_bf16 v[80:95], a[52:55], a[64:67], v[80:95]
ds_read_b64_tr_b16 a[44:45], v15 offset:32768
ds_read_b64_tr_b16 a[46:47], v15 offset:34816
v_mfma_f32_32x32x16_bf16 v[96:111], a[52:55], a[68:71], v[96:111]
v_mfma_f32_32x32x16_bf16 v[112:127], a[52:55], a[72:75], v[112:127]
v_mfma_f32_32x32x16_bf16 v[128:143], a[52:55], a[76:79], v[128:143]
s_waitcnt lgkmcnt(0)
v_mfma_f32_32x32x16_bf16 v[16:31], a[16:19], a[32:35], v[16:31]
ds_read_b128 a[48:51], v8 offset:32768
ds_read_b128 a[52:55], v8 offset:34816
v_mfma_f32_32x32x16_bf16 v[32:47], a[16:19], a[36:39], v[32:47]
ds_read_b64_tr_b16 a[64:65], v6 offset:40960
ds_read_b64_tr_b16 a[66:67], v6 offset:43008
v_mfma_f32_32x32x16_bf16 v[48:63], a[16:19], a[40:43], v[48:63]
ds_read_b64_tr_b16 a[68:69], v7 offset:40960
ds_read_b64_tr_b16 a[70:71], v7 offset:43008
v_mfma_f32_32x32x16_bf16 v[64:79], a[16:19], a[44:47], v[64:79]
ds_read_b64_tr_b16 a[72:73], v9 offset:40960
ds_read_b64_tr_b16 a[74:75], v9 offset:43008
v_mfma_f32_32x32x16_bf16 v[80:95], a[20:23], a[32:35], v[80:95]
ds_read_b64_tr_b16 a[76:77], v15 offset:40960
ds_read_b64_tr_b16 a[78:79], v15 offset:43008
v_mfma_f32_32x32x16_bf16 v[96:111], a[20:23], a[36:39], v[96:111]
v_mfma_f32_32x32x16_bf16 v[112:127], a[20:23], a[40:43], v[112:127]
v_mfma_f32_32x32x16_bf16 v[128:143], a[20:23], a[44:47], v[128:143]
s_waitcnt lgkmcnt(0)
v_mfma_f32_32x32x16_bf16 v[16:31], a[48:51], a[64:67], v[16:31]
v_mfma_f32_32x32x16_bf16 v[32:47], a[48:51], a[68:71], v[32:47]
v_mfma_f32_32x32x16_bf16 v[48:63], a[48:51], a[72:75], v[48:63]
v_mfma_f32_32x32x16_bf16 v[64:79], a[48:51], a[76:79], v[64:79]
v_mfma_f32_32x32x16_bf16 v[80:95], a[52:55], a[64:67], v[80:95]
v_mfma_f32_32x32x16_bf16 v[96:111], a[52:55], a[68:71], v[96:111]
v_mfma_f32_32x32x16_bf16 v[112:127], a[52:55], a[72:75], v[112:127]
v_mfma_f32_32x32x16_bf16 v[128:143], a[52:55], a[76:79], v[128:143]
GE_16:
v_readfirstlane_b32 s70, v3
s_nop 15
v_and_b32 v10, 31, v0
v_lshrrev_b32 v11, 5, v0
s_lshr_b32 s37, s19, 1
s_and_b32 s38, s19, 1
s_lshl_b32 s39, s63, 2
s_sub_u32 s33, 2, s71
s_lshl_b32 s32, s37, s33
s_add_u32 s39, s39, s32
s_mov_b32 s66, 0x3f800000
s_cmp_eq_u32 s59, 0
s_cselect_b32 s66, 0x3e0293ee, s66
s_cmp_eq_u32 s59, 3
s_cselect_b32 s66, 0x3eae1a93, s66
s_mov_b32 s67, s66
s_cmp_ge_u32 s59, 3
s_cbranch_scc1 EA_19
s_lshl_b32 s32, s58, 1
s_add_u32 s32, s32, s38
s_cmp_eq_u32 s59, 2
s_mov_b32 s33, 1064960
s_cselect_b32 s33, 524288, s33
s_mov_b32 s34, 16384
s_cselect_b32 s34, 8192, s34
s_mov_b32 s35, 0x1600000
s_cselect_b32 s35, 0x3800000, s35
s_cselect_b32 s40, 8, 0
s_add_u32 s40, s40, s57
s_mul_i32 s32, s32, s33
s_mul_i32 s33, s39, s34
s_add_u32 s32, s32, s33
s_add_u32 s32, s32, s35
s_cmp_eq_u32 s59, 1
s_cselect_b32 s41, 8192, 0
s_cselect_b32 s33, 10, 12
s_mov_b32 s35, 1024
s_cselect_b32 s35, 2048, s35
s_add_u32 s32, s32, s41
s_add_u32 s64, s14, s32
s_addc_u32 s65, s15, 0
v_lshrrev_b32 v12, 4, v10
v_lshlrev_b32 v12, s33, v12
v_and_b32 v13, 15, v0
v_lshl_add_u32 v13, v11, 4, v13
v_lshl_add_u32 v12, v13, 4, v12
v_add_u32 v13, s35, v12
v_add_u32 v14, s35, v13
v_add_u32 v15, s35, v14
v_pk_mul_f32 v[16:17], v[16:17], s[66:67]
v_pk_mul_f32 v[18:19], v[18:19], s[66:67]
v_pk_mul_f32 v[20:21], v[20:21], s[66:67]
v_pk_mul_f32 v[22:23], v[22:23], s[66:67]
v_pk_mul_f32 v[24:25], v[24:25], s[66:67]
v_pk_mul_f32 v[26:27], v[26:27], s[66:67]
v_pk_mul_f32 v[28:29], v[28:29], s[66:67]
v_pk_mul_f32 v[30:31], v[30:31], s[66:67]
v_cvt_pk_bf16_f32 v16, v16, v17
v_cvt_pk_bf16_f32 v17, v18, v19
v_cvt_pk_bf16_f32 v18, v20, v21
v_cvt_pk_bf16_f32 v19, v22, v23
v_cvt_pk_bf16_f32 v20, v24, v25
v_cvt_pk_bf16_f32 v21, v26, v27
v_cvt_pk_bf16_f32 v22, v28, v29
v_cvt_pk_bf16_f32 v23, v30, v31
s_waitcnt vmcnt(6)
global_store_dwordx4 v12, v[16:19], s[64:65] sc1
global_store_dwordx4 v12, v[20:23], s[64:65] offset:512 sc1
v_pk_mul_f32 v[32:33], v[32:33], s[66:67]
v_pk_mul_f32 v[34:35], v[34:35], s[66:67]
v_pk_mul_f32 v[36:37], v[36:37], s[66:67]
v_pk_mul_f32 v[38:39], v[38:39], s[66:67]
v_pk_mul_f32 v[40:41], v[40:41], s[66:67]
v_pk_mul_f32 v[42:43], v[42:43], s[66:67]
v_pk_mul_f32 v[44:45], v[44:45], s[66:67]
v_pk_mul_f32 v[46:47], v[46:47], s[66:67]
v_cvt_pk_bf16_f32 v32, v32, v33
v_cvt_pk_bf16_f32 v33, v34, v35
v_cvt_pk_bf16_f32 v34, v36, v37
v_cvt_pk_bf16_f32 v35, v38, v39
v_cvt_pk_bf16_f32 v36, v40, v41
v_cvt_pk_bf16_f32 v37, v42, v43
v_cvt_pk_bf16_f32 v38, v44, v45
v_cvt_pk_bf16_f32 v39, v46, v47
s_waitcnt vmcnt(6)
global_store_dwordx4 v13, v[32:35], s[64:65] sc1
global_store_dwordx4 v13, v[36:39], s[64:65] offset:512 sc1
v_pk_mul_f32 v[48:49], v[48:49], s[66:67]
v_pk_mul_f32 v[50:51], v[50:51], s[66:67]
v_pk_mul_f32 v[52:53], v[52:53], s[66:67]
v_pk_mul_f32 v[54:55], v[54:55], s[66:67]
v_pk_mul_f32 v[56:57], v[56:57], s[66:67]
v_pk_mul_f32 v[58:59], v[58:59], s[66:67]
v_pk_mul_f32 v[60:61], v[60:61], s[66:67]
v_pk_mul_f32 v[62:63], v[62:63], s[66:67]
v_cvt_pk_bf16_f32 v48, v48, v49
v_cvt_pk_bf16_f32 v49, v50, v51
v_cvt_pk_bf16_f32 v50, v52, v53
v_cvt_pk_bf16_f32 v51, v54, v55
v_cvt_pk_bf16_f32 v52, v56, v57
v_cvt_pk_bf16_f32 v53, v58, v59
v_cvt_pk_bf16_f32 v54, v60, v61
v_cvt_pk_bf16_f32 v55, v62, v63
s_waitcnt vmcnt(6)
global_store_dwordx4 v14, v[48:51], s[64:65] sc1
global_store_dwordx4 v14, v[52:55], s[64:65] offset:512 sc1
v_pk_mul_f32 v[64:65], v[64:65], s[66:67]
v_pk_mul_f32 v[66:67], v[66:67], s[66:67]
v_pk_mul_f32 v[68:69], v[68:69], s[66:67]
v_pk_mul_f32 v[70:71], v[70:71], s[66:67]
v_pk_mul_f32 v[72:73], v[72:73], s[66:67]
v_pk_mul_f32 v[74:75], v[74:75], s[66:67]
v_pk_mul_f32 v[76:77], v[76:77], s[66:67]
v_pk_mul_f32 v[78:79], v[78:79], s[66:67]
v_cvt_pk_bf16_f32 v64, v64, v65
v_cvt_pk_bf16_f32 v65, v66, v67
v_cvt_pk_bf16_f32 v66, v68, v69
v_cvt_pk_bf16_f32 v67, v70, v71
v_cvt_pk_bf16_f32 v68, v72, v73
v_cvt_pk_bf16_f32 v69, v74, v75
v_cvt_pk_bf16_f32 v70, v76, v77
v_cvt_pk_bf16_f32 v71, v78, v79
s_waitcnt vmcnt(6)
global_store_dwordx4 v15, v[64:67], s[64:65] sc1
global_store_dwordx4 v15, v[68:71], s[64:65] offset:512 sc1
s_add_u32 s64, s64, s34
s_addc_u32 s65, s65, 0
v_pk_mul_f32 v[80:81], v[80:81], s[66:67]
v_pk_mul_f32 v[82:83], v[82:83], s[66:67]
v_pk_mul_f32 v[84:85], v[84:85], s[66:67]
v_pk_mul_f32 v[86:87], v[86:87], s[66:67]
v_pk_mul_f32 v[88:89], v[88:89], s[66:67]
v_pk_mul_f32 v[90:91], v[90:91], s[66:67]
v_pk_mul_f32 v[92:93], v[92:93], s[66:67]
v_pk_mul_f32 v[94:95], v[94:95], s[66:67]
v_cvt_pk_bf16_f32 v80, v80, v81
v_cvt_pk_bf16_f32 v81, v82, v83
v_cvt_pk_bf16_f32 v82, v84, v85
v_cvt_pk_bf16_f32 v83, v86, v87
v_cvt_pk_bf16_f32 v84, v88, v89
v_cvt_pk_bf16_f32 v85, v90, v91
v_cvt_pk_bf16_f32 v86, v92, v93
v_cvt_pk_bf16_f32 v87, v94, v95
s_waitcnt vmcnt(6)
global_store_dwordx4 v12, v[80:83], s[64:65] sc1
global_store_dwordx4 v12, v[84:87], s[64:65] offset:512 sc1
v_pk_mul_f32 v[96:97], v[96:97], s[66:67]
v_pk_mul_f32 v[98:99], v[98:99], s[66:67]
v_pk_mul_f32 v[100:101], v[100:101], s[66:67]
v_pk_mul_f32 v[102:103], v[102:103], s[66:67]
v_pk_mul_f32 v[104:105], v[104:105], s[66:67]
v_pk_mul_f32 v[106:107], v[106:107], s[66:67]
v_pk_mul_f32 v[108:109], v[108:109], s[66:67]
v_pk_mul_f32 v[110:111], v[110:111], s[66:67]
v_cvt_pk_bf16_f32 v96, v96, v97
v_cvt_pk_bf16_f32 v97, v98, v99
v_cvt_pk_bf16_f32 v98, v100, v101
v_cvt_pk_bf16_f32 v99, v102, v103
v_cvt_pk_bf16_f32 v100, v104, v105
v_cvt_pk_bf16_f32 v101, v106, v107
v_cvt_pk_bf16_f32 v102, v108, v109
v_cvt_pk_bf16_f32 v103, v110, v111
s_waitcnt vmcnt(6)
global_store_dwordx4 v13, v[96:99], s[64:65] sc1
global_store_dwordx4 v13, v[100:103], s[64:65] offset:512 sc1
v_pk_mul_f32 v[112:113], v[112:113], s[66:67]
v_pk_mul_f32 v[114:115], v[114:115], s[66:67]
v_pk_mul_f32 v[116:117], v[116:117], s[66:67]
v_pk_mul_f32 v[118:119], v[118:119], s[66:67]
v_pk_mul_f32 v[120:121], v[120:121], s[66:67]
v_pk_mul_f32 v[122:123], v[122:123], s[66:67]
v_pk_mul_f32 v[124:125], v[124:125], s[66:67]
v_pk_mul_f32 v[126:127], v[126:127], s[66:67]
v_cvt_pk_bf16_f32 v112, v112, v113
v_cvt_pk_bf16_f32 v113, v114, v115
v_cvt_pk_bf16_f32 v114, v116, v117
v_cvt_pk_bf16_f32 v115, v118, v119
v_cvt_pk_bf16_f32 v116, v120, v121
v_cvt_pk_bf16_f32 v117, v122, v123
v_cvt_pk_bf16_f32 v118, v124, v125
v_cvt_pk_bf16_f32 v119, v126, v127
s_waitcnt vmcnt(6)
global_store_dwordx4 v14, v[112:115], s[64:65] sc1
global_store_dwordx4 v14, v[116:119], s[64:65] offset:512 sc1
v_pk_mul_f32 v[128:129], v[128:129], s[66:67]
v_pk_mul_f32 v[130:131], v[130:131], s[66:67]
v_pk_mul_f32 v[132:133], v[132:133], s[66:67]
v_pk_mul_f32 v[134:135], v[134:135], s[66:67]
v_pk_mul_f32 v[136:137], v[136:137], s[66:67]
v_pk_mul_f32 v[138:139], v[138:139], s[66:67]
v_pk_mul_f32 v[140:141], v[140:141], s[66:67]
v_pk_mul_f32 v[142:143], v[142:143], s[66:67]
v_cvt_pk_bf16_f32 v128, v128, v129
v_cvt_pk_bf16_f32 v129, v130, v131
v_cvt_pk_bf16_f32 v130, v132, v133
v_cvt_pk_bf16_f32 v131, v134, v135
v_cvt_pk_bf16_f32 v132, v136, v137
v_cvt_pk_bf16_f32 v133, v138, v139
v_cvt_pk_bf16_f32 v134, v140, v141
v_cvt_pk_bf16_f32 v135, v142, v143
s_waitcnt vmcnt(6)
global_store_dwordx4 v15, v[128:131], s[64:65] sc1
global_store_dwordx4 v15, v[132:135], s[64:65] offset:512 sc1
s_add_u32 s64, s64, s34
s_addc_u32 s65, s65, 0
s_cmp_lg_u32 s71, 0
s_cbranch_scc1 ED_20
v_pk_mul_f32 v[144:145], v[144:145], s[66:67]
v_pk_mul_f32 v[146:147], v[146:147], s[66:67]
v_pk_mul_f32 v[148:149], v[148:149], s[66:67]
v_pk_mul_f32 v[150:151], v[150:151], s[66:67]
v_pk_mul_f32 v[152:153], v[152:153], s[66:67]
v_pk_mul_f32 v[154:155], v[154:155], s[66:67]
v_pk_mul_f32 v[156:157], v[156:157], s[66:67]
v_pk_mul_f32 v[158:159], v[158:159], s[66:67]
v_cvt_pk_bf16_f32 v144, v144, v145
v_cvt_pk_bf16_f32 v145, v146, v147
v_cvt_pk_bf16_f32 v146, v148, v149
v_cvt_pk_bf16_f32 v147, v150, v151
v_cvt_pk_bf16_f32 v148, v152, v153
v_cvt_pk_bf16_f32 v149, v154, v155
v_cvt_pk_bf16_f32 v150, v156, v157
v_cvt_pk_bf16_f32 v151, v158, v159
s_waitcnt vmcnt(6)
global_store_dwordx4 v12, v[144:147], s[64:65] sc1
global_store_dwordx4 v12, v[148:151], s[64:65] offset:512 sc1
v_pk_mul_f32 v[160:161], v[160:161], s[66:67]
v_pk_mul_f32 v[162:163], v[162:163], s[66:67]
v_pk_mul_f32 v[164:165], v[164:165], s[66:67]
v_pk_mul_f32 v[166:167], v[166:167], s[66:67]
v_pk_mul_f32 v[168:169], v[168:169], s[66:67]
v_pk_mul_f32 v[170:171], v[170:171], s[66:67]
v_pk_mul_f32 v[172:173], v[172:173], s[66:67]
v_pk_mul_f32 v[174:175], v[174:175], s[66:67]
v_cvt_pk_bf16_f32 v160, v160, v161
v_cvt_pk_bf16_f32 v161, v162, v163
v_cvt_pk_bf16_f32 v162, v164, v165
v_cvt_pk_bf16_f32 v163, v166, v167
v_cvt_pk_bf16_f32 v164, v168, v169
v_cvt_pk_bf16_f32 v165, v170, v171
v_cvt_pk_bf16_f32 v166, v172, v173
v_cvt_pk_bf16_f32 v167, v174, v175
s_waitcnt vmcnt(6)
global_store_dwordx4 v13, v[160:163], s[64:65] sc1
global_store_dwordx4 v13, v[164:167], s[64:65] offset:512 sc1
v_pk_mul_f32 v[176:177], v[176:177], s[66:67]
v_pk_mul_f32 v[178:179], v[178:179], s[66:67]
v_pk_mul_f32 v[180:181], v[180:181], s[66:67]
v_pk_mul_f32 v[182:183], v[182:183], s[66:67]
v_pk_mul_f32 v[184:185], v[184:185], s[66:67]
v_pk_mul_f32 v[186:187], v[186:187], s[66:67]
v_pk_mul_f32 v[188:189], v[188:189], s[66:67]
v_pk_mul_f32 v[190:191], v[190:191], s[66:67]
v_cvt_pk_bf16_f32 v176, v176, v177
v_cvt_pk_bf16_f32 v177, v178, v179
v_cvt_pk_bf16_f32 v178, v180, v181
v_cvt_pk_bf16_f32 v179, v182, v183
v_cvt_pk_bf16_f32 v180, v184, v185
v_cvt_pk_bf16_f32 v181, v186, v187
v_cvt_pk_bf16_f32 v182, v188, v189
v_cvt_pk_bf16_f32 v183, v190, v191
s_waitcnt vmcnt(6)
global_store_dwordx4 v14, v[176:179], s[64:65] sc1
global_store_dwordx4 v14, v[180:183], s[64:65] offset:512 sc1
v_pk_mul_f32 v[192:193], v[192:193], s[66:67]
v_pk_mul_f32 v[194:195], v[194:195], s[66:67]
v_pk_mul_f32 v[196:197], v[196:197], s[66:67]
v_pk_mul_f32 v[198:199], v[198:199], s[66:67]
v_pk_mul_f32 v[200:201], v[200:201], s[66:67]
v_pk_mul_f32 v[202:203], v[202:203], s[66:67]
v_pk_mul_f32 v[204:205], v[204:205], s[66:67]
v_pk_mul_f32 v[206:207], v[206:207], s[66:67]
v_cvt_pk_bf16_f32 v192, v192, v193
v_cvt_pk_bf16_f32 v193, v194, v195
v_cvt_pk_bf16_f32 v194, v196, v197
v_cvt_pk_bf16_f32 v195, v198, v199
v_cvt_pk_bf16_f32 v196, v200, v201
v_cvt_pk_bf16_f32 v197, v202, v203
v_cvt_pk_bf16_f32 v198, v204, v205
v_cvt_pk_bf16_f32 v199, v206, v207
s_waitcnt vmcnt(6)
global_store_dwordx4 v15, v[192:195], s[64:65] sc1
global_store_dwordx4 v15, v[196:199], s[64:65] offset:512 sc1
s_add_u32 s64, s64, s34
s_addc_u32 s65, s65, 0
v_pk_mul_f32 v[208:209], v[208:209], s[66:67]
v_pk_mul_f32 v[210:211], v[210:211], s[66:67]
v_pk_mul_f32 v[212:213], v[212:213], s[66:67]
v_pk_mul_f32 v[214:215], v[214:215], s[66:67]
v_pk_mul_f32 v[216:217], v[216:217], s[66:67]
v_pk_mul_f32 v[218:219], v[218:219], s[66:67]
v_pk_mul_f32 v[220:221], v[220:221], s[66:67]
v_pk_mul_f32 v[222:223], v[222:223], s[66:67]
v_cvt_pk_bf16_f32 v208, v208, v209
v_cvt_pk_bf16_f32 v209, v210, v211
v_cvt_pk_bf16_f32 v210, v212, v213
v_cvt_pk_bf16_f32 v211, v214, v215
v_cvt_pk_bf16_f32 v212, v216, v217
v_cvt_pk_bf16_f32 v213, v218, v219
v_cvt_pk_bf16_f32 v214, v220, v221
v_cvt_pk_bf16_f32 v215, v222, v223
s_waitcnt vmcnt(6)
global_store_dwordx4 v12, v[208:211], s[64:65] sc1
global_store_dwordx4 v12, v[212:215], s[64:65] offset:512 sc1
v_pk_mul_f32 v[224:225], v[224:225], s[66:67]
v_pk_mul_f32 v[226:227], v[226:227], s[66:67]
v_pk_mul_f32 v[228:229], v[228:229], s[66:67]
v_pk_mul_f32 v[230:231], v[230:231], s[66:67]
v_pk_mul_f32 v[232:233], v[232:233], s[66:67]
v_pk_mul_f32 v[234:235], v[234:235], s[66:67]
v_pk_mul_f32 v[236:237], v[236:237], s[66:67]
v_pk_mul_f32 v[238:239], v[238:239], s[66:67]
v_cvt_pk_bf16_f32 v224, v224, v225
v_cvt_pk_bf16_f32 v225, v226, v227
v_cvt_pk_bf16_f32 v226, v228, v229
v_cvt_pk_bf16_f32 v227, v230, v231
v_cvt_pk_bf16_f32 v228, v232, v233
v_cvt_pk_bf16_f32 v229, v234, v235
v_cvt_pk_bf16_f32 v230, v236, v237
v_cvt_pk_bf16_f32 v231, v238, v239
s_waitcnt vmcnt(6)
global_store_dwordx4 v13, v[224:227], s[64:65] sc1
global_store_dwordx4 v13, v[228:231], s[64:65] offset:512 sc1
v_pk_mul_f32 v[240:241], v[240:241], s[66:67]
v_pk_mul_f32 v[242:243], v[242:243], s[66:67]
v_pk_mul_f32 v[244:245], v[244:245], s[66:67]
v_pk_mul_f32 v[246:247], v[246:247], s[66:67]
v_pk_mul_f32 v[248:249], v[248:249], s[66:67]
v_pk_mul_f32 v[250:251], v[250:251], s[66:67]
v_pk_mul_f32 v[252:253], v[252:253], s[66:67]
v_pk_mul_f32 v[254:255], v[254:255], s[66:67]
v_cvt_pk_bf16_f32 v240, v240, v241
v_cvt_pk_bf16_f32 v241, v242, v243
v_cvt_pk_bf16_f32 v242, v244, v245
v_cvt_pk_bf16_f32 v243, v246, v247
v_cvt_pk_bf16_f32 v244, v248, v249
v_cvt_pk_bf16_f32 v245, v250, v251
v_cvt_pk_bf16_f32 v246, v252, v253
v_cvt_pk_bf16_f32 v247, v254, v255
s_waitcnt vmcnt(6)
global_store_dwordx4 v14, v[240:243], s[64:65] sc1
global_store_dwordx4 v14, v[244:247], s[64:65] offset:512 sc1
v_accvgpr_read_b32 v16, a0
v_accvgpr_read_b32 v17, a1
v_accvgpr_read_b32 v18, a2
v_accvgpr_read_b32 v19, a3
v_accvgpr_read_b32 v20, a4
v_accvgpr_read_b32 v21, a5
v_accvgpr_read_b32 v22, a6
v_accvgpr_read_b32 v23, a7
v_accvgpr_read_b32 v24, a8
v_accvgpr_read_b32 v25, a9
v_accvgpr_read_b32 v26, a10
v_accvgpr_read_b32 v27, a11
v_accvgpr_read_b32 v28, a12
v_accvgpr_read_b32 v29, a13
v_accvgpr_read_b32 v30, a14
v_accvgpr_read_b32 v31, a15
v_pk_mul_f32 v[16:17], v[16:17], s[66:67]
v_pk_mul_f32 v[18:19], v[18:19], s[66:67]
v_pk_mul_f32 v[20:21], v[20:21], s[66:67]
v_pk_mul_f32 v[22:23], v[22:23], s[66:67]
v_pk_mul_f32 v[24:25], v[24:25], s[66:67]
v_pk_mul_f32 v[26:27], v[26:27], s[66:67]
v_pk_mul_f32 v[28:29], v[28:29], s[66:67]
v_pk_mul_f32 v[30:31], v[30:31], s[66:67]
v_cvt_pk_bf16_f32 v16, v16, v17
v_cvt_pk_bf16_f32 v17, v18, v19
v_cvt_pk_bf16_f32 v18, v20, v21
v_cvt_pk_bf16_f32 v19, v22, v23
v_cvt_pk_bf16_f32 v20, v24, v25
v_cvt_pk_bf16_f32 v21, v26, v27
v_cvt_pk_bf16_f32 v22, v28, v29
v_cvt_pk_bf16_f32 v23, v30, v31
s_waitcnt vmcnt(6)
global_store_dwordx4 v15, v[16:19], s[64:65] sc1
global_store_dwordx4 v15, v[20:23], s[64:65] offset:512 sc1
s_branch ED_20
EA_19:
s_and_b32 s32, s58, 3
s_add_u32 s40, s32, 16
s_lshl_b32 s32, s32, 3
s_lshl_b32 s33, s38, 2
s_add_u32 s41, s32, s33
s_cmp_eq_u32 s59, 5
s_cbranch_scc1 EV_21
s_cmp_eq_u32 s59, 3
s_mov_b32 s33, 151552
s_cselect_b32 s33, 73728, s33
s_mov_b32 s35, 0x4c00000
s_cselect_b32 s35, 0x4800000, s35
s_mov_b32 s34, 1024
s_cselect_b32 s34, 1152, s34
s_mov_b32 s42, 128
s_cselect_b32 s42, 1152, s42
s_mov_b32 s43, 65536
s_cselect_b32 s43, 1024, s43
s_mul_i32 s32, s41, s33
s_add_u32 s32, s32, s35
s_add_u32 s64, s14, s32
s_addc_u32 s65, s15, 0
s_mul_i32 s44, s39, s34
s_mul_i32 s45, s39, s42
s_add_u32 s45, s45, s43
v_lshlrev_b32 v12, 4, v0
v_add_u32 v12, s44, v12
v_lshlrev_b32 v13, 2, v10
v_add_u32 v13, s45, v13
v_mov_b32 v14, v12
v_mov_b32 v15, v13
v_pk_mul_f32 v[16:17], v[16:17], s[66:67]
v_pk_mul_f32 v[18:19], v[18:19], s[66:67]
v_pk_mul_f32 v[20:21], v[20:21], s[66:67]
v_pk_mul_f32 v[22:23], v[22:23], s[66:67]
v_pk_mul_f32 v[24:25], v[24:25], s[66:67]
v_cvt_pk_bf16_f32 v16, v16, v17
v_cvt_pk_bf16_f32 v17, v18, v19
v_cvt_pk_bf16_f32 v18, v20, v21
v_cvt_pk_bf16_f32 v19, v22, v23
v_cvt_pk_bf16_f32 v20, v24, v25
s_waitcnt vmcnt(6)
global_store_dwordx4 v14, v[16:19], s[64:65] sc1
s_mov_b64 exec, 0xffffffff
global_store_dword v15, v20, s[64:65] sc1
s_mov_b64 exec, -1
v_add_u32 v14, s34, v14
v_add_u32 v15, s42, v15
v_pk_mul_f32 v[80:81], v[80:81], s[66:67]
v_pk_mul_f32 v[82:83], v[82:83], s[66:67]
v_pk_mul_f32 v[84:85], v[84:85], s[66:67]
v_pk_mul_f32 v[86:87], v[86:87], s[66:67]
v_pk_mul_f32 v[88:89], v[88:89], s[66:67]
v_cvt_pk_bf16_f32 v80, v80, v81
v_cvt_pk_bf16_f32 v81, v82, v83
v_cvt_pk_bf16_f32 v82, v84, v85
v_cvt_pk_bf16_f32 v83, v86, v87
v_cvt_pk_bf16_f32 v84, v88, v89
s_waitcnt vmcnt(6)
global_store_dwordx4 v14, v[80:83], s[64:65] sc1
s_mov_b64 exec, 0xffffffff
global_store_dword v15, v84, s[64:65] sc1
s_mov_b64 exec, -1
v_add_u32 v14, s34, v14
v_add_u32 v15, s42, v15
v_pk_mul_f32 v[144:145], v[144:145], s[66:67]
v_pk_mul_f32 v[146:147], v[146:147], s[66:67]
v_pk_mul_f32 v[148:149], v[148:149], s[66:67]
v_pk_mul_f32 v[150:151], v[150:151], s[66:67]
v_pk_mul_f32 v[152:153], v[152:153], s[66:67]
v_cvt_pk_bf16_f32 v144, v144, v145
v_cvt_pk_bf16_f32 v145, v146, v147
v_cvt_pk_bf16_f32 v146, v148, v149
v_cvt_pk_bf16_f32 v147, v150, v151
v_cvt_pk_bf16_f32 v148, v152, v153
s_waitcnt vmcnt(6)
global_store_dwordx4 v14, v[144:147], s[64:65] sc1
s_mov_b64 exec, 0xffffffff
global_store_dword v15, v148, s[64:65] sc1
s_mov_b64 exec, -1
v_add_u32 v14, s34, v14
v_add_u32 v15, s42, v15
v_pk_mul_f32 v[208:209], v[208:209], s[66:67]
v_pk_mul_f32 v[210:211], v[210:211], s[66:67]
v_pk_mul_f32 v[212:213], v[212:213], s[66:67]
v_pk_mul_f32 v[214:215], v[214:215], s[66:67]
v_pk_mul_f32 v[216:217], v[216:217], s[66:67]
v_cvt_pk_bf16_f32 v208, v208, v209
v_cvt_pk_bf16_f32 v209, v210, v211
v_cvt_pk_bf16_f32 v210, v212, v213
v_cvt_pk_bf16_f32 v211, v214, v215
v_cvt_pk_bf16_f32 v212, v216, v217
s_waitcnt vmcnt(6)
global_store_dwordx4 v14, v[208:211], s[64:65] sc1
s_mov_b64 exec, 0xffffffff
global_store_dword v15, v212, s[64:65] sc1
s_mov_b64 exec, -1
s_add_u32 s64, s64, s33
s_addc_u32 s65, s65, 0
v_mov_b32 v14, v12
v_mov_b32 v15, v13
v_pk_mul_f32 v[32:33], v[32:33], s[66:67]
v_pk_mul_f32 v[34:35], v[34:35], s[66:67]
v_pk_mul_f32 v[36:37], v[36:37], s[66:67]
v_pk_mul_f32 v[38:39], v[38:39], s[66:67]
v_pk_mul_f32 v[40:41], v[40:41], s[66:67]
v_cvt_pk_bf16_f32 v32, v32, v33
v_cvt_pk_bf16_f32 v33, v34, v35
v_cvt_pk_bf16_f32 v34, v36, v37
v_cvt_pk_bf16_f32 v35, v38, v39
v_cvt_pk_bf16_f32 v36, v40, v41
s_waitcnt vmcnt(6)
global_store_dwordx4 v14, v[32:35], s[64:65] sc1
s_mov_b64 exec, 0xffffffff
global_store_dword v15, v36, s[64:65] sc1
s_mov_b64 exec, -1
v_add_u32 v14, s34, v14
v_add_u32 v15, s42, v15
v_pk_mul_f32 v[96:97], v[96:97], s[66:67]
v_pk_mul_f32 v[98:99], v[98:99], s[66:67]
v_pk_mul_f32 v[100:101], v[100:101], s[66:67]
v_pk_mul_f32 v[102:103], v[102:103], s[66:67]
v_pk_mul_f32 v[104:105], v[104:105], s[66:67]
v_cvt_pk_bf16_f32 v96, v96, v97
v_cvt_pk_bf16_f32 v97, v98, v99
v_cvt_pk_bf16_f32 v98, v100, v101
v_cvt_pk_bf16_f32 v99, v102, v103
v_cvt_pk_bf16_f32 v100, v104, v105
s_waitcnt vmcnt(6)
global_store_dwordx4 v14, v[96:99], s[64:65] sc1
s_mov_b64 exec, 0xffffffff
global_store_dword v15, v100, s[64:65] sc1
s_mov_b64 exec, -1
v_add_u32 v14, s34, v14
v_add_u32 v15, s42, v15
v_pk_mul_f32 v[160:161], v[160:161], s[66:67]
v_pk_mul_f32 v[162:163], v[162:163], s[66:67]
v_pk_mul_f32 v[164:165], v[164:165], s[66:67]
v_pk_mul_f32 v[166:167], v[166:167], s[66:67]
v_pk_mul_f32 v[168:169], v[168:169], s[66:67]
v_cvt_pk_bf16_f32 v160, v160, v161
v_cvt_pk_bf16_f32 v161, v162, v163
v_cvt_pk_bf16_f32 v162, v164, v165
v_cvt_pk_bf16_f32 v163, v166, v167
v_cvt_pk_bf16_f32 v164, v168, v169
s_waitcnt vmcnt(6)
global_store_dwordx4 v14, v[160:163], s[64:65] sc1
s_mov_b64 exec, 0xffffffff
global_store_dword v15, v164, s[64:65] sc1
s_mov_b64 exec, -1
v_add_u32 v14, s34, v14
v_add_u32 v15, s42, v15
v_pk_mul_f32 v[224:225], v[224:225], s[66:67]
v_pk_mul_f32 v[226:227], v[226:227], s[66:67]
v_pk_mul_f32 v[228:229], v[228:229], s[66:67]
v_pk_mul_f32 v[230:231], v[230:231], s[66:67]
v_pk_mul_f32 v[232:233], v[232:233], s[66:67]
v_cvt_pk_bf16_f32 v224, v224, v225
v_cvt_pk_bf16_f32 v225, v226, v227
v_cvt_pk_bf16_f32 v226, v228, v229
v_cvt_pk_bf16_f32 v227, v230, v231
v_cvt_pk_bf16_f32 v228, v232, v233
s_waitcnt vmcnt(6)
global_store_dwordx4 v14, v[224:227], s[64:65] sc1
s_mov_b64 exec, 0xffffffff
global_store_dword v15, v228, s[64:65] sc1
s_mov_b64 exec, -1
s_add_u32 s64, s64, s33
s_addc_u32 s65, s65, 0
v_mov_b32 v14, v12
v_mov_b32 v15, v13
v_pk_mul_f32 v[48:49], v[48:49], s[66:67]
v_pk_mul_f32 v[50:51], v[50:51], s[66:67]
v_pk_mul_f32 v[52:53], v[52:53], s[66:67]
v_pk_mul_f32 v[54:55], v[54:55], s[66:67]
v_pk_mul_f32 v[56:57], v[56:57], s[66:67]
v_cvt_pk_bf16_f32 v48, v48, v49
v_cvt_pk_bf16_f32 v49, v50, v51
v_cvt_pk_bf16_f32 v50, v52, v53
v_cvt_pk_bf16_f32 v51, v54, v55
v_cvt_pk_bf16_f32 v52, v56, v57
s_waitcnt vmcnt(6)
global_store_dwordx4 v14, v[48:51], s[64:65] sc1
s_mov_b64 exec, 0xffffffff
global_store_dword v15, v52, s[64:65] sc1
s_mov_b64 exec, -1
v_add_u32 v14, s34, v14
v_add_u32 v15, s42, v15
v_pk_mul_f32 v[112:113], v[112:113], s[66:67]
v_pk_mul_f32 v[114:115], v[114:115], s[66:67]
v_pk_mul_f32 v[116:117], v[116:117], s[66:67]
v_pk_mul_f32 v[118:119], v[118:119], s[66:67]
v_pk_mul_f32 v[120:121], v[120:121], s[66:67]
v_cvt_pk_bf16_f32 v112, v112, v113
v_cvt_pk_bf16_f32 v113, v114, v115
v_cvt_pk_bf16_f32 v114, v116, v117
v_cvt_pk_bf16_f32 v115, v118, v119
v_cvt_pk_bf16_f32 v116, v120, v121
s_waitcnt vmcnt(6)
global_store_dwordx4 v14, v[112:115], s[64:65] sc1
s_mov_b64 exec, 0xffffffff
global_store_dword v15, v116, s[64:65] sc1
s_mov_b64 exec, -1
v_add_u32 v14, s34, v14
v_add_u32 v15, s42, v15
v_pk_mul_f32 v[176:177], v[176:177], s[66:67]
v_pk_mul_f32 v[178:179], v[178:179], s[66:67]
v_pk_mul_f32 v[180:181], v[180:181], s[66:67]
v_pk_mul_f32 v[182:183], v[182:183], s[66:67]
v_pk_mul_f32 v[184:185], v[184:185], s[66:67]
v_cvt_pk_bf16_f32 v176, v176, v177
v_cvt_pk_bf16_f32 v177, v178, v179
v_cvt_pk_bf16_f32 v178, v180, v181
v_cvt_pk_bf16_f32 v179, v182, v183
v_cvt_pk_bf16_f32 v180, v184, v185
s_waitcnt vmcnt(6)
global_store_dwordx4 v14, v[176:179], s[64:65] sc1
s_mov_b64 exec, 0xffffffff
global_store_dword v15, v180, s[64:65] sc1
s_mov_b64 exec, -1
v_add_u32 v14, s34, v14
v_add_u32 v15, s42, v15
v_pk_mul_f32 v[240:241], v[240:241], s[66:67]
v_pk_mul_f32 v[242:243], v[242:243], s[66:67]
v_pk_mul_f32 v[244:245], v[244:245], s[66:67]
v_pk_mul_f32 v[246:247], v[246:247], s[66:67]
v_pk_mul_f32 v[248:249], v[248:249], s[66:67]
v_cvt_pk_bf16_f32 v240, v240, v241
v_cvt_pk_bf16_f32 v241, v242, v243
v_cvt_pk_bf16_f32 v242, v244, v245
v_cvt_pk_bf16_f32 v243, v246, v247
v_cvt_pk_bf16_f32 v244, v248, v249
s_waitcnt vmcnt(6)
global_store_dwordx4 v14, v[240:243], s[64:65] sc1
s_mov_b64 exec, 0xffffffff
global_store_dword v15, v244, s[64:65] sc1
s_mov_b64 exec, -1
s_add_u32 s64, s64, s33
s_addc_u32 s65, s65, 0
v_mov_b32 v14, v12
v_mov_b32 v15, v13
v_pk_mul_f32 v[64:65], v[64:65], s[66:67]
v_pk_mul_f32 v[66:67], v[66:67], s[66:67]
v_pk_mul_f32 v[68:69], v[68:69], s[66:67]
v_pk_mul_f32 v[70:71], v[70:71], s[66:67]
v_pk_mul_f32 v[72:73], v[72:73], s[66:67]
v_cvt_pk_bf16_f32 v64, v64, v65
v_cvt_pk_bf16_f32 v65, v66, v67
v_cvt_pk_bf16_f32 v66, v68, v69
v_cvt_pk_bf16_f32 v67, v70, v71
v_cvt_pk_bf16_f32 v68, v72, v73
s_waitcnt vmcnt(6)
global_store_dwordx4 v14, v[64:67], s[64:65] sc1
s_mov_b64 exec, 0xffffffff
global_store_dword v15, v68, s[64:65] sc1
s_mov_b64 exec, -1
v_add_u32 v14, s34, v14
v_add_u32 v15, s42, v15
v_pk_mul_f32 v[128:129], v[128:129], s[66:67]
v_pk_mul_f32 v[130:131], v[130:131], s[66:67]
v_pk_mul_f32 v[132:133], v[132:133], s[66:67]
v_pk_mul_f32 v[134:135], v[134:135], s[66:67]
v_pk_mul_f32 v[136:137], v[136:137], s[66:67]
v_cvt_pk_bf16_f32 v128, v128, v129
v_cvt_pk_bf16_f32 v129, v130, v131
v_cvt_pk_bf16_f32 v130, v132, v133
v_cvt_pk_bf16_f32 v131, v134, v135
v_cvt_pk_bf16_f32 v132, v136, v137
s_waitcnt vmcnt(6)
global_store_dwordx4 v14, v[128:131], s[64:65] sc1
s_mov_b64 exec, 0xffffffff
global_store_dword v15, v132, s[64:65] sc1
s_mov_b64 exec, -1
v_add_u32 v14, s34, v14
v_add_u32 v15, s42, v15
v_pk_mul_f32 v[192:193], v[192:193], s[66:67]
v_pk_mul_f32 v[194:195], v[194:195], s[66:67]
v_pk_mul_f32 v[196:197], v[196:197], s[66:67]
v_pk_mul_f32 v[198:199], v[198:199], s[66:67]
v_pk_mul_f32 v[200:201], v[200:201], s[66:67]
v_cvt_pk_bf16_f32 v192, v192, v193
v_cvt_pk_bf16_f32 v193, v194, v195
v_cvt_pk_bf16_f32 v194, v196, v197
v_cvt_pk_bf16_f32 v195, v198, v199
v_cvt_pk_bf16_f32 v196, v200, v201
s_waitcnt vmcnt(6)
global_store_dwordx4 v14, v[192:195], s[64:65] sc1
s_mov_b64 exec, 0xffffffff
global_store_dword v15, v196, s[64:65] sc1
s_mov_b64 exec, -1
v_add_u32 v14, s34, v14
v_add_u32 v15, s42, v15
v_accvgpr_read_b32 v16, a0
v_accvgpr_read_b32 v17, a1
v_accvgpr_read_b32 v18, a2
v_accvgpr_read_b32 v19, a3
v_accvgpr_read_b32 v20, a4
v_accvgpr_read_b32 v21, a5
v_accvgpr_read_b32 v22, a6
v_accvgpr_read_b32 v23, a7
v_accvgpr_read_b32 v24, a8
v_accvgpr_read_b32 v25, a9
v_pk_mul_f32 v[16:17], v[16:17], s[66:67]
v_pk_mul_f32 v[18:19], v[18:19], s[66:67]
v_pk_mul_f32 v[20:21], v[20:21], s[66:67]
v_pk_mul_f32 v[22:23], v[22:23], s[66:67]
v_pk_mul_f32 v[24:25], v[24:25], s[66:67]
v_cvt_pk_bf16_f32 v16, v16, v17
v_cvt_pk_bf16_f32 v17, v18, v19
v_cvt_pk_bf16_f32 v18, v20, v21
v_cvt_pk_bf16_f32 v19, v22, v23
v_cvt_pk_bf16_f32 v20, v24, v25
s_waitcnt vmcnt(6)
global_store_dwordx4 v14, v[16:19], s[64:65] sc1
s_mov_b64 exec, 0xffffffff
global_store_dword v15, v20, s[64:65] sc1
s_mov_b64 exec, -1
s_branch ED_20
EV_21:
s_mul_i32 s32, s41, 151552
s_mul_i32 s33, s39, 1216
s_add_u32 s32, s32, s33
s_add_u32 s32, s32, 0x4c12000
s_add_u32 s64, s14, s32
s_addc_u32 s65, s15, 0
v_mul_u32_u24 v12, 304, v11
v_lshl_add_u32 v12, v10, 4, v12
v_add_u32 v13, 2432, v12
s_mov_b32 s34, 0x3ffff
s_mov_b32 s35, 0x3ffff
v_cvt_pk_bf16_f32 v16, v16, v17
v_cvt_pk_bf16_f32 v17, v18, v19
v_cvt_pk_bf16_f32 v18, v20, v21
v_cvt_pk_bf16_f32 v19, v22, v23
v_cvt_pk_bf16_f32 v20, v24, v25
v_cvt_pk_bf16_f32 v21, v26, v27
v_cvt_pk_bf16_f32 v22, v28, v29
v_cvt_pk_bf16_f32 v23, v30, v31
s_waitcnt vmcnt(6)
s_mov_b64 exec, s[34:35]
global_store_dwordx4 v12, v[16:19], s[64:65] sc1
global_store_dwordx4 v12, v[20:23], s[64:65] offset:608 sc1
s_mov_b64 exec, -1
v_cvt_pk_bf16_f32 v80, v80, v81
v_cvt_pk_bf16_f32 v81, v82, v83
v_cvt_pk_bf16_f32 v82, v84, v85
v_cvt_pk_bf16_f32 v83, v86, v87
v_cvt_pk_bf16_f32 v84, v88, v89
v_cvt_pk_bf16_f32 v85, v90, v91
v_cvt_pk_bf16_f32 v86, v92, v93
v_cvt_pk_bf16_f32 v87, v94, v95
s_waitcnt vmcnt(6)
s_mov_b64 exec, s[34:35]
global_store_dwordx4 v12, v[80:83], s[64:65] offset:1216 sc1
global_store_dwordx4 v12, v[84:87], s[64:65] offset:1824 sc1
s_mov_b64 exec, -1
v_cvt_pk_bf16_f32 v144, v144, v145
v_cvt_pk_bf16_f32 v145, v146, v147
v_cvt_pk_bf16_f32 v146, v148, v149
v_cvt_pk_bf16_f32 v147, v150, v151
v_cvt_pk_bf16_f32 v148, v152, v153
v_cvt_pk_bf16_f32 v149, v154, v155
v_cvt_pk_bf16_f32 v150, v156, v157
v_cvt_pk_bf16_f32 v151, v158, v159
s_waitcnt vmcnt(6)
s_mov_b64 exec, s[34:35]
global_store_dwordx4 v13, v[144:147], s[64:65] sc1
global_store_dwordx4 v13, v[148:151], s[64:65] offset:608 sc1
s_mov_b64 exec, -1
v_cvt_pk_bf16_f32 v208, v208, v209
v_cvt_pk_bf16_f32 v209, v210, v211
v_cvt_pk_bf16_f32 v210, v212, v213
v_cvt_pk_bf16_f32 v211, v214, v215
v_cvt_pk_bf16_f32 v212, v216, v217
v_cvt_pk_bf16_f32 v213, v218, v219
v_cvt_pk_bf16_f32 v214, v220, v221
v_cvt_pk_bf16_f32 v215, v222, v223
s_waitcnt vmcnt(6)
s_mov_b64 exec, s[34:35]
global_store_dwordx4 v13, v[208:211], s[64:65] offset:1216 sc1
global_store_dwordx4 v13, v[212:215], s[64:65] offset:1824 sc1
s_mov_b64 exec, -1
s_add_u32 s64, s64, 0x25000
s_addc_u32 s65, s65, 0
v_cvt_pk_bf16_f32 v32, v32, v33
v_cvt_pk_bf16_f32 v33, v34, v35
v_cvt_pk_bf16_f32 v34, v36, v37
v_cvt_pk_bf16_f32 v35, v38, v39
v_cvt_pk_bf16_f32 v36, v40, v41
v_cvt_pk_bf16_f32 v37, v42, v43
v_cvt_pk_bf16_f32 v38, v44, v45
v_cvt_pk_bf16_f32 v39, v46, v47
s_waitcnt vmcnt(6)
s_mov_b64 exec, s[34:35]
global_store_dwordx4 v12, v[32:35], s[64:65] sc1
global_store_dwordx4 v12, v[36:39], s[64:65] offset:608 sc1
s_mov_b64 exec, -1
v_cvt_pk_bf16_f32 v96, v96, v97
v_cvt_pk_bf16_f32 v97, v98, v99
v_cvt_pk_bf16_f32 v98, v100, v101
v_cvt_pk_bf16_f32 v99, v102, v103
v_cvt_pk_bf16_f32 v100, v104, v105
v_cvt_pk_bf16_f32 v101, v106, v107
v_cvt_pk_bf16_f32 v102, v108, v109
v_cvt_pk_bf16_f32 v103, v110, v111
s_waitcnt vmcnt(6)
s_mov_b64 exec, s[34:35]
global_store_dwordx4 v12, v[96:99], s[64:65] offset:1216 sc1
global_store_dwordx4 v12, v[100:103], s[64:65] offset:1824 sc1
s_mov_b64 exec, -1
v_cvt_pk_bf16_f32 v160, v160, v161
v_cvt_pk_bf16_f32 v161, v162, v163
v_cvt_pk_bf16_f32 v162, v164, v165
v_cvt_pk_bf16_f32 v163, v166, v167
v_cvt_pk_bf16_f32 v164, v168, v169
v_cvt_pk_bf16_f32 v165, v170, v171
v_cvt_pk_bf16_f32 v166, v172, v173
v_cvt_pk_bf16_f32 v167, v174, v175
s_waitcnt vmcnt(6)
s_mov_b64 exec, s[34:35]
global_store_dwordx4 v13, v[160:163], s[64:65] sc1
global_store_dwordx4 v13, v[164:167], s[64:65] offset:608 sc1
s_mov_b64 exec, -1
v_cvt_pk_bf16_f32 v224, v224, v225
v_cvt_pk_bf16_f32 v225, v226, v227
v_cvt_pk_bf16_f32 v226, v228, v229
v_cvt_pk_bf16_f32 v227, v230, v231
v_cvt_pk_bf16_f32 v228, v232, v233
v_cvt_pk_bf16_f32 v229, v234, v235
v_cvt_pk_bf16_f32 v230, v236, v237
v_cvt_pk_bf16_f32 v231, v238, v239
s_waitcnt vmcnt(6)
s_mov_b64 exec, s[34:35]
global_store_dwordx4 v13, v[224:227], s[64:65] offset:1216 sc1
global_store_dwordx4 v13, v[228:231], s[64:65] offset:1824 sc1
s_mov_b64 exec, -1
s_add_u32 s64, s64, 0x25000
s_addc_u32 s65, s65, 0
v_cvt_pk_bf16_f32 v48, v48, v49
v_cvt_pk_bf16_f32 v49, v50, v51
v_cvt_pk_bf16_f32 v50, v52, v53
v_cvt_pk_bf16_f32 v51, v54, v55
v_cvt_pk_bf16_f32 v52, v56, v57
v_cvt_pk_bf16_f32 v53, v58, v59
v_cvt_pk_bf16_f32 v54, v60, v61
v_cvt_pk_bf16_f32 v55, v62, v63
s_waitcnt vmcnt(6)
s_mov_b64 exec, s[34:35]
global_store_dwordx4 v12, v[48:51], s[64:65] sc1
global_store_dwordx4 v12, v[52:55], s[64:65] offset:608 sc1
s_mov_b64 exec, -1
v_cvt_pk_bf16_f32 v112, v112, v113
v_cvt_pk_bf16_f32 v113, v114, v115
v_cvt_pk_bf16_f32 v114, v116, v117
v_cvt_pk_bf16_f32 v115, v118, v119
v_cvt_pk_bf16_f32 v116, v120, v121
v_cvt_pk_bf16_f32 v117, v122, v123
v_cvt_pk_bf16_f32 v118, v124, v125
v_cvt_pk_bf16_f32 v119, v126, v127
s_waitcnt vmcnt(6)
s_mov_b64 exec, s[34:35]
global_store_dwordx4 v12, v[112:115], s[64:65] offset:1216 sc1
global_store_dwordx4 v12, v[116:119], s[64:65] offset:1824 sc1
s_mov_b64 exec, -1
v_cvt_pk_bf16_f32 v176, v176, v177
v_cvt_pk_bf16_f32 v177, v178, v179
v_cvt_pk_bf16_f32 v178, v180, v181
v_cvt_pk_bf16_f32 v179, v182, v183
v_cvt_pk_bf16_f32 v180, v184, v185
v_cvt_pk_bf16_f32 v181, v186, v187
v_cvt_pk_bf16_f32 v182, v188, v189
v_cvt_pk_bf16_f32 v183, v190, v191
s_waitcnt vmcnt(6)
s_mov_b64 exec, s[34:35]
global_store_dwordx4 v13, v[176:179], s[64:65] sc1
global_store_dwordx4 v13, v[180:183], s[64:65] offset:608 sc1
s_mov_b64 exec, -1
v_cvt_pk_bf16_f32 v240, v240, v241
v_cvt_pk_bf16_f32 v241, v242, v243
v_cvt_pk_bf16_f32 v242, v244, v245
v_cvt_pk_bf16_f32 v243, v246, v247
v_cvt_pk_bf16_f32 v244, v248, v249
v_cvt_pk_bf16_f32 v245, v250, v251
v_cvt_pk_bf16_f32 v246, v252, v253
v_cvt_pk_bf16_f32 v247, v254, v255
s_waitcnt vmcnt(6)
s_mov_b64 exec, s[34:35]
global_store_dwordx4 v13, v[240:243], s[64:65] offset:1216 sc1
global_store_dwordx4 v13, v[244:247], s[64:65] offset:1824 sc1
s_mov_b64 exec, -1
s_add_u32 s64, s64, 0x25000
s_addc_u32 s65, s65, 0
v_cvt_pk_bf16_f32 v64, v64, v65
v_cvt_pk_bf16_f32 v65, v66, v67
v_cvt_pk_bf16_f32 v66, v68, v69
v_cvt_pk_bf16_f32 v67, v70, v71
v_cvt_pk_bf16_f32 v68, v72, v73
v_cvt_pk_bf16_f32 v69, v74, v75
v_cvt_pk_bf16_f32 v70, v76, v77
v_cvt_pk_bf16_f32 v71, v78, v79
s_waitcnt vmcnt(6)
s_mov_b64 exec, s[34:35]
global_store_dwordx4 v12, v[64:67], s[64:65] sc1
global_store_dwordx4 v12, v[68:71], s[64:65] offset:608 sc1
s_mov_b64 exec, -1
v_cvt_pk_bf16_f32 v128, v128, v129
v_cvt_pk_bf16_f32 v129, v130, v131
v_cvt_pk_bf16_f32 v130, v132, v133
v_cvt_pk_bf16_f32 v131, v134, v135
v_cvt_pk_bf16_f32 v132, v136, v137
v_cvt_pk_bf16_f32 v133, v138, v139
v_cvt_pk_bf16_f32 v134, v140, v141
v_cvt_pk_bf16_f32 v135, v142, v143
s_waitcnt vmcnt(6)
s_mov_b64 exec, s[34:35]
global_store_dwordx4 v12, v[128:131], s[64:65] offset:1216 sc1
global_store_dwordx4 v12, v[132:135], s[64:65] offset:1824 sc1
s_mov_b64 exec, -1
v_cvt_pk_bf16_f32 v192, v192, v193
v_cvt_pk_bf16_f32 v193, v194, v195
v_cvt_pk_bf16_f32 v194, v196, v197
v_cvt_pk_bf16_f32 v195, v198, v199
v_cvt_pk_bf16_f32 v196, v200, v201
v_cvt_pk_bf16_f32 v197, v202, v203
v_cvt_pk_bf16_f32 v198, v204, v205
v_cvt_pk_bf16_f32 v199, v206, v207
s_waitcnt vmcnt(6)
s_mov_b64 exec, s[34:35]
global_store_dwordx4 v13, v[192:195], s[64:65] sc1
global_store_dwordx4 v13, v[196:199], s[64:65] offset:608 sc1
s_mov_b64 exec, -1
v_accvgpr_read_b32 v16, a0
v_accvgpr_read_b32 v17, a1
v_accvgpr_read_b32 v18, a2
v_accvgpr_read_b32 v19, a3
v_accvgpr_read_b32 v20, a4
v_accvgpr_read_b32 v21, a5
v_accvgpr_read_b32 v22, a6
v_accvgpr_read_b32 v23, a7
v_accvgpr_read_b32 v24, a8
v_accvgpr_read_b32 v25, a9
v_accvgpr_read_b32 v26, a10
v_accvgpr_read_b32 v27, a11
v_accvgpr_read_b32 v28, a12
v_accvgpr_read_b32 v29, a13
v_accvgpr_read_b32 v30, a14
v_accvgpr_read_b32 v31, a15
v_cvt_pk_bf16_f32 v16, v16, v17
v_cvt_pk_bf16_f32 v17, v18, v19
v_cvt_pk_bf16_f32 v18, v20, v21
v_cvt_pk_bf16_f32 v19, v22, v23
v_cvt_pk_bf16_f32 v20, v24, v25
v_cvt_pk_bf16_f32 v21, v26, v27
v_cvt_pk_bf16_f32 v22, v28, v29
v_cvt_pk_bf16_f32 v23, v30, v31
s_waitcnt vmcnt(6)
s_mov_b64 exec, s[34:35]
global_store_dwordx4 v13, v[16:19], s[64:65] offset:1216 sc1
global_store_dwordx4 v13, v[20:23], s[64:65] offset:1824 sc1
s_mov_b64 exec, -1
ED_20:
s_waitcnt vmcnt(0)
s_cmp_ge_u32 s70, 4
s_cbranch_scc1 GH_22
v_mov_b32 v2, 0xc
PW_23:
global_load_dword v3, v2, s[16:17] sc1
s_waitcnt vmcnt(0)
v_readfirstlane_b32 s33, v3
s_nop 0
s_cmp_ge_u32 s33, 4
s_cbranch_scc1 PG_24
s_sub_u32 s30, s30, 1
s_cbranch_scc1 EXIT1
s_sleep 4
s_branch PW_23
PG_24:
s_mov_b32 s70, 4
GH_22:
s_sub_u32 s41, 2, s71
s_waitcnt vmcnt(0)
s_barrier
s_cmp_lg_u32 s19, 0
s_cbranch_scc1 SIG_25
s_lshl_b32 s32, s40, 7
s_add_u32 s32, s32, 0x20000
s_mov_b64 exec, 1
v_mov_b32 v2, s32
v_mov_b32 v3, s41
global_atomic_add v2, v3, s[14:15]
s_mov_b64 exec, -1
SIG_25:
s_branch GT_6
W1:
s_cmp_ge_u32 s70, 4
s_cbranch_scc1 W1B
v_mov_b32 v2, 0xc
PW_26:
global_load_dword v3, v2, s[16:17] sc1
s_waitcnt vmcnt(0)
v_readfirstlane_b32 s33, v3
s_nop 0
s_cmp_ge_u32 s33, 4
s_cbranch_scc1 PG_27
s_sub_u32 s30, s30, 1
s_cbranch_scc1 EXIT1
s_sleep 4
s_branch PW_26
PG_27:
W1B:
s_mul_hi_u32 s56, s18, 0x24924925
s_mul_i32 s32, s56, 7
s_sub_u32 s57, s18, s32
s_lshl_b32 s57, s57, 2
s_add_u32 s57, s57, s19
s_lshr_b32 s59, s56, 3
s_add_u32 s59, s59, 16
s_lshl_b32 s32, s59, 7
s_add_u32 s32, s32, 0x20000
v_mov_b32 v2, s32
WF_28:
global_load_dword v3, v2, s[14:15] sc1
s_waitcnt vmcnt(0)
v_readfirstlane_b32 s33, v3
s_nop 0
s_cmp_ge_u32 s33, 48
s_cbranch_scc1 WG_29
s_sub_u32 s30, s30, 1
s_cbranch_scc1 EXIT1
s_sleep 8
s_branch WF_28
WG_29:
v_lshlrev_b32 v1, 4, v0
s_mul_i32 s32, s56, 151552
s_mul_i32 s33, s19, 37888
s_add_u32 s32, s32, s33
s_add_u32 s32, s32, 0x4c00000
s_add_u32 s62, s14, s32
s_addc_u32 s63, s15, 0
s_barrier
s_add_u32 m0, s33, 0
s_nop 0
global_load_lds_dwordx4 v1, s[62:63] sc1
global_load_lds_dwordx4 v1, s[62:63] offset:1024 sc1
global_load_lds_dwordx4 v1, s[62:63] offset:2048 sc1
global_load_lds_dwordx4 v1, s[62:63] offset:3072 sc1
s_add_u32 m0, s33, 4096
s_add_u32 s62, s62, 0x1000
s_addc_u32 s63, s63, 0
s_nop 0
global_load_lds_dwordx4 v1, s[62:63] sc1
global_load_lds_dwordx4 v1, s[62:63] offset:1024 sc1
global_load_lds_dwordx4 v1, s[62:63] offset:2048 sc1
global_load_lds_dwordx4 v1, s[62:63] offset:3072 sc1
s_add_u32 m0, s33, 8192
s_add_u32 s62, s62, 0x1000
s_addc_u32 s63, s63, 0
s_nop 0
global_load_lds_dwordx4 v1, s[62:63] sc1
global_load_lds_dwordx4 v1, s[62:63] offset:1024 sc1
global_load_lds_dwordx4 v1, s[62:63] offset:2048 sc1
global_load_lds_dwordx4 v1, s[62:63] offset:3072 sc1
s_add_u32 m0, s33, 12288
s_add_u32 s62, s62, 0x1000
s_addc_u32 s63, s63, 0
s_nop 0
global_load_lds_dwordx4 v1, s[62:63] sc1
global_load_lds_dwordx4 v1, s[62:63] offset:1024 sc1
global_load_lds_dwordx4 v1, s[62:63] offset:2048 sc1
global_load_lds_dwordx4 v1, s[62:63] offset:3072 sc1
s_add_u32 m0, s33, 16384
s_add_u32 s62, s62, 0x1000
s_addc_u32 s63, s63, 0
s_nop 0
global_load_lds_dwordx4 v1, s[62:63] sc1
global_load_lds_dwordx4 v1, s[62:63] offset:1024 sc1
global_load_lds_dwordx4 v1, s[62:63] offset:2048 sc1
global_load_lds_dwordx4 v1, s[62:63] offset:3072 sc1
s_add_u32 m0, s33, 20480
s_add_u32 s62, s62, 0x1000
s_addc_u32 s63, s63, 0
s_nop 0
global_load_lds_dwordx4 v1, s[62:63] sc1
global_load_lds_dwordx4 v1, s[62:63] offset:1024 sc1
global_load_lds_dwordx4 v1, s[62:63] offset:2048 sc1
global_load_lds_dwordx4 v1, s[62:63] offset:3072 sc1
s_add_u32 m0, s33, 24576
s_add_u32 s62, s62, 0x1000
s_addc_u32 s63, s63, 0
s_nop 0
global_load_lds_dwordx4 v1, s[62:63] sc1
global_load_lds_dwordx4 v1, s[62:63] offset:1024 sc1
global_load_lds_dwordx4 v1, s[62:63] offset:2048 sc1
global_load_lds_dwordx4 v1, s[62:63] offset:3072 sc1
s_add_u32 m0, s33, 28672
s_add_u32 s62, s62, 0x1000
s_addc_u32 s63, s63, 0
s_nop 0
global_load_lds_dwordx4 v1, s[62:63] sc1
global_load_lds_dwordx4 v1, s[62:63] offset:1024 sc1
global_load_lds_dwordx4 v1, s[62:63] offset:2048 sc1
global_load_lds_dwordx4 v1, s[62:63] offset:3072 sc1
s_add_u32 m0, s33, 32768
s_add_u32 s62, s62, 0x1000
s_addc_u32 s63, s63, 0
s_nop 0
global_load_lds_dwordx4 v1, s[62:63] sc1
global_load_lds_dwordx4 v1, s[62:63] offset:1024 sc1
global_load_lds_dwordx4 v1, s[62:63] offset:2048 sc1
global_load_lds_dwordx4 v1, s[62:63] offset:3072 sc1
s_add_u32 m0, s33, 36864
s_add_u32 s62, s62, 0x1000
s_addc_u32 s63, s63, 0
s_nop 0
global_load_lds_dwordx4 v1, s[62:63] sc1
s_lshl_b32 s32, s19, 6
v_add_u32 v2, s32, v0
v_mul_u32_u24 v2, 304, v2
v_add_u32 v2, 74016, v2
v_mov_b32 v8, 0x3f803f80
v_mov_b32 v9, 0x3f803f80
v_mov_b32 v10, 0x3f803f80
v_mov_b32 v11, 0x3f803f80
v_and_b32 v7, 31, v0
v_lshlrev_b32 v7, 2, v7
s_waitcnt vmcnt(0)
s_barrier
ds_write_b128 v2, v[8:11]
s_waitcnt lgkmcnt(0)
s_barrier
v_mov_b32 v13, 0
v_mov_b32 v21, 0
v_mov_b32 v37, 0
v_mov_b32 v14, 0
v_mov_b32 v22, 0
v_mov_b32 v38, 0
v_mov_b32 v15, 0
v_mov_b32 v23, 0
v_mov_b32 v39, 0
s_mov_b32 s58, 0
AR_30:
s_cmp_ge_u32 s57, 64
s_cbranch_scc1 AS_31
s_mul_i32 s32, s56, 73728
s_mul_i32 s33, s57, 1152
s_add_u32 s32, s32, s33
s_add_u32 s32, s32, 0x4800000
s_add_u32 s64, s14, s32
s_addc_u32 s65, s15, 0
global_load_dwordx4 v[8:11], v1, s[64:65] sc1
global_load_dword v12, v7, s[64:65] offset:1024 sc1
v_mov_b64 v[112:113], 0
v_mov_b64 v[114:115], 0
v_mov_b64 v[116:117], 0
v_mov_b64 v[118:119], 0
v_mov_b64 v[120:121], 0
v_mov_b64 v[122:123], 0
v_mov_b64 v[124:125], 0
v_mov_b64 v[126:127], 0
s_mov_b32 s61, 0
s_waitcnt vmcnt(0)
s_mov_b64 exec, 0xffffffff
s_not_b64 exec, exec
v_mov_b32 v12, 0
s_mov_b64 exec, -1
AU_32:
v_mov_b32 v4, v1
v_add_u32 v5, 65536, v7
v_and_b32 v2, 31, v0
v_min_u32 v2, 18, v2
v_lshrrev_b32 v3, 5, v0
v_mul_u32_u24 v3, 304, v3
v_lshl_add_u32 v2, v2, 4, v3
v_add_u32 v6, 73728, v2
v_mov_b64 v[96:97], 0
v_mov_b64 v[98:99], 0
v_mov_b64 v[100:101], 0
v_mov_b64 v[102:103], 0
v_mov_b64 v[104:105], 0
v_mov_b64 v[106:107], 0
v_mov_b64 v[108:109], 0
v_mov_b64 v[110:111], 0
ds_read_b128 v[16:19], v4
ds_read_b32 v20, v5
ds_read_b128 v[32:35], v4 offset:1024
ds_read_b32 v36, v5 offset:128
ds_read_b128 v[24:27], v6
ds_read_b128 v[28:31], v6 offset:608
s_waitcnt lgkmcnt(4)
v_mfma_f32_32x32x16_bf16 v[48:63], v[16:19], v[8:11], v[112:127]
v_mfma_f32_32x32x16_bf16 v[48:63], v[20:23], v[12:15], v[48:63]
ds_read_b128 v[16:19], v4 offset:2048
ds_read_b32 v20, v5 offset:256
s_mov_b32 s60, 32
s_nop 7
.p2align 6
AL_33:
s_waitcnt lgkmcnt(4)
v_mfma_f32_32x32x16_bf16 v[64:79], v[32:35], v[8:11], v[112:127]
ds_read_b128 v[40:43], v6 offset:1216
ds_read_b128 v[44:47], v6 offset:1824
v_exp_f32 v48, v48
v_exp_f32 v49, v49
v_exp_f32 v50, v50
v_exp_f32 v51, v51
v_mfma_f32_32x32x16_bf16 v[64:79], v[36:39], v[12:15], v[64:79]
ds_read_b128 v[32:35], v4 offset:3072
ds_read_b32 v36, v5 offset:384
v_exp_f32 v52, v52
v_exp_f32 v53, v53
v_exp_f32 v54, v54
v_exp_f32 v55, v55
v_cvt_pk_bf16_f32 v80, v48, v49
v_cvt_pk_bf16_f32 v81, v50, v51
v_cvt_pk_bf16_f32 v82, v52, v53
v_cvt_pk_bf16_f32 v83, v54, v55
v_exp_f32 v56, v56
s_waitcnt lgkmcnt(6)
v_mfma_f32_32x32x16_bf16 v[96:111], v[24:27], v[80:83], v[96:111]
v_exp_f32 v57, v57
v_exp_f32 v58, v58
v_exp_f32 v59, v59
v_exp_f32 v60, v60
v_exp_f32 v61, v61
v_exp_f32 v62, v62
v_exp_f32 v63, v63
v_cvt_pk_bf16_f32 v84, v56, v57
v_cvt_pk_bf16_f32 v85, v58, v59
v_cvt_pk_bf16_f32 v86, v60, v61
v_cvt_pk_bf16_f32 v87, v62, v63
s_nop 0
s_nop 0
v_mfma_f32_32x32x16_bf16 v[96:111], v[28:31], v[84:87], v[96:111]
s_waitcnt lgkmcnt(4)
v_mfma_f32_32x32x16_bf16 v[48:63], v[16:19], v[8:11], v[112:127]
ds_read_b128 v[24:27], v6 offset:2432
ds_read_b128 v[28:31], v6 offset:3040
v_exp_f32 v64, v64
v_exp_f32 v65, v65
v_exp_f32 v66, v66
v_exp_f32 v67, v67
v_mfma_f32_32x32x16_bf16 v[48:63], v[20:23], v[12:15], v[48:63]
ds_read_b128 v[16:19], v4 offset:4096
ds_read_b32 v20, v5 offset:512
v_exp_f32 v68, v68
v_exp_f32 v69, v69
v_exp_f32 v70, v70
v_exp_f32 v71, v71
v_cvt_pk_bf16_f32 v80, v64, v65
v_cvt_pk_bf16_f32 v81, v66, v67
v_cvt_pk_bf16_f32 v82, v68, v69
v_cvt_pk_bf16_f32 v83, v70, v71
v_exp_f32 v72, v72
s_waitcnt lgkmcnt(6)
v_mfma_f32_32x32x16_bf16 v[96:111], v[40:43], v[80:83], v[96:111]
v_exp_f32 v73, v73
v_exp_f32 v74, v74
v_exp_f32 v75, v75
v_exp_f32 v76, v76
v_exp_f32 v77, v77
v_exp_f32 v78, v78
v_exp_f32 v79, v79
v_cvt_pk_bf16_f32 v84, v72, v73
v_cvt_pk_bf16_f32 v85, v74, v75
v_cvt_pk_bf16_f32 v86, v76, v77
v_cvt_pk_bf16_f32 v87, v78, v79
s_nop 0
s_nop 0
v_mfma_f32_32x32x16_bf16 v[96:111], v[44:47], v[84:87], v[96:111]
v_add_u32 v4, 2048, v4
v_add_u32 v5, 256, v5
v_add_u32 v6, 2432, v6
s_sub_u32 s60, s60, 1
s_cmp_lg_u32 s60, 0
s_cbranch_scc1 AL_33
s_waitcnt lgkmcnt(0)
s_nop 15
v_mov_b32 v2, v106
v_mov_b32 v3, v106
s_nop 1
v_permlane32_swap_b32 v2, v3
s_nop 1
v_subrev_u32 v3, 0x30800000, v2
v_cmp_le_u32 vcc, 0x20800000, v3
s_cmp_lg_u32 s61, 0
s_cbranch_scc1 AO_34
s_cbranch_vccz AO_34
v_mov_b32 v4, v1
v_add_u32 v5, 65536, v7
v_and_b32 v2, 31, v0
v_min_u32 v2, 18, v2
v_lshrrev_b32 v3, 5, v0
v_mul_u32_u24 v3, 304, v3
v_lshl_add_u32 v2, v2, 4, v3
v_add_u32 v6, 73728, v2
v_mov_b32 v2, 0xff800000
s_mov_b32 s60, 64
AM_35:
ds_read_b128 v[16:19], v4
ds_read_b32 v20, v5
s_waitcnt lgkmcnt(0)
v_mfma_f32_32x32x16_bf16 v[48:63], v[16:19], v[8:11], 0
v_mfma_f32_32x32x16_bf16 v[48:63], v[20:23], v[12:15], v[48:63]
s_nop 11
v_max3_f32 v2, v2, v48, v49
v_max3_f32 v2, v2, v50, v51
v_max3_f32 v2, v2, v52, v53
v_max3_f32 v2, v2, v54, v55
v_max3_f32 v2, v2, v56, v57
v_max3_f32 v2, v2, v58, v59
v_max3_f32 v2, v2, v60, v61
v_max3_f32 v2, v2, v62, v63
v_add_u32 v4, 1024, v4
v_add_u32 v5, 128, v5
s_sub_u32 s60, s60, 1
s_cmp_lg_u32 s60, 0
s_cbranch_scc1 AM_35
v_mov_b32 v3, v2
s_nop 1
v_permlane32_swap_b32 v2, v3
s_nop 1
v_max_f32 v2, v2, v3
v_sub_f32 v112, 0, v2
v_sub_f32 v113, 0, v2
v_sub_f32 v114, 0, v2
v_sub_f32 v115, 0, v2
v_sub_f32 v116, 0, v2
v_sub_f32 v117, 0, v2
v_sub_f32 v118, 0, v2
v_sub_f32 v119, 0, v2
v_sub_f32 v120, 0, v2
v_sub_f32 v121, 0, v2
v_sub_f32 v122, 0, v2
v_sub_f32 v123, 0, v2
v_sub_f32 v124, 0, v2
v_sub_f32 v125, 0, v2
v_sub_f32 v126, 0, v2
v_sub_f32 v127, 0, v2
s_mov_b32 s61, 1
s_branch AU_32
AO_34:
v_rcp_f32 v2, v2
s_nop 0
v_mul_f32 v96, v96, v2
v_mul_f32 v97, v97, v2
v_mul_f32 v98, v98, v2
v_mul_f32 v99, v99, v2
v_mul_f32 v100, v100, v2
v_mul_f32 v101, v101, v2
v_mul_f32 v102, v102, v2
v_mul_f32 v103, v103, v2
v_mul_f32 v104, v104, v2
v_mul_f32 v105, v105, v2
v_cvt_pk_bf16_f32 v96, v96, v97
v_cvt_pk_bf16_f32 v97, v98, v99
v_cvt_pk_bf16_f32 v98, v100, v101
v_cvt_pk_bf16_f32 v99, v102, v103
v_cvt_pk_bf16_f32 v100, v104, v105
s_mul_i32 s32, s57, 299008
s_add_u32 s32, s32, 0x5200000
s_add_u32 s64, s14, s32
s_addc_u32 s65, s15, 0
s_lshl_b32 s33, s56, 10
v_add_u32 v2, s33, v1
global_store_dwordx4 v2, v[96:99], s[64:65] sc1
s_lshr_b32 s33, s56, 2
s_lshl_b32 s33, s33, 9
s_and_b32 s34, s56, 3
s_lshl_b32 s34, s34, 2
s_add_u32 s33, s33, s34
s_add_u32 s33, s33, 32768
v_add_u32 v3, s33, v1
s_mov_b64 exec, 0xffffffff
global_store_dword v3, v100, s[64:65] sc1
s_mov_b64 exec, -1
AS_31:
s_waitcnt vmcnt(0)
s_barrier
s_cmp_lg_u32 s19, 0
s_cbranch_scc1 AG_36
v_add_u32 v2, s57, v0
v_cmp_gt_u32 vcc, 64, v2
s_nop 0
s_and_b64 vcc, vcc, 15
s_cbranch_vccz AG_36
v_lshlrev_b32 v2, 7, v2
v_add_u32 v2, 0x21000, v2
v_mov_b32 v3, 1
s_mov_b64 exec, vcc
global_atomic_add v2, v3, s[14:15]
s_mov_b64 exec, -1
AG_36:
s_add_u32 s57, s57, 28
s_add_u32 s58, s58, 1
s_cmp_lt_u32 s58, 3
s_cbranch_scc1 AR_30
s_branch W2
W2:
s_getreg_b32 s68, hwreg(HW_REG_XCC_ID, 0, 4)
s_max_u32 s68, s68, 1
s_sub_u32 s68, s68, 1
s_min_u32 s68, s68, 6
s_lshl_b32 s82, s68, 2
s_add_u32 s82, s82, 168
v_mov_b32 v2, 163832
s_cmp_lg_u32 s19, 0
s_cbranch_scc1 CL_37
s_mov_b64 exec, 1
v_mov_b32 v3, s82
v_mov_b32 v10, 1
global_atomic_add v3, v3, v10, s[16:17] sc0
s_waitcnt vmcnt(0)
ds_write_b32 v2, v3
s_waitcnt lgkmcnt(0)
s_mov_b64 exec, -1
CL_37:
s_barrier
ds_read_b32 v3, v2
s_waitcnt lgkmcnt(0)
v_readfirstlane_b32 s81, v3
s_barrier
s_mov_b32 s82, 200
v_mov_b32 v2, 163832
s_cmp_lg_u32 s19, 0
s_cbranch_scc1 CL_38
s_mov_b64 exec, 1
v_mov_b32 v3, s82
v_mov_b32 v10, 1
global_atomic_add v3, v3, v10, s[16:17] sc0
s_waitcnt vmcnt(0)
ds_write_b32 v2, v3
s_waitcnt lgkmcnt(0)
s_mov_b64 exec, -1
CL_38:
s_barrier
ds_read_b32 v3, v2
s_waitcnt lgkmcnt(0)
v_readfirstlane_b32 s83, v3
s_barrier
s_mov_b32 s80, s68
s_cmp_lt_u32 s81, 18
s_cbranch_scc1 W6
s_mov_b32 s82, 196
v_mov_b32 v2, 163832
s_cmp_lg_u32 s19, 0
s_cbranch_scc1 CL_39
s_mov_b64 exec, 1
v_mov_b32 v3, s82
v_mov_b32 v10, 1
global_atomic_add v3, v3, v10, s[16:17] sc0
s_waitcnt vmcnt(0)
ds_write_b32 v2, v3
s_waitcnt lgkmcnt(0)
s_mov_b64 exec, -1
CL_39:
s_barrier
ds_read_b32 v3, v2
s_waitcnt lgkmcnt(0)
v_readfirstlane_b32 s80, v3
s_barrier
s_cmp_lt_u32 s80, 96
s_cbranch_scc1 W5
v_mov_b32 v2, 0xc8
PW_40:
global_load_dword v3, v2, s[16:17] sc1
s_waitcnt vmcnt(0)
v_readfirstlane_b32 s33, v3
s_nop 0
s_cmp_ge_u32 s33, 224
s_cbranch_scc1 PG_41
s_sub_u32 s30, s30, 1
s_cbranch_scc1 EXIT1
s_sleep 32
s_branch PW_40
PG_41:
s_mov_b32 s80, 0
WS:
s_lshl_b32 s82, s80, 2
s_add_u32 s82, s82, 168
v_mov_b32 v2, 163832
s_cmp_lg_u32 s19, 0
s_cbranch_scc1 CL_42
s_mov_b64 exec, 1
v_mov_b32 v3, s82
v_mov_b32 v10, 1
global_atomic_add v3, v3, v10, s[16:17] sc0
s_waitcnt vmcnt(0)
ds_write_b32 v2, v3
s_waitcnt lgkmcnt(0)
s_mov_b64 exec, -1
CL_42:
s_barrier
ds_read_b32 v3, v2
s_waitcnt lgkmcnt(0)
v_readfirstlane_b32 s81, v3
s_barrier
s_cmp_lt_u32 s81, 18
s_cbranch_scc1 W6
s_add_u32 s80, s80, 1
s_cmp_lt_u32 s80, 7
s_cbranch_scc1 WS
s_branch EXIT1
W6:
s_mov_b32 s56, s80
s_mov_b32 s57, s81
v_lshlrev_b32 v1, 4, v0
v_lshrrev_b32 v2, 5, v0
v_bfe_u32 v3, v0, 4, 1
v_bfe_u32 v20, v0, 2, 2
v_and_b32 v13, 3, v0
v_lshlrev_b32 v13, 4, v13
s_lshl_b32 s32, s57, 6
v_add_u32 v13, s32, v13
v_lshl_add_u32 v14, v2, 2, v20
v_lshl_add_u32 v15, v3, 4, v14
v_mov_b32 v16, 1152
v_mad_u32_u24 v4, v15, v16, v13
v_lshl_add_u32 v15, v3, 3, v14
v_mad_u32_u24 v5, v15, v16, v13
v_bfe_u32 v14, v0, 3, 2
v_lshl_add_u32 v14, v2, 2, v14
v_mul_u32_u24 v14, 18, v14
v_bfe_u32 v15, v0, 2, 1
v_add_u32 v14, v14, v15
v_mad_u32_u24 v6, v14, v16, v13
v_lshl_add_u32 v14, v3, 3, v20
v_lshlrev_b32 v14, 6, v14
v_lshl_add_u32 v14, v2, 10, v14
v_and_b32 v15, 3, v0
v_lshl_add_u32 v14, v15, 3, v14
s_lshl_b32 s36, s19, 15
v_add_u32 v7, s36, v14
v_and_b32 v17, 15, v0
v_lshlrev_b32 v14, 10, v2
v_lshl_add_u32 v14, v3, 9, v14
v_lshl_add_u32 v12, v17, 4, v14
v_lshrrev_b32 v18, 4, v0
v_mul_u32_u24 v14, 1152, v17
s_mul_i32 s33, s19, 320
s_sub_u32 s33, s33, 128
s_cmp_eq_u32 s19, 0
s_cselect_b32 s33, 0, s33
v_lshlrev_b32 v15, 4, v18
v_add_u32 v15, s33, v15
v_add_u32 v8, v14, v15
global_load_dwordx4 v[188:191], v15, s[26:27]
global_load_dwordx4 v[192:195], v15, s[26:27] offset:64
global_load_dwordx4 v[196:199], v15, s[26:27] offset:128
global_load_dwordx4 v[200:203], v15, s[26:27] offset:192
global_load_dwordx4 v[204:207], v15, s[26:27] offset:256
s_lshl_b32 s33, s19, 5
s_add_u32 s33, s33, s32
v_lshl_add_u32 v14, v18, 3, v14
v_add_u32 v9, s33, v14
s_lshl_b32 s33, s19, 11
v_add_u32 v10, s33, v1
s_lshl_b32 s33, s19, 10
v_add_u32 v11, s33, v1
s_barrier
s_cmp_eq_u32 s19, 0
s_cbranch_scc1 FW_43
s_mul_i32 s66, s19, 72
s_sub_u32 s66, s66, 32
s_mul_i32 s32, s66, 18432
s_add_u32 s62, s10, s32
s_addc_u32 s63, s11, 0
s_add_u32 s66, s66, 2
s_add_u32 m0, s36, 0
s_nop 0
global_load_lds_dwordx4 v4, s[62:63]
s_add_u32 s62, s62, 0x2400
s_addc_u32 s63, s63, 0
s_add_u32 m0, s36, 1024
s_nop 0
global_load_lds_dwordx4 v4, s[62:63]
s_mul_i32 s32, s66, 18432
s_add_u32 s62, s10, s32
s_addc_u32 s63, s11, 0
s_add_u32 s66, s66, 2
s_add_u32 m0, s36, 2048
s_nop 0
global_load_lds_dwordx4 v4, s[62:63]
s_add_u32 s62, s62, 0x2400
s_addc_u32 s63, s63, 0
s_add_u32 m0, s36, 3072
s_nop 0
global_load_lds_dwordx4 v4, s[62:63]
s_mul_i32 s32, s66, 18432
s_add_u32 s62, s10, s32
s_addc_u32 s63, s11, 0
s_add_u32 s66, s66, 2
s_add_u32 m0, s36, 4096
s_nop 0
global_load_lds_dwordx4 v4, s[62:63]
s_add_u32 s62, s62, 0x2400
s_addc_u32 s63, s63, 0
s_add_u32 m0, s36, 5120
s_nop 0
global_load_lds_dwordx4 v4, s[62:63]
s_mul_i32 s32, s66, 18432
s_add_u32 s62, s10, s32
s_addc_u32 s63, s11, 0
s_add_u32 s66, s66, 2
s_add_u32 m0, s36, 6144
s_nop 0
global_load_lds_dwordx4 v4, s[62:63]
s_add_u32 s62, s62, 0x2400
s_addc_u32 s63, s63, 0
s_add_u32 m0, s36, 7168
s_nop 0
global_load_lds_dwordx4 v4, s[62:63]
s_mul_i32 s32, s66, 18432
s_add_u32 s62, s10, s32
s_addc_u32 s63, s11, 0
s_add_u32 s66, s66, 2
s_add_u32 m0, s36, 8192
s_nop 0
global_load_lds_dwordx4 v4, s[62:63]
s_add_u32 s62, s62, 0x2400
s_addc_u32 s63, s63, 0
s_add_u32 m0, s36, 9216
s_nop 0
global_load_lds_dwordx4 v4, s[62:63]
s_mul_i32 s32, s66, 18432
s_add_u32 s62, s10, s32
s_addc_u32 s63, s11, 0
s_add_u32 s66, s66, 2
s_add_u32 m0, s36, 10240
s_nop 0
global_load_lds_dwordx4 v4, s[62:63]
s_add_u32 s62, s62, 0x2400
s_addc_u32 s63, s63, 0
s_add_u32 m0, s36, 11264
s_nop 0
global_load_lds_dwordx4 v4, s[62:63]
s_mul_i32 s32, s66, 18432
s_add_u32 s62, s10, s32
s_addc_u32 s63, s11, 0
s_add_u32 s66, s66, 2
s_add_u32 m0, s36, 12288
s_nop 0
global_load_lds_dwordx4 v4, s[62:63]
s_add_u32 s62, s62, 0x2400
s_addc_u32 s63, s63, 0
s_add_u32 m0, s36, 13312
s_nop 0
global_load_lds_dwordx4 v4, s[62:63]
s_mul_i32 s32, s66, 18432
s_add_u32 s62, s10, s32
s_addc_u32 s63, s11, 0
s_add_u32 s66, s66, 2
s_add_u32 m0, s36, 14336
s_nop 0
global_load_lds_dwordx4 v4, s[62:63]
s_add_u32 s62, s62, 0x2400
s_addc_u32 s63, s63, 0
s_add_u32 m0, s36, 15360
s_nop 0
global_load_lds_dwordx4 v4, s[62:63]
s_mul_i32 s32, s66, 18432
s_add_u32 s62, s10, s32
s_addc_u32 s63, s11, 0
s_add_u32 s66, s66, 2
s_add_u32 m0, s36, 16384
s_nop 0
global_load_lds_dwordx4 v4, s[62:63]
s_add_u32 s62, s62, 0x2400
s_addc_u32 s63, s63, 0
s_add_u32 m0, s36, 17408
s_nop 0
global_load_lds_dwordx4 v4, s[62:63]
s_mul_i32 s32, s66, 18432
s_add_u32 s62, s10, s32
s_addc_u32 s63, s11, 0
s_add_u32 s66, s66, 2
s_add_u32 m0, s36, 18432
s_nop 0
global_load_lds_dwordx4 v4, s[62:63]
s_add_u32 s62, s62, 0x2400
s_addc_u32 s63, s63, 0
s_add_u32 m0, s36, 19456
s_nop 0
global_load_lds_dwordx4 v4, s[62:63]
s_mul_i32 s32, s66, 18432
s_add_u32 s62, s10, s32
s_addc_u32 s63, s11, 0
s_add_u32 s66, s66, 2
s_add_u32 m0, s36, 20480
s_nop 0
global_load_lds_dwordx4 v4, s[62:63]
s_add_u32 s62, s62, 0x2400
s_addc_u32 s63, s63, 0
s_add_u32 m0, s36, 21504
s_nop 0
global_load_lds_dwordx4 v4, s[62:63]
s_mul_i32 s32, s66, 18432
s_add_u32 s62, s10, s32
s_addc_u32 s63, s11, 0
s_add_u32 s66, s66, 2
s_add_u32 m0, s36, 22528
s_nop 0
global_load_lds_dwordx4 v4, s[62:63]
s_add_u32 s62, s62, 0x2400
s_addc_u32 s63, s63, 0
s_add_u32 m0, s36, 23552
s_nop 0
global_load_lds_dwordx4 v4, s[62:63]
s_mul_i32 s32, s66, 18432
s_add_u32 s62, s10, s32
s_addc_u32 s63, s11, 0
s_add_u32 s66, s66, 2
s_add_u32 m0, s36, 24576
s_nop 0
global_load_lds_dwordx4 v4, s[62:63]
s_add_u32 s62, s62, 0x2400
s_addc_u32 s63, s63, 0
s_add_u32 m0, s36, 25600
s_nop 0
global_load_lds_dwordx4 v4, s[62:63]
s_mul_i32 s32, s66, 18432
s_add_u32 s62, s10, s32
s_addc_u32 s63, s11, 0
s_add_u32 s66, s66, 2
s_add_u32 m0, s36, 26624
s_nop 0
global_load_lds_dwordx4 v4, s[62:63]
s_add_u32 s62, s62, 0x2400
s_addc_u32 s63, s63, 0
s_add_u32 m0, s36, 27648
s_nop 0
global_load_lds_dwordx4 v4, s[62:63]
s_mul_i32 s32, s66, 18432
s_add_u32 s62, s10, s32
s_addc_u32 s63, s11, 0
s_add_u32 s66, s66, 2
s_add_u32 m0, s36, 28672
s_nop 0
global_load_lds_dwordx4 v4, s[62:63]
s_add_u32 s62, s62, 0x2400
s_addc_u32 s63, s63, 0
s_add_u32 m0, s36, 29696
s_nop 0
global_load_lds_dwordx4 v4, s[62:63]
s_mul_i32 s32, s66, 18432
s_add_u32 s62, s10, s32
s_addc_u32 s63, s11, 0
s_add_u32 s66, s66, 2
s_add_u32 m0, s36, 30720
s_nop 0
global_load_lds_dwordx4 v4, s[62:63]
s_add_u32 s62, s62, 0x2400
s_addc_u32 s63, s63, 0
s_add_u32 m0, s36, 31744
s_nop 0
global_load_lds_dwordx4 v4, s[62:63]
s_waitcnt vmcnt(30)
ds_read_b64_tr_b16 a[0:1], v7
ds_read_b64_tr_b16 a[2:3], v7 offset:256
ds_read_b64_tr_b16 a[4:5], v7 offset:32
ds_read_b64_tr_b16 a[6:7], v7 offset:288
s_waitcnt vmcnt(28)
ds_read_b64_tr_b16 a[8:9], v7 offset:2048
ds_read_b64_tr_b16 a[10:11], v7 offset:2304
ds_read_b64_tr_b16 a[12:13], v7 offset:2080
ds_read_b64_tr_b16 a[14:15], v7 offset:2336
s_waitcnt vmcnt(26)
ds_read_b64_tr_b16 a[16:17], v7 offset:4096
ds_read_b64_tr_b16 a[18:19], v7 offset:4352
ds_read_b64_tr_b16 a[20:21], v7 offset:4128
ds_read_b64_tr_b16 a[22:23], v7 offset:4384
s_waitcnt vmcnt(24)
ds_read_b64_tr_b16 a[24:25], v7 offset:6144
ds_read_b64_tr_b16 a[26:27], v7 offset:6400
ds_read_b64_tr_b16 a[28:29], v7 offset:6176
ds_read_b64_tr_b16 a[30:31], v7 offset:6432
s_waitcnt vmcnt(22)
ds_read_b64_tr_b16 a[32:33], v7 offset:8192
ds_read_b64_tr_b16 a[34:35], v7 offset:8448
ds_read_b64_tr_b16 a[36:37], v7 offset:8224
ds_read_b64_tr_b16 a[38:39], v7 offset:8480
s_waitcnt vmcnt(20)
ds_read_b64_tr_b16 a[40:41], v7 offset:10240
ds_read_b64_tr_b16 a[42:43], v7 offset:10496
ds_read_b64_tr_b16 a[44:45], v7 offset:10272
ds_read_b64_tr_b16 a[46:47], v7 offset:10528
s_waitcnt vmcnt(18)
ds_read_b64_tr_b16 a[48:49], v7 offset:12288
ds_read_b64_tr_b16 a[50:51], v7 offset:12544
ds_read_b64_tr_b16 a[52:53], v7 offset:12320
ds_read_b64_tr_b16 a[54:55], v7 offset:12576
s_waitcnt vmcnt(16)
ds_read_b64_tr_b16 a[56:57], v7 offset:14336
ds_read_b64_tr_b16 a[58:59], v7 offset:14592
ds_read_b64_tr_b16 a[60:61], v7 offset:14368
ds_read_b64_tr_b16 a[62:63], v7 offset:14624
s_waitcnt vmcnt(14)
ds_read_b64_tr_b16 a[64:65], v7 offset:16384
ds_read_b64_tr_b16 a[66:67], v7 offset:16640
ds_read_b64_tr_b16 a[68:69], v7 offset:16416
ds_read_b64_tr_b16 a[70:71], v7 offset:16672
s_waitcnt vmcnt(12)
ds_read_b64_tr_b16 a[72:73], v7 offset:18432
ds_read_b64_tr_b16 a[74:75], v7 offset:18688
ds_read_b64_tr_b16 a[76:77], v7 offset:18464
ds_read_b64_tr_b16 a[78:79], v7 offset:18720
s_waitcnt vmcnt(10)
ds_read_b64_tr_b16 a[80:81], v7 offset:20480
ds_read_b64_tr_b16 a[82:83], v7 offset:20736
ds_read_b64_tr_b16 a[84:85], v7 offset:20512
ds_read_b64_tr_b16 a[86:87], v7 offset:20768
s_waitcnt vmcnt(8)
ds_read_b64_tr_b16 a[88:89], v7 offset:22528
ds_read_b64_tr_b16 a[90:91], v7 offset:22784
ds_read_b64_tr_b16 a[92:93], v7 offset:22560
ds_read_b64_tr_b16 a[94:95], v7 offset:22816
s_waitcnt vmcnt(6)
ds_read_b64_tr_b16 a[96:97], v7 offset:24576
ds_read_b64_tr_b16 a[98:99], v7 offset:24832
ds_read_b64_tr_b16 a[100:101], v7 offset:24608
ds_read_b64_tr_b16 a[102:103], v7 offset:24864
s_waitcnt vmcnt(4)
ds_read_b64_tr_b16 a[104:105], v7 offset:26624
ds_read_b64_tr_b16 a[106:107], v7 offset:26880
ds_read_b64_tr_b16 a[108:109], v7 offset:26656
ds_read_b64_tr_b16 a[110:111], v7 offset:26912
s_waitcnt vmcnt(2)
ds_read_b64_tr_b16 a[112:113], v7 offset:28672
ds_read_b64_tr_b16 a[114:115], v7 offset:28928
ds_read_b64_tr_b16 a[116:117], v7 offset:28704
ds_read_b64_tr_b16 a[118:119], v7 offset:28960
s_waitcnt vmcnt(0)
ds_read_b64_tr_b16 a[120:121], v7 offset:30720
ds_read_b64_tr_b16 a[122:123], v7 offset:30976
ds_read_b64_tr_b16 a[124:125], v7 offset:30752
ds_read_b64_tr_b16 a[126:127], v7 offset:31008
s_waitcnt lgkmcnt(0)
s_mul_i32 s32, s66, 18432
s_add_u32 s62, s10, s32
s_addc_u32 s63, s11, 0
s_add_u32 s66, s66, 2
s_add_u32 m0, s36, 0
s_nop 0
global_load_lds_dwordx4 v4, s[62:63]
s_add_u32 s62, s62, 0x2400
s_addc_u32 s63, s63, 0
s_add_u32 m0, s36, 1024
s_nop 0
global_load_lds_dwordx4 v4, s[62:63]
s_mul_i32 s32, s66, 18432
s_add_u32 s62, s10, s32
s_addc_u32 s63, s11, 0
s_add_u32 s66, s66, 2
s_add_u32 m0, s36, 2048
s_nop 0
global_load_lds_dwordx4 v4, s[62:63]
s_add_u32 s62, s62, 0x2400
s_addc_u32 s63, s63, 0
s_add_u32 m0, s36, 3072
s_nop 0
global_load_lds_dwordx4 v4, s[62:63]
s_mul_i32 s32, s66, 18432
s_add_u32 s62, s10, s32
s_addc_u32 s63, s11, 0
s_add_u32 s66, s66, 2
s_add_u32 m0, s36, 4096
s_nop 0
global_load_lds_dwordx4 v4, s[62:63]
s_add_u32 s62, s62, 0x2400
s_addc_u32 s63, s63, 0
s_add_u32 m0, s36, 5120
s_nop 0
global_load_lds_dwordx4 v4, s[62:63]
s_mul_i32 s32, s66, 18432
s_add_u32 s62, s10, s32
s_addc_u32 s63, s11, 0
s_add_u32 s66, s66, 2
s_add_u32 m0, s36, 6144
s_nop 0
global_load_lds_dwordx4 v4, s[62:63]
s_add_u32 s62, s62, 0x2400
s_addc_u32 s63, s63, 0
s_add_u32 m0, s36, 7168
s_nop 0
global_load_lds_dwordx4 v4, s[62:63]
s_mul_i32 s32, s66, 18432
s_add_u32 s62, s10, s32
s_addc_u32 s63, s11, 0
s_add_u32 s66, s66, 2
s_add_u32 m0, s36, 8192
s_nop 0
global_load_lds_dwordx4 v4, s[62:63]
s_add_u32 s62, s62, 0x2400
s_addc_u32 s63, s63, 0
s_add_u32 m0, s36, 9216
s_nop 0
global_load_lds_dwordx4 v4, s[62:63]
s_mul_i32 s32, s66, 18432
s_add_u32 s62, s10, s32
s_addc_u32 s63, s11, 0
s_add_u32 s66, s66, 2
s_add_u32 m0, s36, 10240
s_nop 0
global_load_lds_dwordx4 v4, s[62:63]
s_add_u32 s62, s62, 0x2400
s_addc_u32 s63, s63, 0
s_add_u32 m0, s36, 11264
s_nop 0
global_load_lds_dwordx4 v4, s[62:63]
s_mul_i32 s32, s66, 18432
s_add_u32 s62, s10, s32
s_addc_u32 s63, s11, 0
s_add_u32 s66, s66, 2
s_add_u32 m0, s36, 12288
s_nop 0
global_load_lds_dwordx4 v4, s[62:63]
s_add_u32 s62, s62, 0x2400
s_addc_u32 s63, s63, 0
s_add_u32 m0, s36, 13312
s_nop 0
global_load_lds_dwordx4 v4, s[62:63]
s_mul_i32 s32, s66, 18432
s_add_u32 s62, s10, s32
s_addc_u32 s63, s11, 0
s_add_u32 s66, s66, 2
s_add_u32 m0, s36, 14336
s_nop 0
global_load_lds_dwordx4 v4, s[62:63]
s_add_u32 s62, s62, 0x2400
s_addc_u32 s63, s63, 0
s_add_u32 m0, s36, 15360
s_nop 0
global_load_lds_dwordx4 v4, s[62:63]
s_mul_i32 s32, s66, 18432
s_add_u32 s62, s10, s32
s_addc_u32 s63, s11, 0
s_add_u32 s66, s66, 2
s_add_u32 m0, s36, 16384
s_nop 0
global_load_lds_dwordx4 v4, s[62:63]
s_add_u32 s62, s62, 0x2400
s_addc_u32 s63, s63, 0
s_add_u32 m0, s36, 17408
s_nop 0
global_load_lds_dwordx4 v4, s[62:63]
s_mul_i32 s32, s66, 18432
s_add_u32 s62, s10, s32
s_addc_u32 s63, s11, 0
s_add_u32 s66, s66, 2
s_add_u32 m0, s36, 18432
s_nop 0
global_load_lds_dwordx4 v4, s[62:63]
s_add_u32 s62, s62, 0x2400
s_addc_u32 s63, s63, 0
s_add_u32 m0, s36, 19456
s_nop 0
global_load_lds_dwordx4 v4, s[62:63]
s_mul_i32 s32, s66, 18432
s_add_u32 s62, s10, s32
s_addc_u32 s63, s11, 0
s_add_u32 s66, s66, 2
s_add_u32 m0, s36, 20480
s_nop 0
global_load_lds_dwordx4 v4, s[62:63]
s_add_u32 s62, s62, 0x2400
s_addc_u32 s63, s63, 0
s_add_u32 m0, s36, 21504
s_nop 0
global_load_lds_dwordx4 v4, s[62:63]
s_mul_i32 s32, s66, 18432
s_add_u32 s62, s10, s32
s_addc_u32 s63, s11, 0
s_add_u32 s66, s66, 2
s_add_u32 m0, s36, 22528
s_nop 0
global_load_lds_dwordx4 v4, s[62:63]
s_add_u32 s62, s62, 0x2400
s_addc_u32 s63, s63, 0
s_add_u32 m0, s36, 23552
s_nop 0
global_load_lds_dwordx4 v4, s[62:63]
s_mul_i32 s32, s66, 18432
s_add_u32 s62, s10, s32
s_addc_u32 s63, s11, 0
s_add_u32 s66, s66, 2
s_add_u32 m0, s36, 24576
s_nop 0
global_load_lds_dwordx4 v4, s[62:63]
s_add_u32 s62, s62, 0x2400
s_addc_u32 s63, s63, 0
s_add_u32 m0, s36, 25600
s_nop 0
global_load_lds_dwordx4 v4, s[62:63]
s_mul_i32 s32, s66, 18432
s_add_u32 s62, s10, s32
s_addc_u32 s63, s11, 0
s_add_u32 s66, s66, 2
s_add_u32 m0, s36, 26624
s_nop 0
global_load_lds_dwordx4 v4, s[62:63]
s_add_u32 s62, s62, 0x2400
s_addc_u32 s63, s63, 0
s_add_u32 m0, s36, 27648
s_nop 0
global_load_lds_dwordx4 v4, s[62:63]
s_mul_i32 s32, s66, 18432
s_add_u32 s62, s10, s32
s_addc_u32 s63, s11, 0
s_add_u32 s66, s66, 2
s_add_u32 m0, s36, 28672
s_nop 0
global_load_lds_dwordx4 v4, s[62:63]
s_add_u32 s62, s62, 0x2400
s_addc_u32 s63, s63, 0
s_add_u32 m0, s36, 29696
s_nop 0
global_load_lds_dwordx4 v4, s[62:63]
s_mul_i32 s32, s66, 18432
s_add_u32 s62, s10, s32
s_addc_u32 s63, s11, 0
s_add_u32 s66, s66, 2
s_add_u32 m0, s36, 30720
s_nop 0
global_load_lds_dwordx4 v4, s[62:63]
s_add_u32 s62, s62, 0x2400
s_addc_u32 s63, s63, 0
s_add_u32 m0, s36, 31744
s_nop 0
global_load_lds_dwordx4 v4, s[62:63]
s_waitcnt vmcnt(30)
ds_read_b64_tr_b16 a[128:129], v7
ds_read_b64_tr_b16 a[130:131], v7 offset:256
ds_read_b64_tr_b16 a[132:133], v7 offset:32
ds_read_b64_tr_b16 a[134:135], v7 offset:288
s_waitcnt vmcnt(28)
ds_read_b64_tr_b16 a[136:137], v7 offset:2048
ds_read_b64_tr_b16 a[138:139], v7 offset:2304
ds_read_b64_tr_b16 a[140:141], v7 offset:2080
ds_read_b64_tr_b16 a[142:143], v7 offset:2336
s_waitcnt vmcnt(26)
ds_read_b64_tr_b16 a[144:145], v7 offset:4096
ds_read_b64_tr_b16 a[146:147], v7 offset:4352
ds_read_b64_tr_b16 a[148:149], v7 offset:4128
ds_read_b64_tr_b16 a[150:151], v7 offset:4384
s_waitcnt vmcnt(24)
ds_read_b64_tr_b16 a[152:153], v7 offset:6144
ds_read_b64_tr_b16 a[154:155], v7 offset:6400
ds_read_b64_tr_b16 a[156:157], v7 offset:6176
ds_read_b64_tr_b16 a[158:159], v7 offset:6432
s_waitcnt vmcnt(22)
ds_read_b64_tr_b16 a[160:161], v7 offset:8192
ds_read_b64_tr_b16 a[162:163], v7 offset:8448
ds_read_b64_tr_b16 a[164:165], v7 offset:8224
ds_read_b64_tr_b16 a[166:167], v7 offset:8480
s_waitcnt vmcnt(20)
ds_read_b64_tr_b16 a[168:169], v7 offset:10240
ds_read_b64_tr_b16 a[170:171], v7 offset:10496
ds_read_b64_tr_b16 a[172:173], v7 offset:10272
ds_read_b64_tr_b16 a[174:175], v7 offset:10528
s_waitcnt vmcnt(18)
ds_read_b64_tr_b16 a[176:177], v7 offset:12288
ds_read_b64_tr_b16 a[178:179], v7 offset:12544
ds_read_b64_tr_b16 a[180:181], v7 offset:12320
ds_read_b64_tr_b16 a[182:183], v7 offset:12576
s_waitcnt vmcnt(16)
ds_read_b64_tr_b16 a[184:185], v7 offset:14336
ds_read_b64_tr_b16 a[186:187], v7 offset:14592
ds_read_b64_tr_b16 a[188:189], v7 offset:14368
ds_read_b64_tr_b16 a[190:191], v7 offset:14624
s_waitcnt vmcnt(14)
ds_read_b64_tr_b16 a[192:193], v7 offset:16384
ds_read_b64_tr_b16 a[194:195], v7 offset:16640
ds_read_b64_tr_b16 a[196:197], v7 offset:16416
ds_read_b64_tr_b16 a[198:199], v7 offset:16672
s_waitcnt vmcnt(12)
ds_read_b64_tr_b16 a[200:201], v7 offset:18432
ds_read_b64_tr_b16 a[202:203], v7 offset:18688
ds_read_b64_tr_b16 a[204:205], v7 offset:18464
ds_read_b64_tr_b16 a[206:207], v7 offset:18720
s_waitcnt vmcnt(10)
ds_read_b64_tr_b16 a[208:209], v7 offset:20480
ds_read_b64_tr_b16 a[210:211], v7 offset:20736
ds_read_b64_tr_b16 a[212:213], v7 offset:20512
ds_read_b64_tr_b16 a[214:215], v7 offset:20768
s_waitcnt vmcnt(8)
ds_read_b64_tr_b16 a[216:217], v7 offset:22528
ds_read_b64_tr_b16 a[218:219], v7 offset:22784
ds_read_b64_tr_b16 a[220:221], v7 offset:22560
ds_read_b64_tr_b16 a[222:223], v7 offset:22816
s_waitcnt vmcnt(6)
ds_read_b64_tr_b16 a[224:225], v7 offset:24576
ds_read_b64_tr_b16 a[226:227], v7 offset:24832
ds_read_b64_tr_b16 a[228:229], v7 offset:24608
ds_read_b64_tr_b16 a[230:231], v7 offset:24864
s_waitcnt vmcnt(4)
ds_read_b64_tr_b16 a[232:233], v7 offset:26624
ds_read_b64_tr_b16 a[234:235], v7 offset:26880
ds_read_b64_tr_b16 a[236:237], v7 offset:26656
ds_read_b64_tr_b16 a[238:239], v7 offset:26912
s_waitcnt vmcnt(2)
ds_read_b64_tr_b16 a[240:241], v7 offset:28672
ds_read_b64_tr_b16 a[242:243], v7 offset:28928
ds_read_b64_tr_b16 a[244:245], v7 offset:28704
ds_read_b64_tr_b16 a[246:247], v7 offset:28960
s_waitcnt vmcnt(0)
ds_read_b64_tr_b16 a[248:249], v7 offset:30720
ds_read_b64_tr_b16 a[250:251], v7 offset:30976
ds_read_b64_tr_b16 a[252:253], v7 offset:30752
ds_read_b64_tr_b16 a[254:255], v7 offset:31008
s_waitcnt lgkmcnt(0)
s_mul_i32 s32, s66, 18432
s_add_u32 s62, s10, s32
s_addc_u32 s63, s11, 0
s_add_u32 s66, s66, 2
s_add_u32 m0, s36, 0
s_nop 0
global_load_lds_dwordx4 v4, s[62:63]
s_add_u32 s62, s62, 0x2400
s_addc_u32 s63, s63, 0
s_add_u32 m0, s36, 1024
s_nop 0
global_load_lds_dwordx4 v4, s[62:63]
s_mul_i32 s32, s66, 18432
s_add_u32 s62, s10, s32
s_addc_u32 s63, s11, 0
s_add_u32 s66, s66, 2
s_add_u32 m0, s36, 2048
s_nop 0
global_load_lds_dwordx4 v4, s[62:63]
s_add_u32 s62, s62, 0x2400
s_addc_u32 s63, s63, 0
s_add_u32 m0, s36, 3072
s_nop 0
global_load_lds_dwordx4 v4, s[62:63]
s_mul_i32 s32, s66, 18432
s_add_u32 s62, s10, s32
s_addc_u32 s63, s11, 0
s_add_u32 s66, s66, 2
s_add_u32 m0, s36, 4096
s_nop 0
global_load_lds_dwordx4 v4, s[62:63]
s_add_u32 s62, s62, 0x2400
s_addc_u32 s63, s63, 0
s_add_u32 m0, s36, 5120
s_nop 0
global_load_lds_dwordx4 v4, s[62:63]
s_mul_i32 s32, s66, 18432
s_add_u32 s62, s10, s32
s_addc_u32 s63, s11, 0
s_add_u32 s66, s66, 2
s_add_u32 m0, s36, 6144
s_nop 0
global_load_lds_dwordx4 v4, s[62:63]
s_add_u32 s62, s62, 0x2400
s_addc_u32 s63, s63, 0
s_add_u32 m0, s36, 7168
s_nop 0
global_load_lds_dwordx4 v4, s[62:63]
s_waitcnt vmcnt(6)
ds_read_b64_tr_b16 v[208:209], v7
ds_read_b64_tr_b16 v[210:211], v7 offset:256
ds_read_b64_tr_b16 v[212:213], v7 offset:32
ds_read_b64_tr_b16 v[214:215], v7 offset:288
s_waitcnt vmcnt(4)
ds_read_b64_tr_b16 v[216:217], v7 offset:2048
ds_read_b64_tr_b16 v[218:219], v7 offset:2304
ds_read_b64_tr_b16 v[220:221], v7 offset:2080
ds_read_b64_tr_b16 v[222:223], v7 offset:2336
s_waitcnt vmcnt(2)
ds_read_b64_tr_b16 v[224:225], v7 offset:4096
ds_read_b64_tr_b16 v[226:227], v7 offset:4352
ds_read_b64_tr_b16 v[228:229], v7 offset:4128
ds_read_b64_tr_b16 v[230:231], v7 offset:4384
s_waitcnt vmcnt(0)
ds_read_b64_tr_b16 v[232:233], v7 offset:6144
ds_read_b64_tr_b16 v[234:235], v7 offset:6400
ds_read_b64_tr_b16 v[236:237], v7 offset:6176
ds_read_b64_tr_b16 v[238:239], v7 offset:6432
s_waitcnt lgkmcnt(0)
s_branch FG_44
FW_43:
s_add_u32 s62, s24, 0x0
s_addc_u32 s63, s25, 0
s_add_u32 m0, s36, 0
s_nop 0
global_load_lds_dwordx4 v5, s[62:63]
s_add_u32 s62, s24, 0x5100
s_addc_u32 s63, s25, 0
s_add_u32 m0, s36, 1024
s_nop 0
global_load_lds_dwordx4 v5, s[62:63]
s_add_u32 s62, s24, 0xa200
s_addc_u32 s63, s25, 0
s_add_u32 m0, s36, 2048
s_nop 0
global_load_lds_dwordx4 v5, s[62:63]
s_add_u32 s62, s24, 0xf300
s_addc_u32 s63, s25, 0
s_add_u32 m0, s36, 3072
s_nop 0
global_load_lds_dwordx4 v5, s[62:63]
s_add_u32 s62, s24, 0x14400
s_addc_u32 s63, s25, 0
s_add_u32 m0, s36, 4096
s_nop 0
global_load_lds_dwordx4 v5, s[62:63]
s_add_u32 s62, s24, 0x19500
s_addc_u32 s63, s25, 0
s_add_u32 m0, s36, 5120
s_nop 0
global_load_lds_dwordx4 v5, s[62:63]
s_add_u32 s62, s24, 0x1e600
s_addc_u32 s63, s25, 0
s_add_u32 m0, s36, 6144
s_nop 0
global_load_lds_dwordx4 v5, s[62:63]
s_add_u32 s62, s24, 0x23700
s_addc_u32 s63, s25, 0
s_add_u32 m0, s36, 7168
s_nop 0
global_load_lds_dwordx4 v5, s[62:63]
s_add_u32 s62, s24, 0x28800
s_addc_u32 s63, s25, 0
s_add_u32 m0, s36, 8192
s_nop 0
global_load_lds_dwordx4 v5, s[62:63]
s_add_u32 s62, s24, 0x2d900
s_addc_u32 s63, s25, 0
s_add_u32 m0, s36, 9216
s_nop 0
global_load_lds_dwordx4 v5, s[62:63]
s_add_u32 s62, s24, 0x32a00
s_addc_u32 s63, s25, 0
s_add_u32 m0, s36, 10240
s_nop 0
global_load_lds_dwordx4 v5, s[62:63]
s_add_u32 s62, s24, 0x37b00
s_addc_u32 s63, s25, 0
s_add_u32 m0, s36, 11264
s_nop 0
global_load_lds_dwordx4 v5, s[62:63]
s_add_u32 s62, s24, 0x3cc00
s_addc_u32 s63, s25, 0
s_add_u32 m0, s36, 12288
s_nop 0
global_load_lds_dwordx4 v5, s[62:63]
s_add_u32 s62, s24, 0x41d00
s_addc_u32 s63, s25, 0
s_add_u32 m0, s36, 13312
s_nop 0
global_load_lds_dwordx4 v5, s[62:63]
s_add_u32 s62, s24, 0x46e00
s_addc_u32 s63, s25, 0
s_add_u32 m0, s36, 14336
s_nop 0
global_load_lds_dwordx4 v5, s[62:63]
s_add_u32 s62, s24, 0x4bf00
s_addc_u32 s63, s25, 0
s_add_u32 m0, s36, 15360
s_nop 0
global_load_lds_dwordx4 v5, s[62:63]
s_add_u32 s62, s24, 0x51000
s_addc_u32 s63, s25, 0
s_add_u32 m0, s36, 16384
s_nop 0
global_load_lds_dwordx4 v5, s[62:63]
s_add_u32 s62, s24, 0x56100
s_addc_u32 s63, s25, 0
s_add_u32 m0, s36, 17408
s_nop 0
global_load_lds_dwordx4 v5, s[62:63]
s_add_u32 s62, s24, 0x5b200
s_addc_u32 s63, s25, 0
s_add_u32 m0, s36, 18432
s_nop 0
global_load_lds_dwordx4 v5, s[62:63]
s_add_u32 s62, s24, 0x60300
s_addc_u32 s63, s25, 0
s_add_u32 m0, s36, 19456
s_nop 0
global_load_lds_dwordx4 v5, s[62:63]
s_add_u32 s62, s24, 0x65400
s_addc_u32 s63, s25, 0
s_add_u32 m0, s36, 20480
s_nop 0
global_load_lds_dwordx4 v5, s[62:63]
s_add_u32 s62, s24, 0x6a500
s_addc_u32 s63, s25, 0
s_add_u32 m0, s36, 21504
s_nop 0
global_load_lds_dwordx4 v5, s[62:63]
s_add_u32 s62, s24, 0x6f600
s_addc_u32 s63, s25, 0
s_add_u32 m0, s36, 22528
s_nop 0
global_load_lds_dwordx4 v5, s[62:63]
s_add_u32 s62, s24, 0x74700
s_addc_u32 s63, s25, 0
s_add_u32 m0, s36, 23552
s_nop 0
global_load_lds_dwordx4 v5, s[62:63]
s_add_u32 s62, s24, 0x79800
s_addc_u32 s63, s25, 0
s_add_u32 m0, s36, 24576
s_nop 0
global_load_lds_dwordx4 v5, s[62:63]
s_add_u32 s62, s24, 0x7e900
s_addc_u32 s63, s25, 0
s_add_u32 m0, s36, 25600
s_nop 0
global_load_lds_dwordx4 v5, s[62:63]
s_add_u32 s62, s24, 0x83a00
s_addc_u32 s63, s25, 0
s_add_u32 m0, s36, 26624
s_nop 0
global_load_lds_dwordx4 v5, s[62:63]
s_add_u32 s62, s24, 0x88b00
s_addc_u32 s63, s25, 0
s_add_u32 m0, s36, 27648
s_nop 0
global_load_lds_dwordx4 v5, s[62:63]
s_add_u32 s62, s24, 0x8dc00
s_addc_u32 s63, s25, 0
s_add_u32 m0, s36, 28672
s_nop 0
global_load_lds_dwordx4 v5, s[62:63]
s_add_u32 s62, s24, 0x92d00
s_addc_u32 s63, s25, 0
s_add_u32 m0, s36, 29696
s_nop 0
global_load_lds_dwordx4 v5, s[62:63]
s_add_u32 s62, s24, 0x97e00
s_addc_u32 s63, s25, 0
s_add_u32 m0, s36, 30720
s_nop 0
global_load_lds_dwordx4 v5, s[62:63]
s_add_u32 s62, s24, 0x9cf00
s_addc_u32 s63, s25, 0
s_add_u32 m0, s36, 31744
s_nop 0
global_load_lds_dwordx4 v5, s[62:63]
s_waitcnt vmcnt(30)
ds_read_b64_tr_b16 a[0:1], v7
ds_read_b64_tr_b16 a[2:3], v7 offset:256
ds_read_b64_tr_b16 a[4:5], v7 offset:32
ds_read_b64_tr_b16 a[6:7], v7 offset:288
s_waitcnt vmcnt(28)
ds_read_b64_tr_b16 a[8:9], v7 offset:2048
ds_read_b64_tr_b16 a[10:11], v7 offset:2304
ds_read_b64_tr_b16 a[12:13], v7 offset:2080
ds_read_b64_tr_b16 a[14:15], v7 offset:2336
s_waitcnt vmcnt(26)
ds_read_b64_tr_b16 a[16:17], v7 offset:4096
ds_read_b64_tr_b16 a[18:19], v7 offset:4352
ds_read_b64_tr_b16 a[20:21], v7 offset:4128
ds_read_b64_tr_b16 a[22:23], v7 offset:4384
s_waitcnt vmcnt(24)
ds_read_b64_tr_b16 a[24:25], v7 offset:6144
ds_read_b64_tr_b16 a[26:27], v7 offset:6400
ds_read_b64_tr_b16 a[28:29], v7 offset:6176
ds_read_b64_tr_b16 a[30:31], v7 offset:6432
s_waitcnt vmcnt(22)
ds_read_b64_tr_b16 a[32:33], v7 offset:8192
ds_read_b64_tr_b16 a[34:35], v7 offset:8448
ds_read_b64_tr_b16 a[36:37], v7 offset:8224
ds_read_b64_tr_b16 a[38:39], v7 offset:8480
s_waitcnt vmcnt(20)
ds_read_b64_tr_b16 a[40:41], v7 offset:10240
ds_read_b64_tr_b16 a[42:43], v7 offset:10496
ds_read_b64_tr_b16 a[44:45], v7 offset:10272
ds_read_b64_tr_b16 a[46:47], v7 offset:10528
s_waitcnt vmcnt(18)
ds_read_b64_tr_b16 a[48:49], v7 offset:12288
ds_read_b64_tr_b16 a[50:51], v7 offset:12544
ds_read_b64_tr_b16 a[52:53], v7 offset:12320
ds_read_b64_tr_b16 a[54:55], v7 offset:12576
s_waitcnt vmcnt(16)
ds_read_b64_tr_b16 a[56:57], v7 offset:14336
ds_read_b64_tr_b16 a[58:59], v7 offset:14592
ds_read_b64_tr_b16 a[60:61], v7 offset:14368
ds_read_b64_tr_b16 a[62:63], v7 offset:14624
s_waitcnt vmcnt(14)
ds_read_b64_tr_b16 a[64:65], v7 offset:16384
ds_read_b64_tr_b16 a[66:67], v7 offset:16640
ds_read_b64_tr_b16 a[68:69], v7 offset:16416
ds_read_b64_tr_b16 a[70:71], v7 offset:16672
s_waitcnt vmcnt(12)
ds_read_b64_tr_b16 a[72:73], v7 offset:18432
ds_read_b64_tr_b16 a[74:75], v7 offset:18688
ds_read_b64_tr_b16 a[76:77], v7 offset:18464
ds_read_b64_tr_b16 a[78:79], v7 offset:18720
s_waitcnt vmcnt(10)
ds_read_b64_tr_b16 a[80:81], v7 offset:20480
ds_read_b64_tr_b16 a[82:83], v7 offset:20736
ds_read_b64_tr_b16 a[84:85], v7 offset:20512
ds_read_b64_tr_b16 a[86:87], v7 offset:20768
s_waitcnt vmcnt(8)
ds_read_b64_tr_b16 a[88:89], v7 offset:22528
ds_read_b64_tr_b16 a[90:91], v7 offset:22784
ds_read_b64_tr_b16 a[92:93], v7 offset:22560
ds_read_b64_tr_b16 a[94:95], v7 offset:22816
s_waitcnt vmcnt(6)
ds_read_b64_tr_b16 a[96:97], v7 offset:24576
ds_read_b64_tr_b16 a[98:99], v7 offset:24832
ds_read_b64_tr_b16 a[100:101], v7 offset:24608
ds_read_b64_tr_b16 a[102:103], v7 offset:24864
s_waitcnt vmcnt(4)
ds_read_b64_tr_b16 a[104:105], v7 offset:26624
ds_read_b64_tr_b16 a[106:107], v7 offset:26880
ds_read_b64_tr_b16 a[108:109], v7 offset:26656
ds_read_b64_tr_b16 a[110:111], v7 offset:26912
s_waitcnt vmcnt(2)
ds_read_b64_tr_b16 a[112:113], v7 offset:28672
ds_read_b64_tr_b16 a[114:115], v7 offset:28928
ds_read_b64_tr_b16 a[116:117], v7 offset:28704
ds_read_b64_tr_b16 a[118:119], v7 offset:28960
s_waitcnt vmcnt(0)
ds_read_b64_tr_b16 a[120:121], v7 offset:30720
ds_read_b64_tr_b16 a[122:123], v7 offset:30976
ds_read_b64_tr_b16 a[124:125], v7 offset:30752
ds_read_b64_tr_b16 a[126:127], v7 offset:31008
s_waitcnt lgkmcnt(0)
s_add_u32 s62, s24, 0x4800
s_addc_u32 s63, s25, 0
s_add_u32 m0, s36, 0
s_nop 0
global_load_lds_dwordx4 v6, s[62:63]
s_add_u32 s62, s24, 0x2d000
s_addc_u32 s63, s25, 0
s_add_u32 m0, s36, 1024
s_nop 0
global_load_lds_dwordx4 v6, s[62:63]
s_add_u32 s62, s24, 0x55800
s_addc_u32 s63, s25, 0
s_add_u32 m0, s36, 2048
s_nop 0
global_load_lds_dwordx4 v6, s[62:63]
s_add_u32 s62, s24, 0x7e000
s_addc_u32 s63, s25, 0
s_add_u32 m0, s36, 3072
s_nop 0
global_load_lds_dwordx4 v6, s[62:63]
s_add_u32 s62, s10, 0x0
s_addc_u32 s63, s11, 0
s_add_u32 m0, s36, 4096
s_nop 0
global_load_lds_dwordx4 v4, s[62:63]
s_add_u32 s62, s10, 0x2400
s_addc_u32 s63, s11, 0
s_add_u32 m0, s36, 5120
s_nop 0
global_load_lds_dwordx4 v4, s[62:63]
s_add_u32 s62, s10, 0x9000
s_addc_u32 s63, s11, 0
s_add_u32 m0, s36, 6144
s_nop 0
global_load_lds_dwordx4 v4, s[62:63]
s_add_u32 s62, s10, 0xb400
s_addc_u32 s63, s11, 0
s_add_u32 m0, s36, 7168
s_nop 0
global_load_lds_dwordx4 v4, s[62:63]
s_add_u32 s62, s10, 0x12000
s_addc_u32 s63, s11, 0
s_add_u32 m0, s36, 8192
s_nop 0
global_load_lds_dwordx4 v4, s[62:63]
s_add_u32 s62, s10, 0x14400
s_addc_u32 s63, s11, 0
s_add_u32 m0, s36, 9216
s_nop 0
global_load_lds_dwordx4 v4, s[62:63]
s_add_u32 s62, s10, 0x1b000
s_addc_u32 s63, s11, 0
s_add_u32 m0, s36, 10240
s_nop 0
global_load_lds_dwordx4 v4, s[62:63]
s_add_u32 s62, s10, 0x1d400
s_addc_u32 s63, s11, 0
s_add_u32 m0, s36, 11264
s_nop 0
global_load_lds_dwordx4 v4, s[62:63]
s_add_u32 s62, s10, 0x24000
s_addc_u32 s63, s11, 0
s_add_u32 m0, s36, 12288
s_nop 0
global_load_lds_dwordx4 v4, s[62:63]
s_add_u32 s62, s10, 0x26400
s_addc_u32 s63, s11, 0
s_add_u32 m0, s36, 13312
s_nop 0
global_load_lds_dwordx4 v4, s[62:63]
s_add_u32 s62, s10, 0x2d000
s_addc_u32 s63, s11, 0
s_add_u32 m0, s36, 14336
s_nop 0
global_load_lds_dwordx4 v4, s[62:63]
s_add_u32 s62, s10, 0x2f400
s_addc_u32 s63, s11, 0
s_add_u32 m0, s36, 15360
s_nop 0
global_load_lds_dwordx4 v4, s[62:63]
s_add_u32 s62, s10, 0x36000
s_addc_u32 s63, s11, 0
s_add_u32 m0, s36, 16384
s_nop 0
global_load_lds_dwordx4 v4, s[62:63]
s_add_u32 s62, s10, 0x38400
s_addc_u32 s63, s11, 0
s_add_u32 m0, s36, 17408
s_nop 0
global_load_lds_dwordx4 v4, s[62:63]
s_add_u32 s62, s10, 0x3f000
s_addc_u32 s63, s11, 0
s_add_u32 m0, s36, 18432
s_nop 0
global_load_lds_dwordx4 v4, s[62:63]
s_add_u32 s62, s10, 0x41400
s_addc_u32 s63, s11, 0
s_add_u32 m0, s36, 19456
s_nop 0
global_load_lds_dwordx4 v4, s[62:63]
s_add_u32 s62, s10, 0x48000
s_addc_u32 s63, s11, 0
s_add_u32 m0, s36, 20480
s_nop 0
global_load_lds_dwordx4 v4, s[62:63]
s_add_u32 s62, s10, 0x4a400
s_addc_u32 s63, s11, 0
s_add_u32 m0, s36, 21504
s_nop 0
global_load_lds_dwordx4 v4, s[62:63]
s_add_u32 s62, s10, 0x51000
s_addc_u32 s63, s11, 0
s_add_u32 m0, s36, 22528
s_nop 0
global_load_lds_dwordx4 v4, s[62:63]
s_add_u32 s62, s10, 0x53400
s_addc_u32 s63, s11, 0
s_add_u32 m0, s36, 23552
s_nop 0
global_load_lds_dwordx4 v4, s[62:63]
s_add_u32 s62, s10, 0x5a000
s_addc_u32 s63, s11, 0
s_add_u32 m0, s36, 24576
s_nop 0
global_load_lds_dwordx4 v4, s[62:63]
s_add_u32 s62, s10, 0x5c400
s_addc_u32 s63, s11, 0
s_add_u32 m0, s36, 25600
s_nop 0
global_load_lds_dwordx4 v4, s[62:63]
s_add_u32 s62, s10, 0x63000
s_addc_u32 s63, s11, 0
s_add_u32 m0, s36, 26624
s_nop 0
global_load_lds_dwordx4 v4, s[62:63]
s_add_u32 s62, s10, 0x65400
s_addc_u32 s63, s11, 0
s_add_u32 m0, s36, 27648
s_nop 0
global_load_lds_dwordx4 v4, s[62:63]
s_add_u32 s62, s10, 0x6c000
s_addc_u32 s63, s11, 0
s_add_u32 m0, s36, 28672
s_nop 0
global_load_lds_dwordx4 v4, s[62:63]
s_add_u32 s62, s10, 0x6e400
s_addc_u32 s63, s11, 0
s_add_u32 m0, s36, 29696
s_nop 0
global_load_lds_dwordx4 v4, s[62:63]
s_add_u32 s62, s10, 0x75000
s_addc_u32 s63, s11, 0
s_add_u32 m0, s36, 30720
s_nop 0
global_load_lds_dwordx4 v4, s[62:63]
s_add_u32 s62, s10, 0x77400
s_addc_u32 s63, s11, 0
s_add_u32 m0, s36, 31744
s_nop 0
global_load_lds_dwordx4 v4, s[62:63]
s_waitcnt vmcnt(30)
ds_read_b64_tr_b16 a[128:129], v7
ds_read_b64_tr_b16 a[130:131], v7 offset:256
ds_read_b64_tr_b16 a[132:133], v7 offset:32
ds_read_b64_tr_b16 a[134:135], v7 offset:288
s_waitcnt vmcnt(28)
ds_read_b64_tr_b16 a[136:137], v7 offset:2048
ds_read_b64_tr_b16 a[138:139], v7 offset:2304
ds_read_b64_tr_b16 a[140:141], v7 offset:2080
ds_read_b64_tr_b16 a[142:143], v7 offset:2336
s_waitcnt vmcnt(26)
ds_read_b64_tr_b16 a[144:145], v7 offset:4096
ds_read_b64_tr_b16 a[146:147], v7 offset:4352
ds_read_b64_tr_b16 a[148:149], v7 offset:4128
ds_read_b64_tr_b16 a[150:151], v7 offset:4384
s_waitcnt vmcnt(24)
ds_read_b64_tr_b16 a[152:153], v7 offset:6144
ds_read_b64_tr_b16 a[154:155], v7 offset:6400
ds_read_b64_tr_b16 a[156:157], v7 offset:6176
ds_read_b64_tr_b16 a[158:159], v7 offset:6432
s_waitcnt vmcnt(22)
ds_read_b64_tr_b16 a[160:161], v7 offset:8192
ds_read_b64_tr_b16 a[162:163], v7 offset:8448
ds_read_b64_tr_b16 a[164:165], v7 offset:8224
ds_read_b64_tr_b16 a[166:167], v7 offset:8480
s_waitcnt vmcnt(20)
ds_read_b64_tr_b16 a[168:169], v7 offset:10240
ds_read_b64_tr_b16 a[170:171], v7 offset:10496
ds_read_b64_tr_b16 a[172:173], v7 offset:10272
ds_read_b64_tr_b16 a[174:175], v7 offset:10528
s_waitcnt vmcnt(18)
ds_read_b64_tr_b16 a[176:177], v7 offset:12288
ds_read_b64_tr_b16 a[178:179], v7 offset:12544
ds_read_b64_tr_b16 a[180:181], v7 offset:12320
ds_read_b64_tr_b16 a[182:183], v7 offset:12576
s_waitcnt vmcnt(16)
ds_read_b64_tr_b16 a[184:185], v7 offset:14336
ds_read_b64_tr_b16 a[186:187], v7 offset:14592
ds_read_b64_tr_b16 a[188:189], v7 offset:14368
ds_read_b64_tr_b16 a[190:191], v7 offset:14624
s_waitcnt vmcnt(14)
ds_read_b64_tr_b16 a[192:193], v7 offset:16384
ds_read_b64_tr_b16 a[194:195], v7 offset:16640
ds_read_b64_tr_b16 a[196:197], v7 offset:16416
ds_read_b64_tr_b16 a[198:199], v7 offset:16672
s_waitcnt vmcnt(12)
ds_read_b64_tr_b16 a[200:201], v7 offset:18432
ds_read_b64_tr_b16 a[202:203], v7 offset:18688
ds_read_b64_tr_b16 a[204:205], v7 offset:18464
ds_read_b64_tr_b16 a[206:207], v7 offset:18720
s_waitcnt vmcnt(10)
ds_read_b64_tr_b16 a[208:209], v7 offset:20480
ds_read_b64_tr_b16 a[210:211], v7 offset:20736
ds_read_b64_tr_b16 a[212:213], v7 offset:20512
ds_read_b64_tr_b16 a[214:215], v7 offset:20768
s_waitcnt vmcnt(8)
ds_read_b64_tr_b16 a[216:217], v7 offset:22528
ds_read_b64_tr_b16 a[218:219], v7 offset:22784
ds_read_b64_tr_b16 a[220:221], v7 offset:22560
ds_read_b64_tr_b16 a[222:223], v7 offset:22816
s_waitcnt vmcnt(6)
ds_read_b64_tr_b16 a[224:225], v7 offset:24576
ds_read_b64_tr_b16 a[226:227], v7 offset:24832
ds_read_b64_tr_b16 a[228:229], v7 offset:24608
ds_read_b64_tr_b16 a[230:231], v7 offset:24864
s_waitcnt vmcnt(4)
ds_read_b64_tr_b16 a[232:233], v7 offset:26624
ds_read_b64_tr_b16 a[234:235], v7 offset:26880
ds_read_b64_tr_b16 a[236:237], v7 offset:26656
ds_read_b64_tr_b16 a[238:239], v7 offset:26912
s_waitcnt vmcnt(2)
ds_read_b64_tr_b16 a[240:241], v7 offset:28672
ds_read_b64_tr_b16 a[242:243], v7 offset:28928
ds_read_b64_tr_b16 a[244:245], v7 offset:28704
ds_read_b64_tr_b16 a[246:247], v7 offset:28960
s_waitcnt vmcnt(0)
ds_read_b64_tr_b16 a[248:249], v7 offset:30720
ds_read_b64_tr_b16 a[250:251], v7 offset:30976
ds_read_b64_tr_b16 a[252:253], v7 offset:30752
ds_read_b64_tr_b16 a[254:255], v7 offset:31008
s_waitcnt lgkmcnt(0)
s_add_u32 s62, s10, 0x7e000
s_addc_u32 s63, s11, 0
s_add_u32 m0, s36, 0
s_nop 0
global_load_lds_dwordx4 v4, s[62:63]
s_add_u32 s62, s10, 0x80400
s_addc_u32 s63, s11, 0
s_add_u32 m0, s36, 1024
s_nop 0
global_load_lds_dwordx4 v4, s[62:63]
s_add_u32 s62, s10, 0x87000
s_addc_u32 s63, s11, 0
s_add_u32 m0, s36, 2048
s_nop 0
global_load_lds_dwordx4 v4, s[62:63]
s_add_u32 s62, s10, 0x89400
s_addc_u32 s63, s11, 0
s_add_u32 m0, s36, 3072
s_nop 0
global_load_lds_dwordx4 v4, s[62:63]
s_add_u32 s62, s10, 0x90000
s_addc_u32 s63, s11, 0
s_add_u32 m0, s36, 4096
s_nop 0
global_load_lds_dwordx4 v4, s[62:63]
s_add_u32 s62, s10, 0x92400
s_addc_u32 s63, s11, 0
s_add_u32 m0, s36, 5120
s_nop 0
global_load_lds_dwordx4 v4, s[62:63]
s_add_u32 s62, s10, 0x99000
s_addc_u32 s63, s11, 0
s_add_u32 m0, s36, 6144
s_nop 0
global_load_lds_dwordx4 v4, s[62:63]
s_add_u32 s62, s10, 0x9b400
s_addc_u32 s63, s11, 0
s_add_u32 m0, s36, 7168
s_nop 0
global_load_lds_dwordx4 v4, s[62:63]
s_add_u32 s62, s10, 0xa2000
s_addc_u32 s63, s11, 0
s_add_u32 m0, s36, 8192
s_nop 0
global_load_lds_dwordx4 v4, s[62:63]
s_add_u32 s62, s10, 0xa4400
s_addc_u32 s63, s11, 0
s_add_u32 m0, s36, 9216
s_nop 0
global_load_lds_dwordx4 v4, s[62:63]
s_add_u32 s62, s10, 0xab000
s_addc_u32 s63, s11, 0
s_add_u32 m0, s36, 10240
s_nop 0
global_load_lds_dwordx4 v4, s[62:63]
s_add_u32 s62, s10, 0xad400
s_addc_u32 s63, s11, 0
s_add_u32 m0, s36, 11264
s_nop 0
global_load_lds_dwordx4 v4, s[62:63]
s_waitcnt vmcnt(10)
ds_read_b64_tr_b16 v[208:209], v7
ds_read_b64_tr_b16 v[210:211], v7 offset:256
ds_read_b64_tr_b16 v[212:213], v7 offset:32
ds_read_b64_tr_b16 v[214:215], v7 offset:288
s_waitcnt vmcnt(8)
ds_read_b64_tr_b16 v[216:217], v7 offset:2048
ds_read_b64_tr_b16 v[218:219], v7 offset:2304
ds_read_b64_tr_b16 v[220:221], v7 offset:2080
ds_read_b64_tr_b16 v[222:223], v7 offset:2336
s_waitcnt vmcnt(6)
ds_read_b64_tr_b16 v[224:225], v7 offset:4096
ds_read_b64_tr_b16 v[226:227], v7 offset:4352
ds_read_b64_tr_b16 v[228:229], v7 offset:4128
ds_read_b64_tr_b16 v[230:231], v7 offset:4384
s_waitcnt vmcnt(4)
ds_read_b64_tr_b16 v[232:233], v7 offset:6144
ds_read_b64_tr_b16 v[234:235], v7 offset:6400
ds_read_b64_tr_b16 v[236:237], v7 offset:6176
ds_read_b64_tr_b16 v[238:239], v7 offset:6432
s_waitcnt vmcnt(2)
ds_read_b64_tr_b16 v[240:241], v7 offset:8192
ds_read_b64_tr_b16 v[242:243], v7 offset:8448
ds_read_b64_tr_b16 v[244:245], v7 offset:8224
ds_read_b64_tr_b16 v[246:247], v7 offset:8480
s_waitcnt vmcnt(0)
ds_read_b64_tr_b16 v[248:249], v7 offset:10240
ds_read_b64_tr_b16 v[250:251], v7 offset:10496
ds_read_b64_tr_b16 v[252:253], v7 offset:10272
ds_read_b64_tr_b16 v[254:255], v7 offset:10528
s_waitcnt lgkmcnt(0)
FG_44:
s_barrier
s_mov_b32 s60, 0
v_and_b32 v4, 1, v0
v_mul_u32_u24 v4, 16640, v4
v_add_u32 v4, 0x21000, v4
v_min_u32 v2, 16, v0
s_mul_i32 s34, s57, 17
v_add_u32 v2, s34, v2
v_min_u32 v2, 287, v2
v_lshrrev_b32 v3, 1, v2
v_lshlrev_b32 v3, 9, v3
v_and_b32 v2, 1, v2
v_lshl_add_u32 v6, v2, 7, v3
s_mul_i32 s66, s19, 73728
s_cmp_eq_u32 s19, 0
s_cselect_b32 s35, 0, 4096
s_add_u32 s66, s66, s35
s_add_u32 s66, s66, 0x5201000
s_mov_b32 s67, 0
FT_45:
s_cmp_ge_u32 s56, 128
s_cbranch_scc1 W3
s_lshr_b32 s61, s56, 1
s_mul_i32 s34, s56, 18432
s_add_u32 s68, s28, s34
s_addc_u32 s69, s29, 0
s_cmp_lg_u32 s67, 0
s_cbranch_scc1 FX_50
s_mul_i32 s34, s56, 18432
s_add_u32 s64, s20, s34
s_addc_u32 s65, s21, 0
s_lshr_b32 s34, s56, 1
s_mul_i32 s34, s34, 299008
s_add_u32 s34, s34, s66
s_and_b32 s35, s56, 1
s_lshl_b32 s35, s35, 8
s_add_u32 s34, s34, s35
s_add_u32 s62, s14, s34
s_addc_u32 s63, s15, 0
global_load_dwordx4 v[56:59], v8, s[64:65]
global_load_dwordx4 v[60:63], v8, s[64:65] offset:64
global_load_dwordx4 v[64:67], v8, s[64:65] offset:128
global_load_dwordx4 v[68:71], v8, s[64:65] offset:192
global_load_dwordx4 v[72:75], v8, s[64:65] offset:256
FX_50:
s_cmp_lg_u32 s60, 0
s_cbranch_scc1 FS_48
s_cmp_lg_u32 s19, 0
s_cbranch_scc1 FB_51
s_add_u32 s59, s61, 32
s_lshl_b32 s32, s59, 7
s_add_u32 s32, s32, 0x20000
v_mov_b32 v14, s32
WF_52:
global_load_dword v15, v14, s[14:15] sc1
s_waitcnt vmcnt(0)
v_readfirstlane_b32 s33, v15
s_nop 0
s_cmp_ge_u32 s33, 32
s_cbranch_scc1 WG_53
s_sub_u32 s30, s30, 1
s_cbranch_scc1 EXIT1
s_sleep 8
s_branch WF_52
WG_53:
FB_51:
s_cmp_lg_u32 s19, 0
s_cbranch_scc1 FB_54
s_add_u32 s59, s61, 162
s_lshl_b32 s32, s59, 7
s_add_u32 s32, s32, 0x20000
v_mov_b32 v14, s32
WF_55:
global_load_dword v15, v14, s[14:15] sc1
s_waitcnt vmcnt(0)
v_readfirstlane_b32 s33, v15
s_nop 0
s_cmp_ge_u32 s33, 32
s_cbranch_scc1 WG_56
s_sub_u32 s30, s30, 1
s_cbranch_scc1 EXIT1
s_sleep 1
s_branch WF_55
WG_56:
FB_54:
s_barrier
FS_48:
s_cmp_lg_u32 s67, 0
s_cbranch_scc1 FH_49
global_load_dword v3, v6, s[62:63] offset:-4096 sc1
global_load_dwordx4 v[76:79], v12, s[62:63] offset:-4096 sc1
global_load_dwordx4 v[80:83], v12, s[62:63] offset:-2048 sc1
global_load_dwordx4 v[84:87], v12, s[62:63] sc1
global_load_dwordx4 v[88:91], v12, s[62:63] offset:2048 sc1
s_add_u32 s62, s62, 0x2000
s_addc_u32 s63, s63, 0
global_load_dwordx4 v[92:95], v12, s[62:63] offset:-4096 sc1
global_load_dwordx4 v[96:99], v12, s[62:63] offset:-2048 sc1
global_load_dwordx4 v[100:103], v12, s[62:63] sc1
global_load_dwordx4 v[104:107], v12, s[62:63] offset:2048 sc1
s_add_u32 s62, s62, 0x2000
s_addc_u32 s63, s63, 0
global_load_dwordx4 v[108:111], v12, s[62:63] offset:-4096 sc1
global_load_dwordx4 v[112:115], v12, s[62:63] offset:-2048 sc1
global_load_dwordx4 v[116:119], v12, s[62:63] sc1
global_load_dwordx4 v[120:123], v12, s[62:63] offset:2048 sc1
s_add_u32 s62, s62, 0x2000
s_addc_u32 s63, s63, 0
global_load_dwordx4 v[124:127], v12, s[62:63] offset:-4096 sc1
global_load_dwordx4 v[128:131], v12, s[62:63] offset:-2048 sc1
global_load_dwordx4 v[132:135], v12, s[62:63] sc1
global_load_dwordx4 v[136:139], v12, s[62:63] offset:2048 sc1
s_add_u32 s62, s62, 0x2000
s_addc_u32 s63, s63, 0
global_load_dwordx4 v[140:143], v12, s[62:63] offset:-4096 sc1
global_load_dwordx4 v[144:147], v12, s[62:63] offset:-2048 sc1
global_load_dwordx4 v[148:151], v12, s[62:63] sc1
global_load_dwordx4 v[152:155], v12, s[62:63] offset:2048 sc1
s_add_u32 s62, s62, 0x2000
s_addc_u32 s63, s63, 0
global_load_dwordx4 v[156:159], v12, s[62:63] offset:-4096 sc1
global_load_dwordx4 v[160:163], v12, s[62:63] offset:-2048 sc1
global_load_dwordx4 v[164:167], v12, s[62:63] sc1
global_load_dwordx4 v[168:171], v12, s[62:63] offset:2048 sc1
s_add_u32 s62, s62, 0x2000
s_addc_u32 s63, s63, 0
global_load_dwordx4 v[172:175], v12, s[62:63] offset:-4096 sc1
global_load_dwordx4 v[176:179], v12, s[62:63] offset:-2048 sc1
global_load_dwordx4 v[180:183], v12, s[62:63] sc1
global_load_dwordx4 v[184:187], v12, s[62:63] offset:2048 sc1
FH_49:
s_add_u32 s58, s56, 7
s_lshr_b32 s32, s58, 1
s_lshl_b32 s32, s32, 7
v_add_u32 v2, s32, v4
global_load_dword v5, v2, s[14:15] sc1
s_cmp_eq_u32 s19, 0
s_cbranch_scc1 FV_46
s_waitcnt vmcnt(30)
v_mfma_f32_16x16x32_bf16 v[32:35], v[188:191], v[56:59], 0
v_mfma_f32_16x16x32_bf16 v[32:35], v[192:195], v[60:63], v[32:35]
v_mfma_f32_16x16x32_bf16 v[32:35], v[196:199], v[64:67], v[32:35]
v_mfma_f32_16x16x32_bf16 v[32:35], v[200:203], v[68:71], v[32:35]
v_mfma_f32_16x16x32_bf16 v[32:35], v[204:207], v[72:75], v[32:35]
s_waitcnt vmcnt(28)
v_mfma_f32_16x16x32_bf16 v[16:19], a[0:3], v[76:79], 0
v_mfma_f32_16x16x32_bf16 v[20:23], a[4:7], v[76:79], 0
s_add_u32 s62, s62, 0x2000
s_addc_u32 s63, s63, 0
global_load_dwordx4 v[76:79], v12, s[62:63] offset:-4096 sc1
s_waitcnt vmcnt(28)
v_mfma_f32_16x16x32_bf16 v[16:19], a[8:11], v[80:83], v[16:19]
v_mfma_f32_16x16x32_bf16 v[20:23], a[12:15], v[80:83], v[20:23]
global_load_dwordx4 v[80:83], v12, s[62:63] offset:-2048 sc1
s_waitcnt vmcnt(28)
v_mfma_f32_16x16x32_bf16 v[16:19], a[16:19], v[84:87], v[16:19]
v_mfma_f32_16x16x32_bf16 v[20:23], a[20:23], v[84:87], v[20:23]
global_load_dwordx4 v[84:87], v12, s[62:63] sc1
s_waitcnt vmcnt(28)
v_mfma_f32_16x16x32_bf16 v[16:19], a[24:27], v[88:91], v[16:19]
v_mfma_f32_16x16x32_bf16 v[20:23], a[28:31], v[88:91], v[20:23]
global_load_dwordx4 v[88:91], v12, s[62:63] offset:2048 sc1
s_waitcnt vmcnt(28)
v_mfma_f32_16x16x32_bf16 v[16:19], a[32:35], v[92:95], v[16:19]
v_mfma_f32_16x16x32_bf16 v[20:23], a[36:39], v[92:95], v[20:23]
s_add_u32 s62, s62, 0x2000
s_addc_u32 s63, s63, 0
global_load_dwordx4 v[92:95], v12, s[62:63] offset:-4096 sc1
s_waitcnt vmcnt(28)
v_mfma_f32_16x16x32_bf16 v[16:19], a[40:43], v[96:99], v[16:19]
v_mfma_f32_16x16x32_bf16 v[20:23], a[44:47], v[96:99], v[20:23]
global_load_dwordx4 v[96:99], v12, s[62:63] offset:-2048 sc1
s_waitcnt vmcnt(28)
v_mfma_f32_16x16x32_bf16 v[16:19], a[48:51], v[100:103], v[16:19]
v_mfma_f32_16x16x32_bf16 v[20:23], a[52:55], v[100:103], v[20:23]
global_load_dwordx4 v[100:103], v12, s[62:63] sc1
s_waitcnt vmcnt(28)
v_mfma_f32_16x16x32_bf16 v[16:19], a[56:59], v[104:107], v[16:19]
v_mfma_f32_16x16x32_bf16 v[20:23], a[60:63], v[104:107], v[20:23]
global_load_dwordx4 v[104:107], v12, s[62:63] offset:2048 sc1
s_waitcnt vmcnt(28)
v_mfma_f32_16x16x32_bf16 v[16:19], a[64:67], v[108:111], v[16:19]
v_mfma_f32_16x16x32_bf16 v[20:23], a[68:71], v[108:111], v[20:23]
s_waitcnt vmcnt(27)
v_mfma_f32_16x16x32_bf16 v[16:19], a[72:75], v[112:115], v[16:19]
v_mfma_f32_16x16x32_bf16 v[20:23], a[76:79], v[112:115], v[20:23]
s_waitcnt vmcnt(26)
v_mfma_f32_16x16x32_bf16 v[16:19], a[80:83], v[116:119], v[16:19]
v_mfma_f32_16x16x32_bf16 v[20:23], a[84:87], v[116:119], v[20:23]
s_waitcnt vmcnt(25)
v_mfma_f32_16x16x32_bf16 v[16:19], a[88:91], v[120:123], v[16:19]
v_mfma_f32_16x16x32_bf16 v[20:23], a[92:95], v[120:123], v[20:23]
s_waitcnt vmcnt(24)
v_mfma_f32_16x16x32_bf16 v[16:19], a[96:99], v[124:127], v[16:19]
v_mfma_f32_16x16x32_bf16 v[20:23], a[100:103], v[124:127], v[20:23]
s_waitcnt vmcnt(23)
v_mfma_f32_16x16x32_bf16 v[16:19], a[104:107], v[128:131], v[16:19]
v_mfma_f32_16x16x32_bf16 v[20:23], a[108:111], v[128:131], v[20:23]
s_waitcnt vmcnt(22)
v_mfma_f32_16x16x32_bf16 v[16:19], a[112:115], v[132:135], v[16:19]
v_mfma_f32_16x16x32_bf16 v[20:23], a[116:119], v[132:135], v[20:23]
s_waitcnt vmcnt(21)
v_mfma_f32_16x16x32_bf16 v[16:19], a[120:123], v[136:139], v[16:19]
v_mfma_f32_16x16x32_bf16 v[20:23], a[124:127], v[136:139], v[20:23]
s_waitcnt vmcnt(20)
v_mfma_f32_16x16x32_bf16 v[16:19], a[128:131], v[140:143], v[16:19]
v_mfma_f32_16x16x32_bf16 v[20:23], a[132:135], v[140:143], v[20:23]
s_waitcnt vmcnt(19)
v_mfma_f32_16x16x32_bf16 v[16:19], a[136:139], v[144:147], v[16:19]
v_mfma_f32_16x16x32_bf16 v[20:23], a[140:143], v[144:147], v[20:23]
s_waitcnt vmcnt(18)
v_mfma_f32_16x16x32_bf16 v[16:19], a[144:147], v[148:151], v[16:19]
v_mfma_f32_16x16x32_bf16 v[20:23], a[148:151], v[148:151], v[20:23]
s_waitcnt vmcnt(17)
v_mfma_f32_16x16x32_bf16 v[16:19], a[152:155], v[152:155], v[16:19]
v_mfma_f32_16x16x32_bf16 v[20:23], a[156:159], v[152:155], v[20:23]
s_waitcnt vmcnt(16)
v_mfma_f32_16x16x32_bf16 v[16:19], a[160:163], v[156:159], v[16:19]
v_mfma_f32_16x16x32_bf16 v[20:23], a[164:167], v[156:159], v[20:23]
s_waitcnt vmcnt(15)
v_mfma_f32_16x16x32_bf16 v[16:19], a[168:171], v[160:163], v[16:19]
v_mfma_f32_16x16x32_bf16 v[20:23], a[172:175], v[160:163], v[20:23]
s_waitcnt vmcnt(14)
v_mfma_f32_16x16x32_bf16 v[16:19], a[176:179], v[164:167], v[16:19]
v_mfma_f32_16x16x32_bf16 v[20:23], a[180:183], v[164:167], v[20:23]
s_waitcnt vmcnt(13)
v_mfma_f32_16x16x32_bf16 v[16:19], a[184:187], v[168:171], v[16:19]
v_mfma_f32_16x16x32_bf16 v[20:23], a[188:191], v[168:171], v[20:23]
s_waitcnt vmcnt(12)
v_mfma_f32_16x16x32_bf16 v[16:19], a[192:195], v[172:175], v[16:19]
v_mfma_f32_16x16x32_bf16 v[20:23], a[196:199], v[172:175], v[20:23]
s_waitcnt vmcnt(11)
v_mfma_f32_16x16x32_bf16 v[16:19], a[200:203], v[176:179], v[16:19]
v_mfma_f32_16x16x32_bf16 v[20:23], a[204:207], v[176:179], v[20:23]
s_waitcnt vmcnt(10)
v_mfma_f32_16x16x32_bf16 v[16:19], a[208:211], v[180:183], v[16:19]
v_mfma_f32_16x16x32_bf16 v[20:23], a[212:215], v[180:183], v[20:23]
s_waitcnt vmcnt(9)
v_mfma_f32_16x16x32_bf16 v[16:19], a[216:219], v[184:187], v[16:19]
v_mfma_f32_16x16x32_bf16 v[20:23], a[220:223], v[184:187], v[20:23]
s_waitcnt vmcnt(7)
v_mfma_f32_16x16x32_bf16 v[16:19], a[224:227], v[76:79], v[16:19]
v_mfma_f32_16x16x32_bf16 v[20:23], a[228:231], v[76:79], v[20:23]
s_waitcnt vmcnt(6)
v_mfma_f32_16x16x32_bf16 v[16:19], a[232:235], v[80:83], v[16:19]
v_mfma_f32_16x16x32_bf16 v[20:23], a[236:239], v[80:83], v[20:23]
s_waitcnt vmcnt(5)
v_mfma_f32_16x16x32_bf16 v[16:19], a[240:243], v[84:87], v[16:19]
v_mfma_f32_16x16x32_bf16 v[20:23], a[244:247], v[84:87], v[20:23]
s_waitcnt vmcnt(4)
v_mfma_f32_16x16x32_bf16 v[16:19], a[248:251], v[88:91], v[16:19]
v_mfma_f32_16x16x32_bf16 v[20:23], a[252:255], v[88:91], v[20:23]
s_waitcnt vmcnt(3)
v_mfma_f32_16x16x32_bf16 v[16:19], v[208:211], v[92:95], v[16:19]
v_mfma_f32_16x16x32_bf16 v[20:23], v[212:215], v[92:95], v[20:23]
s_waitcnt vmcnt(2)
v_mfma_f32_16x16x32_bf16 v[16:19], v[216:219], v[96:99], v[16:19]
v_mfma_f32_16x16x32_bf16 v[20:23], v[220:223], v[96:99], v[20:23]
s_waitcnt vmcnt(1)
v_mfma_f32_16x16x32_bf16 v[16:19], v[224:227], v[100:103], v[16:19]
v_mfma_f32_16x16x32_bf16 v[20:23], v[228:231], v[100:103], v[20:23]
s_waitcnt vmcnt(0)
v_mfma_f32_16x16x32_bf16 v[16:19], v[232:235], v[104:107], v[16:19]
v_mfma_f32_16x16x32_bf16 v[20:23], v[236:239], v[104:107], v[20:23]
s_nop 7
s_branch FR_47
FV_46:
s_waitcnt vmcnt(30)
v_mfma_f32_16x16x32_bf16 v[32:35], v[188:191], v[56:59], 0
v_mfma_f32_16x16x32_bf16 v[32:35], v[192:195], v[60:63], v[32:35]
v_mfma_f32_16x16x32_bf16 v[32:35], v[196:199], v[64:67], v[32:35]
s_waitcnt vmcnt(28)
v_mfma_f32_16x16x32_bf16 v[24:27], a[0:3], v[76:79], 0
v_mfma_f32_16x16x32_bf16 v[28:31], a[4:7], v[76:79], 0
s_add_u32 s62, s62, 0x2000
s_addc_u32 s63, s63, 0
global_load_dwordx4 v[76:79], v12, s[62:63] offset:-4096 sc1
s_waitcnt vmcnt(28)
v_mfma_f32_16x16x32_bf16 v[24:27], a[8:11], v[80:83], v[24:27]
v_mfma_f32_16x16x32_bf16 v[28:31], a[12:15], v[80:83], v[28:31]
global_load_dwordx4 v[80:83], v12, s[62:63] offset:-2048 sc1
s_waitcnt vmcnt(28)
v_mfma_f32_16x16x32_bf16 v[24:27], a[16:19], v[84:87], v[24:27]
v_mfma_f32_16x16x32_bf16 v[28:31], a[20:23], v[84:87], v[28:31]
global_load_dwordx4 v[84:87], v12, s[62:63] sc1
s_waitcnt vmcnt(28)
v_mfma_f32_16x16x32_bf16 v[24:27], a[24:27], v[88:91], v[24:27]
v_mfma_f32_16x16x32_bf16 v[28:31], a[28:31], v[88:91], v[28:31]
global_load_dwordx4 v[88:91], v12, s[62:63] offset:2048 sc1
s_waitcnt vmcnt(28)
v_mfma_f32_16x16x32_bf16 v[24:27], a[32:35], v[92:95], v[24:27]
v_mfma_f32_16x16x32_bf16 v[28:31], a[36:39], v[92:95], v[28:31]
s_add_u32 s62, s62, 0x2000
s_addc_u32 s63, s63, 0
global_load_dwordx4 v[92:95], v12, s[62:63] offset:-4096 sc1
s_waitcnt vmcnt(28)
v_mfma_f32_16x16x32_bf16 v[24:27], a[40:43], v[96:99], v[24:27]
v_mfma_f32_16x16x32_bf16 v[28:31], a[44:47], v[96:99], v[28:31]
global_load_dwordx4 v[96:99], v12, s[62:63] offset:-2048 sc1
s_waitcnt vmcnt(28)
v_mfma_f32_16x16x32_bf16 v[24:27], a[48:51], v[100:103], v[24:27]
v_mfma_f32_16x16x32_bf16 v[28:31], a[52:55], v[100:103], v[28:31]
global_load_dwordx4 v[100:103], v12, s[62:63] sc1
s_waitcnt vmcnt(28)
v_mfma_f32_16x16x32_bf16 v[24:27], a[56:59], v[104:107], v[24:27]
v_mfma_f32_16x16x32_bf16 v[28:31], a[60:63], v[104:107], v[28:31]
global_load_dwordx4 v[104:107], v12, s[62:63] offset:2048 sc1
s_waitcnt vmcnt(28)
v_mfma_f32_16x16x32_bf16 v[24:27], a[64:67], v[108:111], v[24:27]
v_mfma_f32_16x16x32_bf16 v[28:31], a[68:71], v[108:111], v[28:31]
s_add_u32 s62, s62, 0x2000
s_addc_u32 s63, s63, 0
global_load_dwordx4 v[108:111], v12, s[62:63] offset:-4096 sc1
s_waitcnt vmcnt(28)
v_mfma_f32_16x16x32_bf16 v[24:27], a[72:75], v[112:115], v[24:27]
v_mfma_f32_16x16x32_bf16 v[28:31], a[76:79], v[112:115], v[28:31]
global_load_dwordx4 v[112:115], v12, s[62:63] offset:-2048 sc1
s_waitcnt vmcnt(28)
v_mfma_f32_16x16x32_bf16 v[24:27], a[80:83], v[116:119], v[24:27]
v_mfma_f32_16x16x32_bf16 v[28:31], a[84:87], v[116:119], v[28:31]
s_waitcnt vmcnt(27)
v_mfma_f32_16x16x32_bf16 v[24:27], a[88:91], v[120:123], v[24:27]
v_mfma_f32_16x16x32_bf16 v[28:31], a[92:95], v[120:123], v[28:31]
s_waitcnt vmcnt(26)
v_mfma_f32_16x16x32_bf16 v[24:27], a[96:99], v[124:127], v[24:27]
v_mfma_f32_16x16x32_bf16 v[28:31], a[100:103], v[124:127], v[28:31]
s_waitcnt vmcnt(25)
v_mfma_f32_16x16x32_bf16 v[24:27], a[104:107], v[128:131], v[24:27]
v_mfma_f32_16x16x32_bf16 v[28:31], a[108:111], v[128:131], v[28:31]
s_waitcnt vmcnt(24)
v_mfma_f32_16x16x32_bf16 v[24:27], a[112:115], v[132:135], v[24:27]
v_mfma_f32_16x16x32_bf16 v[28:31], a[116:119], v[132:135], v[28:31]
s_waitcnt vmcnt(23)
v_mfma_f32_16x16x32_bf16 v[24:27], a[120:123], v[136:139], v[24:27]
v_mfma_f32_16x16x32_bf16 v[28:31], a[124:127], v[136:139], v[28:31]
s_waitcnt vmcnt(22)
v_mfma_f32_16x16x32_bf16 v[24:27], a[128:131], v[140:143], v[24:27]
v_mfma_f32_16x16x32_bf16 v[28:31], a[132:135], v[140:143], v[28:31]
s_waitcnt vmcnt(21)
v_mfma_f32_16x16x32_bf16 v[24:27], a[136:139], v[144:147], v[24:27]
v_mfma_f32_16x16x32_bf16 v[28:31], a[140:143], v[144:147], v[28:31]
s_waitcnt vmcnt(20)
v_mfma_f32_16x16x32_bf16 v[16:19], a[144:147], v[148:151], 0
v_mfma_f32_16x16x32_bf16 v[20:23], a[148:151], v[148:151], 0
s_waitcnt vmcnt(19)
v_mfma_f32_16x16x32_bf16 v[16:19], a[152:155], v[152:155], v[16:19]
v_mfma_f32_16x16x32_bf16 v[20:23], a[156:159], v[152:155], v[20:23]
s_waitcnt vmcnt(18)
v_mfma_f32_16x16x32_bf16 v[16:19], a[160:163], v[156:159], v[16:19]
v_mfma_f32_16x16x32_bf16 v[20:23], a[164:167], v[156:159], v[20:23]
s_waitcnt vmcnt(17)
v_mfma_f32_16x16x32_bf16 v[16:19], a[168:171], v[160:163], v[16:19]
v_mfma_f32_16x16x32_bf16 v[20:23], a[172:175], v[160:163], v[20:23]
s_waitcnt vmcnt(16)
v_mfma_f32_16x16x32_bf16 v[16:19], a[176:179], v[164:167], v[16:19]
v_mfma_f32_16x16x32_bf16 v[20:23], a[180:183], v[164:167], v[20:23]
s_waitcnt vmcnt(15)
v_mfma_f32_16x16x32_bf16 v[16:19], a[184:187], v[168:171], v[16:19]
v_mfma_f32_16x16x32_bf16 v[20:23], a[188:191], v[168:171], v[20:23]
s_waitcnt vmcnt(14)
v_mfma_f32_16x16x32_bf16 v[16:19], a[192:195], v[172:175], v[16:19]
v_mfma_f32_16x16x32_bf16 v[20:23], a[196:199], v[172:175], v[20:23]
s_waitcnt vmcnt(13)
v_mfma_f32_16x16x32_bf16 v[16:19], a[200:203], v[176:179], v[16:19]
v_mfma_f32_16x16x32_bf16 v[20:23], a[204:207], v[176:179], v[20:23]
s_waitcnt vmcnt(12)
v_mfma_f32_16x16x32_bf16 v[16:19], a[208:211], v[180:183], v[16:19]
v_mfma_f32_16x16x32_bf16 v[20:23], a[212:215], v[180:183], v[20:23]
s_waitcnt vmcnt(11)
v_mfma_f32_16x16x32_bf16 v[16:19], a[216:219], v[184:187], v[16:19]
v_mfma_f32_16x16x32_bf16 v[20:23], a[220:223], v[184:187], v[20:23]
s_waitcnt vmcnt(9)
v_mfma_f32_16x16x32_bf16 v[16:19], a[224:227], v[76:79], v[16:19]
v_mfma_f32_16x16x32_bf16 v[20:23], a[228:231], v[76:79], v[20:23]
s_waitcnt vmcnt(8)
v_mfma_f32_16x16x32_bf16 v[16:19], a[232:235], v[80:83], v[16:19]
v_mfma_f32_16x16x32_bf16 v[20:23], a[236:239], v[80:83], v[20:23]
s_waitcnt vmcnt(7)
v_mfma_f32_16x16x32_bf16 v[16:19], a[240:243], v[84:87], v[16:19]
v_mfma_f32_16x16x32_bf16 v[20:23], a[244:247], v[84:87], v[20:23]
s_waitcnt vmcnt(6)
v_mfma_f32_16x16x32_bf16 v[16:19], a[248:251], v[88:91], v[16:19]
v_mfma_f32_16x16x32_bf16 v[20:23], a[252:255], v[88:91], v[20:23]
s_waitcnt vmcnt(5)
v_mfma_f32_16x16x32_bf16 v[16:19], v[208:211], v[92:95], v[16:19]
v_mfma_f32_16x16x32_bf16 v[20:23], v[212:215], v[92:95], v[20:23]
s_waitcnt vmcnt(4)
v_mfma_f32_16x16x32_bf16 v[16:19], v[216:219], v[96:99], v[16:19]
v_mfma_f32_16x16x32_bf16 v[20:23], v[220:223], v[96:99], v[20:23]
s_waitcnt vmcnt(3)
v_mfma_f32_16x16x32_bf16 v[16:19], v[224:227], v[100:103], v[16:19]
v_mfma_f32_16x16x32_bf16 v[20:23], v[228:231], v[100:103], v[20:23]
s_waitcnt vmcnt(2)
v_mfma_f32_16x16x32_bf16 v[16:19], v[232:235], v[104:107], v[16:19]
v_mfma_f32_16x16x32_bf16 v[20:23], v[236:239], v[104:107], v[20:23]
s_waitcnt vmcnt(1)
v_mfma_f32_16x16x32_bf16 v[16:19], v[240:243], v[108:111], v[16:19]
v_mfma_f32_16x16x32_bf16 v[20:23], v[244:247], v[108:111], v[20:23]
s_waitcnt vmcnt(0)
v_mfma_f32_16x16x32_bf16 v[16:19], v[248:251], v[112:115], v[16:19]
v_mfma_f32_16x16x32_bf16 v[20:23], v[252:255], v[112:115], v[20:23]
s_nop 7
ds_write_b128 v10, v[24:27] offset:8192
ds_write_b128 v10, v[28:31] offset:9216
ds_write_b32 v10, v5 offset:14336
FR_47:
ds_write_b128 v10, v[16:19]
ds_write_b128 v10, v[20:23] offset:1024
ds_write_b32 v11, v32 offset:10240
v_cmp_gt_u32 vcc, 32, v5
s_mov_b32 s67, 0
s_cbranch_vccnz FP_57
s_cmp_ge_u32 s58, 128
s_cbranch_scc1 FP_57
s_mul_i32 s34, s58, 18432
s_add_u32 s64, s20, s34
s_addc_u32 s65, s21, 0
s_lshr_b32 s34, s58, 1
s_mul_i32 s34, s34, 299008
s_add_u32 s34, s34, s66
s_and_b32 s35, s58, 1
s_lshl_b32 s35, s35, 8
s_add_u32 s34, s34, s35
s_add_u32 s62, s14, s34
s_addc_u32 s63, s15, 0
global_load_dwordx4 v[56:59], v8, s[64:65]
global_load_dwordx4 v[60:63], v8, s[64:65] offset:64
global_load_dwordx4 v[64:67], v8, s[64:65] offset:128
global_load_dwordx4 v[68:71], v8, s[64:65] offset:192
global_load_dwordx4 v[72:75], v8, s[64:65] offset:256
global_load_dword v3, v6, s[62:63] offset:-4096 sc1
global_load_dwordx4 v[76:79], v12, s[62:63] offset:-4096 sc1
global_load_dwordx4 v[80:83], v12, s[62:63] offset:-2048 sc1
global_load_dwordx4 v[84:87], v12, s[62:63] sc1
global_load_dwordx4 v[88:91], v12, s[62:63] offset:2048 sc1
s_add_u32 s62, s62, 0x2000
s_addc_u32 s63, s63, 0
global_load_dwordx4 v[92:95], v12, s[62:63] offset:-4096 sc1
global_load_dwordx4 v[96:99], v12, s[62:63] offset:-2048 sc1
global_load_dwordx4 v[100:103], v12, s[62:63] sc1
global_load_dwordx4 v[104:107], v12, s[62:63] offset:2048 sc1
s_add_u32 s62, s62, 0x2000
s_addc_u32 s63, s63, 0
global_load_dwordx4 v[108:111], v12, s[62:63] offset:-4096 sc1
global_load_dwordx4 v[112:115], v12, s[62:63] offset:-2048 sc1
global_load_dwordx4 v[116:119], v12, s[62:63] sc1
global_load_dwordx4 v[120:123], v12, s[62:63] offset:2048 sc1
s_add_u32 s62, s62, 0x2000
s_addc_u32 s63, s63, 0
global_load_dwordx4 v[124:127], v12, s[62:63] offset:-4096 sc1
global_load_dwordx4 v[128:131], v12, s[62:63] offset:-2048 sc1
global_load_dwordx4 v[132:135], v12, s[62:63] sc1
global_load_dwordx4 v[136:139], v12, s[62:63] offset:2048 sc1
s_add_u32 s62, s62, 0x2000
s_addc_u32 s63, s63, 0
global_load_dwordx4 v[140:143], v12, s[62:63] offset:-4096 sc1
global_load_dwordx4 v[144:147], v12, s[62:63] offset:-2048 sc1
global_load_dwordx4 v[148:151], v12, s[62:63] sc1
global_load_dwordx4 v[152:155], v12, s[62:63] offset:2048 sc1
s_add_u32 s62, s62, 0x2000
s_addc_u32 s63, s63, 0
global_load_dwordx4 v[156:159], v12, s[62:63] offset:-4096 sc1
global_load_dwordx4 v[160:163], v12, s[62:63] offset:-2048 sc1
global_load_dwordx4 v[164:167], v12, s[62:63] sc1
global_load_dwordx4 v[168:171], v12, s[62:63] offset:2048 sc1
s_add_u32 s62, s62, 0x2000
s_addc_u32 s63, s63, 0
global_load_dwordx4 v[172:175], v12, s[62:63] offset:-4096 sc1
global_load_dwordx4 v[176:179], v12, s[62:63] offset:-2048 sc1
global_load_dwordx4 v[180:183], v12, s[62:63] sc1
global_load_dwordx4 v[184:187], v12, s[62:63] offset:2048 sc1
s_mov_b32 s67, 1
FP_57:
s_waitcnt lgkmcnt(0)
s_barrier
s_lshl_b32 s33, s19, 10
v_subrev_u32 v2, s33, v11
ds_read_b32 v13, v2 offset:14336
s_cmp_ge_u32 s19, 2
s_cbranch_scc1 FN_58
ds_read_b128 v[36:39], v11
ds_read_b128 v[40:43], v11 offset:2048
ds_read_b128 v[44:47], v11 offset:4096
ds_read_b128 v[48:51], v11 offset:6144
ds_read_b128 v[52:55], v11 offset:8192
ds_read_b32 v32, v2 offset:10240
ds_read_b32 v33, v2 offset:11264
ds_read_b32 v34, v2 offset:12288
ds_read_b32 v35, v2 offset:13312
s_waitcnt lgkmcnt(0)
v_add_f32 v2, v32, v33
v_add_f32 v14, v34, v35
v_add_f32 v2, v2, v14
v_mul_f32 v2, 0xbfb8aa3b, v2
v_exp_f32 v2, v2
s_nop 0
v_add_f32 v2, 1.0, v2
v_rcp_f32 v2, v2
v_add_f32 v36, v36, v40
v_add_f32 v44, v44, v48
v_add_f32 v36, v36, v44
v_sub_f32 v52, v52, v36
v_fma_f32 v36, v2, v52, v36
v_add_f32 v37, v37, v41
v_add_f32 v45, v45, v49
v_add_f32 v37, v37, v45
v_sub_f32 v53, v53, v37
v_fma_f32 v37, v2, v53, v37
v_add_f32 v38, v38, v42
v_add_f32 v46, v46, v50
v_add_f32 v38, v38, v46
v_sub_f32 v54, v54, v38
v_fma_f32 v38, v2, v54, v38
v_add_f32 v39, v39, v43
v_add_f32 v47, v47, v51
v_add_f32 v39, v39, v47
v_sub_f32 v55, v55, v39
v_fma_f32 v39, v2, v55, v39
v_cvt_pk_bf16_f32 v36, v36, v37
v_cvt_pk_bf16_f32 v37, v38, v39
global_store_dwordx2 v9, v[36:37], s[68:69]
FN_58:
s_waitcnt lgkmcnt(0)
v_cmp_gt_u32 vcc, 32, v13
s_nop 1
s_cmp_eq_u64 vcc, 0
s_cselect_b32 s60, 1, 0
v_xor_b32 v10, 0x4000, v10
v_xor_b32 v11, 0x4000, v11
s_add_u32 s56, s56, 7
s_branch FT_45
W5:
s_and_b32 s56, s80, 31
s_lshr_b32 s57, s80, 5
s_mov_b32 s76, 0x3e0293ee
s_mov_b32 s60, 0
s_mov_b32 s61, 0
v_lshlrev_b32 v1, 4, v0
v_lshrrev_b32 v12, 4, v0
v_and_b32 v13, 15, v0
v_lshrrev_b32 v14, 2, v13
v_and_b32 v15, 3, v13
s_and_b32 s33, s19, 1
s_lshl_b32 s32, s33, 2
v_add_u32 v16, s32, v12
v_lshrrev_b32 v17, 1, v13
v_xor_b32 v18, v16, v17
v_and_b32 v17, 1, v13
v_lshlrev_b32 v17, 4, v17
v_lshl_add_u32 v18, v18, 5, v17
v_lshrrev_b32 v16, 1, v12
v_and_b32 v19, 1, v12
v_lshlrev_b32 v20, 16, v16
v_add_u32 v20, v20, v18
v_lshl_add_u32 v21, v19, 19, v20
v_lshl_add_u32 v20, v19, 13, v20
s_lshr_b32 s32, s19, 1
s_lshl_b32 s34, s32, 4
s_lshl_b32 s35, s33, 2
s_add_u32 s77, s34, s35
s_lshl_b32 s35, s33, 1
s_add_u32 s78, s34, s35
s_lshl_b32 s77, s77, 13
s_lshl_b32 s78, s78, 13
s_lshl_b32 s34, s56, 8
s_add_u32 s77, s77, s34
s_add_u32 s78, s78, s34
s_lshl_b32 s79, s19, 10
s_barrier
s_add_u32 s32, s77, 0x400000
s_add_u32 s62, s6, s32
s_addc_u32 s63, s7, 0
s_add_u32 m0, s79, 0x0
s_nop 0
global_load_lds_dwordx4 v20, s[62:63]
s_add_u32 s32, s77, 0x404000
s_add_u32 s62, s6, s32
s_addc_u32 s63, s7, 0
s_add_u32 m0, s79, 0x1000
s_nop 0
global_load_lds_dwordx4 v20, s[62:63]
s_add_u32 s32, s77, 0x440000
s_add_u32 s62, s6, s32
s_addc_u32 s63, s7, 0
s_add_u32 m0, s79, 0x2000
s_nop 0
global_load_lds_dwordx4 v20, s[62:63]
s_add_u32 s32, s77, 0x444000
s_add_u32 s62, s6, s32
s_addc_u32 s63, s7, 0
s_add_u32 m0, s79, 0x3000
s_nop 0
global_load_lds_dwordx4 v20, s[62:63]
s_add_u32 s32, s77, 0x400000
s_add_u32 s62, s8, s32
s_addc_u32 s63, s9, 0
s_add_u32 m0, s79, 0x4000
s_nop 0
global_load_lds_dwordx4 v20, s[62:63]
s_add_u32 s32, s77, 0x404000
s_add_u32 s62, s8, s32
s_addc_u32 s63, s9, 0
s_add_u32 m0, s79, 0x5000
s_nop 0
global_load_lds_dwordx4 v20, s[62:63]
s_add_u32 s32, s77, 0x440000
s_add_u32 s62, s8, s32
s_addc_u32 s63, s9, 0
s_add_u32 m0, s79, 0x6000
s_nop 0
global_load_lds_dwordx4 v20, s[62:63]
s_add_u32 s32, s77, 0x444000
s_add_u32 s62, s8, s32
s_addc_u32 s63, s9, 0
s_add_u32 m0, s79, 0x7000
s_nop 0
global_load_lds_dwordx4 v20, s[62:63]
s_add_u32 s32, s78, 0x0
s_add_u32 s62, s6, s32
s_addc_u32 s63, s7, 0
s_add_u32 m0, s79, 0x8000
s_nop 0
global_load_lds_dwordx4 v21, s[62:63]
s_add_u32 s32, s78, 0x2000
s_add_u32 s62, s6, s32
s_addc_u32 s63, s7, 0
s_add_u32 m0, s79, 0x9000
s_nop 0
global_load_lds_dwordx4 v21, s[62:63]
s_add_u32 s32, s78, 0x40000
s_add_u32 s62, s6, s32
s_addc_u32 s63, s7, 0
s_add_u32 m0, s79, 0xa000
s_nop 0
global_load_lds_dwordx4 v21, s[62:63]
s_add_u32 s32, s78, 0x42000
s_add_u32 s62, s6, s32
s_addc_u32 s63, s7, 0
s_add_u32 m0, s79, 0xb000
s_nop 0
global_load_lds_dwordx4 v21, s[62:63]
s_add_u32 s32, s78, 0x0
s_add_u32 s62, s8, s32
s_addc_u32 s63, s9, 0
s_add_u32 m0, s79, 0xc000
s_nop 0
global_load_lds_dwordx4 v21, s[62:63]
s_add_u32 s32, s78, 0x2000
s_add_u32 s62, s8, s32
s_addc_u32 s63, s9, 0
s_add_u32 m0, s79, 0xd000
s_nop 0
global_load_lds_dwordx4 v21, s[62:63]
s_add_u32 s32, s78, 0x40000
s_add_u32 s62, s8, s32
s_addc_u32 s63, s9, 0
s_add_u32 m0, s79, 0xe000
s_nop 0
global_load_lds_dwordx4 v21, s[62:63]
s_add_u32 s32, s78, 0x42000
s_add_u32 s62, s8, s32
s_addc_u32 s63, s9, 0
s_add_u32 m0, s79, 0xf000
s_nop 0
global_load_lds_dwordx4 v21, s[62:63]
s_add_u32 s32, s78, 0x8000
s_add_u32 s62, s6, s32
s_addc_u32 s63, s7, 0
s_add_u32 m0, s79, 0x10000
s_nop 0
global_load_lds_dwordx4 v21, s[62:63]
s_add_u32 s32, s78, 0xa000
s_add_u32 s62, s6, s32
s_addc_u32 s63, s7, 0
s_add_u32 m0, s79, 0x11000
s_nop 0
global_load_lds_dwordx4 v21, s[62:63]
s_add_u32 s32, s78, 0x48000
s_add_u32 s62, s6, s32
s_addc_u32 s63, s7, 0
s_add_u32 m0, s79, 0x12000
s_nop 0
global_load_lds_dwordx4 v21, s[62:63]
s_add_u32 s32, s78, 0x4a000
s_add_u32 s62, s6, s32
s_addc_u32 s63, s7, 0
s_add_u32 m0, s79, 0x13000
s_nop 0
global_load_lds_dwordx4 v21, s[62:63]
s_add_u32 s32, s78, 0x8000
s_add_u32 s62, s8, s32
s_addc_u32 s63, s9, 0
s_add_u32 m0, s79, 0x14000
s_nop 0
global_load_lds_dwordx4 v21, s[62:63]
s_add_u32 s32, s78, 0xa000
s_add_u32 s62, s8, s32
s_addc_u32 s63, s9, 0
s_add_u32 m0, s79, 0x15000
s_nop 0
global_load_lds_dwordx4 v21, s[62:63]
s_add_u32 s32, s78, 0x48000
s_add_u32 s62, s8, s32
s_addc_u32 s63, s9, 0
s_add_u32 m0, s79, 0x16000
s_nop 0
global_load_lds_dwordx4 v21, s[62:63]
s_add_u32 s32, s78, 0x4a000
s_add_u32 s62, s8, s32
s_addc_u32 s63, s9, 0
s_add_u32 m0, s79, 0x17000
s_nop 0
global_load_lds_dwordx4 v21, s[62:63]
s_add_u32 s32, s77, 0x100000
s_add_u32 s62, s6, s32
s_addc_u32 s63, s7, 0
s_add_u32 m0, s79, 0x18000
s_nop 0
global_load_lds_dwordx4 v20, s[62:63]
s_add_u32 s32, s77, 0x104000
s_add_u32 s62, s6, s32
s_addc_u32 s63, s7, 0
s_add_u32 m0, s79, 0x19000
s_nop 0
global_load_lds_dwordx4 v20, s[62:63]
s_add_u32 s32, s77, 0x140000
s_add_u32 s62, s6, s32
s_addc_u32 s63, s7, 0
s_add_u32 m0, s79, 0x1a000
s_nop 0
global_load_lds_dwordx4 v20, s[62:63]
s_add_u32 s32, s77, 0x144000
s_add_u32 s62, s6, s32
s_addc_u32 s63, s7, 0
s_add_u32 m0, s79, 0x1b000
s_nop 0
global_load_lds_dwordx4 v20, s[62:63]
s_add_u32 s32, s77, 0x100000
s_add_u32 s62, s8, s32
s_addc_u32 s63, s9, 0
s_add_u32 m0, s79, 0x1c000
s_nop 0
global_load_lds_dwordx4 v20, s[62:63]
s_add_u32 s32, s77, 0x104000
s_add_u32 s62, s8, s32
s_addc_u32 s63, s9, 0
s_add_u32 m0, s79, 0x1d000
s_nop 0
global_load_lds_dwordx4 v20, s[62:63]
s_add_u32 s32, s77, 0x140000
s_add_u32 s62, s8, s32
s_addc_u32 s63, s9, 0
s_add_u32 m0, s79, 0x1e000
s_nop 0
global_load_lds_dwordx4 v20, s[62:63]
s_add_u32 s32, s77, 0x144000
s_add_u32 s62, s8, s32
s_addc_u32 s63, s9, 0
s_add_u32 m0, s79, 0x1f000
s_nop 0
global_load_lds_dwordx4 v20, s[62:63]
s_add_u32 s32, s78, 0x180000
s_add_u32 s62, s6, s32
s_addc_u32 s63, s7, 0
s_add_u32 m0, s79, 0x20000
s_nop 0
global_load_lds_dwordx4 v21, s[62:63]
s_add_u32 s32, s78, 0x182000
s_add_u32 s62, s6, s32
s_addc_u32 s63, s7, 0
s_add_u32 m0, s79, 0x21000
s_nop 0
global_load_lds_dwordx4 v21, s[62:63]
s_add_u32 s32, s78, 0x1c0000
s_add_u32 s62, s6, s32
s_addc_u32 s63, s7, 0
s_add_u32 m0, s79, 0x22000
s_nop 0
global_load_lds_dwordx4 v21, s[62:63]
s_add_u32 s32, s78, 0x1c2000
s_add_u32 s62, s6, s32
s_addc_u32 s63, s7, 0
s_add_u32 m0, s79, 0x23000
s_nop 0
global_load_lds_dwordx4 v21, s[62:63]
v_lshl_add_u32 v16, v12, 2, v14
v_and_b32 v17, 7, v16
v_lshlrev_b32 v16, 8, v16
v_lshl_add_u32 v16, v15, 3, v16
s_lshl_b32 s32, s19, 1
v_xor_b32 v18, s32, v17
v_lshl_add_u32 v22, v18, 5, v16
v_xor_b32 v23, 32, v22
s_waitcnt vmcnt(32)
s_barrier
ds_read_b64_tr_b16 a[0:1], v22
ds_read_b64_tr_b16 a[2:3], v22 offset:4096
ds_read_b64_tr_b16 a[4:5], v22 offset:8192
ds_read_b64_tr_b16 a[6:7], v22 offset:12288
ds_read_b64_tr_b16 a[8:9], v23
ds_read_b64_tr_b16 a[10:11], v23 offset:4096
ds_read_b64_tr_b16 a[12:13], v23 offset:8192
ds_read_b64_tr_b16 a[14:15], v23 offset:12288
s_waitcnt vmcnt(28) lgkmcnt(0)
s_barrier
s_add_u32 s32, s78, 0x180000
s_add_u32 s62, s8, s32
s_addc_u32 s63, s9, 0
s_add_u32 m0, s79, 0x0
s_nop 0
global_load_lds_dwordx4 v21, s[62:63]
s_add_u32 s32, s78, 0x182000
s_add_u32 s62, s8, s32
s_addc_u32 s63, s9, 0
s_add_u32 m0, s79, 0x1000
s_nop 0
global_load_lds_dwordx4 v21, s[62:63]
s_add_u32 s32, s78, 0x1c0000
s_add_u32 s62, s8, s32
s_addc_u32 s63, s9, 0
s_add_u32 m0, s79, 0x2000
s_nop 0
global_load_lds_dwordx4 v21, s[62:63]
s_add_u32 s32, s78, 0x1c2000
s_add_u32 s62, s8, s32
s_addc_u32 s63, s9, 0
s_add_u32 m0, s79, 0x3000
s_nop 0
global_load_lds_dwordx4 v21, s[62:63]
ds_read_b64_tr_b16 a[16:17], v22 offset:16384
ds_read_b64_tr_b16 a[18:19], v22 offset:20480
ds_read_b64_tr_b16 a[20:21], v22 offset:24576
ds_read_b64_tr_b16 a[22:23], v22 offset:28672
ds_read_b64_tr_b16 a[24:25], v23 offset:16384
ds_read_b64_tr_b16 a[26:27], v23 offset:20480
ds_read_b64_tr_b16 a[28:29], v23 offset:24576
ds_read_b64_tr_b16 a[30:31], v23 offset:28672
s_waitcnt vmcnt(28) lgkmcnt(0)
s_barrier
s_add_u32 s32, s78, 0x188000
s_add_u32 s62, s6, s32
s_addc_u32 s63, s7, 0
s_add_u32 m0, s79, 0x4000
s_nop 0
global_load_lds_dwordx4 v21, s[62:63]
s_add_u32 s32, s78, 0x18a000
s_add_u32 s62, s6, s32
s_addc_u32 s63, s7, 0
s_add_u32 m0, s79, 0x5000
s_nop 0
global_load_lds_dwordx4 v21, s[62:63]
s_add_u32 s32, s78, 0x1c8000
s_add_u32 s62, s6, s32
s_addc_u32 s63, s7, 0
s_add_u32 m0, s79, 0x6000
s_nop 0
global_load_lds_dwordx4 v21, s[62:63]
s_add_u32 s32, s78, 0x1ca000
s_add_u32 s62, s6, s32
s_addc_u32 s63, s7, 0
s_add_u32 m0, s79, 0x7000
s_nop 0
global_load_lds_dwordx4 v21, s[62:63]
ds_read_b64_tr_b16 a[32:33], v22 offset:32768
ds_read_b64_tr_b16 a[34:35], v22 offset:36864
ds_read_b64_tr_b16 a[36:37], v22 offset:40960
ds_read_b64_tr_b16 a[38:39], v22 offset:45056
ds_read_b64_tr_b16 a[40:41], v23 offset:32768
ds_read_b64_tr_b16 a[42:43], v23 offset:36864
ds_read_b64_tr_b16 a[44:45], v23 offset:40960
ds_read_b64_tr_b16 a[46:47], v23 offset:45056
s_waitcnt vmcnt(28) lgkmcnt(0)
s_barrier
s_add_u32 s32, s78, 0x188000
s_add_u32 s62, s8, s32
s_addc_u32 s63, s9, 0
s_add_u32 m0, s79, 0x8000
s_nop 0
global_load_lds_dwordx4 v21, s[62:63]
s_add_u32 s32, s78, 0x18a000
s_add_u32 s62, s8, s32
s_addc_u32 s63, s9, 0
s_add_u32 m0, s79, 0x9000
s_nop 0
global_load_lds_dwordx4 v21, s[62:63]
s_add_u32 s32, s78, 0x1c8000
s_add_u32 s62, s8, s32
s_addc_u32 s63, s9, 0
s_add_u32 m0, s79, 0xa000
s_nop 0
global_load_lds_dwordx4 v21, s[62:63]
s_add_u32 s32, s78, 0x1ca000
s_add_u32 s62, s8, s32
s_addc_u32 s63, s9, 0
s_add_u32 m0, s79, 0xb000
s_nop 0
global_load_lds_dwordx4 v21, s[62:63]
ds_read_b64_tr_b16 a[48:49], v22 offset:49152
ds_read_b64_tr_b16 a[50:51], v22 offset:53248
ds_read_b64_tr_b16 a[52:53], v22 offset:57344
ds_read_b64_tr_b16 a[54:55], v22 offset:61440
ds_read_b64_tr_b16 a[56:57], v23 offset:49152
ds_read_b64_tr_b16 a[58:59], v23 offset:53248
ds_read_b64_tr_b16 a[60:61], v23 offset:57344
ds_read_b64_tr_b16 a[62:63], v23 offset:61440
s_waitcnt vmcnt(28) lgkmcnt(0)
s_barrier
s_add_u32 s32, s77, 0x280000
s_add_u32 s62, s6, s32
s_addc_u32 s63, s7, 0
s_add_u32 m0, s79, 0xc000
s_nop 0
global_load_lds_dwordx4 v20, s[62:63]
s_add_u32 s32, s77, 0x284000
s_add_u32 s62, s6, s32
s_addc_u32 s63, s7, 0
s_add_u32 m0, s79, 0xd000
s_nop 0
global_load_lds_dwordx4 v20, s[62:63]
s_add_u32 s32, s77, 0x2c0000
s_add_u32 s62, s6, s32
s_addc_u32 s63, s7, 0
s_add_u32 m0, s79, 0xe000
s_nop 0
global_load_lds_dwordx4 v20, s[62:63]
s_add_u32 s32, s77, 0x2c4000
s_add_u32 s62, s6, s32
s_addc_u32 s63, s7, 0
s_add_u32 m0, s79, 0xf000
s_nop 0
global_load_lds_dwordx4 v20, s[62:63]
v_add_u32 v18, 0x10000, v22
ds_read_b64_tr_b16 a[64:65], v18
ds_read_b64_tr_b16 a[66:67], v18 offset:4096
ds_read_b64_tr_b16 a[68:69], v18 offset:8192
ds_read_b64_tr_b16 a[70:71], v18 offset:12288
v_add_u32 v19, 0x10000, v23
ds_read_b64_tr_b16 a[72:73], v19
ds_read_b64_tr_b16 a[74:75], v19 offset:4096
ds_read_b64_tr_b16 a[76:77], v19 offset:8192
ds_read_b64_tr_b16 a[78:79], v19 offset:12288
s_waitcnt vmcnt(28) lgkmcnt(0)
s_barrier
s_add_u32 s32, s77, 0x280000
s_add_u32 s62, s8, s32
s_addc_u32 s63, s9, 0
s_add_u32 m0, s79, 0x10000
s_nop 0
global_load_lds_dwordx4 v20, s[62:63]
s_add_u32 s32, s77, 0x284000
s_add_u32 s62, s8, s32
s_addc_u32 s63, s9, 0
s_add_u32 m0, s79, 0x11000
s_nop 0
global_load_lds_dwordx4 v20, s[62:63]
s_add_u32 s32, s77, 0x2c0000
s_add_u32 s62, s8, s32
s_addc_u32 s63, s9, 0
s_add_u32 m0, s79, 0x12000
s_nop 0
global_load_lds_dwordx4 v20, s[62:63]
s_add_u32 s32, s77, 0x2c4000
s_add_u32 s62, s8, s32
s_addc_u32 s63, s9, 0
s_add_u32 m0, s79, 0x13000
s_nop 0
global_load_lds_dwordx4 v20, s[62:63]
v_add_u32 v18, 0x10000, v22
ds_read_b64_tr_b16 a[80:81], v18 offset:16384
ds_read_b64_tr_b16 a[82:83], v18 offset:20480
ds_read_b64_tr_b16 a[84:85], v18 offset:24576
ds_read_b64_tr_b16 a[86:87], v18 offset:28672
v_add_u32 v19, 0x10000, v23
ds_read_b64_tr_b16 a[88:89], v19 offset:16384
ds_read_b64_tr_b16 a[90:91], v19 offset:20480
ds_read_b64_tr_b16 a[92:93], v19 offset:24576
ds_read_b64_tr_b16 a[94:95], v19 offset:28672
s_waitcnt vmcnt(28) lgkmcnt(0)
s_barrier
s_add_u32 s32, s78, 0x300000
s_add_u32 s62, s6, s32
s_addc_u32 s63, s7, 0
s_add_u32 m0, s79, 0x14000
s_nop 0
global_load_lds_dwordx4 v21, s[62:63]
s_add_u32 s32, s78, 0x302000
s_add_u32 s62, s6, s32
s_addc_u32 s63, s7, 0
s_add_u32 m0, s79, 0x15000
s_nop 0
global_load_lds_dwordx4 v21, s[62:63]
s_add_u32 s32, s78, 0x340000
s_add_u32 s62, s6, s32
s_addc_u32 s63, s7, 0
s_add_u32 m0, s79, 0x16000
s_nop 0
global_load_lds_dwordx4 v21, s[62:63]
s_add_u32 s32, s78, 0x342000
s_add_u32 s62, s6, s32
s_addc_u32 s63, s7, 0
s_add_u32 m0, s79, 0x17000
s_nop 0
global_load_lds_dwordx4 v21, s[62:63]
v_add_u32 v18, 0x10000, v22
ds_read_b64_tr_b16 a[96:97], v18 offset:32768
ds_read_b64_tr_b16 a[98:99], v18 offset:36864
ds_read_b64_tr_b16 a[100:101], v18 offset:40960
ds_read_b64_tr_b16 a[102:103], v18 offset:45056
v_add_u32 v19, 0x10000, v23
ds_read_b64_tr_b16 a[104:105], v19 offset:32768
ds_read_b64_tr_b16 a[106:107], v19 offset:36864
ds_read_b64_tr_b16 a[108:109], v19 offset:40960
ds_read_b64_tr_b16 a[110:111], v19 offset:45056
s_waitcnt vmcnt(28) lgkmcnt(0)
s_barrier
s_add_u32 s32, s78, 0x300000
s_add_u32 s62, s8, s32
s_addc_u32 s63, s9, 0
s_add_u32 m0, s79, 0x18000
s_nop 0
global_load_lds_dwordx4 v21, s[62:63]
s_add_u32 s32, s78, 0x302000
s_add_u32 s62, s8, s32
s_addc_u32 s63, s9, 0
s_add_u32 m0, s79, 0x19000
s_nop 0
global_load_lds_dwordx4 v21, s[62:63]
s_add_u32 s32, s78, 0x340000
s_add_u32 s62, s8, s32
s_addc_u32 s63, s9, 0
s_add_u32 m0, s79, 0x1a000
s_nop 0
global_load_lds_dwordx4 v21, s[62:63]
s_add_u32 s32, s78, 0x342000
s_add_u32 s62, s8, s32
s_addc_u32 s63, s9, 0
s_add_u32 m0, s79, 0x1b000
s_nop 0
global_load_lds_dwordx4 v21, s[62:63]
v_add_u32 v18, 0x10000, v22
ds_read_b64_tr_b16 a[112:113], v18 offset:49152
ds_read_b64_tr_b16 a[114:115], v18 offset:53248
ds_read_b64_tr_b16 a[116:117], v18 offset:57344
ds_read_b64_tr_b16 a[118:119], v18 offset:61440
v_add_u32 v19, 0x10000, v23
ds_read_b64_tr_b16 a[120:121], v19 offset:49152
ds_read_b64_tr_b16 a[122:123], v19 offset:53248
ds_read_b64_tr_b16 a[124:125], v19 offset:57344
ds_read_b64_tr_b16 a[126:127], v19 offset:61440
s_waitcnt vmcnt(28) lgkmcnt(0)
s_barrier
s_add_u32 s32, s78, 0x308000
s_add_u32 s62, s6, s32
s_addc_u32 s63, s7, 0
s_add_u32 m0, s79, 0x1c000
s_nop 0
global_load_lds_dwordx4 v21, s[62:63]
s_add_u32 s32, s78, 0x30a000
s_add_u32 s62, s6, s32
s_addc_u32 s63, s7, 0
s_add_u32 m0, s79, 0x1d000
s_nop 0
global_load_lds_dwordx4 v21, s[62:63]
s_add_u32 s32, s78, 0x348000
s_add_u32 s62, s6, s32
s_addc_u32 s63, s7, 0
s_add_u32 m0, s79, 0x1e000
s_nop 0
global_load_lds_dwordx4 v21, s[62:63]
s_add_u32 s32, s78, 0x34a000
s_add_u32 s62, s6, s32
s_addc_u32 s63, s7, 0
s_add_u32 m0, s79, 0x1f000
s_nop 0
global_load_lds_dwordx4 v21, s[62:63]
v_add_u32 v18, 0x20000, v22
ds_read_b64_tr_b16 a[128:129], v18
ds_read_b64_tr_b16 a[130:131], v18 offset:4096
ds_read_b64_tr_b16 a[132:133], v18 offset:8192
ds_read_b64_tr_b16 a[134:135], v18 offset:12288
v_add_u32 v19, 0x20000, v23
ds_read_b64_tr_b16 a[136:137], v19
ds_read_b64_tr_b16 a[138:139], v19 offset:4096
ds_read_b64_tr_b16 a[140:141], v19 offset:8192
ds_read_b64_tr_b16 a[142:143], v19 offset:12288
s_waitcnt vmcnt(28) lgkmcnt(0)
s_barrier
s_add_u32 s32, s78, 0x308000
s_add_u32 s62, s8, s32
s_addc_u32 s63, s9, 0
s_add_u32 m0, s79, 0x20000
s_nop 0
global_load_lds_dwordx4 v21, s[62:63]
s_add_u32 s32, s78, 0x30a000
s_add_u32 s62, s8, s32
s_addc_u32 s63, s9, 0
s_add_u32 m0, s79, 0x21000
s_nop 0
global_load_lds_dwordx4 v21, s[62:63]
s_add_u32 s32, s78, 0x348000
s_add_u32 s62, s8, s32
s_addc_u32 s63, s9, 0
s_add_u32 m0, s79, 0x22000
s_nop 0
global_load_lds_dwordx4 v21, s[62:63]
s_add_u32 s32, s78, 0x34a000
s_add_u32 s62, s8, s32
s_addc_u32 s63, s9, 0
s_add_u32 m0, s79, 0x23000
s_nop 0
global_load_lds_dwordx4 v21, s[62:63]
ds_read_b64_tr_b16 a[144:145], v22
ds_read_b64_tr_b16 a[146:147], v22 offset:4096
ds_read_b64_tr_b16 a[148:149], v22 offset:8192
ds_read_b64_tr_b16 a[150:151], v22 offset:12288
ds_read_b64_tr_b16 a[152:153], v23
ds_read_b64_tr_b16 a[154:155], v23 offset:4096
ds_read_b64_tr_b16 a[156:157], v23 offset:8192
ds_read_b64_tr_b16 a[158:159], v23 offset:12288
s_waitcnt vmcnt(28) lgkmcnt(0)
s_barrier
ds_read_b64_tr_b16 a[160:161], v22 offset:16384
ds_read_b64_tr_b16 a[162:163], v22 offset:20480
ds_read_b64_tr_b16 a[164:165], v22 offset:24576
ds_read_b64_tr_b16 a[166:167], v22 offset:28672
ds_read_b64_tr_b16 a[168:169], v23 offset:16384
ds_read_b64_tr_b16 a[170:171], v23 offset:20480
ds_read_b64_tr_b16 a[172:173], v23 offset:24576
ds_read_b64_tr_b16 a[174:175], v23 offset:28672
s_waitcnt vmcnt(24) lgkmcnt(0)
s_barrier
ds_read_b64_tr_b16 a[176:177], v22 offset:32768
ds_read_b64_tr_b16 a[178:179], v22 offset:36864
ds_read_b64_tr_b16 a[180:181], v22 offset:40960
ds_read_b64_tr_b16 a[182:183], v22 offset:45056
ds_read_b64_tr_b16 a[184:185], v23 offset:32768
ds_read_b64_tr_b16 a[186:187], v23 offset:36864
ds_read_b64_tr_b16 a[188:189], v23 offset:40960
ds_read_b64_tr_b16 a[190:191], v23 offset:45056
s_waitcnt vmcnt(20) lgkmcnt(0)
s_barrier
ds_read_b64_tr_b16 a[192:193], v22 offset:49152
ds_read_b64_tr_b16 a[194:195], v22 offset:53248
ds_read_b64_tr_b16 a[196:197], v22 offset:57344
ds_read_b64_tr_b16 a[198:199], v22 offset:61440
ds_read_b64_tr_b16 a[200:201], v23 offset:49152
ds_read_b64_tr_b16 a[202:203], v23 offset:53248
ds_read_b64_tr_b16 a[204:205], v23 offset:57344
ds_read_b64_tr_b16 a[206:207], v23 offset:61440
s_waitcnt vmcnt(16) lgkmcnt(0)
s_barrier
v_add_u32 v18, 0x10000, v22
ds_read_b64_tr_b16 a[208:209], v18
ds_read_b64_tr_b16 a[210:211], v18 offset:4096
ds_read_b64_tr_b16 a[212:213], v18 offset:8192
ds_read_b64_tr_b16 a[214:215], v18 offset:12288
v_add_u32 v19, 0x10000, v23
ds_read_b64_tr_b16 a[216:217], v19
ds_read_b64_tr_b16 a[218:219], v19 offset:4096
ds_read_b64_tr_b16 a[220:221], v19 offset:8192
ds_read_b64_tr_b16 a[222:223], v19 offset:12288
s_waitcnt vmcnt(12) lgkmcnt(0)
s_barrier
v_add_u32 v18, 0x10000, v22
ds_read_b64_tr_b16 a[224:225], v18 offset:16384
ds_read_b64_tr_b16 a[226:227], v18 offset:20480
ds_read_b64_tr_b16 a[228:229], v18 offset:24576
ds_read_b64_tr_b16 a[230:231], v18 offset:28672
v_add_u32 v19, 0x10000, v23
ds_read_b64_tr_b16 a[232:233], v19 offset:16384
ds_read_b64_tr_b16 a[234:235], v19 offset:20480
ds_read_b64_tr_b16 a[236:237], v19 offset:24576
ds_read_b64_tr_b16 a[238:239], v19 offset:28672
s_waitcnt vmcnt(8) lgkmcnt(0)
s_barrier
v_add_u32 v18, 0x10000, v22
ds_read_b64_tr_b16 a[240:241], v18 offset:32768
ds_read_b64_tr_b16 a[242:243], v18 offset:36864
ds_read_b64_tr_b16 a[244:245], v18 offset:40960
ds_read_b64_tr_b16 a[246:247], v18 offset:45056
v_add_u32 v19, 0x10000, v23
ds_read_b64_tr_b16 a[248:249], v19 offset:32768
ds_read_b64_tr_b16 a[250:251], v19 offset:36864
ds_read_b64_tr_b16 a[252:253], v19 offset:40960
ds_read_b64_tr_b16 a[254:255], v19 offset:45056
s_waitcnt vmcnt(4) lgkmcnt(0)
s_barrier
v_add_u32 v18, 0x10000, v22
ds_read_b64_tr_b16 v[224:225], v18 offset:49152
ds_read_b64_tr_b16 v[226:227], v18 offset:53248
ds_read_b64_tr_b16 v[228:229], v18 offset:57344
ds_read_b64_tr_b16 v[230:231], v18 offset:61440
v_add_u32 v19, 0x10000, v23
ds_read_b64_tr_b16 v[232:233], v19 offset:49152
ds_read_b64_tr_b16 v[234:235], v19 offset:53248
ds_read_b64_tr_b16 v[236:237], v19 offset:57344
ds_read_b64_tr_b16 v[238:239], v19 offset:61440
s_waitcnt vmcnt(0) lgkmcnt(0)
s_barrier
v_add_u32 v18, 0x20000, v22
ds_read_b64_tr_b16 v[240:241], v18
ds_read_b64_tr_b16 v[242:243], v18 offset:4096
ds_read_b64_tr_b16 v[244:245], v18 offset:8192
ds_read_b64_tr_b16 v[246:247], v18 offset:12288
v_add_u32 v19, 0x20000, v23
ds_read_b64_tr_b16 v[248:249], v19
ds_read_b64_tr_b16 v[250:251], v19 offset:4096
ds_read_b64_tr_b16 v[252:253], v19 offset:8192
ds_read_b64_tr_b16 v[254:255], v19 offset:12288
v_and_b32 v16, 2, v13
v_cmp_eq_u32 vcc, 0, v16
v_mov_b32 v17, 0xeeee
v_mov_b32 v18, 0x4444
v_cndmask_b32 v4, v17, v18, vcc
v_xor_b32 v16, v12, v14
v_lshlrev_b32 v16, 3, v16
v_lshl_add_u32 v16, v13, 5, v16
s_add_u32 s32, s79, 67584
v_add_u32 v6, s32, v16
v_xor_b32 v16, v12, v15
v_lshlrev_b32 v16, 3, v16
v_lshl_add_u32 v17, v12, 2, v14
v_lshl_add_u32 v16, v17, 5, v16
v_add_u32 v7, 67584, v16
v_lshrrev_b32 v16, 1, v12
v_lshlrev_b32 v16, 10, v16
v_and_b32 v17, 1, v12
v_lshl_add_u32 v17, v17, 5, v13
v_lshl_add_u32 v5, v17, 4, v16
v_lshlrev_b32 v16, 2, v12
v_add_u32 v17, 0, v16
v_cmp_le_u32 s[68:69], v17, v13
v_add_u32 v17, 1, v16
v_cmp_le_u32 s[70:71], v17, v13
v_add_u32 v17, 2, v16
v_cmp_le_u32 s[72:73], v17, v13
v_add_u32 v17, 3, v16
v_cmp_le_u32 s[74:75], v17, v13
s_waitcnt lgkmcnt(0)
v_mov_b32 v204, 0x3f803f80
v_mov_b32 v205, 0x3f803f80
v_mov_b32 v206, 0x3f803f80
v_mov_b32 v207, 0x3f803f80
v_mov_b32 v208, 0xff800000
v_mov_b32 v194, 0
v_mov_b32 v195, 0
v_mov_b32 v201, 0
v_mov_b32 v203, 0
v_mov_b32 v153, 0
v_mov_b32 v155, 0
v_min_u32 v2, 15, v0
v_cmp_gt_u32 vcc, 8, v2
v_mov_b32 v9, 32
v_mov_b32 v10, 64
v_cndmask_b32 v9, v9, v10, vcc
v_lshlrev_b32 v2, 7, v2
v_add_u32 v2, 0x20000, v2
BW_59:
global_load_dword v3, v2, s[14:15] sc1
s_waitcnt vmcnt(0)
v_cmp_gt_u32 vcc, v9, v3
s_cbranch_vccz BG_60
s_sub_u32 s30, s30, 1
s_cbranch_scc1 EXIT1
s_sleep 8
s_branch BW_59
BG_60:
v_and_b32 v9, 31, v0
v_mul_u32_u24 v9, 4352, v9
v_add_u32 v9, 0x40000, v9
s_barrier
s_mov_b32 s38, s57
s_mov_b32 s39, 0
s_mul_i32 s32, s56, 1064960
s_lshl_b32 s33, s38, 14
s_add_u32 s32, s32, s33
s_lshl_b32 s34, s19, 11
s_add_u32 s32, s32, s34
s_add_u32 s32, s32, 0x1600000
s_add_u32 s62, s14, s32
s_addc_u32 s63, s15, 0
s_lshl_b32 s32, s56, 19
s_lshl_b32 s33, s38, 13
s_add_u32 s32, s32, s33
s_add_u32 s32, s32, s34
s_add_u32 s32, s32, 0x3800000
s_add_u32 s64, s14, s32
s_addc_u32 s65, s15, 0
s_add_u32 s34, s34, s39
s_add_u32 m0, s34, 0
s_nop 0
global_load_lds_dwordx4 v1, s[64:65] sc1
global_load_lds_dwordx4 v1, s[64:65] offset:1024 sc1
s_add_u32 m0, s34, 8192
s_nop 0
global_load_lds_dwordx4 v1, s[62:63] sc1
global_load_lds_dwordx4 v1, s[62:63] offset:1024 sc1
s_add_u32 s62, s62, 0x2000
s_addc_u32 s63, s63, 0
s_add_u32 m0, s34, 16384
s_nop 0
global_load_lds_dwordx4 v1, s[62:63] sc1
global_load_lds_dwordx4 v1, s[62:63] offset:1024 sc1
s_mov_b32 s81, 0
s_mov_b32 s82, 0
s_mov_b32 s83, 49152
BT_61:
s_cmp_ge_u32 s57, 64
s_cbranch_scc1 W3
v_add_u32 v8, s61, v1
v_add_u32 v11, s83, v1
s_waitcnt vmcnt(0)
s_barrier
ds_read_b128 v[12:15], v8
ds_read_b128 v[44:47], v8 offset:8192
ds_read_b128 v[16:19], v8 offset:1024
ds_read_b128 v[48:51], v8 offset:9216
ds_read_b128 v[20:23], v8 offset:2048
ds_read_b128 v[52:55], v8 offset:10240
ds_read_b128 v[24:27], v8 offset:3072
ds_read_b128 v[56:59], v8 offset:11264
ds_read_b128 v[28:31], v8 offset:4096
ds_read_b128 v[60:63], v8 offset:12288
ds_read_b128 v[32:35], v8 offset:5120
ds_read_b128 v[64:67], v8 offset:13312
ds_read_b128 v[36:39], v8 offset:6144
ds_read_b128 v[68:71], v8 offset:14336
ds_read_b128 v[40:43], v8 offset:7168
ds_read_b128 v[72:75], v8 offset:15360
s_lshl_b32 s32, s79, 1
v_add_u32 v10, s32, v8
ds_read_b128 v[76:79], v10 offset:16384
ds_read_b128 v[80:83], v10 offset:17408
s_cmp_eq_u32 s82, 0
s_cbranch_scc1 BQ_66
s_cmp_lg_u32 s19, 0
s_cbranch_scc1 BQ_66
s_mov_b64 exec, 1
v_mov_b32 v2, s82
v_mov_b32 v3, 1
global_atomic_add v2, v3, s[14:15]
s_mov_b64 exec, -1
BQ_66:
s_add_u32 s40, s57, 3
s_cmp_ge_u32 s40, 64
s_cbranch_scc1 BR_67
s_mov_b32 s38, s40
s_xor_b32 s39, s61, 24576
s_mul_i32 s32, s56, 1064960
s_lshl_b32 s33, s38, 14
s_add_u32 s32, s32, s33
s_lshl_b32 s34, s19, 11
s_add_u32 s32, s32, s34
s_add_u32 s32, s32, 0x1600000
s_add_u32 s62, s14, s32
s_addc_u32 s63, s15, 0
s_lshl_b32 s32, s56, 19
s_lshl_b32 s33, s38, 13
s_add_u32 s32, s32, s33
s_add_u32 s32, s32, s34
s_add_u32 s32, s32, 0x3800000
s_add_u32 s64, s14, s32
s_addc_u32 s65, s15, 0
s_add_u32 s34, s34, s39
s_add_u32 m0, s34, 0
s_nop 0
global_load_lds_dwordx4 v1, s[64:65] sc1
global_load_lds_dwordx4 v1, s[64:65] offset:1024 sc1
s_add_u32 m0, s34, 8192
s_nop 0
global_load_lds_dwordx4 v1, s[62:63] sc1
global_load_lds_dwordx4 v1, s[62:63] offset:1024 sc1
s_add_u32 s62, s62, 0x2000
s_addc_u32 s63, s63, 0
s_add_u32 m0, s34, 16384
s_nop 0
global_load_lds_dwordx4 v1, s[62:63] sc1
global_load_lds_dwordx4 v1, s[62:63] offset:1024 sc1
BR_67:
v_mov_b64 v[136:137], 0
v_mov_b64 v[138:139], 0
v_mov_b64 v[140:141], 0
v_mov_b64 v[142:143], 0
v_mov_b64 v[144:145], 0
v_mov_b64 v[146:147], 0
v_mov_b64 v[148:149], 0
v_mov_b64 v[150:151], 0
s_waitcnt lgkmcnt(0)
v_mfma_f32_16x16x32_bf16 v[156:159], v[44:47], v[12:15], 0
v_mfma_f32_16x16x32_bf16 v[160:163], v[44:47], v[28:31], 0
v_mfma_f32_16x16x32_bf16 v[164:167], v[60:63], v[28:31], 0
v_mfma_f32_16x16x32_bf16 v[156:159], v[48:51], v[16:19], v[156:159]
v_mfma_f32_16x16x32_bf16 v[160:163], v[48:51], v[32:35], v[160:163]
v_mfma_f32_16x16x32_bf16 v[164:167], v[64:67], v[32:35], v[164:167]
v_mfma_f32_16x16x32_bf16 v[156:159], v[52:55], v[20:23], v[156:159]
v_mfma_f32_16x16x32_bf16 v[160:163], v[52:55], v[36:39], v[160:163]
v_mfma_f32_16x16x32_bf16 v[164:167], v[68:71], v[36:39], v[164:167]
v_mfma_f32_16x16x32_bf16 v[156:159], v[56:59], v[24:27], v[156:159]
v_mfma_f32_16x16x32_bf16 v[160:163], v[56:59], v[40:43], v[160:163]
v_mfma_f32_16x16x32_bf16 v[164:167], v[72:75], v[40:43], v[164:167]
s_nop 5
v_cndmask_b32 v156, v208, v156, s[68:69]
s_nop 0
v_cndmask_b32 v164, v208, v164, s[68:69]
v_cndmask_b32 v157, v208, v157, s[70:71]
v_cndmask_b32 v165, v208, v165, s[70:71]
v_cndmask_b32 v158, v208, v158, s[72:73]
v_cndmask_b32 v166, v208, v166, s[72:73]
v_cndmask_b32 v159, v208, v159, s[74:75]
v_cndmask_b32 v167, v208, v167, s[74:75]
v_exp_f32 v176, v156
v_exp_f32 v177, v157
v_exp_f32 v178, v158
v_exp_f32 v179, v159
v_exp_f32 v180, v160
v_exp_f32 v181, v161
v_exp_f32 v182, v162
v_exp_f32 v183, v163
v_exp_f32 v184, v164
v_exp_f32 v185, v165
v_exp_f32 v186, v166
v_exp_f32 v187, v167
s_cmp_lg_u32 s81, 0
s_cbranch_scc1 BH_64
s_cmp_lt_u32 s57, s60
s_cbranch_scc1 BM_63
v_mov_b32 v2, 75776
s_cmp_lg_u32 s19, 0
s_cbranch_scc1 BL_62_b
BL_62:
global_load_dword v3, v9, s[14:15] sc1
s_waitcnt vmcnt(0)
v_cmp_ge_u32 vcc, s57, v3
s_add_u32 s32, s57, 12
s_cbranch_vccz BL_62_ok
s_sub_u32 s30, s30, 1
s_cbranch_scc1 EXIT1
s_sleep 4
s_branch BL_62
BL_62_ok:
v_cmp_ge_u32 vcc, s32, v3
s_nop 1
s_cmp_eq_u64 vcc, 0
s_cselect_b32 s60, s32, s57
s_add_u32 s60, s60, 1
v_mov_b32 v3, s60
ds_write_b32 v2, v3
s_waitcnt lgkmcnt(0)
BL_62_b:
s_barrier
ds_read_b32 v3, v2
s_waitcnt lgkmcnt(0)
v_readfirstlane_b32 s60, v3
BM_63:
s_mul_i32 s32, s57, 9216
s_add_u32 s32, s32, s79
s_add_u32 s32, s32, 0x500000
s_add_u32 s66, s14, s32
s_addc_u32 s67, s15, 0
s_add_u32 s33, s79, s83
s_add_u32 m0, s33, 0
s_nop 0
global_load_lds_dwordx4 v1, s[66:67] sc1
s_add_u32 s66, s66, 0x1000
s_addc_u32 s67, s67, 0
s_add_u32 m0, s33, 4096
s_nop 0
global_load_lds_dwordx4 v1, s[66:67] sc1
s_add_u32 s66, s66, 0x1000
s_addc_u32 s67, s67, 0
s_add_u32 m0, s33, 8192
s_cmp_eq_u32 s19, 0
s_cselect_b32 m0, m0, 71680
s_nop 0
global_load_lds_dwordx4 v1, s[66:67] sc1
s_waitcnt vmcnt(0)
s_barrier
BH_64:
ds_read_b128 v[100:103], v11
ds_read_b128 v[104:107], v11 offset:1024
ds_read_b128 v[108:111], v11 offset:2048
ds_read_b128 v[112:115], v11 offset:3072
ds_read_b128 v[116:119], v11 offset:4096
ds_read_b128 v[120:123], v11 offset:5120
ds_read_b128 v[124:127], v11 offset:6144
ds_read_b128 v[128:131], v11 offset:7168
ds_read_b128 v[132:135], v11 offset:8192
s_xor_b32 s83, s83, 9216
s_cmp_lt_u32 s40, s60
s_cselect_b32 s81, 1, 0
s_cbranch_scc0 BN_65
s_mul_i32 s32, s40, 9216
s_add_u32 s32, s32, s79
s_add_u32 s32, s32, 0x500000
s_add_u32 s66, s14, s32
s_addc_u32 s67, s15, 0
s_add_u32 s33, s79, s83
s_add_u32 m0, s33, 0
s_nop 0
global_load_lds_dwordx4 v1, s[66:67] sc1
s_add_u32 s66, s66, 0x1000
s_addc_u32 s67, s67, 0
s_add_u32 m0, s33, 4096
s_nop 0
global_load_lds_dwordx4 v1, s[66:67] sc1
s_add_u32 s66, s66, 0x1000
s_addc_u32 s67, s67, 0
s_add_u32 m0, s33, 8192
s_cmp_eq_u32 s19, 0
s_cselect_b32 m0, m0, 71680
s_nop 0
global_load_lds_dwordx4 v1, s[66:67] sc1
BN_65:
s_waitcnt lgkmcnt(8)
v_smfmac_f32_16x16x64_bf16 v[136:139], v[100:103], a[0:7], v4
v_smfmac_f32_16x16x64_bf16 v[140:143], v[100:103], a[8:15], v4
s_waitcnt lgkmcnt(7)
v_smfmac_f32_16x16x64_bf16 v[136:139], v[104:107], a[32:39], v4
v_smfmac_f32_16x16x64_bf16 v[140:143], v[104:107], a[40:47], v4
s_waitcnt lgkmcnt(6)
v_smfmac_f32_16x16x64_bf16 v[136:139], v[108:111], a[64:71], v4
v_smfmac_f32_16x16x64_bf16 v[140:143], v[108:111], a[72:79], v4
s_waitcnt lgkmcnt(5)
v_smfmac_f32_16x16x64_bf16 v[136:139], v[112:115], a[96:103], v4
v_smfmac_f32_16x16x64_bf16 v[140:143], v[112:115], a[104:111], v4
s_waitcnt lgkmcnt(4)
v_smfmac_f32_16x16x64_bf16 v[136:139], v[116:119], a[128:135], v4
v_smfmac_f32_16x16x64_bf16 v[140:143], v[116:119], a[136:143], v4
s_waitcnt lgkmcnt(3)
v_smfmac_f32_16x16x64_bf16 v[136:139], v[120:123], a[160:167], v4
v_smfmac_f32_16x16x64_bf16 v[140:143], v[120:123], a[168:175], v4
s_waitcnt lgkmcnt(2)
v_smfmac_f32_16x16x64_bf16 v[136:139], v[124:127], a[192:199], v4
v_smfmac_f32_16x16x64_bf16 v[140:143], v[124:127], a[200:207], v4
s_waitcnt lgkmcnt(1)
v_smfmac_f32_16x16x64_bf16 v[136:139], v[128:131], a[224:231], v4
v_smfmac_f32_16x16x64_bf16 v[140:143], v[128:131], a[232:239], v4
s_waitcnt lgkmcnt(0)
v_smfmac_f32_16x16x64_bf16 v[136:139], v[132:135], v[224:231], v4
v_smfmac_f32_16x16x64_bf16 v[140:143], v[132:135], v[232:239], v4
v_smfmac_f32_16x16x64_bf16 v[144:147], v[100:103], a[16:23], v4
v_smfmac_f32_16x16x64_bf16 v[148:151], v[100:103], a[24:31], v4
v_smfmac_f32_16x16x64_bf16 v[144:147], v[104:107], a[48:55], v4
v_smfmac_f32_16x16x64_bf16 v[148:151], v[104:107], a[56:63], v4
s_nop 2
v_add_f32 v136, v136, v138
v_add_f32 v137, v137, v139
v_cvt_pk_bf16_f32 v136, v136, v137
ds_write_b32 v6, v136
v_add_f32 v140, v140, v142
v_add_f32 v141, v141, v143
v_cvt_pk_bf16_f32 v140, v140, v141
ds_write_b32 v6, v140 offset:512
v_smfmac_f32_16x16x64_bf16 v[144:147], v[108:111], a[80:87], v4
v_smfmac_f32_16x16x64_bf16 v[148:151], v[108:111], a[88:95], v4
v_smfmac_f32_16x16x64_bf16 v[144:147], v[112:115], a[112:119], v4
v_smfmac_f32_16x16x64_bf16 v[148:151], v[112:115], a[120:127], v4
v_smfmac_f32_16x16x64_bf16 v[144:147], v[116:119], a[144:151], v4
v_smfmac_f32_16x16x64_bf16 v[148:151], v[116:119], a[152:159], v4
s_waitcnt lgkmcnt(0)
s_barrier
ds_read_b64_tr_b16 v[84:85], v7
ds_read_b64_tr_b16 v[86:87], v7 offset:512
ds_read_b64_tr_b16 v[88:89], v7 offset:1024
ds_read_b64_tr_b16 v[90:91], v7 offset:1536
ds_read_b64_tr_b16 v[92:93], v7 offset:2048
ds_read_b64_tr_b16 v[94:95], v7 offset:2560
ds_read_b64_tr_b16 v[96:97], v7 offset:3072
ds_read_b64_tr_b16 v[98:99], v7 offset:3584
v_smfmac_f32_16x16x64_bf16 v[144:147], v[120:123], a[176:183], v4
v_smfmac_f32_16x16x64_bf16 v[148:151], v[120:123], a[184:191], v4
v_smfmac_f32_16x16x64_bf16 v[144:147], v[124:127], a[208:215], v4
v_smfmac_f32_16x16x64_bf16 v[148:151], v[124:127], a[216:223], v4
v_smfmac_f32_16x16x64_bf16 v[144:147], v[128:131], a[240:247], v4
v_smfmac_f32_16x16x64_bf16 v[148:151], v[128:131], a[248:255], v4
v_smfmac_f32_16x16x64_bf16 v[144:147], v[132:135], v[240:247], v4
v_smfmac_f32_16x16x64_bf16 v[148:151], v[132:135], v[248:255], v4
s_waitcnt lgkmcnt(0)
v_mfma_f32_16x16x32_bf16 v[168:171], v[84:87], v[12:15], 0
v_mfma_f32_16x16x32_bf16 v[172:175], v[84:87], v[28:31], 0
v_mfma_f32_16x16x32_bf16 v[168:171], v[88:91], v[16:19], v[168:171]
v_mfma_f32_16x16x32_bf16 v[172:175], v[88:91], v[32:35], v[172:175]
v_mfma_f32_16x16x32_bf16 v[168:171], v[92:95], v[20:23], v[168:171]
v_mfma_f32_16x16x32_bf16 v[172:175], v[92:95], v[36:39], v[172:175]
v_mfma_f32_16x16x32_bf16 v[168:171], v[96:99], v[24:27], v[168:171]
v_mfma_f32_16x16x32_bf16 v[172:175], v[96:99], v[40:43], v[172:175]
v_add_f32 v144, v144, v146
v_add_f32 v145, v145, v147
v_cvt_pk_bf16_f32 v152, v144, v145
v_add_f32 v148, v148, v150
v_add_f32 v149, v149, v151
v_cvt_pk_bf16_f32 v154, v148, v149
s_nop 0
v_mul_f32 v168, s76, v168
v_mul_f32 v169, s76, v169
v_mul_f32 v172, s76, v172
v_mul_f32 v173, s76, v173
v_exp_f32 v188, v168
v_exp_f32 v189, v169
v_exp_f32 v190, v172
v_exp_f32 v191, v173
s_mov_b32 s37, 0
BP_68:
v_cvt_pk_bf16_f32 v192, v176, v177
v_cvt_pk_bf16_f32 v193, v178, v179
v_cvt_pk_bf16_f32 v196, v180, v181
v_cvt_pk_bf16_f32 v197, v182, v183
v_cvt_pk_bf16_f32 v198, v184, v185
v_cvt_pk_bf16_f32 v199, v186, v187
v_cvt_pk_bf16_f32 v200, v188, v189
v_cvt_pk_bf16_f32 v202, v190, v191
v_mfma_f32_16x16x32_bf16 v[212:215], v[204:207], v[192:195], 0
v_mfma_f32_16x16x32_bf16 v[216:219], v[204:207], v[196:199], 0
v_mfma_f32_16x16x32_bf16 v[100:103], v[76:79], v[192:195], 0
v_mfma_f32_16x16x32_bf16 v[104:107], v[80:83], v[192:195], 0
v_mfma_f32_16x16x32_bf16 v[108:111], v[76:79], v[196:199], 0
v_mfma_f32_16x16x32_bf16 v[112:115], v[80:83], v[196:199], 0
s_nop 0
v_mfma_f32_16x16x16_bf16 v[212:215], v[204:205], v[200:201], v[212:215]
v_mfma_f32_16x16x16_bf16 v[216:219], v[204:205], v[202:203], v[216:219]
v_mfma_f32_16x16x16_bf16 v[100:103], v[152:153], v[200:201], v[100:103]
v_mfma_f32_16x16x16_bf16 v[104:107], v[154:155], v[200:201], v[104:107]
v_mfma_f32_16x16x16_bf16 v[108:111], v[152:153], v[202:203], v[108:111]
v_mfma_f32_16x16x16_bf16 v[112:115], v[154:155], v[202:203], v[112:115]
s_nop 2
v_subrev_u32 v2, 0x30800000, v212
v_subrev_u32 v3, 0x30800000, v216
v_max_u32 v2, v2, v3
v_cmp_le_u32 vcc, 0x20800000, v2
s_cmp_lg_u32 s37, 0
s_cbranch_scc1 BO_69
s_cbranch_vccz BO_69
v_max_f32 v2, v156, v157
v_max3_f32 v2, v2, v158, v159
v_max3_f32 v2, v2, v168, v169
v_mov_b32 v3, v2
s_nop 1
v_permlane16_swap_b32 v2, v3
s_nop 1
v_max_f32 v2, v2, v3
v_mov_b32 v3, v2
s_nop 1
v_permlane32_swap_b32 v2, v3
s_nop 1
v_max_f32 v2, v2, v3
v_max_f32 v210, v160, v161
v_max3_f32 v210, v210, v162, v163
v_max3_f32 v210, v210, v164, v165
v_max3_f32 v210, v210, v166, v167
v_max3_f32 v210, v210, v172, v173
v_mov_b32 v211, v210
s_nop 1
v_permlane16_swap_b32 v210, v211
s_nop 1
v_max_f32 v210, v210, v211
v_mov_b32 v211, v210
s_nop 1
v_permlane32_swap_b32 v210, v211
s_nop 1
v_max_f32 v210, v210, v211
v_sub_f32 v176, v156, v2
v_exp_f32 v176, v176
v_sub_f32 v177, v157, v2
v_exp_f32 v177, v177
v_sub_f32 v178, v158, v2
v_exp_f32 v178, v178
v_sub_f32 v179, v159, v2
v_exp_f32 v179, v179
v_sub_f32 v180, v160, v210
v_exp_f32 v180, v180
v_sub_f32 v181, v161, v210
v_exp_f32 v181, v181
v_sub_f32 v182, v162, v210
v_exp_f32 v182, v182
v_sub_f32 v183, v163, v210
v_exp_f32 v183, v183
v_sub_f32 v184, v164, v210
v_exp_f32 v184, v184
v_sub_f32 v185, v165, v210
v_exp_f32 v185, v185
v_sub_f32 v186, v166, v210
v_exp_f32 v186, v186
v_sub_f32 v187, v167, v210
v_exp_f32 v187, v187
v_sub_f32 v188, v168, v2
v_exp_f32 v188, v188
v_sub_f32 v189, v169, v2
v_exp_f32 v189, v189
v_sub_f32 v190, v172, v210
v_exp_f32 v190, v190
v_sub_f32 v191, v173, v210
v_exp_f32 v191, v191
s_mov_b32 s37, 1
s_nop 7
s_branch BP_68
BO_69:
v_rcp_f32 v2, v212
v_rcp_f32 v3, v216
s_mul_i32 s32, s57, 299008
s_lshl_b32 s33, s56, 13
s_add_u32 s32, s32, s33
s_lshl_b32 s33, s79, 1
s_add_u32 s32, s32, s33
s_add_u32 s32, s32, 0x5209000
s_add_u32 s64, s14, s32
s_addc_u32 s65, s15, 0
v_mul_f32 v100, v100, v2
v_mul_f32 v101, v101, v2
v_mul_f32 v102, v102, v2
v_mul_f32 v103, v103, v2
v_mul_f32 v104, v104, v2
v_mul_f32 v105, v105, v2
v_mul_f32 v106, v106, v2
v_mul_f32 v107, v107, v2
v_cvt_pk_bf16_f32 v176, v100, v101
v_cvt_pk_bf16_f32 v177, v102, v103
v_cvt_pk_bf16_f32 v178, v104, v105
v_cvt_pk_bf16_f32 v179, v106, v107
global_store_dwordx4 v5, v[176:179], s[64:65] sc1
v_mul_f32 v108, v108, v3
v_mul_f32 v109, v109, v3
v_mul_f32 v110, v110, v3
v_mul_f32 v111, v111, v3
v_mul_f32 v112, v112, v3
v_mul_f32 v113, v113, v3
v_mul_f32 v114, v114, v3
v_mul_f32 v115, v115, v3
v_cvt_pk_bf16_f32 v180, v108, v109
v_cvt_pk_bf16_f32 v181, v110, v111
v_cvt_pk_bf16_f32 v182, v112, v113
v_cvt_pk_bf16_f32 v183, v114, v115
global_store_dwordx4 v5, v[180:183], s[64:65] offset:256 sc1
s_add_u32 s59, s57, 162
s_lshl_b32 s82, s59, 7
s_add_u32 s82, s82, 0x20000
s_cmp_lg_u32 s81, 0
s_cbranch_scc1 BS_70
s_waitcnt vmcnt(0)
s_barrier
s_cmp_lg_u32 s19, 0
s_cbranch_scc1 SIG_71
s_lshl_b32 s32, s59, 7
s_add_u32 s32, s32, 0x20000
s_mov_b64 exec, 1
v_mov_b32 v2, s32
v_mov_b32 v3, 1
global_atomic_add v2, v3, s[14:15]
s_mov_b64 exec, -1
SIG_71:
s_mov_b32 s82, 0
BS_70:
s_xor_b32 s61, s61, 24576
s_add_u32 s57, s57, 3
s_branch BT_61
W3:
EXIT1:
s_endpgm
CHAIN:
v_and_b32 v12, 63, v0
v_lshrrev_b32 v13, 4, v12
v_and_b32 v14, 15, v12
v_lshrrev_b32 v15, 2, v14
v_and_b32 v16, 3, v14
v_lshlrev_b32 v0, 4, v12
v_add_u32 v9, 0x10000, v0
v_add_u32 v4, 0x20000, v0
s_and_b32 s48, s19, 1
s_lshl_b32 s48, s48, 2
v_add_u32 v17, s48, v13
v_lshrrev_b32 v18, 1, v14
v_xor_b32 v27, v17, v18
v_and_b32 v18, 1, v14
v_lshlrev_b32 v18, 4, v18
v_lshl_add_u32 v19, v27, 5, v18
v_lshrrev_b32 v17, 1, v13
v_and_b32 v20, 1, v13
v_lshlrev_b32 v21, 16, v17
v_add_u32 v21, v21, v19
v_lshl_add_u32 v22, v20, 19, v21
v_lshl_add_u32 v21, v20, 13, v21
v_lshl_add_u32 v17, v17, 6, v20
v_mul_u32_u24 v17, 1152, v17
v_add_u32 v23, v17, v19
v_lshrrev_b32 v20, 2, v27
v_mul_u32_u24 v20, 36864, v20
v_and_b32 v24, 3, v27
v_lshl_add_u32 v24, v24, 5, v18
v_add3_u32 v24, v24, v17, v20
s_lshr_b32 s48, s19, 1
s_and_b32 s49, s19, 1
s_lshl_b32 s50, s48, 4
s_lshl_b32 s51, s49, 2
s_add_u32 s62, s50, s51
s_lshl_b32 s51, s49, 1
s_add_u32 s63, s50, s51
s_lshl_b32 s62, s62, 13
s_lshl_b32 s63, s63, 13
s_lshl_b32 s50, s18, 8
s_add_u32 s62, s62, s50
s_add_u32 s63, s63, s50
s_lshl_b32 s50, s49, 4
s_lshl_b32 s51, s48, 2
s_add_u32 s64, s50, s51
s_mul_i32 s64, s64, 1152
s_mul_i32 s50, s18, 147456
s_add_u32 s64, s64, s50
s_lshl_b32 s65, s19, 10
s_add_u32 s48, s62, 0x280000
s_add_u32 s52, s8, s48
s_addc_u32 s53, s9, 0
s_add_u32 m0, s65, 0x8000
s_nop 0
global_load_lds_dwordx4 v21, s[52:53] nt
s_add_u32 s48, s62, 0x284000
s_add_u32 s52, s8, s48
s_addc_u32 s53, s9, 0
s_add_u32 m0, s65, 0x9000
s_nop 0
global_load_lds_dwordx4 v21, s[52:53] nt
s_add_u32 s48, s62, 0x2c0000
s_add_u32 s52, s8, s48
s_addc_u32 s53, s9, 0
s_add_u32 m0, s65, 0xa000
s_nop 0
global_load_lds_dwordx4 v21, s[52:53] nt
s_add_u32 s48, s62, 0x2c4000
s_add_u32 s52, s8, s48
s_addc_u32 s53, s9, 0
s_add_u32 m0, s65, 0xb000
s_nop 0
global_load_lds_dwordx4 v21, s[52:53] nt
s_add_u32 s48, s62, 0x400000
s_add_u32 s52, s4, s48
s_addc_u32 s53, s5, 0
s_add_u32 m0, s65, 0xc000
s_nop 0
global_load_lds_dwordx4 v21, s[52:53] nt
s_add_u32 s48, s62, 0x404000
s_add_u32 s52, s4, s48
s_addc_u32 s53, s5, 0
s_add_u32 m0, s65, 0xd000
s_nop 0
global_load_lds_dwordx4 v21, s[52:53] nt
s_add_u32 s48, s62, 0x440000
s_add_u32 s52, s4, s48
s_addc_u32 s53, s5, 0
s_add_u32 m0, s65, 0xe000
s_nop 0
global_load_lds_dwordx4 v21, s[52:53] nt
s_add_u32 s48, s62, 0x444000
s_add_u32 s52, s4, s48
s_addc_u32 s53, s5, 0
s_add_u32 m0, s65, 0xf000
s_nop 0
global_load_lds_dwordx4 v21, s[52:53] nt
s_add_u32 s48, s63, 0x0
s_add_u32 s52, s4, s48
s_addc_u32 s53, s5, 0
s_add_u32 m0, s65, 0x10000
s_nop 0
global_load_lds_dwordx4 v22, s[52:53] nt
s_add_u32 s48, s63, 0x2000
s_add_u32 s52, s4, s48
s_addc_u32 s53, s5, 0
s_add_u32 m0, s65, 0x11000
s_nop 0
global_load_lds_dwordx4 v22, s[52:53] nt
s_add_u32 s48, s63, 0x40000
s_add_u32 s52, s4, s48
s_addc_u32 s53, s5, 0
s_add_u32 m0, s65, 0x12000
s_nop 0
global_load_lds_dwordx4 v22, s[52:53] nt
s_add_u32 s48, s63, 0x42000
s_add_u32 s52, s4, s48
s_addc_u32 s53, s5, 0
s_add_u32 m0, s65, 0x13000
s_nop 0
global_load_lds_dwordx4 v22, s[52:53] nt
s_add_u32 s48, s63, 0x8000
s_add_u32 s52, s4, s48
s_addc_u32 s53, s5, 0
s_add_u32 m0, s65, 0x14000
s_nop 0
global_load_lds_dwordx4 v22, s[52:53] nt
s_add_u32 s48, s63, 0xa000
s_add_u32 s52, s4, s48
s_addc_u32 s53, s5, 0
s_add_u32 m0, s65, 0x15000
s_nop 0
global_load_lds_dwordx4 v22, s[52:53] nt
s_add_u32 s48, s63, 0x48000
s_add_u32 s52, s4, s48
s_addc_u32 s53, s5, 0
s_add_u32 m0, s65, 0x16000
s_nop 0
global_load_lds_dwordx4 v22, s[52:53] nt
s_add_u32 s48, s63, 0x4a000
s_add_u32 s52, s4, s48
s_addc_u32 s53, s5, 0
s_add_u32 m0, s65, 0x17000
s_nop 0
global_load_lds_dwordx4 v22, s[52:53] nt
s_add_u32 s48, s62, 0x100000
s_add_u32 s52, s4, s48
s_addc_u32 s53, s5, 0
s_add_u32 m0, s65, 0x18000
s_nop 0
global_load_lds_dwordx4 v21, s[52:53] nt
s_add_u32 s48, s62, 0x104000
s_add_u32 s52, s4, s48
s_addc_u32 s53, s5, 0
s_add_u32 m0, s65, 0x19000
s_nop 0
global_load_lds_dwordx4 v21, s[52:53] nt
s_add_u32 s48, s62, 0x140000
s_add_u32 s52, s4, s48
s_addc_u32 s53, s5, 0
s_add_u32 m0, s65, 0x1a000
s_nop 0
global_load_lds_dwordx4 v21, s[52:53] nt
s_add_u32 s48, s62, 0x144000
s_add_u32 s52, s4, s48
s_addc_u32 s53, s5, 0
s_add_u32 m0, s65, 0x1b000
s_nop 0
global_load_lds_dwordx4 v21, s[52:53] nt
s_add_u32 s48, s63, 0x180000
s_add_u32 s52, s4, s48
s_addc_u32 s53, s5, 0
s_add_u32 m0, s65, 0x1c000
s_nop 0
global_load_lds_dwordx4 v22, s[52:53] nt
s_add_u32 s48, s63, 0x182000
s_add_u32 s52, s4, s48
s_addc_u32 s53, s5, 0
s_add_u32 m0, s65, 0x1d000
s_nop 0
global_load_lds_dwordx4 v22, s[52:53] nt
s_add_u32 s48, s63, 0x1c0000
s_add_u32 s52, s4, s48
s_addc_u32 s53, s5, 0
s_add_u32 m0, s65, 0x1e000
s_nop 0
global_load_lds_dwordx4 v22, s[52:53] nt
s_add_u32 s48, s63, 0x1c2000
s_add_u32 s52, s4, s48
s_addc_u32 s53, s5, 0
s_add_u32 m0, s65, 0x1f000
s_nop 0
global_load_lds_dwordx4 v22, s[52:53] nt
s_add_u32 s48, s63, 0x188000
s_add_u32 s52, s4, s48
s_addc_u32 s53, s5, 0
s_add_u32 m0, s65, 0x20000
s_nop 0
global_load_lds_dwordx4 v22, s[52:53] nt
s_add_u32 s48, s63, 0x18a000
s_add_u32 s52, s4, s48
s_addc_u32 s53, s5, 0
s_add_u32 m0, s65, 0x21000
s_nop 0
global_load_lds_dwordx4 v22, s[52:53] nt
s_add_u32 s48, s63, 0x1c8000
s_add_u32 s52, s4, s48
s_addc_u32 s53, s5, 0
s_add_u32 m0, s65, 0x22000
s_nop 0
global_load_lds_dwordx4 v22, s[52:53] nt
s_add_u32 s48, s63, 0x1ca000
s_add_u32 s52, s4, s48
s_addc_u32 s53, s5, 0
s_add_u32 m0, s65, 0x23000
s_nop 0
global_load_lds_dwordx4 v22, s[52:53] nt
s_add_u32 s48, s62, 0x280000
s_add_u32 s52, s4, s48
s_addc_u32 s53, s5, 0
s_add_u32 m0, s65, 0x24000
s_nop 0
global_load_lds_dwordx4 v21, s[52:53] nt
s_add_u32 s48, s62, 0x284000
s_add_u32 s52, s4, s48
s_addc_u32 s53, s5, 0
s_add_u32 m0, s65, 0x25000
s_nop 0
global_load_lds_dwordx4 v21, s[52:53] nt
s_add_u32 s48, s62, 0x2c0000
s_add_u32 s52, s4, s48
s_addc_u32 s53, s5, 0
s_add_u32 m0, s65, 0x26000
s_nop 0
global_load_lds_dwordx4 v21, s[52:53] nt
s_add_u32 s48, s62, 0x2c4000
s_add_u32 s52, s4, s48
s_addc_u32 s53, s5, 0
s_add_u32 m0, s65, 0x27000
s_nop 0
global_load_lds_dwordx4 v21, s[52:53] nt
s_add_u32 s48, s63, 0x300000
s_add_u32 s52, s4, s48
s_addc_u32 s53, s5, 0
s_add_u32 m0, s65, 0x0
s_nop 0
global_load_lds_dwordx4 v22, s[52:53] nt
s_add_u32 s48, s63, 0x302000
s_add_u32 s52, s4, s48
s_addc_u32 s53, s5, 0
s_add_u32 m0, s65, 0x1000
s_nop 0
global_load_lds_dwordx4 v22, s[52:53] nt
s_add_u32 s48, s63, 0x340000
s_add_u32 s52, s4, s48
s_addc_u32 s53, s5, 0
s_add_u32 m0, s65, 0x2000
s_nop 0
global_load_lds_dwordx4 v22, s[52:53] nt
s_add_u32 s48, s63, 0x342000
s_add_u32 s52, s4, s48
s_addc_u32 s53, s5, 0
s_add_u32 m0, s65, 0x3000
s_nop 0
global_load_lds_dwordx4 v22, s[52:53] nt
s_add_u32 s48, s63, 0x308000
s_add_u32 s52, s4, s48
s_addc_u32 s53, s5, 0
s_add_u32 m0, s65, 0x4000
s_nop 0
global_load_lds_dwordx4 v22, s[52:53] nt
s_add_u32 s48, s63, 0x30a000
s_add_u32 s52, s4, s48
s_addc_u32 s53, s5, 0
s_add_u32 m0, s65, 0x5000
s_nop 0
global_load_lds_dwordx4 v22, s[52:53] nt
s_add_u32 s48, s63, 0x348000
s_add_u32 s52, s4, s48
s_addc_u32 s53, s5, 0
s_add_u32 m0, s65, 0x6000
s_nop 0
global_load_lds_dwordx4 v22, s[52:53] nt
s_add_u32 s48, s63, 0x34a000
s_add_u32 s52, s4, s48
s_addc_u32 s53, s5, 0
s_add_u32 m0, s65, 0x7000
s_nop 0
global_load_lds_dwordx4 v22, s[52:53] nt
v_lshl_add_u32 v17, v13, 2, v15
v_and_b32 v18, 7, v17
v_lshlrev_b32 v17, 8, v17
v_lshl_add_u32 v17, v16, 3, v17
s_lshl_b32 s48, s19, 1
v_xor_b32 v19, s48, v18
v_lshl_add_u32 v28, v19, 5, v17
v_xor_b32 v29, 32, v28
v_xor_b32 v19, s19, v18
v_lshl_add_u32 v30, v19, 5, v17
v_xor_b32 v31, 128, v30
v_and_b32 v17, 2, v14
v_cmp_eq_u32 vcc, 0, v17
v_mov_b32 v18, 0xeeee
v_mov_b32 v19, 0x4444
v_cndmask_b32 v1, v18, v19, vcc
v_xor_b32 v17, v13, v15
v_lshlrev_b32 v17, 3, v17
v_lshl_add_u32 v17, v14, 5, v17
s_add_u32 s48, s65, 155648
v_add_u32 v2, s48, v17
v_xor_b32 v17, v13, v16
v_lshlrev_b32 v17, 3, v17
v_lshl_add_u32 v18, v13, 2, v15
v_lshl_add_u32 v17, v18, 5, v17
v_add_u32 v3, 155648, v17
v_lshrrev_b32 v17, 3, v12
s_lshl_b32 s48, s19, 3
v_add_u32 v17, s48, v17
v_mul_u32_u24 v17, 12288, v17
v_and_b32 v18, 7, v12
v_lshlrev_b32 v19, 4, v18
s_lshl_b32 s48, s18, 7
v_add3_u32 v5, v17, v19, s48
v_lshlrev_b32 v6, 3, v0
s_lshr_b32 s48, s18, 3
s_lshl_b32 s48, s48, 8
s_and_b32 s49, s18, 7
s_lshl_b32 s49, s49, 5
s_add_u32 s48, s48, s49
v_and_b32 v17, 1, v18
v_lshlrev_b32 v17, 4, v17
v_lshrrev_b32 v19, 1, v18
v_lshl_add_u32 v17, v19, 2, v17
v_lshrrev_b32 v19, 2, v18
v_lshlrev_b32 v19, 10, v19
v_and_b32 v20, 3, v18
v_lshl_add_u32 v19, v20, 2, v19
v_lshrrev_b32 v20, 1, v13
v_lshl_add_u32 v19, v20, 4, v19
v_add_u32 v19, 1024, v19
v_cmp_eq_u32 vcc, 0, v13
s_nop 1
v_cndmask_b32 v17, v19, v17, vcc
v_add_u32 v7, s48, v17
s_lshl_b32 s48, s18, 2
s_add_u32 s48, s48, 3072
v_lshlrev_b32 v17, 7, v12
v_add_u32 v17, s48, v17
v_and_b32 v19, 60, v12
v_cmp_eq_u32 vcc, 48, v19
s_nop 1
v_cndmask_b32 v7, v7, v17, vcc
s_and_b32 s48, s18, 3
s_lshl_b32 s48, s48, 7
s_add_u32 s48, s48, 6144
v_and_b32 v17, 31, v12
v_lshlrev_b32 v17, 2, v17
v_add_u32 v6, s48, v17
s_and_b32 s96, s18, 0
s_lshl_b32 s96, s96, 14
v_and_b32 v17, 1, v12
v_cmp_eq_u32 vcc, 0, v17
v_mov_b32 v18, 0x03020706
v_mov_b32 v19, 0x05040100
v_cndmask_b32 v8, v18, v19, vcc
v_mov_b32 v11, 0
v_mov_b32 v10, 0
v_mov_b32 v76, -1
v_mov_b32 v77, -1
v_mov_b32 v78, -1
v_mov_b32 v79, -1
s_mov_b32 s44, 0x3e0293ee
s_mov_b32 s45, 0x30800000
s_mov_b32 s46, 0x20800000
s_mov_b32 s57, 0x3f803f80
s_mul_i32 s26, s18, 4352
s_add_u32 s26, s26, 0x40000
s_mov_b32 s27, 2
s_mov_b32 s47, 99
s_mov_b32 s42, 0
s_mov_b32 s43, 0x40000
s_add_u32 s28, s14, 0x100000
s_addc_u32 s29, s15, 0
s_add_u32 s30, s14, 0x100000
s_addc_u32 s31, s15, 0
s_mov_b32 s75, 1
s_mul_i32 s48, s18, 12288
s_min_u32 s49, s19, 2
s_lshl_b32 s49, s49, 12
s_add_u32 s48, s48, s49
s_add_u32 s48, s48, 0x100000
s_add_u32 s32, s14, s48
s_addc_u32 s33, s15, 0
s_add_u32 s34, s32, 0x0
s_addc_u32 s35, s33, 0
s_lshl_b32 s48, s18, 15
s_lshl_b32 s49, s19, 13
s_add_u32 s48, s48, s49
s_add_u32 s48, s48, 0x201000
s_add_u32 s40, s14, s48
s_addc_u32 s41, s15, 0
s_mul_i32 s97, s18, 288
s_add_u32 s48, s97, 0x500000
s_add_u32 s38, s14, s48
s_addc_u32 s39, s15, 0
s_mul_i32 s48, s18, 1064960
s_lshl_b32 s49, s19, 11
s_add_u32 s48, s48, s49
s_add_u32 s48, s48, 0x1600000
s_add_u32 s36, s14, s48
s_addc_u32 s37, s15, 0
v_mov_b32 v60, 0
v_mov_b32 v61, 0
v_mov_b32 v62, 0
v_mov_b32 v63, 0
global_store_dwordx4 v0, v[60:63], s[32:33] sc1
global_store_dwordx4 v0, v[60:63], s[32:33] offset:1024 sc1
global_store_dwordx4 v0, v[60:63], s[32:33] offset:2048 sc1
global_store_dwordx4 v0, v[60:63], s[32:33] offset:3072 sc1
global_store_dwordx4 v0, v[60:63], s[34:35] sc1
global_store_dwordx4 v0, v[60:63], s[34:35] offset:1024 sc1
global_store_dwordx4 v0, v[60:63], s[34:35] offset:2048 sc1
global_store_dwordx4 v0, v[60:63], s[34:35] offset:3072 sc1
s_lshl_b32 s48, s19, 15
s_add_u32 s48, s48, 3072
s_add_u32 s52, s14, s48
s_addc_u32 s53, s15, 0
global_store_dword v7, v76, s[52:53] offset:-3072 sc1
global_store_dword v7, v76, s[52:53] sc1
global_store_dword v7, v76, s[52:53] offset:3072 sc1
s_waitcnt vmcnt(47)
s_barrier
s_lshl_b32 s66, s19, 12
s_lshl_b32 s67, s19, 11
ds_read_b64_tr_b16 v[44:45], v28 offset:32768
ds_read_b64_tr_b16 v[46:47], v28 offset:36864
ds_read_b64_tr_b16 v[48:49], v28 offset:40960
ds_read_b64_tr_b16 v[50:51], v28 offset:45056
ds_read_b64_tr_b16 v[52:53], v29 offset:32768
ds_read_b64_tr_b16 v[54:55], v29 offset:36864
ds_read_b64_tr_b16 v[56:57], v29 offset:40960
ds_read_b64_tr_b16 v[58:59], v29 offset:45056
s_waitcnt lgkmcnt(0)
global_store_dwordx4 v0, v[44:47], s[40:41] offset:-4096
global_store_dwordx4 v0, v[48:51], s[40:41] offset:-3072
global_store_dwordx4 v0, v[52:55], s[40:41] offset:-2048
global_store_dwordx4 v0, v[56:59], s[40:41] offset:-1024
s_waitcnt vmcnt(47)
s_barrier
s_add_u32 s48, s63, 0x0
s_add_u32 s52, s6, s48
s_addc_u32 s53, s7, 0
s_add_u32 m0, s65, 0x8000
s_nop 0
global_load_lds_dwordx4 v22, s[52:53] nt
s_add_u32 s48, s63, 0x2000
s_add_u32 s52, s6, s48
s_addc_u32 s53, s7, 0
s_add_u32 m0, s65, 0x9000
s_nop 0
global_load_lds_dwordx4 v22, s[52:53] nt
s_add_u32 s48, s63, 0x40000
s_add_u32 s52, s6, s48
s_addc_u32 s53, s7, 0
s_add_u32 m0, s65, 0xa000
s_nop 0
global_load_lds_dwordx4 v22, s[52:53] nt
s_add_u32 s48, s63, 0x42000
s_add_u32 s52, s6, s48
s_addc_u32 s53, s7, 0
s_add_u32 m0, s65, 0xb000
s_nop 0
global_load_lds_dwordx4 v22, s[52:53] nt
ds_read_b64_tr_b16 v[80:81], v28 offset:49152
ds_read_b64_tr_b16 v[82:83], v28 offset:53248
ds_read_b64_tr_b16 v[84:85], v28 offset:57344
ds_read_b64_tr_b16 v[86:87], v28 offset:61440
ds_read_b64_tr_b16 v[88:89], v29 offset:49152
ds_read_b64_tr_b16 v[90:91], v29 offset:53248
ds_read_b64_tr_b16 v[92:93], v29 offset:57344
ds_read_b64_tr_b16 v[94:95], v29 offset:61440
s_waitcnt vmcnt(47) lgkmcnt(0)
s_barrier
s_add_u32 s48, s62, 0x100000
s_add_u32 s52, s6, s48
s_addc_u32 s53, s7, 0
s_add_u32 m0, s65, 0xc000
s_nop 0
global_load_lds_dwordx4 v21, s[52:53] nt
s_add_u32 s48, s62, 0x104000
s_add_u32 s52, s6, s48
s_addc_u32 s53, s7, 0
s_add_u32 m0, s65, 0xd000
s_nop 0
global_load_lds_dwordx4 v21, s[52:53] nt
s_add_u32 s48, s62, 0x140000
s_add_u32 s52, s6, s48
s_addc_u32 s53, s7, 0
s_add_u32 m0, s65, 0xe000
s_nop 0
global_load_lds_dwordx4 v21, s[52:53] nt
s_add_u32 s48, s62, 0x144000
s_add_u32 s52, s6, s48
s_addc_u32 s53, s7, 0
s_add_u32 m0, s65, 0xf000
s_nop 0
global_load_lds_dwordx4 v21, s[52:53] nt
v_add_u32 v19, 0x10000, v28
ds_read_b64_tr_b16 v[96:97], v19
ds_read_b64_tr_b16 v[98:99], v19 offset:4096
ds_read_b64_tr_b16 v[100:101], v19 offset:8192
ds_read_b64_tr_b16 v[102:103], v19 offset:12288
v_add_u32 v20, 0x10000, v29
ds_read_b64_tr_b16 v[104:105], v20
ds_read_b64_tr_b16 v[106:107], v20 offset:4096
ds_read_b64_tr_b16 v[108:109], v20 offset:8192
ds_read_b64_tr_b16 v[110:111], v20 offset:12288
s_waitcnt vmcnt(47) lgkmcnt(0)
s_barrier
s_add_u32 s48, s63, 0x188000
s_add_u32 s52, s6, s48
s_addc_u32 s53, s7, 0
s_add_u32 m0, s65, 0x10000
s_nop 0
global_load_lds_dwordx4 v22, s[52:53] nt
s_add_u32 s48, s63, 0x18a000
s_add_u32 s52, s6, s48
s_addc_u32 s53, s7, 0
s_add_u32 m0, s65, 0x11000
s_nop 0
global_load_lds_dwordx4 v22, s[52:53] nt
s_add_u32 s48, s63, 0x1c8000
s_add_u32 s52, s6, s48
s_addc_u32 s53, s7, 0
s_add_u32 m0, s65, 0x12000
s_nop 0
global_load_lds_dwordx4 v22, s[52:53] nt
s_add_u32 s48, s63, 0x1ca000
s_add_u32 s52, s6, s48
s_addc_u32 s53, s7, 0
s_add_u32 m0, s65, 0x13000
s_nop 0
global_load_lds_dwordx4 v22, s[52:53] nt
v_add_u32 v19, 0x10000, v28
ds_read_b64_tr_b16 v[112:113], v19 offset:16384
ds_read_b64_tr_b16 v[114:115], v19 offset:20480
ds_read_b64_tr_b16 v[116:117], v19 offset:24576
ds_read_b64_tr_b16 v[118:119], v19 offset:28672
v_add_u32 v20, 0x10000, v29
ds_read_b64_tr_b16 v[120:121], v20 offset:16384
ds_read_b64_tr_b16 v[122:123], v20 offset:20480
ds_read_b64_tr_b16 v[124:125], v20 offset:24576
ds_read_b64_tr_b16 v[126:127], v20 offset:28672
s_waitcnt vmcnt(47) lgkmcnt(0)
s_barrier
s_add_u32 s48, s63, 0x300000
s_add_u32 s52, s6, s48
s_addc_u32 s53, s7, 0
s_add_u32 m0, s65, 0x14000
s_nop 0
global_load_lds_dwordx4 v22, s[52:53] nt
s_add_u32 s48, s63, 0x302000
s_add_u32 s52, s6, s48
s_addc_u32 s53, s7, 0
s_add_u32 m0, s65, 0x15000
s_nop 0
global_load_lds_dwordx4 v22, s[52:53] nt
s_add_u32 s48, s63, 0x340000
s_add_u32 s52, s6, s48
s_addc_u32 s53, s7, 0
s_add_u32 m0, s65, 0x16000
s_nop 0
global_load_lds_dwordx4 v22, s[52:53] nt
s_add_u32 s48, s63, 0x342000
s_add_u32 s52, s6, s48
s_addc_u32 s53, s7, 0
s_add_u32 m0, s65, 0x17000
s_nop 0
global_load_lds_dwordx4 v22, s[52:53] nt
v_and_b32 v17, 1, v14
v_lshl_add_u32 v17, v15, 1, v17
v_mul_u32_u24 v17, 1152, v17
v_and_b32 v18, 2, v14
v_lshlrev_b32 v18, 3, v18
v_lshl_add_u32 v18, v13, 5, v18
v_add_u32 v10, v17, v18
global_load_dwordx4 v[32:35], v10, s[12:13] offset:1024
global_load_dwordx4 v[44:47], v10, s[12:13]
global_load_dwordx4 v[48:51], v10, s[12:13] offset:128
global_load_dwordx4 v[36:39], v10, s[12:13] offset:256
global_load_dwordx4 v[52:55], v10, s[12:13] offset:384
global_load_dwordx4 v[56:59], v10, s[12:13] offset:512
global_load_dwordx4 v[40:43], v10, s[12:13] offset:640
global_load_dwordx4 v[60:63], v10, s[12:13] offset:768
global_load_dwordx4 v[64:67], v10, s[12:13] offset:896
v_add_u32 v19, 0x10000, v28
ds_read_b64_tr_b16 v[128:129], v19 offset:32768
ds_read_b64_tr_b16 v[130:131], v19 offset:36864
ds_read_b64_tr_b16 v[132:133], v19 offset:40960
ds_read_b64_tr_b16 v[134:135], v19 offset:45056
v_add_u32 v20, 0x10000, v29
ds_read_b64_tr_b16 v[136:137], v20 offset:32768
ds_read_b64_tr_b16 v[138:139], v20 offset:36864
ds_read_b64_tr_b16 v[140:141], v20 offset:40960
ds_read_b64_tr_b16 v[142:143], v20 offset:45056
s_waitcnt vmcnt(56) lgkmcnt(0)
s_barrier
s_add_u32 s48, s62, 0x400000
s_add_u32 s52, s8, s48
s_addc_u32 s53, s9, 0
s_add_u32 m0, s65, 0x18000
s_nop 0
global_load_lds_dwordx4 v21, s[52:53] nt
s_add_u32 s48, s62, 0x404000
s_add_u32 s52, s8, s48
s_addc_u32 s53, s9, 0
s_add_u32 m0, s65, 0x19000
s_nop 0
global_load_lds_dwordx4 v21, s[52:53] nt
s_add_u32 s48, s62, 0x440000
s_add_u32 s52, s8, s48
s_addc_u32 s53, s9, 0
s_add_u32 m0, s65, 0x1a000
s_nop 0
global_load_lds_dwordx4 v21, s[52:53] nt
s_add_u32 s48, s62, 0x444000
s_add_u32 s52, s8, s48
s_addc_u32 s53, s9, 0
s_add_u32 m0, s65, 0x1b000
s_nop 0
global_load_lds_dwordx4 v21, s[52:53] nt
v_add_u32 v19, 0x10000, v28
ds_read_b64_tr_b16 v[144:145], v19 offset:49152
ds_read_b64_tr_b16 v[146:147], v19 offset:53248
ds_read_b64_tr_b16 v[148:149], v19 offset:57344
ds_read_b64_tr_b16 v[150:151], v19 offset:61440
v_add_u32 v20, 0x10000, v29
ds_read_b64_tr_b16 v[152:153], v20 offset:49152
ds_read_b64_tr_b16 v[154:155], v20 offset:53248
ds_read_b64_tr_b16 v[156:157], v20 offset:57344
ds_read_b64_tr_b16 v[158:159], v20 offset:61440
s_waitcnt vmcnt(56) lgkmcnt(0)
s_barrier
s_add_u32 s48, s63, 0x0
s_add_u32 s52, s8, s48
s_addc_u32 s53, s9, 0
s_add_u32 m0, s65, 0x1c000
s_nop 0
global_load_lds_dwordx4 v22, s[52:53] nt
s_add_u32 s48, s63, 0x2000
s_add_u32 s52, s8, s48
s_addc_u32 s53, s9, 0
s_add_u32 m0, s65, 0x1d000
s_nop 0
global_load_lds_dwordx4 v22, s[52:53] nt
s_add_u32 s48, s63, 0x40000
s_add_u32 s52, s8, s48
s_addc_u32 s53, s9, 0
s_add_u32 m0, s65, 0x1e000
s_nop 0
global_load_lds_dwordx4 v22, s[52:53] nt
s_add_u32 s48, s63, 0x42000
s_add_u32 s52, s8, s48
s_addc_u32 s53, s9, 0
s_add_u32 m0, s65, 0x1f000
s_nop 0
global_load_lds_dwordx4 v22, s[52:53] nt
v_add_u32 v19, 0x20000, v28
ds_read_b64_tr_b16 v[160:161], v19
ds_read_b64_tr_b16 v[162:163], v19 offset:4096
ds_read_b64_tr_b16 v[164:165], v19 offset:8192
ds_read_b64_tr_b16 v[166:167], v19 offset:12288
v_add_u32 v20, 0x20000, v29
ds_read_b64_tr_b16 v[168:169], v20
ds_read_b64_tr_b16 v[170:171], v20 offset:4096
ds_read_b64_tr_b16 v[172:173], v20 offset:8192
ds_read_b64_tr_b16 v[174:175], v20 offset:12288
s_waitcnt vmcnt(56) lgkmcnt(0)
s_barrier
s_add_u32 s48, s63, 0x8000
s_add_u32 s52, s8, s48
s_addc_u32 s53, s9, 0
s_add_u32 m0, s65, 0x20000
s_nop 0
global_load_lds_dwordx4 v22, s[52:53] nt
s_add_u32 s48, s63, 0xa000
s_add_u32 s52, s8, s48
s_addc_u32 s53, s9, 0
s_add_u32 m0, s65, 0x21000
s_nop 0
global_load_lds_dwordx4 v22, s[52:53] nt
s_add_u32 s48, s63, 0x48000
s_add_u32 s52, s8, s48
s_addc_u32 s53, s9, 0
s_add_u32 m0, s65, 0x22000
s_nop 0
global_load_lds_dwordx4 v22, s[52:53] nt
s_add_u32 s48, s63, 0x4a000
s_add_u32 s52, s8, s48
s_addc_u32 s53, s9, 0
s_add_u32 m0, s65, 0x23000
s_nop 0
global_load_lds_dwordx4 v22, s[52:53] nt
v_add_u32 v19, 0x20000, v28
ds_read_b64_tr_b16 v[176:177], v19 offset:16384
ds_read_b64_tr_b16 v[178:179], v19 offset:20480
ds_read_b64_tr_b16 v[180:181], v19 offset:24576
ds_read_b64_tr_b16 v[182:183], v19 offset:28672
v_add_u32 v20, 0x20000, v29
ds_read_b64_tr_b16 v[184:185], v20 offset:16384
ds_read_b64_tr_b16 v[186:187], v20 offset:20480
ds_read_b64_tr_b16 v[188:189], v20 offset:24576
ds_read_b64_tr_b16 v[190:191], v20 offset:28672
s_waitcnt vmcnt(56) lgkmcnt(0)
s_barrier
s_add_u32 s48, s62, 0x100000
s_add_u32 s52, s8, s48
s_addc_u32 s53, s9, 0
s_add_u32 m0, s65, 0x24000
s_nop 0
global_load_lds_dwordx4 v21, s[52:53] nt
s_add_u32 s48, s62, 0x104000
s_add_u32 s52, s8, s48
s_addc_u32 s53, s9, 0
s_add_u32 m0, s65, 0x25000
s_nop 0
global_load_lds_dwordx4 v21, s[52:53] nt
s_add_u32 s48, s62, 0x140000
s_add_u32 s52, s8, s48
s_addc_u32 s53, s9, 0
s_add_u32 m0, s65, 0x26000
s_nop 0
global_load_lds_dwordx4 v21, s[52:53] nt
s_add_u32 s48, s62, 0x144000
s_add_u32 s52, s8, s48
s_addc_u32 s53, s9, 0
s_add_u32 m0, s65, 0x27000
s_nop 0
global_load_lds_dwordx4 v21, s[52:53] nt
ds_read_b64_tr_b16 v[192:193], v28
ds_read_b64_tr_b16 v[194:195], v28 offset:4096
ds_read_b64_tr_b16 v[196:197], v28 offset:8192
ds_read_b64_tr_b16 v[198:199], v28 offset:12288
ds_read_b64_tr_b16 v[200:201], v29
ds_read_b64_tr_b16 v[202:203], v29 offset:4096
ds_read_b64_tr_b16 v[204:205], v29 offset:8192
ds_read_b64_tr_b16 v[206:207], v29 offset:12288
s_waitcnt vmcnt(56) lgkmcnt(0)
s_barrier
s_add_u32 s48, s63, 0x180000
s_add_u32 s52, s8, s48
s_addc_u32 s53, s9, 0
s_add_u32 m0, s65, 0x0
s_nop 0
global_load_lds_dwordx4 v22, s[52:53] nt
s_add_u32 s48, s63, 0x182000
s_add_u32 s52, s8, s48
s_addc_u32 s53, s9, 0
s_add_u32 m0, s65, 0x1000
s_nop 0
global_load_lds_dwordx4 v22, s[52:53] nt
s_add_u32 s48, s63, 0x1c0000
s_add_u32 s52, s8, s48
s_addc_u32 s53, s9, 0
s_add_u32 m0, s65, 0x2000
s_nop 0
global_load_lds_dwordx4 v22, s[52:53] nt
s_add_u32 s48, s63, 0x1c2000
s_add_u32 s52, s8, s48
s_addc_u32 s53, s9, 0
s_add_u32 m0, s65, 0x3000
s_nop 0
global_load_lds_dwordx4 v22, s[52:53] nt
ds_read_b64_tr_b16 v[208:209], v28 offset:16384
ds_read_b64_tr_b16 v[210:211], v28 offset:20480
ds_read_b64_tr_b16 v[212:213], v28 offset:24576
ds_read_b64_tr_b16 v[214:215], v28 offset:28672
ds_read_b64_tr_b16 v[216:217], v29 offset:16384
ds_read_b64_tr_b16 v[218:219], v29 offset:20480
ds_read_b64_tr_b16 v[220:221], v29 offset:24576
ds_read_b64_tr_b16 v[222:223], v29 offset:28672
s_waitcnt vmcnt(41) lgkmcnt(0)
s_mov_b64 exec, 1
v_mov_b32 v17, 1
v_mov_b32 v18, 4
global_atomic_add v18, v17, s[16:17]
s_mov_b64 exec, -1
s_barrier
s_add_u32 s48, s63, 0x188000
s_add_u32 s52, s8, s48
s_addc_u32 s53, s9, 0
s_add_u32 m0, s65, 0x4000
s_nop 0
global_load_lds_dwordx4 v22, s[52:53] nt
s_add_u32 s48, s63, 0x18a000
s_add_u32 s52, s8, s48
s_addc_u32 s53, s9, 0
s_add_u32 m0, s65, 0x5000
s_nop 0
global_load_lds_dwordx4 v22, s[52:53] nt
s_add_u32 s48, s63, 0x1c8000
s_add_u32 s52, s8, s48
s_addc_u32 s53, s9, 0
s_add_u32 m0, s65, 0x6000
s_nop 0
global_load_lds_dwordx4 v22, s[52:53] nt
s_add_u32 s48, s63, 0x1ca000
s_add_u32 s52, s8, s48
s_addc_u32 s53, s9, 0
s_add_u32 m0, s65, 0x7000
s_nop 0
global_load_lds_dwordx4 v22, s[52:53] nt
ds_read_b64_tr_b16 v[224:225], v28 offset:32768
ds_read_b64_tr_b16 v[226:227], v28 offset:36864
ds_read_b64_tr_b16 v[228:229], v28 offset:40960
ds_read_b64_tr_b16 v[230:231], v28 offset:45056
ds_read_b64_tr_b16 v[232:233], v29 offset:32768
ds_read_b64_tr_b16 v[234:235], v29 offset:36864
ds_read_b64_tr_b16 v[236:237], v29 offset:40960
ds_read_b64_tr_b16 v[238:239], v29 offset:45056
s_waitcnt vmcnt(42) lgkmcnt(0)
s_barrier
s_add_u32 s48, s63, 0x300000
s_add_u32 s52, s8, s48
s_addc_u32 s53, s9, 0
s_add_u32 m0, s65, 0x8000
s_nop 0
global_load_lds_dwordx4 v22, s[52:53] nt
s_add_u32 s48, s63, 0x302000
s_add_u32 s52, s8, s48
s_addc_u32 s53, s9, 0
s_add_u32 m0, s65, 0x9000
s_nop 0
global_load_lds_dwordx4 v22, s[52:53] nt
s_add_u32 s48, s63, 0x340000
s_add_u32 s52, s8, s48
s_addc_u32 s53, s9, 0
s_add_u32 m0, s65, 0xa000
s_nop 0
global_load_lds_dwordx4 v22, s[52:53] nt
s_add_u32 s48, s63, 0x342000
s_add_u32 s52, s8, s48
s_addc_u32 s53, s9, 0
s_add_u32 m0, s65, 0xb000
s_nop 0
global_load_lds_dwordx4 v22, s[52:53] nt
ds_read_b64_tr_b16 v[240:241], v28 offset:49152
ds_read_b64_tr_b16 v[242:243], v28 offset:53248
ds_read_b64_tr_b16 v[244:245], v28 offset:57344
ds_read_b64_tr_b16 v[246:247], v28 offset:61440
ds_read_b64_tr_b16 v[248:249], v29 offset:49152
ds_read_b64_tr_b16 v[250:251], v29 offset:53248
ds_read_b64_tr_b16 v[252:253], v29 offset:57344
ds_read_b64_tr_b16 v[254:255], v29 offset:61440
s_waitcnt vmcnt(42) lgkmcnt(0)
s_barrier
s_add_u32 s48, s63, 0x308000
s_add_u32 s52, s8, s48
s_addc_u32 s53, s9, 0
s_add_u32 m0, s65, 0xc000
s_nop 0
global_load_lds_dwordx4 v22, s[52:53] nt
s_add_u32 s48, s63, 0x30a000
s_add_u32 s52, s8, s48
s_addc_u32 s53, s9, 0
s_add_u32 m0, s65, 0xd000
s_nop 0
global_load_lds_dwordx4 v22, s[52:53] nt
s_add_u32 s48, s63, 0x348000
s_add_u32 s52, s8, s48
s_addc_u32 s53, s9, 0
s_add_u32 m0, s65, 0xe000
s_nop 0
global_load_lds_dwordx4 v22, s[52:53] nt
s_add_u32 s48, s63, 0x34a000
s_add_u32 s52, s8, s48
s_addc_u32 s53, s9, 0
s_add_u32 m0, s65, 0xf000
s_nop 0
global_load_lds_dwordx4 v22, s[52:53] nt
v_add_u32 v19, 0x10000, v28
ds_read_b64_tr_b16 a[0:1], v19
ds_read_b64_tr_b16 a[2:3], v19 offset:4096
ds_read_b64_tr_b16 a[4:5], v19 offset:8192
ds_read_b64_tr_b16 a[6:7], v19 offset:12288
v_add_u32 v20, 0x10000, v29
ds_read_b64_tr_b16 a[8:9], v20
ds_read_b64_tr_b16 a[10:11], v20 offset:4096
ds_read_b64_tr_b16 a[12:13], v20 offset:8192
ds_read_b64_tr_b16 a[14:15], v20 offset:12288
s_waitcnt vmcnt(42) lgkmcnt(0)
s_barrier
s_add_u32 s48, s64, 0x0
s_add_u32 s52, s10, s48
s_addc_u32 s53, s11, 0
s_add_u32 m0, s65, 0x10000
s_nop 0
global_load_lds_dwordx4 v23, s[52:53] nt
s_add_u32 s48, s64, 0x900
s_add_u32 s52, s10, s48
s_addc_u32 s53, s11, 0
s_add_u32 m0, s65, 0x11000
s_nop 0
global_load_lds_dwordx4 v23, s[52:53] nt
s_add_u32 s48, s64, 0x2400
s_add_u32 s52, s10, s48
s_addc_u32 s53, s11, 0
s_add_u32 m0, s65, 0x12000
s_nop 0
global_load_lds_dwordx4 v23, s[52:53] nt
s_add_u32 s48, s64, 0x2d00
s_add_u32 s52, s10, s48
s_addc_u32 s53, s11, 0
s_add_u32 m0, s65, 0x13000
s_nop 0
global_load_lds_dwordx4 v23, s[52:53] nt
v_add_u32 v19, 0x10000, v28
ds_read_b64_tr_b16 a[16:17], v19 offset:16384
ds_read_b64_tr_b16 a[18:19], v19 offset:20480
ds_read_b64_tr_b16 a[20:21], v19 offset:24576
ds_read_b64_tr_b16 a[22:23], v19 offset:28672
v_add_u32 v20, 0x10000, v29
ds_read_b64_tr_b16 a[24:25], v20 offset:16384
ds_read_b64_tr_b16 a[26:27], v20 offset:20480
ds_read_b64_tr_b16 a[28:29], v20 offset:24576
ds_read_b64_tr_b16 a[30:31], v20 offset:28672
s_waitcnt vmcnt(33) lgkmcnt(0)
s_barrier
s_add_u32 s48, s64, 0x9000
s_add_u32 s52, s10, s48
s_addc_u32 s53, s11, 0
s_add_u32 m0, s65, 0x14000
s_nop 0
global_load_lds_dwordx4 v23, s[52:53] nt
s_add_u32 s48, s64, 0x9900
s_add_u32 s52, s10, s48
s_addc_u32 s53, s11, 0
s_add_u32 m0, s65, 0x15000
s_nop 0
global_load_lds_dwordx4 v23, s[52:53] nt
s_add_u32 s48, s64, 0xb400
s_add_u32 s52, s10, s48
s_addc_u32 s53, s11, 0
s_add_u32 m0, s65, 0x16000
s_nop 0
global_load_lds_dwordx4 v23, s[52:53] nt
s_add_u32 s48, s64, 0xbd00
s_add_u32 s52, s10, s48
s_addc_u32 s53, s11, 0
s_add_u32 m0, s65, 0x17000
s_nop 0
global_load_lds_dwordx4 v23, s[52:53] nt
v_add_u32 v19, 0x10000, v28
ds_read_b64_tr_b16 a[32:33], v19 offset:32768
ds_read_b64_tr_b16 a[34:35], v19 offset:36864
ds_read_b64_tr_b16 a[36:37], v19 offset:40960
ds_read_b64_tr_b16 a[38:39], v19 offset:45056
v_add_u32 v20, 0x10000, v29
ds_read_b64_tr_b16 a[40:41], v20 offset:32768
ds_read_b64_tr_b16 a[42:43], v20 offset:36864
ds_read_b64_tr_b16 a[44:45], v20 offset:40960
ds_read_b64_tr_b16 a[46:47], v20 offset:45056
s_waitcnt vmcnt(33) lgkmcnt(0)
s_barrier
s_add_u32 s48, s64, 0x100
s_add_u32 s52, s10, s48
s_addc_u32 s53, s11, 0
s_add_u32 m0, s65, 0x18000
s_nop 0
global_load_lds_dwordx4 v23, s[52:53] nt
s_add_u32 s48, s64, 0xa00
s_add_u32 s52, s10, s48
s_addc_u32 s53, s11, 0
s_add_u32 m0, s65, 0x19000
s_nop 0
global_load_lds_dwordx4 v23, s[52:53] nt
s_add_u32 s48, s64, 0x2500
s_add_u32 s52, s10, s48
s_addc_u32 s53, s11, 0
s_add_u32 m0, s65, 0x1a000
s_nop 0
global_load_lds_dwordx4 v23, s[52:53] nt
s_add_u32 s48, s64, 0x2e00
s_add_u32 s52, s10, s48
s_addc_u32 s53, s11, 0
s_add_u32 m0, s65, 0x1b000
s_nop 0
global_load_lds_dwordx4 v23, s[52:53] nt
s_lshl_b32 s48, s18, 2
s_add_u32 s48, s48, s19
s_lshl_b32 s48, s48, 14
s_add_u32 s48, s48, 0x300000
s_add_u32 s68, s14, s48
s_addc_u32 s69, s15, 0
s_add_u32 s70, s68, 0xc00
s_addc_u32 s71, s69, 0
s_mov_b32 s48, 0x05040100
s_mov_b32 s49, 0x07060302
s_add_u32 s52, s68, 0x0
s_addc_u32 s53, s69, 0
global_store_dwordx4 v0, v[32:35], s[52:53]
v_perm_b32 v68, v48, v44, s48
v_perm_b32 v69, v48, v44, s49
v_perm_b32 v70, v49, v45, s48
v_perm_b32 v71, v49, v45, s49
global_store_dwordx4 v0, v[68:71], s[52:53] offset:1024
v_perm_b32 v72, v50, v46, s48
v_perm_b32 v73, v50, v46, s49
v_perm_b32 v74, v51, v47, s48
v_perm_b32 v75, v51, v47, s49
global_store_dwordx4 v0, v[72:75], s[52:53] offset:2048
s_add_u32 s52, s68, 0xc00
s_addc_u32 s53, s69, 0
global_store_dwordx4 v0, v[36:39], s[52:53]
v_perm_b32 v68, v56, v52, s48
v_perm_b32 v69, v56, v52, s49
v_perm_b32 v70, v57, v53, s48
v_perm_b32 v71, v57, v53, s49
global_store_dwordx4 v0, v[68:71], s[52:53] offset:1024
v_perm_b32 v72, v58, v54, s48
v_perm_b32 v73, v58, v54, s49
v_perm_b32 v74, v59, v55, s48
v_perm_b32 v75, v59, v55, s49
global_store_dwordx4 v0, v[72:75], s[52:53] offset:2048
s_add_u32 s52, s68, 0x1800
s_addc_u32 s53, s69, 0
global_store_dwordx4 v0, v[40:43], s[52:53]
v_perm_b32 v68, v64, v60, s48
v_perm_b32 v69, v64, v60, s49
v_perm_b32 v70, v65, v61, s48
v_perm_b32 v71, v65, v61, s49
global_store_dwordx4 v0, v[68:71], s[52:53] offset:1024
v_perm_b32 v72, v66, v62, s48
v_perm_b32 v73, v66, v62, s49
v_perm_b32 v74, v67, v63, s48
v_perm_b32 v75, v67, v63, s49
global_store_dwordx4 v0, v[72:75], s[52:53] offset:2048
v_add_u32 v19, 0x10000, v28
ds_read_b64_tr_b16 a[48:49], v19 offset:49152
ds_read_b64_tr_b16 a[50:51], v19 offset:53248
ds_read_b64_tr_b16 a[52:53], v19 offset:57344
ds_read_b64_tr_b16 a[54:55], v19 offset:61440
v_add_u32 v20, 0x10000, v29
ds_read_b64_tr_b16 a[56:57], v20 offset:49152
ds_read_b64_tr_b16 a[58:59], v20 offset:53248
ds_read_b64_tr_b16 a[60:61], v20 offset:57344
ds_read_b64_tr_b16 a[62:63], v20 offset:61440
s_waitcnt vmcnt(42) lgkmcnt(0)
s_barrier
s_add_u32 s48, s64, 0x200
s_add_u32 s52, s10, s48
s_addc_u32 s53, s11, 0
s_add_u32 m0, s65, 0x1c000
s_nop 0
global_load_lds_dwordx4 v23, s[52:53] nt
s_add_u32 s48, s64, 0xb00
s_add_u32 s52, s10, s48
s_addc_u32 s53, s11, 0
s_add_u32 m0, s65, 0x1d000
s_nop 0
global_load_lds_dwordx4 v23, s[52:53] nt
s_add_u32 s48, s64, 0x2600
s_add_u32 s52, s10, s48
s_addc_u32 s53, s11, 0
s_add_u32 m0, s65, 0x1e000
s_nop 0
global_load_lds_dwordx4 v23, s[52:53] nt
s_add_u32 s48, s64, 0x2f00
s_add_u32 s52, s10, s48
s_addc_u32 s53, s11, 0
s_add_u32 m0, s65, 0x1f000
s_nop 0
global_load_lds_dwordx4 v23, s[52:53] nt
v_add_u32 v19, 0x20000, v28
ds_read_b64_tr_b16 a[64:65], v19
ds_read_b64_tr_b16 a[66:67], v19 offset:4096
ds_read_b64_tr_b16 a[68:69], v19 offset:8192
ds_read_b64_tr_b16 a[70:71], v19 offset:12288
v_add_u32 v20, 0x20000, v29
ds_read_b64_tr_b16 a[72:73], v20
ds_read_b64_tr_b16 a[74:75], v20 offset:4096
ds_read_b64_tr_b16 a[76:77], v20 offset:8192
ds_read_b64_tr_b16 a[78:79], v20 offset:12288
s_waitcnt vmcnt(42) lgkmcnt(0)
s_barrier
s_add_u32 s48, s64, 0x300
s_add_u32 s52, s10, s48
s_addc_u32 s53, s11, 0
s_add_u32 m0, s65, 0x20000
s_nop 0
global_load_lds_dwordx4 v23, s[52:53] nt
s_add_u32 s48, s64, 0xc00
s_add_u32 s52, s10, s48
s_addc_u32 s53, s11, 0
s_add_u32 m0, s65, 0x21000
s_nop 0
global_load_lds_dwordx4 v23, s[52:53] nt
s_add_u32 s48, s64, 0x2700
s_add_u32 s52, s10, s48
s_addc_u32 s53, s11, 0
s_add_u32 m0, s65, 0x22000
s_nop 0
global_load_lds_dwordx4 v23, s[52:53] nt
s_add_u32 s48, s64, 0x3000
s_add_u32 s52, s10, s48
s_addc_u32 s53, s11, 0
s_add_u32 m0, s65, 0x23000
s_nop 0
global_load_lds_dwordx4 v23, s[52:53] nt
v_add_u32 v19, 0x20000, v28
ds_read_b64_tr_b16 a[80:81], v19 offset:16384
ds_read_b64_tr_b16 a[82:83], v19 offset:20480
ds_read_b64_tr_b16 a[84:85], v19 offset:24576
ds_read_b64_tr_b16 a[86:87], v19 offset:28672
v_add_u32 v20, 0x20000, v29
ds_read_b64_tr_b16 a[88:89], v20 offset:16384
ds_read_b64_tr_b16 a[90:91], v20 offset:20480
ds_read_b64_tr_b16 a[92:93], v20 offset:24576
ds_read_b64_tr_b16 a[94:95], v20 offset:28672
s_waitcnt vmcnt(42) lgkmcnt(0)
s_barrier
s_add_u32 s48, s64, 0x400
s_add_u32 s52, s10, s48
s_addc_u32 s53, s11, 0
s_add_u32 m0, s65, 0x24000
s_nop 0
global_load_lds_dwordx4 v24, s[52:53] nt
s_add_u32 s48, s64, 0xd00
s_add_u32 s52, s10, s48
s_addc_u32 s53, s11, 0
s_add_u32 m0, s65, 0x25000
s_nop 0
global_load_lds_dwordx4 v24, s[52:53] nt
s_add_u32 s48, s64, 0x2800
s_add_u32 s52, s10, s48
s_addc_u32 s53, s11, 0
s_add_u32 m0, s65, 0x26000
s_nop 0
global_load_lds_dwordx4 v24, s[52:53] nt
s_add_u32 s48, s64, 0x3100
s_add_u32 s52, s10, s48
s_addc_u32 s53, s11, 0
s_add_u32 m0, s65, 0x27000
s_nop 0
global_load_lds_dwordx4 v24, s[52:53] nt
ds_read_b64_tr_b16 a[96:97], v28
ds_read_b64_tr_b16 a[98:99], v28 offset:4096
ds_read_b64_tr_b16 a[100:101], v28 offset:8192
ds_read_b64_tr_b16 a[102:103], v28 offset:12288
ds_read_b64_tr_b16 a[104:105], v29
ds_read_b64_tr_b16 a[106:107], v29 offset:4096
ds_read_b64_tr_b16 a[108:109], v29 offset:8192
ds_read_b64_tr_b16 a[110:111], v29 offset:12288
s_waitcnt vmcnt(41) lgkmcnt(0)
s_barrier
s_add_u32 s48, s62, 0x400000
s_add_u32 s52, s6, s48
s_addc_u32 s53, s7, 0
s_add_u32 m0, s65, 0x0
s_nop 0
global_load_lds_dwordx4 v21, s[52:53] nt
s_add_u32 s48, s62, 0x404000
s_add_u32 s52, s6, s48
s_addc_u32 s53, s7, 0
s_add_u32 m0, s65, 0x1000
s_nop 0
global_load_lds_dwordx4 v21, s[52:53] nt
s_add_u32 s48, s62, 0x440000
s_add_u32 s52, s6, s48
s_addc_u32 s53, s7, 0
s_add_u32 m0, s65, 0x2000
s_nop 0
global_load_lds_dwordx4 v21, s[52:53] nt
s_add_u32 s48, s62, 0x444000
s_add_u32 s52, s6, s48
s_addc_u32 s53, s7, 0
s_add_u32 m0, s65, 0x3000
s_nop 0
global_load_lds_dwordx4 v21, s[52:53] nt
ds_read_b64_tr_b16 a[112:113], v28 offset:16384
ds_read_b64_tr_b16 a[114:115], v28 offset:20480
ds_read_b64_tr_b16 a[116:117], v28 offset:24576
ds_read_b64_tr_b16 a[118:119], v28 offset:28672
ds_read_b64_tr_b16 a[120:121], v29 offset:16384
ds_read_b64_tr_b16 a[122:123], v29 offset:20480
ds_read_b64_tr_b16 a[124:125], v29 offset:24576
ds_read_b64_tr_b16 a[126:127], v29 offset:28672
s_waitcnt vmcnt(41) lgkmcnt(0)
s_barrier
s_add_u32 s48, s63, 0x8000
s_add_u32 s52, s6, s48
s_addc_u32 s53, s7, 0
s_add_u32 m0, s65, 0x4000
s_nop 0
global_load_lds_dwordx4 v22, s[52:53] nt
s_add_u32 s48, s63, 0xa000
s_add_u32 s52, s6, s48
s_addc_u32 s53, s7, 0
s_add_u32 m0, s65, 0x5000
s_nop 0
global_load_lds_dwordx4 v22, s[52:53] nt
s_add_u32 s48, s63, 0x48000
s_add_u32 s52, s6, s48
s_addc_u32 s53, s7, 0
s_add_u32 m0, s65, 0x6000
s_nop 0
global_load_lds_dwordx4 v22, s[52:53] nt
s_add_u32 s48, s63, 0x4a000
s_add_u32 s52, s6, s48
s_addc_u32 s53, s7, 0
s_add_u32 m0, s65, 0x7000
s_nop 0
global_load_lds_dwordx4 v22, s[52:53] nt
ds_read_b64_tr_b16 a[128:129], v28 offset:32768
ds_read_b64_tr_b16 a[130:131], v28 offset:36864
ds_read_b64_tr_b16 a[132:133], v28 offset:40960
ds_read_b64_tr_b16 a[134:135], v28 offset:45056
ds_read_b64_tr_b16 a[136:137], v29 offset:32768
ds_read_b64_tr_b16 a[138:139], v29 offset:36864
ds_read_b64_tr_b16 a[140:141], v29 offset:40960
ds_read_b64_tr_b16 a[142:143], v29 offset:45056
s_waitcnt vmcnt(41) lgkmcnt(0)
s_barrier
s_add_u32 s48, s63, 0x180000
s_add_u32 s52, s6, s48
s_addc_u32 s53, s7, 0
s_add_u32 m0, s65, 0x8000
s_nop 0
global_load_lds_dwordx4 v22, s[52:53] nt
s_add_u32 s48, s63, 0x182000
s_add_u32 s52, s6, s48
s_addc_u32 s53, s7, 0
s_add_u32 m0, s65, 0x9000
s_nop 0
global_load_lds_dwordx4 v22, s[52:53] nt
s_add_u32 s48, s63, 0x1c0000
s_add_u32 s52, s6, s48
s_addc_u32 s53, s7, 0
s_add_u32 m0, s65, 0xa000
s_nop 0
global_load_lds_dwordx4 v22, s[52:53] nt
s_add_u32 s48, s63, 0x1c2000
s_add_u32 s52, s6, s48
s_addc_u32 s53, s7, 0
s_add_u32 m0, s65, 0xb000
s_nop 0
global_load_lds_dwordx4 v22, s[52:53] nt
ds_read_b64_tr_b16 a[144:145], v28 offset:49152
ds_read_b64_tr_b16 a[146:147], v28 offset:53248
ds_read_b64_tr_b16 a[148:149], v28 offset:57344
ds_read_b64_tr_b16 a[150:151], v28 offset:61440
ds_read_b64_tr_b16 a[152:153], v29 offset:49152
ds_read_b64_tr_b16 a[154:155], v29 offset:53248
ds_read_b64_tr_b16 a[156:157], v29 offset:57344
ds_read_b64_tr_b16 a[158:159], v29 offset:61440
s_waitcnt vmcnt(41) lgkmcnt(0)
s_barrier
s_add_u32 s48, s62, 0x280000
s_add_u32 s52, s6, s48
s_addc_u32 s53, s7, 0
s_add_u32 m0, s65, 0xc000
s_nop 0
global_load_lds_dwordx4 v21, s[52:53] nt
s_add_u32 s48, s62, 0x284000
s_add_u32 s52, s6, s48
s_addc_u32 s53, s7, 0
s_add_u32 m0, s65, 0xd000
s_nop 0
global_load_lds_dwordx4 v21, s[52:53] nt
s_add_u32 s48, s62, 0x2c0000
s_add_u32 s52, s6, s48
s_addc_u32 s53, s7, 0
s_add_u32 m0, s65, 0xe000
s_nop 0
global_load_lds_dwordx4 v21, s[52:53] nt
s_add_u32 s48, s62, 0x2c4000
s_add_u32 s52, s6, s48
s_addc_u32 s53, s7, 0
s_add_u32 m0, s65, 0xf000
s_nop 0
global_load_lds_dwordx4 v21, s[52:53] nt
v_add_u32 v19, 0x10000, v30
ds_read_b64_tr_b16 a[160:161], v19
ds_read_b64_tr_b16 a[162:163], v19 offset:4096
ds_read_b64_tr_b16 a[164:165], v19 offset:8192
ds_read_b64_tr_b16 a[166:167], v19 offset:12288
v_add_u32 v20, 0x10000, v31
ds_read_b64_tr_b16 a[168:169], v20
ds_read_b64_tr_b16 a[170:171], v20 offset:4096
ds_read_b64_tr_b16 a[172:173], v20 offset:8192
ds_read_b64_tr_b16 a[174:175], v20 offset:12288
s_waitcnt vmcnt(41) lgkmcnt(0)
s_barrier
s_add_u32 s48, s63, 0x308000
s_add_u32 s52, s6, s48
s_addc_u32 s53, s7, 0
s_add_u32 m0, s65, 0x10000
s_nop 0
global_load_lds_dwordx4 v22, s[52:53] nt
s_add_u32 s48, s63, 0x30a000
s_add_u32 s52, s6, s48
s_addc_u32 s53, s7, 0
s_add_u32 m0, s65, 0x11000
s_nop 0
global_load_lds_dwordx4 v22, s[52:53] nt
s_add_u32 s48, s63, 0x348000
s_add_u32 s52, s6, s48
s_addc_u32 s53, s7, 0
s_add_u32 m0, s65, 0x12000
s_nop 0
global_load_lds_dwordx4 v22, s[52:53] nt
s_add_u32 s48, s63, 0x34a000
s_add_u32 s52, s6, s48
s_addc_u32 s53, s7, 0
s_add_u32 m0, s65, 0x13000
s_nop 0
global_load_lds_dwordx4 v22, s[52:53] nt
v_add_u32 v19, 0x10000, v30
ds_read_b64_tr_b16 a[176:177], v19 offset:16384
ds_read_b64_tr_b16 a[178:179], v19 offset:20480
ds_read_b64_tr_b16 a[180:181], v19 offset:24576
ds_read_b64_tr_b16 a[182:183], v19 offset:28672
v_add_u32 v20, 0x10000, v31
ds_read_b64_tr_b16 a[184:185], v20 offset:16384
ds_read_b64_tr_b16 a[186:187], v20 offset:20480
ds_read_b64_tr_b16 a[188:189], v20 offset:24576
ds_read_b64_tr_b16 a[190:191], v20 offset:28672
s_waitcnt vmcnt(41) lgkmcnt(0)
s_barrier
s_add_u32 s48, s64, 0x9100
s_add_u32 s52, s10, s48
s_addc_u32 s53, s11, 0
s_add_u32 m0, s65, 0x14000
s_nop 0
global_load_lds_dwordx4 v23, s[52:53] nt
s_add_u32 s48, s64, 0x9a00
s_add_u32 s52, s10, s48
s_addc_u32 s53, s11, 0
s_add_u32 m0, s65, 0x15000
s_nop 0
global_load_lds_dwordx4 v23, s[52:53] nt
s_add_u32 s48, s64, 0xb500
s_add_u32 s52, s10, s48
s_addc_u32 s53, s11, 0
s_add_u32 m0, s65, 0x16000
s_nop 0
global_load_lds_dwordx4 v23, s[52:53] nt
s_add_u32 s48, s64, 0xbe00
s_add_u32 s52, s10, s48
s_addc_u32 s53, s11, 0
s_add_u32 m0, s65, 0x17000
s_nop 0
global_load_lds_dwordx4 v23, s[52:53] nt
v_add_u32 v19, 0x10000, v30
ds_read_b64_tr_b16 a[192:193], v19 offset:32768
ds_read_b64_tr_b16 a[194:195], v19 offset:36864
ds_read_b64_tr_b16 a[196:197], v19 offset:40960
ds_read_b64_tr_b16 a[198:199], v19 offset:45056
v_add_u32 v20, 0x10000, v31
ds_read_b64_tr_b16 a[200:201], v20 offset:32768
ds_read_b64_tr_b16 a[202:203], v20 offset:36864
ds_read_b64_tr_b16 a[204:205], v20 offset:40960
ds_read_b64_tr_b16 a[206:207], v20 offset:45056
s_waitcnt vmcnt(32) lgkmcnt(0)
s_barrier
s_add_u32 s48, s64, 0x9200
s_add_u32 s52, s10, s48
s_addc_u32 s53, s11, 0
s_add_u32 m0, s65, 0x18000
s_nop 0
global_load_lds_dwordx4 v23, s[52:53] nt
s_add_u32 s48, s64, 0x9b00
s_add_u32 s52, s10, s48
s_addc_u32 s53, s11, 0
s_add_u32 m0, s65, 0x19000
s_nop 0
global_load_lds_dwordx4 v23, s[52:53] nt
s_add_u32 s48, s64, 0xb600
s_add_u32 s52, s10, s48
s_addc_u32 s53, s11, 0
s_add_u32 m0, s65, 0x1a000
s_nop 0
global_load_lds_dwordx4 v23, s[52:53] nt
s_add_u32 s48, s64, 0xbf00
s_add_u32 s52, s10, s48
s_addc_u32 s53, s11, 0
s_add_u32 m0, s65, 0x1b000
s_nop 0
global_load_lds_dwordx4 v23, s[52:53] nt
v_add_u32 v19, 0x10000, v30
ds_read_b64_tr_b16 a[208:209], v19 offset:49152
ds_read_b64_tr_b16 a[210:211], v19 offset:53248
ds_read_b64_tr_b16 a[212:213], v19 offset:57344
ds_read_b64_tr_b16 a[214:215], v19 offset:61440
v_add_u32 v20, 0x10000, v31
ds_read_b64_tr_b16 a[216:217], v20 offset:49152
ds_read_b64_tr_b16 a[218:219], v20 offset:53248
ds_read_b64_tr_b16 a[220:221], v20 offset:57344
ds_read_b64_tr_b16 a[222:223], v20 offset:61440
s_waitcnt vmcnt(32) lgkmcnt(0)
s_barrier
s_add_u32 s48, s64, 0x9300
s_add_u32 s52, s10, s48
s_addc_u32 s53, s11, 0
s_add_u32 m0, s65, 0x1c000
s_nop 0
global_load_lds_dwordx4 v23, s[52:53] nt
s_add_u32 s48, s64, 0x9c00
s_add_u32 s52, s10, s48
s_addc_u32 s53, s11, 0
s_add_u32 m0, s65, 0x1d000
s_nop 0
global_load_lds_dwordx4 v23, s[52:53] nt
s_add_u32 s48, s64, 0xb700
s_add_u32 s52, s10, s48
s_addc_u32 s53, s11, 0
s_add_u32 m0, s65, 0x1e000
s_nop 0
global_load_lds_dwordx4 v23, s[52:53] nt
s_add_u32 s48, s64, 0xc000
s_add_u32 s52, s10, s48
s_addc_u32 s53, s11, 0
s_add_u32 m0, s65, 0x1f000
s_nop 0
global_load_lds_dwordx4 v23, s[52:53] nt
v_add_u32 v19, 0x20000, v30
ds_read_b64_tr_b16 a[224:225], v19
ds_read_b64_tr_b16 a[226:227], v19 offset:4096
ds_read_b64_tr_b16 a[228:229], v19 offset:8192
ds_read_b64_tr_b16 a[230:231], v19 offset:12288
v_add_u32 v20, 0x20000, v31
ds_read_b64_tr_b16 a[232:233], v20
ds_read_b64_tr_b16 a[234:235], v20 offset:4096
ds_read_b64_tr_b16 a[236:237], v20 offset:8192
ds_read_b64_tr_b16 a[238:239], v20 offset:12288
s_waitcnt vmcnt(32) lgkmcnt(0)
s_barrier
v_add_u32 v19, 0x20000, v30
ds_read_b64_tr_b16 a[240:241], v19 offset:16384
ds_read_b64_tr_b16 a[242:243], v19 offset:20480
ds_read_b64_tr_b16 a[244:245], v19 offset:24576
ds_read_b64_tr_b16 a[246:247], v19 offset:28672
v_add_u32 v20, 0x20000, v31
ds_read_b64_tr_b16 a[248:249], v20 offset:16384
ds_read_b64_tr_b16 a[250:251], v20 offset:20480
ds_read_b64_tr_b16 a[252:253], v20 offset:24576
ds_read_b64_tr_b16 a[254:255], v20 offset:28672
s_waitcnt vmcnt(28) lgkmcnt(0)
s_barrier
v_min_u32 v17, 2, v15
v_mov_b32 v18, 0x3f80
v_mov_b32 v19, 0x3f800000
v_cmp_eq_u32 vcc, 0, v16
s_nop 1
v_cndmask_b32 v18, 0, v18, vcc
v_cmp_eq_u32 vcc, 1, v16
s_nop 1
v_cndmask_b32 v18, v18, v19, vcc
v_cmp_eq_u32 vcc, 0, v17
s_nop 1
v_cndmask_b32 v76, 0, v18, vcc
v_cmp_eq_u32 vcc, 1, v17
s_nop 1
v_cndmask_b32 v77, 0, v18, vcc
v_cmp_eq_u32 vcc, 2, v17
s_nop 1
v_cndmask_b32 v78, 0, v18, vcc
v_mov_b32 v79, 0
v_lshlrev_b32 v17, 4, v14
v_add_u32 v17, 162816, v17
ds_write_b128 v17, v[76:79]
v_mov_b32 v17, 163328
ds_write_b32 v17, v79
s_add_u32 s48, s65, 0
s_add_u32 s52, s68, s48
s_addc_u32 s53, s69, 0
s_add_u32 m0, s48, 0x22000
s_nop 0
global_load_lds_dwordx4 v0, s[52:53]
s_add_u32 s48, s65, 4096
s_add_u32 s52, s68, s48
s_addc_u32 s53, s69, 0
s_add_u32 m0, s48, 0x22000
s_nop 0
global_load_lds_dwordx4 v0, s[52:53]
s_add_u32 s52, s68, 0x2000
s_addc_u32 s53, s69, 0
s_mov_b32 m0, 0x27800
s_nop 0
global_load_lds_dwordx4 v0, s[52:53]
v_lshlrev_b32 v38, 3, v0
v_and_b32 v39, 0xfff, v38
s_getpc_b64 s[52:53]
IPC:
s_add_u32 s52, s52, CE00-IPC
s_addc_u32 s53, s53, 0
s_mul_i32 s48, s18, 1536
s_add_u32 s100, s52, s48
s_addc_u32 s101, s53, 0
s_mul_i32 s48, s19, CE01-CE00
s_add_u32 s52, s52, s48
s_addc_u32 s53, s53, 0
global_load_dword v40, v38, s[52:53]
s_add_u32 s52, s52, 0xc00
s_addc_u32 s53, s53, 0
global_load_dword v40, v38, s[52:53]
global_load_dword v40, v39, s[32:33] sc1
global_load_dword v40, v39, s[40:41] offset:-4096 sc1
s_lshl_b32 s48, s19, 15
s_add_u32 s52, s14, s48
s_addc_u32 s53, s15, 0
global_load_dword v40, v38, s[52:53] sc1
s_add_u32 s52, s52, 0x2000
s_addc_u32 s53, s53, 0
global_load_dword v40, v38, s[52:53] sc1
ds_read_b64_tr_b16 v[44:45], v28
ds_read_b64_tr_b16 v[46:47], v28 offset:4096
ds_read_b64_tr_b16 v[48:49], v28 offset:8192
ds_read_b64_tr_b16 v[50:51], v28 offset:12288
ds_read_b64_tr_b16 v[52:53], v29
ds_read_b64_tr_b16 v[54:55], v29 offset:4096
ds_read_b64_tr_b16 v[56:57], v29 offset:8192
ds_read_b64_tr_b16 v[58:59], v29 offset:12288
s_waitcnt vmcnt(33) lgkmcnt(0)
s_barrier
v_add_u32 v17, s66, v0
ds_write_b128 v17, v[44:47]
ds_write_b128 v17, v[48:51] offset:1024
ds_write_b128 v17, v[52:55] offset:2048
ds_write_b128 v17, v[56:59] offset:3072
ds_read_b64_tr_b16 v[60:61], v28 offset:16384
ds_read_b64_tr_b16 v[62:63], v28 offset:20480
ds_read_b64_tr_b16 v[64:65], v28 offset:24576
ds_read_b64_tr_b16 v[66:67], v28 offset:28672
ds_read_b64_tr_b16 v[68:69], v29 offset:16384
ds_read_b64_tr_b16 v[70:71], v29 offset:20480
ds_read_b64_tr_b16 v[72:73], v29 offset:24576
ds_read_b64_tr_b16 v[74:75], v29 offset:28672
s_waitcnt vmcnt(29) lgkmcnt(0)
s_barrier
v_add_u32 v17, s66, v0
ds_write_b128 v17, v[60:63] offset:16384
ds_write_b128 v17, v[64:67] offset:17408
ds_write_b128 v17, v[68:71] offset:18432
ds_write_b128 v17, v[72:75] offset:19456
ds_read_b64_tr_b16 v[44:45], v28 offset:32768
ds_read_b64_tr_b16 v[46:47], v28 offset:36864
ds_read_b64_tr_b16 v[48:49], v28 offset:40960
ds_read_b64_tr_b16 v[50:51], v28 offset:45056
ds_read_b64_tr_b16 v[52:53], v29 offset:32768
ds_read_b64_tr_b16 v[54:55], v29 offset:36864
ds_read_b64_tr_b16 v[56:57], v29 offset:40960
ds_read_b64_tr_b16 v[58:59], v29 offset:45056
s_waitcnt vmcnt(25) lgkmcnt(0)
s_barrier
v_add_u32 v17, s66, v0
ds_write_b128 v17, v[44:47] offset:32768
ds_write_b128 v17, v[48:51] offset:33792
ds_write_b128 v17, v[52:55] offset:34816
ds_write_b128 v17, v[56:59] offset:35840
ds_read_b64_tr_b16 v[60:61], v28 offset:49152
ds_read_b64_tr_b16 v[62:63], v28 offset:53248
ds_read_b64_tr_b16 v[64:65], v28 offset:57344
ds_read_b64_tr_b16 v[66:67], v28 offset:61440
ds_read_b64_tr_b16 v[68:69], v29 offset:49152
ds_read_b64_tr_b16 v[70:71], v29 offset:53248
ds_read_b64_tr_b16 v[72:73], v29 offset:57344
ds_read_b64_tr_b16 v[74:75], v29 offset:61440
s_waitcnt vmcnt(21) lgkmcnt(0)
s_barrier
v_add_u32 v17, s66, v0
ds_write_b128 v17, v[60:63] offset:49152
ds_write_b128 v17, v[64:67] offset:50176
ds_write_b128 v17, v[68:71] offset:51200
ds_write_b128 v17, v[72:75] offset:52224
v_add_u32 v19, 0x10000, v28
ds_read_b64_tr_b16 v[44:45], v19
ds_read_b64_tr_b16 v[46:47], v19 offset:4096
ds_read_b64_tr_b16 v[48:49], v19 offset:8192
ds_read_b64_tr_b16 v[50:51], v19 offset:12288
v_add_u32 v20, 0x10000, v29
ds_read_b64_tr_b16 v[52:53], v20
ds_read_b64_tr_b16 v[54:55], v20 offset:4096
ds_read_b64_tr_b16 v[56:57], v20 offset:8192
ds_read_b64_tr_b16 v[58:59], v20 offset:12288
s_waitcnt vmcnt(17) lgkmcnt(0)
s_barrier
v_add_u32 v17, s66, v9
ds_write_b128 v17, v[44:47]
ds_write_b128 v17, v[48:51] offset:1024
ds_write_b128 v17, v[52:55] offset:2048
ds_write_b128 v17, v[56:59] offset:3072
v_min_u32 v37, 0, v12
v_lshlrev_b32 v37, 7, v37
v_add_u32 v37, 0x20000, v37
global_load_dwordx4 v[32:35], v11, s[16:17] sc1
global_load_dword v36, v37, s[14:15] sc1
v_add_u32 v19, 0x10000, v30
ds_read_b64_tr_b16 v[60:61], v19 offset:16384
ds_read_b64_tr_b16 v[62:63], v19 offset:20480
ds_read_b64_tr_b16 v[64:65], v19 offset:24576
ds_read_b64_tr_b16 v[66:67], v19 offset:28672
v_add_u32 v20, 0x10000, v31
ds_read_b64_tr_b16 v[68:69], v20 offset:16384
ds_read_b64_tr_b16 v[70:71], v20 offset:20480
ds_read_b64_tr_b16 v[72:73], v20 offset:24576
ds_read_b64_tr_b16 v[74:75], v20 offset:28672
s_waitcnt vmcnt(15) lgkmcnt(0)
s_barrier
v_add_u32 v17, s66, v9
ds_write_b128 v17, v[60:63] offset:16384
ds_write_b128 v17, v[64:67] offset:17408
ds_write_b128 v17, v[68:71] offset:18432
ds_write_b128 v17, v[72:75] offset:19456
v_add_u32 v19, 0x10000, v30
ds_read_b64_tr_b16 v[44:45], v19 offset:32768
ds_read_b64_tr_b16 v[46:47], v19 offset:36864
ds_read_b64_tr_b16 v[48:49], v19 offset:40960
ds_read_b64_tr_b16 v[50:51], v19 offset:45056
v_add_u32 v20, 0x10000, v31
ds_read_b64_tr_b16 v[52:53], v20 offset:32768
ds_read_b64_tr_b16 v[54:55], v20 offset:36864
ds_read_b64_tr_b16 v[56:57], v20 offset:40960
ds_read_b64_tr_b16 v[58:59], v20 offset:45056
s_waitcnt vmcnt(11) lgkmcnt(0)
s_barrier
v_add_u32 v17, s66, v9
ds_write_b128 v17, v[44:47] offset:32768
ds_write_b128 v17, v[48:51] offset:33792
ds_write_b128 v17, v[52:55] offset:34816
ds_write_b128 v17, v[56:59] offset:35840
v_add_u32 v19, 0x10000, v30
ds_read_b64_tr_b16 v[60:61], v19 offset:49152
ds_read_b64_tr_b16 v[62:63], v19 offset:53248
ds_read_b64_tr_b16 v[64:65], v19 offset:57344
ds_read_b64_tr_b16 v[66:67], v19 offset:61440
v_add_u32 v20, 0x10000, v31
ds_read_b64_tr_b16 v[68:69], v20 offset:49152
ds_read_b64_tr_b16 v[70:71], v20 offset:53248
ds_read_b64_tr_b16 v[72:73], v20 offset:57344
ds_read_b64_tr_b16 v[74:75], v20 offset:61440
s_waitcnt lgkmcnt(0)
s_barrier
v_add_u32 v17, s66, v9
ds_write_b128 v17, v[60:63] offset:49152
ds_write_b128 v17, v[64:67] offset:50176
ds_write_b128 v17, v[68:71] offset:51200
ds_write_b128 v17, v[72:75] offset:52224
s_waitcnt vmcnt(0) lgkmcnt(0)
s_branch MC_73
MB_72:
s_sub_u32 s43, s43, 1
s_cbranch_scc1 EXIT2
global_load_dwordx4 v[32:35], v11, s[16:17] sc1
global_load_dword v36, v37, s[14:15] sc1
s_waitcnt vmcnt(0)
MC_73:
v_readfirstlane_b32 s48, v33
v_readfirstlane_b32 s62, v34
v_readfirstlane_b32 s50, v35
v_cmp_gt_u32 vcc, 64, v36
s_cmp_lt_u32 s48, 128
s_cbranch_scc1 MB_72
s_cmp_lt_u32 s50, 4
s_cbranch_scc1 MB_72
s_cbranch_vccnz MB_72
s_add_u32 m0, s67, 0x20000
s_nop 0
global_load_lds_dwordx4 v0, s[36:37] sc1
global_load_lds_dwordx4 v0, s[36:37] offset:1024 sc1
s_add_u32 s52, s36, 0x2000
s_addc_u32 s53, s37, 0
s_add_u32 m0, s67, 0x24000
s_nop 0
global_load_lds_dwordx4 v0, s[52:53] sc1
global_load_lds_dwordx4 v0, s[52:53] offset:1024 sc1
s_add_u32 s36, s36, 0x4000
s_addc_u32 s37, s37, 0
s_waitcnt vmcnt(0)
s_barrier
s_add_u32 s72, s14, 0x0
s_addc_u32 s73, s15, 0
s_mov_b32 s56, 0
s_mov_b32 s76, 0
s_mov_b32 s77, 0
s_mul_i32 s48, s19, 3072
s_cmp_eq_u32 s19, 3
s_cselect_b32 s48, 0, s48
s_add_u32 s96, s96, s48
s_add_u32 s68, s68, s48
s_addc_u32 s69, s69, 0
s_add_u32 s51, s56, 0x18c00
s_and_b32 s51, s51, 0x1ffff
s_add_u32 s24, s14, s51
s_addc_u32 s25, s15, 0
s_add_u32 s56, s56, 0x8000
s_and_b32 s56, s56, 0x1ffff
s_add_u32 s51, s56, 3072
s_add_u32 s22, s14, s51
s_addc_u32 s23, s15, 0
s_add_u32 s51, s56, s96
s_add_u32 s20, s14, s51
s_addc_u32 s21, s15, 0
s_cmp_lg_u32 s62, 0
s_cbranch_scc1 SLOWSEL_74
s_cmp_eq_u32 s19, 0
s_cbranch_scc1 CE00
s_cmp_eq_u32 s19, 1
s_cbranch_scc1 CE01
s_cmp_eq_u32 s19, 2
s_cbranch_scc1 CE02
s_branch CE03
SLOWSEL_74:
s_cmp_eq_u32 s19, 0
s_cbranch_scc1 CE10
s_cmp_eq_u32 s19, 1
s_cbranch_scc1 CE11
s_cmp_eq_u32 s19, 2
s_cbranch_scc1 CE12
s_branch CE13
EXIT2:
s_endpgm
DONE:
s_cmp_lg_u32 s19, 3
s_cbranch_scc1 EXIT2
s_waitcnt vmcnt(0)
s_add_u32 s42, s42, 1
v_mov_b32 v76, s26
v_mov_b32 v77, s42
s_mov_b64 exec, 1
global_store_dword v76, v77, s[14:15] sc1
s_mov_b64 exec, -1
s_mov_b64 exec, 1
s_endpgm
.macro CHAINLOOPS sfx, md
.p2align 6
CE\sfx\()0:
ds_read_b128 v[44:47], v0
ds_read_b128 v[48:51], v0 offset:1024
ds_read_b128 v[52:55], v0 offset:2048
ds_read_b128 v[56:59], v0 offset:3072
v_mov_b64 v[28:29], 0
v_mov_b64 v[30:31], 0
v_mov_b64 v[32:33], 0
v_mov_b64 v[34:35], 0
v_mov_b64 v[36:37], 0
v_mov_b64 v[38:39], 0
v_mov_b64 v[40:41], 0
v_mov_b64 v[42:43], 0
s_nop 1
C\sfx\()0_0_qk:
ds_read_b128 v[12:15], v4 offset:8192
ds_read_b128 v[16:19], v4 offset:9216
ds_read_b128 v[20:23], v4 offset:10240
C\sfx\()0_0_back0:
s_waitcnt lgkmcnt(2)
v_smfmac_f32_16x16x64_bf16 v[28:31], v[12:15], v[80:87], v1
s_waitcnt lgkmcnt(0)
v_add_f32 v10, v12, v16
v_cmp_u_f32 vcc, v10, v20
v_smfmac_f32_16x16x64_bf16 v[32:35], v[12:15], v[88:95], v1
s_cbranch_vccnz C\sfx\()0_0_retry0
v_smfmac_f32_16x16x64_bf16 v[36:39], v[12:15], v[44:51], v1
ds_read_b128 v[44:47], v0 offset:16384
v_smfmac_f32_16x16x64_bf16 v[40:43], v[12:15], v[52:59], v1
ds_read_b128 v[48:51], v0 offset:17408
v_smfmac_f32_16x16x64_bf16 v[28:31], v[16:19], v[96:103], v1
ds_read_b128 v[52:55], v0 offset:18432
v_smfmac_f32_16x16x64_bf16 v[32:35], v[16:19], v[104:111], v1
ds_read_b128 v[56:59], v0 offset:19456
global_load_dwordx4 v[60:63], v0, s[40:41] offset:-4096
v_smfmac_f32_16x16x64_bf16 v[36:39], v[16:19], v[224:231], v1
v_smfmac_f32_16x16x64_bf16 v[40:43], v[16:19], v[232:239], v1
v_smfmac_f32_16x16x64_bf16 v[28:31], v[20:23], v[112:119], v1
ds_read_b128 v[24:27], v4 offset:11264
v_smfmac_f32_16x16x64_bf16 v[32:35], v[20:23], v[120:127], v1
ds_read_b128 v[12:15], v4 offset:12288
global_load_dwordx4 v[64:67], v0, s[40:41] offset:-3072
s_waitcnt lgkmcnt(4)
v_smfmac_f32_16x16x64_bf16 v[36:39], v[20:23], v[44:51], v1
ds_read_b128 v[16:19], v4 offset:13312
s_waitcnt lgkmcnt(1)
v_cmp_u_f32 vcc, v24, v12
v_smfmac_f32_16x16x64_bf16 v[40:43], v[20:23], v[52:59], v1
ds_read_b128 v[44:47], v0 offset:32768
s_cbranch_vccnz C\sfx\()0_0_retry1
C\sfx\()0_0_back1:
v_smfmac_f32_16x16x64_bf16 v[28:31], v[24:27], v[128:135], v1
ds_read_b128 v[48:51], v0 offset:33792
v_smfmac_f32_16x16x64_bf16 v[32:35], v[24:27], v[136:143], v1
ds_read_b128 v[52:55], v0 offset:34816
global_load_dwordx4 v[68:71], v0, s[40:41] offset:-2048
v_smfmac_f32_16x16x64_bf16 v[36:39], v[24:27], v[240:247], v1
ds_read_b128 v[56:59], v0 offset:35840
v_smfmac_f32_16x16x64_bf16 v[40:43], v[24:27], v[248:255], v1
v_smfmac_f32_16x16x64_bf16 v[28:31], v[12:15], v[144:151], v1
s_waitcnt lgkmcnt(4)
v_cmp_u_f32 vcc, v16, v16
v_smfmac_f32_16x16x64_bf16 v[32:35], v[12:15], v[152:159], v1
global_load_dwordx4 v[72:75], v0, s[40:41] offset:-1024
s_waitcnt lgkmcnt(2)
v_smfmac_f32_16x16x64_bf16 v[36:39], v[12:15], v[44:51], v1
ds_read_b128 v[20:23], v4 offset:14336
s_cbranch_vccnz C\sfx\()0_0_retry1b
C\sfx\()0_0_back1b:
s_waitcnt lgkmcnt(1)
v_smfmac_f32_16x16x64_bf16 v[40:43], v[12:15], v[52:59], v1
ds_read_b128 v[24:27], v4 offset:15360
v_smfmac_f32_16x16x64_bf16 v[28:31], v[16:19], v[160:167], v1
ds_read_b128 v[44:47], v0 offset:49152
v_smfmac_f32_16x16x64_bf16 v[32:35], v[16:19], v[168:175], v1
ds_read_b128 v[48:51], v0 offset:50176
s_waitcnt lgkmcnt(2)
v_cmp_u_f32 vcc, v20, v24
v_smfmac_f32_16x16x64_bf16 v[36:39], v[16:19], a[0:7], v1
ds_read_b128 v[52:55], v0 offset:51200
v_smfmac_f32_16x16x64_bf16 v[40:43], v[16:19], a[8:15], v1
ds_read_b128 v[56:59], v0 offset:52224
s_cbranch_vccnz C\sfx\()0_0_retry2
C\sfx\()0_0_back2:
v_smfmac_f32_16x16x64_bf16 v[28:31], v[20:23], v[176:183], v1
ds_read_b128 v[12:15], v4 offset:30720
s_waitcnt lgkmcnt(3)
v_smfmac_f32_16x16x64_bf16 v[36:39], v[20:23], v[44:51], v1
ds_read_b128 v[44:47], v9
v_smfmac_f32_16x16x64_bf16 v[32:35], v[20:23], v[184:191], v1
ds_read_b128 v[48:51], v9 offset:1024
s_waitcnt lgkmcnt(3)
v_smfmac_f32_16x16x64_bf16 v[40:43], v[20:23], v[52:59], v1
ds_read_b128 v[52:55], v9 offset:2048
s_waitcnt lgkmcnt(3)
v_cmp_u_f32 vcc, v12, v12
v_smfmac_f32_16x16x64_bf16 v[28:31], v[24:27], v[192:199], v1
ds_read_b128 v[56:59], v9 offset:3072
v_smfmac_f32_16x16x64_bf16 v[36:39], v[24:27], a[16:23], v1
s_cbranch_vccnz C\sfx\()0_0_retry2b
C\sfx\()0_0_back2b:
v_smfmac_f32_16x16x64_bf16 v[28:31], v[12:15], v[208:215], v1
s_add_u32 s52, s36, 0x2000
s_addc_u32 s53, s37, 0
s_waitcnt lgkmcnt(2)
v_smfmac_f32_16x16x64_bf16 v[36:39], v[12:15], v[44:51], v1
v_smfmac_f32_16x16x64_bf16 v[32:35], v[24:27], v[200:207], v1
v_mov_b64 v[44:45], 0
v_smfmac_f32_16x16x64_bf16 v[40:43], v[24:27], a[24:31], v1
v_mov_b64 v[48:49], 0
v_add_f32 v28, v28, v30
v_smfmac_f32_16x16x64_bf16 v[32:35], v[12:15], v[216:223], v1
v_add_f32 v29, v29, v31
v_cvt_pk_bf16_f32 v77, v28, v29
v_add_f32 v36, v36, v38
s_waitcnt lgkmcnt(0)
v_smfmac_f32_16x16x64_bf16 v[40:43], v[12:15], v[52:59], v1
v_add_f32 v37, v37, v39
v_cvt_pk_bf16_f32 v76, v36, v37
ds_write_b64 v2, v[76:77]
v_mov_b64 v[46:47], 0
v_mov_b64 v[50:51], 0
C\sfx\()0_0_postqk:
s_waitcnt vmcnt(0)
v_smfmac_f32_16x16x64_bf16 v[44:47], v[20:23], v[60:67], v1
v_add_f32 v32, v32, v34
v_add_f32 v33, v33, v35
v_cvt_pk_bf16_f32 v79, v32, v33
v_add_f32 v40, v40, v42
v_add_f32 v41, v41, v43
v_cvt_pk_bf16_f32 v78, v40, v41
ds_write_b64 v2, v[78:79] offset:512
v_cmp_u_f32 vcc, v40, v41
v_smfmac_f32_16x16x64_bf16 v[48:51], v[20:23], v[68:75], v1
ds_read_b128 v[28:31], v4
v_smfmac_f32_16x16x64_bf16 v[44:47], v[12:15], a[144:151], v1
ds_read_b128 v[32:35], v4 offset:1024
v_smfmac_f32_16x16x64_bf16 v[48:51], v[12:15], a[152:159], v1
ds_read_b128 v[36:39], v4 offset:2048
s_cbranch_vccnz C\sfx\()0_0_retry_ag
v_smfmac_f32_16x16x64_bf16 v[44:47], v[24:27], a[128:135], v1
ds_read_b128 v[40:43], v4 offset:3072
s_waitcnt lgkmcnt(4)
s_barrier
ds_read_b64_tr_b16 v[60:61], v3
ds_read_b64_tr_b16 v[62:63], v3 offset:512
ds_read_b64_tr_b16 v[64:65], v3 offset:1024
ds_read_b64_tr_b16 v[66:67], v3 offset:1536
v_smfmac_f32_16x16x64_bf16 v[48:51], v[24:27], a[136:143], v1
ds_read_b64_tr_b16 v[68:69], v3 offset:2048
ds_read_b64_tr_b16 v[70:71], v3 offset:2560
ds_read_b64_tr_b16 v[72:73], v3 offset:3072
ds_read_b64_tr_b16 v[74:75], v3 offset:3584
v_smfmac_f32_16x16x64_bf16 v[44:47], v[16:19], a[112:119], v1
ds_read_b128 v[52:55], v4 offset:4096
v_smfmac_f32_16x16x64_bf16 v[48:51], v[16:19], a[120:127], v1
ds_read_b128 v[56:59], v4 offset:5120
s_waitcnt lgkmcnt(8)
v_mfma_f32_16x16x32_bf16 v[76:79], v[28:31], v[60:63], 0
ds_read_b128 v[12:15], v4 offset:6144
s_waitcnt lgkmcnt(7)
v_mfma_f32_16x16x32_bf16 v[76:79], v[32:35], v[64:67], v[76:79]
ds_read_b128 v[24:27], v4 offset:7168
s_waitcnt lgkmcnt(6)
v_mfma_f32_16x16x32_bf16 v[76:79], v[36:39], v[68:71], v[76:79]
ds_read_b128 v[20:23], v4 offset:8192
s_waitcnt lgkmcnt(5)
v_mfma_f32_16x16x32_bf16 v[76:79], v[40:43], v[72:75], v[76:79]
ds_read_b128 v[16:19], v4 offset:9216
s_waitcnt lgkmcnt(5)
v_mfma_f32_16x16x32_bf16 v[28:31], v[52:55], v[60:63], 0
v_mov_b32 v36, s57
v_mov_b32 v37, s57
s_waitcnt lgkmcnt(4)
v_mfma_f32_16x16x32_bf16 v[28:31], v[56:59], v[64:67], v[28:31]
ds_read_b128 v[52:55], v4 offset:16384
v_mov_b32 v38, s57
v_mov_b32 v39, s57
s_waitcnt lgkmcnt(4)
v_mfma_f32_16x16x32_bf16 v[28:31], v[12:15], v[68:71], v[28:31]
ds_read_b128 v[56:59], v4 offset:17408
v_exp_f32 v76, v76
s_waitcnt lgkmcnt(4)
v_mfma_f32_16x16x32_bf16 v[28:31], v[24:27], v[72:75], v[28:31]
ds_read_b128 v[12:15], v4 offset:10240
v_exp_f32 v77, v77
v_mfma_f32_16x16x32_bf16 v[32:35], v[60:63], v[60:63], 0
ds_read_b128 v[24:27], v4 offset:11264
v_exp_f32 v78, v78
v_mfma_f32_16x16x32_bf16 v[32:35], v[64:67], v[64:67], v[32:35]
v_exp_f32 v79, v79
v_mfma_f32_16x16x32_bf16 v[32:35], v[68:71], v[68:71], v[32:35]
v_cvt_pk_bf16_f32 v76, v76, v77
v_cvt_pk_bf16_f32 v77, v78, v79
v_mfma_f32_16x16x32_bf16 v[32:35], v[72:75], v[72:75], v[32:35]
v_exp_f32 v28, v28
s_waitcnt lgkmcnt(5)
v_smfmac_f32_16x16x64_bf16 v[44:47], v[20:23], a[32:39], v1
v_exp_f32 v29, v29
v_smfmac_f32_16x16x64_bf16 v[48:51], v[20:23], a[40:47], v1
v_exp_f32 v30, v30
s_waitcnt lgkmcnt(4)
v_smfmac_f32_16x16x64_bf16 v[44:47], v[16:19], a[48:55], v1
ds_read_b128 v[20:23], v4 offset:12288
v_exp_f32 v31, v31
v_smfmac_f32_16x16x64_bf16 v[48:51], v[16:19], a[56:63], v1
v_mul_f32 v32, s44, v32
s_waitcnt lgkmcnt(2)
v_smfmac_f32_16x16x64_bf16 v[44:47], v[12:15], a[64:71], v1
v_cvt_pk_bf16_f32 v78, v28, v29
v_smfmac_f32_16x16x64_bf16 v[48:51], v[12:15], a[72:79], v1
v_cvt_pk_bf16_f32 v79, v30, v31
s_waitcnt lgkmcnt(1)
v_smfmac_f32_16x16x64_bf16 v[44:47], v[24:27], a[80:87], v1
v_mul_f32 v33, s44, v33
s_waitcnt lgkmcnt(0)
v_smfmac_f32_16x16x64_bf16 v[44:47], v[20:23], a[96:103], v1
v_exp_f32 v32, v32
v_mfma_f32_16x16x32_bf16 v[40:43], v[76:79], v[36:39], 0
v_exp_f32 v33, v33
v_smfmac_f32_16x16x64_bf16 v[48:51], v[24:27], a[88:95], v1
v_cvt_pk_bf16_f32 v10, v32, v33
v_mfma_f32_16x16x32_bf16 v[60:63], v[76:79], v[52:55], 0
v_smfmac_f32_16x16x64_bf16 v[48:51], v[20:23], a[104:111], v1
s_nop 0
v_add_f32 v44, v44, v46
v_mfma_f32_16x16x32_bf16 v[64:67], v[76:79], v[56:59], 0
v_add_f32 v45, v45, v47
v_cvt_pk_bf16_f32 v52, v44, v45
v_mfma_f32_16x16x16_bf16 v[40:43], v[10:11], v[36:37], v[40:43]
s_nop 0
v_mfma_f32_16x16x16_bf16 v[60:63], v[10:11], v[52:53], v[60:63]
v_add_f32 v48, v48, v50
v_add_f32 v49, v49, v51
v_cvt_pk_bf16_f32 v56, v48, v49
s_nop 1
v_mfma_f32_16x16x16_bf16 v[64:67], v[10:11], v[56:57], v[64:67]
v_rcp_f32 v70, v42
v_rcp_f32 v71, v43
v_subrev_u32 v40, s45, v42
v_subrev_u32 v41, s45, v43
v_mul_f32 v62, v62, v70
v_mul_f32 v63, v63, v71
v_cvt_pk_bf16_f32 v68, v62, v63
ds_write_b32 v2, v68 offset:4096
v_mul_f32 v66, v66, v70
v_mul_f32 v67, v67, v71
v_cvt_pk_bf16_f32 v69, v66, v67
ds_write_b32 v2, v69 offset:4608
v_max_u32 v40, v40, v41
v_cmp_le_u32 vcc, s46, v40
v_mov_b64 v[12:13], 0
v_mov_b64 v[14:15], 0
v_mov_b64 v[16:17], 0
v_mov_b64 v[18:19], 0
v_mov_b64 v[20:21], 0
v_mov_b64 v[22:23], 0
s_cbranch_vccnz C\sfx\()0_0_slow
C\sfx\()0_0_oskip:
s_mov_b32 m0, 0x24000
v_mov_b64 v[24:25], 0
v_mov_b64 v[26:27], 0
global_load_lds_dwordx4 v0, s[52:53] sc1
global_load_lds_dwordx4 v0, s[52:53] offset:1024 sc1
s_waitcnt lgkmcnt(0)
s_barrier
ds_read_b64_tr_b16 v[44:45], v3 offset:4096
ds_read_b64_tr_b16 v[46:47], v3 offset:4608
ds_read_b64_tr_b16 v[48:49], v3 offset:5120
ds_read_b64_tr_b16 v[50:51], v3 offset:5632
v_mov_b64 v[28:29], 0
v_mov_b64 v[30:31], 0
v_mov_b64 v[32:33], 0
v_mov_b64 v[34:35], 0
s_waitcnt lgkmcnt(2)
v_smfmac_f32_16x16x64_bf16 v[12:15], v[44:47], a[240:247], v1
ds_read_b128 v[52:55], v9 offset:16384
s_add_u32 s54, s36, 0x0
s_addc_u32 s55, s37, 0
s_waitcnt lgkmcnt(1)
v_smfmac_f32_16x16x64_bf16 v[12:15], v[48:51], a[248:255], v1
ds_read_b128 v[56:59], v9 offset:17408
s_mov_b32 m0, 0x22000
s_cmp_eq_u32 s42, 63
global_load_lds_dwordx4 v0, s[54:55] sc1
v_smfmac_f32_16x16x64_bf16 v[16:19], v[44:47], a[160:167], v1
ds_read_b128 v[60:63], v9 offset:18432
global_load_lds_dwordx4 v0, s[54:55] offset:1024 sc1
global_load_lds_dwordx4 v0, s[54:55] offset:2048 sc1
s_cbranch_scc1 DONE
v_smfmac_f32_16x16x64_bf16 v[16:19], v[48:51], a[176:183], v1
ds_read_b128 v[64:67], v9 offset:19456
s_add_u32 s42, s42, 1
v_smfmac_f32_16x16x64_bf16 v[20:23], v[44:47], a[168:175], v1
ds_read_b128 v[68:71], v9 offset:32768
s_add_u32 s36, s36, 0x4000
s_addc_u32 s37, s37, 0
v_add_f32 v12, v12, v14
v_smfmac_f32_16x16x64_bf16 v[20:23], v[48:51], a[184:191], v1
ds_read_b128 v[72:75], v9 offset:33792
v_add_f32 v13, v13, v15
v_cvt_pk_bf16_f32 v12, v12, v13
v_smfmac_f32_16x16x64_bf16 v[24:27], v[44:47], a[192:199], v1
v_add_f32 v14, v16, v18
v_add_f32 v15, v17, v19
v_mov_b32_dpp v13, v12 quad_perm:[1,0,3,2] row_mask:0xf bank_mask:0xf
s_waitcnt lgkmcnt(4)
v_smfmac_f32_16x16x64_bf16 v[24:27], v[48:51], v[52:59], v1
ds_read_b128 v[52:55], v9 offset:34816
v_mov_b32 v19, s75
v_perm_b32 v16, v13, v12, v8
v_add_f32 v20, v20, v22
v_add_f32 v21, v21, v23
v_cvt_pk_bf16_f32 v17, v14, v20
v_cvt_pk_bf16_f32 v18, v15, v21
global_store_dwordx4 v5, v[16:19], s[28:29] \md
v_smfmac_f32_16x16x64_bf16 v[28:31], v[44:47], a[200:207], v1
ds_read_b128 v[56:59], v9 offset:35840
s_add_u32 s64, s28, 0x1000
s_addc_u32 s65, s29, 0
v_mov_b64 v[36:37], 0
s_waitcnt lgkmcnt(4)
v_smfmac_f32_16x16x64_bf16 v[28:31], v[48:51], v[60:67], v1
ds_read_b128 v[60:63], v9 offset:49152
v_mov_b64 v[38:39], 0
v_smfmac_f32_16x16x64_bf16 v[32:35], v[44:47], a[208:215], v1
ds_read_b128 v[64:67], v9 offset:50176
v_add_f32 v24, v24, v26
v_mov_b64 v[40:41], 0
s_waitcnt lgkmcnt(4)
v_smfmac_f32_16x16x64_bf16 v[32:35], v[48:51], v[68:75], v1
ds_read_b128 v[68:71], v9 offset:51200
v_add_f32 v25, v25, v27
v_cvt_pk_bf16_f32 v24, v24, v25
v_mov_b64 v[42:43], 0
v_smfmac_f32_16x16x64_bf16 v[36:39], v[44:47], a[216:223], v1
ds_read_b128 v[72:75], v9 offset:52224
v_add_f32 v26, v28, v30
v_add_f32 v27, v29, v31
v_mov_b32_dpp v25, v24 quad_perm:[1,0,3,2] row_mask:0xf bank_mask:0xf
v_mov_b64 v[76:77], 0
s_waitcnt lgkmcnt(4)
v_smfmac_f32_16x16x64_bf16 v[36:39], v[48:51], v[52:59], v1
v_mov_b64 v[78:79], 0
v_mov_b32 v31, s75
v_perm_b32 v28, v25, v24, v8
v_add_f32 v32, v32, v34
v_add_f32 v33, v33, v35
v_cvt_pk_bf16_f32 v29, v26, v32
v_cvt_pk_bf16_f32 v30, v27, v33
global_store_dwordx4 v5, v[28:31], s[64:65] \md
v_smfmac_f32_16x16x64_bf16 v[40:43], v[44:47], a[224:231], v1
s_add_u32 s64, s28, 0x2000
s_addc_u32 s65, s29, 0
s_waitcnt lgkmcnt(2)
v_smfmac_f32_16x16x64_bf16 v[40:43], v[48:51], v[60:67], v1
v_smfmac_f32_16x16x64_bf16 v[76:79], v[44:47], a[232:239], v1
v_add_f32 v36, v36, v38
s_waitcnt lgkmcnt(0)
v_smfmac_f32_16x16x64_bf16 v[76:79], v[48:51], v[68:75], v1
v_add_f32 v37, v37, v39
v_cvt_pk_bf16_f32 v36, v36, v37
s_nop 1
v_add_f32 v38, v40, v42
v_add_f32 v39, v41, v43
v_mov_b32_dpp v37, v36 quad_perm:[1,0,3,2] row_mask:0xf bank_mask:0xf
v_mov_b32 v43, s75
v_perm_b32 v40, v37, v36, v8
v_add_f32 v76, v76, v78
v_add_f32 v77, v77, v79
v_cvt_pk_bf16_f32 v41, v38, v76
v_cvt_pk_bf16_f32 v42, v39, v77
global_store_dwordx4 v5, v[40:43], s[64:65] \md
v_and_b32 v10, 0x200ff, v4
ds_read_b128 v[76:79], v10 offset:31744
s_add_u32 s51, s56, 0x18c00
s_and_b32 s51, s51, 0x1ffff
s_add_u32 s72, s14, s51
s_addc_u32 s73, s15, 0
s_add_u32 s56, s56, 0x8000
s_and_b32 s56, s56, 0x1ffff
s_add_u32 s51, s56, 3072
s_add_u32 s70, s14, s51
s_addc_u32 s71, s15, 0
s_add_u32 s51, s56, s96
s_add_u32 s68, s14, s51
s_addc_u32 s69, s15, 0
s_mov_b32 s74, 0
s_nop 7
global_load_dwordx4 v[12:15], v0, s[32:33] sc1
global_load_dwordx4 v[16:19], v0, s[32:33] offset:1024 sc1
global_load_dwordx4 v[20:23], v0, s[32:33] offset:2048 sc1
global_load_dwordx4 v[24:27], v0, s[32:33] offset:3072 sc1
s_waitcnt lgkmcnt(0)
s_waitcnt vmcnt(3)
v_mfma_f32_16x16x32_bf16 v[44:47], v[76:79], v[12:15], 0
s_waitcnt vmcnt(2)
v_mfma_f32_16x16x32_bf16 v[44:47], v[76:79], v[16:19], v[44:47]
s_waitcnt vmcnt(1)
v_mfma_f32_16x16x32_bf16 v[44:47], v[76:79], v[20:23], v[44:47]
v_min3_u32 v48, v15, v19, v23
s_waitcnt vmcnt(0)
v_mfma_f32_16x16x32_bf16 v[44:47], v[76:79], v[24:27], v[44:47]
v_min_u32 v48, v48, v27
v_cmp_ne_u32 vcc, s75, v48
s_nop 4
s_cbranch_vccnz C\sfx\()0_0_retry_u1
v_add_f32_dpp v46, v44, v44 row_ror:8 row_mask:0xf bank_mask:0xf
v_add_f32_dpp v47, v45, v45 row_ror:8 row_mask:0xf bank_mask:0xf
v_cvt_pk_bf16_f32 v44, v46, v47
global_store_dword v7, v44, s[22:23] offset:-3072 \md
C\sfx\()0_0_done_u1:
v_mov_b32 v49, s75
v_mov_b32 v50, 163328
ds_write_b32 v50, v49
v_mov_b32 v48, -1
global_store_dword v7, v48, s[24:25] offset:-3072 \md
s_waitcnt vmcnt(2)
ds_read_b128 v[44:47], v0
ds_read_b128 v[48:51], v0 offset:1024
ds_read_b128 v[52:55], v0 offset:2048
ds_read_b128 v[56:59], v0 offset:3072
v_mov_b64 v[28:29], 0
v_mov_b64 v[30:31], 0
v_mov_b64 v[32:33], 0
v_mov_b64 v[34:35], 0
v_mov_b64 v[36:37], 0
v_mov_b64 v[38:39], 0
v_mov_b64 v[40:41], 0
v_mov_b64 v[42:43], 0
s_waitcnt lgkmcnt(0)
s_sleep 1
s_nop 7
s_add_u32 s54, s20, 0xc00
s_addc_u32 s55, s21, 0
s_mov_b32 m0, 0x20000
global_load_dword v72, v6, s[22:23] sc1
global_load_lds_dwordx4 v0, s[20:21] sc1
global_load_lds_dwordx4 v0, s[20:21] offset:1024 sc1
global_load_lds_dwordx4 v0, s[20:21] offset:2048 sc1
s_nop 7
s_nop 3
global_load_dword v73, v6, s[22:23] sc1
global_load_lds_dwordx4 v0, s[20:21] sc1
global_load_lds_dwordx4 v0, s[20:21] offset:1024 sc1
global_load_lds_dwordx4 v0, s[20:21] offset:2048 sc1
s_nop 7
s_nop 3
global_load_dword v74, v6, s[22:23] sc1
global_load_lds_dwordx4 v0, s[20:21] sc1
global_load_lds_dwordx4 v0, s[20:21] offset:1024 sc1
global_load_lds_dwordx4 v0, s[20:21] offset:2048 sc1
FP\sfx\()_79:
s_waitcnt vmcnt(11)
v_cmp_u_f32 vcc, v72, v72
s_cbranch_vccz FO\sfx\()_80
global_load_dword v72, v6, s[22:23] sc1
global_load_lds_dwordx4 v0, s[20:21] sc1
global_load_lds_dwordx4 v0, s[20:21] offset:1024 sc1
global_load_lds_dwordx4 v0, s[20:21] offset:2048 sc1
s_waitcnt vmcnt(11)
v_cmp_u_f32 vcc, v73, v73
s_cbranch_vccz FO\sfx\()_80
global_load_dword v73, v6, s[22:23] sc1
global_load_lds_dwordx4 v0, s[20:21] sc1
global_load_lds_dwordx4 v0, s[20:21] offset:1024 sc1
global_load_lds_dwordx4 v0, s[20:21] offset:2048 sc1
s_waitcnt vmcnt(11)
v_cmp_u_f32 vcc, v74, v74
s_cbranch_vccz FO\sfx\()_80
global_load_dword v74, v6, s[22:23] sc1
global_load_lds_dwordx4 v0, s[20:21] sc1
global_load_lds_dwordx4 v0, s[20:21] offset:1024 sc1
global_load_lds_dwordx4 v0, s[20:21] offset:2048 sc1
s_add_u32 s77, s77, 1
s_sub_u32 s43, s43, 1
s_cbranch_scc1 EXIT2
s_branch FP\sfx\()_79
FO\sfx\()_80:
s_mov_b32 m0, 0x20c00
s_nop 0
global_load_lds_dwordx4 v0, s[54:55] sc1
global_load_lds_dwordx4 v0, s[54:55] offset:1024 sc1
global_load_lds_dwordx4 v0, s[54:55] offset:2048 sc1
s_waitcnt vmcnt(11)
s_add_u32 s75, s75, 1
s_barrier
C\sfx\()0_1_qk:
ds_read_b128 v[12:15], v4
ds_read_b128 v[16:19], v4 offset:1024
ds_read_b128 v[20:23], v4 offset:2048
C\sfx\()0_1_back0:
s_waitcnt lgkmcnt(2)
v_smfmac_f32_16x16x64_bf16 v[28:31], v[12:15], v[80:87], v1
s_waitcnt lgkmcnt(0)
v_add_f32 v10, v12, v16
v_cmp_u_f32 vcc, v10, v20
v_smfmac_f32_16x16x64_bf16 v[32:35], v[12:15], v[88:95], v1
s_cbranch_vccnz C\sfx\()0_1_retry0
v_smfmac_f32_16x16x64_bf16 v[36:39], v[12:15], v[44:51], v1
ds_read_b128 v[44:47], v0 offset:16384
v_smfmac_f32_16x16x64_bf16 v[40:43], v[12:15], v[52:59], v1
ds_read_b128 v[48:51], v0 offset:17408
v_smfmac_f32_16x16x64_bf16 v[28:31], v[16:19], v[96:103], v1
ds_read_b128 v[52:55], v0 offset:18432
v_smfmac_f32_16x16x64_bf16 v[32:35], v[16:19], v[104:111], v1
ds_read_b128 v[56:59], v0 offset:19456
global_load_dwordx4 v[60:63], v0, s[40:41] offset:-4096
v_smfmac_f32_16x16x64_bf16 v[36:39], v[16:19], v[224:231], v1
v_smfmac_f32_16x16x64_bf16 v[40:43], v[16:19], v[232:239], v1
v_smfmac_f32_16x16x64_bf16 v[28:31], v[20:23], v[112:119], v1
ds_read_b128 v[24:27], v4 offset:3072
v_smfmac_f32_16x16x64_bf16 v[32:35], v[20:23], v[120:127], v1
ds_read_b128 v[12:15], v4 offset:4096
global_load_dwordx4 v[64:67], v0, s[40:41] offset:-3072
s_waitcnt lgkmcnt(4)
v_smfmac_f32_16x16x64_bf16 v[36:39], v[20:23], v[44:51], v1
ds_read_b128 v[16:19], v4 offset:5120
s_waitcnt lgkmcnt(1)
v_cmp_u_f32 vcc, v24, v12
v_smfmac_f32_16x16x64_bf16 v[40:43], v[20:23], v[52:59], v1
ds_read_b128 v[44:47], v0 offset:32768
s_cbranch_vccnz C\sfx\()0_1_retry1
C\sfx\()0_1_back1:
v_smfmac_f32_16x16x64_bf16 v[28:31], v[24:27], v[128:135], v1
ds_read_b128 v[48:51], v0 offset:33792
v_smfmac_f32_16x16x64_bf16 v[32:35], v[24:27], v[136:143], v1
ds_read_b128 v[52:55], v0 offset:34816
global_load_dwordx4 v[68:71], v0, s[40:41] offset:-2048
v_smfmac_f32_16x16x64_bf16 v[36:39], v[24:27], v[240:247], v1
ds_read_b128 v[56:59], v0 offset:35840
v_smfmac_f32_16x16x64_bf16 v[40:43], v[24:27], v[248:255], v1
v_smfmac_f32_16x16x64_bf16 v[28:31], v[12:15], v[144:151], v1
s_waitcnt lgkmcnt(4)
v_cmp_u_f32 vcc, v16, v16
v_smfmac_f32_16x16x64_bf16 v[32:35], v[12:15], v[152:159], v1
global_load_dwordx4 v[72:75], v0, s[40:41] offset:-1024
s_waitcnt lgkmcnt(2)
v_smfmac_f32_16x16x64_bf16 v[36:39], v[12:15], v[44:51], v1
ds_read_b128 v[20:23], v4 offset:6144
s_cbranch_vccnz C\sfx\()0_1_retry1b
C\sfx\()0_1_back1b:
s_waitcnt lgkmcnt(1)
v_smfmac_f32_16x16x64_bf16 v[40:43], v[12:15], v[52:59], v1
ds_read_b128 v[24:27], v4 offset:7168
v_smfmac_f32_16x16x64_bf16 v[28:31], v[16:19], v[160:167], v1
ds_read_b128 v[44:47], v0 offset:49152
v_smfmac_f32_16x16x64_bf16 v[32:35], v[16:19], v[168:175], v1
ds_read_b128 v[48:51], v0 offset:50176
s_waitcnt lgkmcnt(2)
v_cmp_u_f32 vcc, v20, v24
v_smfmac_f32_16x16x64_bf16 v[36:39], v[16:19], a[0:7], v1
ds_read_b128 v[52:55], v0 offset:51200
v_smfmac_f32_16x16x64_bf16 v[40:43], v[16:19], a[8:15], v1
ds_read_b128 v[56:59], v0 offset:52224
s_cbranch_vccnz C\sfx\()0_1_retry2
C\sfx\()0_1_back2:
v_smfmac_f32_16x16x64_bf16 v[28:31], v[20:23], v[176:183], v1
ds_read_b128 v[12:15], v4 offset:30720
s_waitcnt lgkmcnt(3)
v_smfmac_f32_16x16x64_bf16 v[36:39], v[20:23], v[44:51], v1
ds_read_b128 v[44:47], v9
v_smfmac_f32_16x16x64_bf16 v[32:35], v[20:23], v[184:191], v1
ds_read_b128 v[48:51], v9 offset:1024
s_waitcnt lgkmcnt(3)
v_smfmac_f32_16x16x64_bf16 v[40:43], v[20:23], v[52:59], v1
ds_read_b128 v[52:55], v9 offset:2048
s_waitcnt lgkmcnt(3)
v_cmp_u_f32 vcc, v12, v12
v_smfmac_f32_16x16x64_bf16 v[28:31], v[24:27], v[192:199], v1
ds_read_b128 v[56:59], v9 offset:3072
v_smfmac_f32_16x16x64_bf16 v[36:39], v[24:27], a[16:23], v1
s_cbranch_vccnz C\sfx\()0_1_retry2b
C\sfx\()0_1_back2b:
v_smfmac_f32_16x16x64_bf16 v[28:31], v[12:15], v[208:215], v1
s_add_u32 s52, s36, 0x2000
s_addc_u32 s53, s37, 0
s_waitcnt lgkmcnt(2)
v_smfmac_f32_16x16x64_bf16 v[36:39], v[12:15], v[44:51], v1
v_smfmac_f32_16x16x64_bf16 v[32:35], v[24:27], v[200:207], v1
v_mov_b64 v[44:45], 0
v_smfmac_f32_16x16x64_bf16 v[40:43], v[24:27], a[24:31], v1
v_mov_b64 v[48:49], 0
v_add_f32 v28, v28, v30
v_smfmac_f32_16x16x64_bf16 v[32:35], v[12:15], v[216:223], v1
v_add_f32 v29, v29, v31
v_cvt_pk_bf16_f32 v77, v28, v29
v_add_f32 v36, v36, v38
s_waitcnt lgkmcnt(0)
v_smfmac_f32_16x16x64_bf16 v[40:43], v[12:15], v[52:59], v1
v_add_f32 v37, v37, v39
v_cvt_pk_bf16_f32 v76, v36, v37
ds_write_b64 v2, v[76:77]
v_mov_b64 v[46:47], 0
v_mov_b64 v[50:51], 0
C\sfx\()0_1_postqk:
s_waitcnt vmcnt(0)
v_smfmac_f32_16x16x64_bf16 v[44:47], v[20:23], v[60:67], v1
v_add_f32 v32, v32, v34
v_add_f32 v33, v33, v35
v_cvt_pk_bf16_f32 v79, v32, v33
v_add_f32 v40, v40, v42
v_add_f32 v41, v41, v43
v_cvt_pk_bf16_f32 v78, v40, v41
ds_write_b64 v2, v[78:79] offset:512
v_cmp_u_f32 vcc, v40, v41
v_smfmac_f32_16x16x64_bf16 v[48:51], v[20:23], v[68:75], v1
ds_read_b128 v[28:31], v4 offset:8192
v_smfmac_f32_16x16x64_bf16 v[44:47], v[12:15], a[144:151], v1
ds_read_b128 v[32:35], v4 offset:9216
v_smfmac_f32_16x16x64_bf16 v[48:51], v[12:15], a[152:159], v1
ds_read_b128 v[36:39], v4 offset:10240
s_cbranch_vccnz C\sfx\()0_1_retry_ag
v_smfmac_f32_16x16x64_bf16 v[44:47], v[24:27], a[128:135], v1
ds_read_b128 v[40:43], v4 offset:11264
s_waitcnt lgkmcnt(4)
s_barrier
ds_read_b64_tr_b16 v[60:61], v3
ds_read_b64_tr_b16 v[62:63], v3 offset:512
ds_read_b64_tr_b16 v[64:65], v3 offset:1024
ds_read_b64_tr_b16 v[66:67], v3 offset:1536
v_smfmac_f32_16x16x64_bf16 v[48:51], v[24:27], a[136:143], v1
ds_read_b64_tr_b16 v[68:69], v3 offset:2048
ds_read_b64_tr_b16 v[70:71], v3 offset:2560
ds_read_b64_tr_b16 v[72:73], v3 offset:3072
ds_read_b64_tr_b16 v[74:75], v3 offset:3584
v_smfmac_f32_16x16x64_bf16 v[44:47], v[16:19], a[112:119], v1
ds_read_b128 v[52:55], v4 offset:12288
v_smfmac_f32_16x16x64_bf16 v[48:51], v[16:19], a[120:127], v1
ds_read_b128 v[56:59], v4 offset:13312
s_waitcnt lgkmcnt(8)
v_mfma_f32_16x16x32_bf16 v[76:79], v[28:31], v[60:63], 0
ds_read_b128 v[12:15], v4 offset:14336
s_waitcnt lgkmcnt(7)
v_mfma_f32_16x16x32_bf16 v[76:79], v[32:35], v[64:67], v[76:79]
ds_read_b128 v[24:27], v4 offset:15360
s_waitcnt lgkmcnt(6)
v_mfma_f32_16x16x32_bf16 v[76:79], v[36:39], v[68:71], v[76:79]
ds_read_b128 v[20:23], v4
s_waitcnt lgkmcnt(5)
v_mfma_f32_16x16x32_bf16 v[76:79], v[40:43], v[72:75], v[76:79]
ds_read_b128 v[16:19], v4 offset:1024
s_waitcnt lgkmcnt(5)
v_mfma_f32_16x16x32_bf16 v[28:31], v[52:55], v[60:63], 0
v_mov_b32 v36, s57
v_mov_b32 v37, s57
s_waitcnt lgkmcnt(4)
v_mfma_f32_16x16x32_bf16 v[28:31], v[56:59], v[64:67], v[28:31]
ds_read_b128 v[52:55], v4 offset:16384
v_mov_b32 v38, s57
v_mov_b32 v39, s57
s_waitcnt lgkmcnt(4)
v_mfma_f32_16x16x32_bf16 v[28:31], v[12:15], v[68:71], v[28:31]
ds_read_b128 v[56:59], v4 offset:17408
v_exp_f32 v76, v76
s_waitcnt lgkmcnt(4)
v_mfma_f32_16x16x32_bf16 v[28:31], v[24:27], v[72:75], v[28:31]
ds_read_b128 v[12:15], v4 offset:2048
v_exp_f32 v77, v77
v_mfma_f32_16x16x32_bf16 v[32:35], v[60:63], v[60:63], 0
ds_read_b128 v[24:27], v4 offset:3072
v_exp_f32 v78, v78
v_mfma_f32_16x16x32_bf16 v[32:35], v[64:67], v[64:67], v[32:35]
v_exp_f32 v79, v79
v_mfma_f32_16x16x32_bf16 v[32:35], v[68:71], v[68:71], v[32:35]
v_cvt_pk_bf16_f32 v76, v76, v77
v_cvt_pk_bf16_f32 v77, v78, v79
v_mfma_f32_16x16x32_bf16 v[32:35], v[72:75], v[72:75], v[32:35]
v_exp_f32 v28, v28
s_waitcnt lgkmcnt(5)
v_smfmac_f32_16x16x64_bf16 v[44:47], v[20:23], a[32:39], v1
v_exp_f32 v29, v29
v_smfmac_f32_16x16x64_bf16 v[48:51], v[20:23], a[40:47], v1
v_exp_f32 v30, v30
s_waitcnt lgkmcnt(4)
v_smfmac_f32_16x16x64_bf16 v[44:47], v[16:19], a[48:55], v1
ds_read_b128 v[20:23], v4 offset:4096
v_exp_f32 v31, v31
v_smfmac_f32_16x16x64_bf16 v[48:51], v[16:19], a[56:63], v1
v_mul_f32 v32, s44, v32
s_waitcnt lgkmcnt(2)
v_smfmac_f32_16x16x64_bf16 v[44:47], v[12:15], a[64:71], v1
v_cvt_pk_bf16_f32 v78, v28, v29
v_smfmac_f32_16x16x64_bf16 v[48:51], v[12:15], a[72:79], v1
v_cvt_pk_bf16_f32 v79, v30, v31
s_waitcnt lgkmcnt(1)
v_smfmac_f32_16x16x64_bf16 v[44:47], v[24:27], a[80:87], v1
v_mul_f32 v33, s44, v33
s_waitcnt lgkmcnt(0)
v_smfmac_f32_16x16x64_bf16 v[44:47], v[20:23], a[96:103], v1
v_exp_f32 v32, v32
v_mfma_f32_16x16x32_bf16 v[40:43], v[76:79], v[36:39], 0
v_exp_f32 v33, v33
v_smfmac_f32_16x16x64_bf16 v[48:51], v[24:27], a[88:95], v1
v_cvt_pk_bf16_f32 v10, v32, v33
v_mfma_f32_16x16x32_bf16 v[60:63], v[76:79], v[52:55], 0
v_smfmac_f32_16x16x64_bf16 v[48:51], v[20:23], a[104:111], v1
s_nop 0
v_add_f32 v44, v44, v46
v_mfma_f32_16x16x32_bf16 v[64:67], v[76:79], v[56:59], 0
v_add_f32 v45, v45, v47
v_cvt_pk_bf16_f32 v52, v44, v45
v_mfma_f32_16x16x16_bf16 v[40:43], v[10:11], v[36:37], v[40:43]
s_nop 0
v_mfma_f32_16x16x16_bf16 v[60:63], v[10:11], v[52:53], v[60:63]
v_add_f32 v48, v48, v50
v_add_f32 v49, v49, v51
v_cvt_pk_bf16_f32 v56, v48, v49
s_nop 1
v_mfma_f32_16x16x16_bf16 v[64:67], v[10:11], v[56:57], v[64:67]
v_rcp_f32 v70, v42
v_rcp_f32 v71, v43
v_subrev_u32 v40, s45, v42
v_subrev_u32 v41, s45, v43
v_mul_f32 v62, v62, v70
v_mul_f32 v63, v63, v71
v_cvt_pk_bf16_f32 v68, v62, v63
ds_write_b32 v2, v68 offset:4096
v_mul_f32 v66, v66, v70
v_mul_f32 v67, v67, v71
v_cvt_pk_bf16_f32 v69, v66, v67
ds_write_b32 v2, v69 offset:4608
v_max_u32 v40, v40, v41
v_cmp_le_u32 vcc, s46, v40
v_mov_b64 v[12:13], 0
v_mov_b64 v[14:15], 0
v_mov_b64 v[16:17], 0
v_mov_b64 v[18:19], 0
v_mov_b64 v[20:21], 0
v_mov_b64 v[22:23], 0
s_cbranch_vccnz C\sfx\()0_1_slow
C\sfx\()0_1_oskip:
s_mov_b32 m0, 0x24000
v_mov_b64 v[24:25], 0
v_mov_b64 v[26:27], 0
global_load_lds_dwordx4 v0, s[52:53] sc1
global_load_lds_dwordx4 v0, s[52:53] offset:1024 sc1
s_waitcnt lgkmcnt(0)
s_barrier
ds_read_b64_tr_b16 v[44:45], v3 offset:4096
ds_read_b64_tr_b16 v[46:47], v3 offset:4608
ds_read_b64_tr_b16 v[48:49], v3 offset:5120
ds_read_b64_tr_b16 v[50:51], v3 offset:5632
v_mov_b64 v[28:29], 0
v_mov_b64 v[30:31], 0
v_mov_b64 v[32:33], 0
v_mov_b64 v[34:35], 0
s_waitcnt lgkmcnt(2)
v_smfmac_f32_16x16x64_bf16 v[12:15], v[44:47], a[240:247], v1
ds_read_b128 v[52:55], v9 offset:16384
s_add_u32 s54, s36, 0x0
s_addc_u32 s55, s37, 0
s_waitcnt lgkmcnt(1)
v_smfmac_f32_16x16x64_bf16 v[12:15], v[48:51], a[248:255], v1
ds_read_b128 v[56:59], v9 offset:17408
s_mov_b32 m0, 0x20000
s_cmp_eq_u32 s42, 63
global_load_lds_dwordx4 v0, s[54:55] sc1
v_smfmac_f32_16x16x64_bf16 v[16:19], v[44:47], a[160:167], v1
ds_read_b128 v[60:63], v9 offset:18432
global_load_lds_dwordx4 v0, s[54:55] offset:1024 sc1
global_load_lds_dwordx4 v0, s[54:55] offset:2048 sc1
s_cbranch_scc1 DONE
v_smfmac_f32_16x16x64_bf16 v[16:19], v[48:51], a[176:183], v1
ds_read_b128 v[64:67], v9 offset:19456
s_add_u32 s42, s42, 1
v_smfmac_f32_16x16x64_bf16 v[20:23], v[44:47], a[168:175], v1
ds_read_b128 v[68:71], v9 offset:32768
s_add_u32 s36, s36, 0x4000
s_addc_u32 s37, s37, 0
v_add_f32 v12, v12, v14
v_smfmac_f32_16x16x64_bf16 v[20:23], v[48:51], a[184:191], v1
ds_read_b128 v[72:75], v9 offset:33792
v_add_f32 v13, v13, v15
v_cvt_pk_bf16_f32 v12, v12, v13
v_smfmac_f32_16x16x64_bf16 v[24:27], v[44:47], a[192:199], v1
v_add_f32 v14, v16, v18
v_add_f32 v15, v17, v19
v_mov_b32_dpp v13, v12 quad_perm:[1,0,3,2] row_mask:0xf bank_mask:0xf
s_waitcnt lgkmcnt(4)
v_smfmac_f32_16x16x64_bf16 v[24:27], v[48:51], v[52:59], v1
ds_read_b128 v[52:55], v9 offset:34816
v_mov_b32 v19, s75
v_perm_b32 v16, v13, v12, v8
v_add_f32 v20, v20, v22
v_add_f32 v21, v21, v23
v_cvt_pk_bf16_f32 v17, v14, v20
v_cvt_pk_bf16_f32 v18, v15, v21
global_store_dwordx4 v5, v[16:19], s[30:31] \md
v_smfmac_f32_16x16x64_bf16 v[28:31], v[44:47], a[200:207], v1
ds_read_b128 v[56:59], v9 offset:35840
s_add_u32 s64, s30, 0x1000
s_addc_u32 s65, s31, 0
v_mov_b64 v[36:37], 0
s_waitcnt lgkmcnt(4)
v_smfmac_f32_16x16x64_bf16 v[28:31], v[48:51], v[60:67], v1
ds_read_b128 v[60:63], v9 offset:49152
v_mov_b64 v[38:39], 0
v_smfmac_f32_16x16x64_bf16 v[32:35], v[44:47], a[208:215], v1
ds_read_b128 v[64:67], v9 offset:50176
v_add_f32 v24, v24, v26
v_mov_b64 v[40:41], 0
s_waitcnt lgkmcnt(4)
v_smfmac_f32_16x16x64_bf16 v[32:35], v[48:51], v[68:75], v1
ds_read_b128 v[68:71], v9 offset:51200
v_add_f32 v25, v25, v27
v_cvt_pk_bf16_f32 v24, v24, v25
v_mov_b64 v[42:43], 0
v_smfmac_f32_16x16x64_bf16 v[36:39], v[44:47], a[216:223], v1
ds_read_b128 v[72:75], v9 offset:52224
v_add_f32 v26, v28, v30
v_add_f32 v27, v29, v31
v_mov_b32_dpp v25, v24 quad_perm:[1,0,3,2] row_mask:0xf bank_mask:0xf
v_mov_b64 v[76:77], 0
s_waitcnt lgkmcnt(4)
v_smfmac_f32_16x16x64_bf16 v[36:39], v[48:51], v[52:59], v1
v_mov_b64 v[78:79], 0
v_mov_b32 v31, s75
v_perm_b32 v28, v25, v24, v8
v_add_f32 v32, v32, v34
v_add_f32 v33, v33, v35
v_cvt_pk_bf16_f32 v29, v26, v32
v_cvt_pk_bf16_f32 v30, v27, v33
global_store_dwordx4 v5, v[28:31], s[64:65] \md
v_smfmac_f32_16x16x64_bf16 v[40:43], v[44:47], a[224:231], v1
s_add_u32 s64, s30, 0x2000
s_addc_u32 s65, s31, 0
s_waitcnt lgkmcnt(2)
v_smfmac_f32_16x16x64_bf16 v[40:43], v[48:51], v[60:67], v1
v_smfmac_f32_16x16x64_bf16 v[76:79], v[44:47], a[232:239], v1
v_add_f32 v36, v36, v38
s_waitcnt lgkmcnt(0)
v_smfmac_f32_16x16x64_bf16 v[76:79], v[48:51], v[68:75], v1
v_add_f32 v37, v37, v39
v_cvt_pk_bf16_f32 v36, v36, v37
s_nop 1
v_add_f32 v38, v40, v42
v_add_f32 v39, v41, v43
v_mov_b32_dpp v37, v36 quad_perm:[1,0,3,2] row_mask:0xf bank_mask:0xf
v_mov_b32 v43, s75
v_perm_b32 v40, v37, v36, v8
v_add_f32 v76, v76, v78
v_add_f32 v77, v77, v79
v_cvt_pk_bf16_f32 v41, v38, v76
v_cvt_pk_bf16_f32 v42, v39, v77
global_store_dwordx4 v5, v[40:43], s[64:65] \md
v_and_b32 v10, 0x200ff, v4
ds_read_b128 v[76:79], v10 offset:31744
s_add_u32 s51, s56, 0x18c00
s_and_b32 s51, s51, 0x1ffff
s_add_u32 s24, s14, s51
s_addc_u32 s25, s15, 0
s_add_u32 s56, s56, 0x8000
s_and_b32 s56, s56, 0x1ffff
s_add_u32 s51, s56, 3072
s_add_u32 s22, s14, s51
s_addc_u32 s23, s15, 0
s_add_u32 s51, s56, s96
s_add_u32 s20, s14, s51
s_addc_u32 s21, s15, 0
s_mov_b32 s74, 0
s_nop 7
global_load_dwordx4 v[12:15], v0, s[34:35] sc1
global_load_dwordx4 v[16:19], v0, s[34:35] offset:1024 sc1
global_load_dwordx4 v[20:23], v0, s[34:35] offset:2048 sc1
global_load_dwordx4 v[24:27], v0, s[34:35] offset:3072 sc1
s_waitcnt lgkmcnt(0)
s_waitcnt vmcnt(3)
v_mfma_f32_16x16x32_bf16 v[44:47], v[76:79], v[12:15], 0
s_waitcnt vmcnt(2)
v_mfma_f32_16x16x32_bf16 v[44:47], v[76:79], v[16:19], v[44:47]
s_waitcnt vmcnt(1)
v_mfma_f32_16x16x32_bf16 v[44:47], v[76:79], v[20:23], v[44:47]
v_min3_u32 v48, v15, v19, v23
s_waitcnt vmcnt(0)
v_mfma_f32_16x16x32_bf16 v[44:47], v[76:79], v[24:27], v[44:47]
v_min_u32 v48, v48, v27
v_cmp_ne_u32 vcc, s75, v48
s_nop 4
s_cbranch_vccnz C\sfx\()0_1_retry_u1
v_add_f32_dpp v46, v44, v44 row_ror:8 row_mask:0xf bank_mask:0xf
v_add_f32_dpp v47, v45, v45 row_ror:8 row_mask:0xf bank_mask:0xf
v_cvt_pk_bf16_f32 v44, v46, v47
global_store_dword v7, v44, s[70:71] offset:-3072 \md
C\sfx\()0_1_done_u1:
v_mov_b32 v49, s75
v_mov_b32 v50, 163328
ds_write_b32 v50, v49
v_mov_b32 v48, -1
global_store_dword v7, v48, s[72:73] offset:-3072 \md
s_waitcnt vmcnt(2)
ds_read_b128 v[44:47], v0
ds_read_b128 v[48:51], v0 offset:1024
ds_read_b128 v[52:55], v0 offset:2048
ds_read_b128 v[56:59], v0 offset:3072
v_mov_b64 v[28:29], 0
v_mov_b64 v[30:31], 0
v_mov_b64 v[32:33], 0
v_mov_b64 v[34:35], 0
v_mov_b64 v[36:37], 0
v_mov_b64 v[38:39], 0
v_mov_b64 v[40:41], 0
v_mov_b64 v[42:43], 0
s_waitcnt lgkmcnt(0)
s_sleep 1
s_nop 7
s_add_u32 s54, s68, 0xc00
s_addc_u32 s55, s69, 0
s_mov_b32 m0, 0x22000
global_load_dword v72, v6, s[70:71] sc1
global_load_lds_dwordx4 v0, s[68:69] sc1
global_load_lds_dwordx4 v0, s[68:69] offset:1024 sc1
global_load_lds_dwordx4 v0, s[68:69] offset:2048 sc1
s_nop 7
s_nop 3
global_load_dword v73, v6, s[70:71] sc1
global_load_lds_dwordx4 v0, s[68:69] sc1
global_load_lds_dwordx4 v0, s[68:69] offset:1024 sc1
global_load_lds_dwordx4 v0, s[68:69] offset:2048 sc1
s_nop 7
s_nop 3
global_load_dword v74, v6, s[70:71] sc1
global_load_lds_dwordx4 v0, s[68:69] sc1
global_load_lds_dwordx4 v0, s[68:69] offset:1024 sc1
global_load_lds_dwordx4 v0, s[68:69] offset:2048 sc1
FP\sfx\()_81:
s_waitcnt vmcnt(11)
v_cmp_u_f32 vcc, v72, v72
s_cbranch_vccz FO\sfx\()_82
global_load_dword v72, v6, s[70:71] sc1
global_load_lds_dwordx4 v0, s[68:69] sc1
global_load_lds_dwordx4 v0, s[68:69] offset:1024 sc1
global_load_lds_dwordx4 v0, s[68:69] offset:2048 sc1
s_waitcnt vmcnt(11)
v_cmp_u_f32 vcc, v73, v73
s_cbranch_vccz FO\sfx\()_82
global_load_dword v73, v6, s[70:71] sc1
global_load_lds_dwordx4 v0, s[68:69] sc1
global_load_lds_dwordx4 v0, s[68:69] offset:1024 sc1
global_load_lds_dwordx4 v0, s[68:69] offset:2048 sc1
s_waitcnt vmcnt(11)
v_cmp_u_f32 vcc, v74, v74
s_cbranch_vccz FO\sfx\()_82
global_load_dword v74, v6, s[70:71] sc1
global_load_lds_dwordx4 v0, s[68:69] sc1
global_load_lds_dwordx4 v0, s[68:69] offset:1024 sc1
global_load_lds_dwordx4 v0, s[68:69] offset:2048 sc1
s_add_u32 s77, s77, 1
s_sub_u32 s43, s43, 1
s_cbranch_scc1 EXIT2
s_branch FP\sfx\()_81
FO\sfx\()_82:
s_mov_b32 m0, 0x22c00
s_nop 0
global_load_lds_dwordx4 v0, s[54:55] sc1
global_load_lds_dwordx4 v0, s[54:55] offset:1024 sc1
global_load_lds_dwordx4 v0, s[54:55] offset:2048 sc1
s_waitcnt vmcnt(11)
s_add_u32 s75, s75, 1
s_barrier
s_branch C\sfx\()0_0_qk
C\sfx\()0_0_retry_ag:
s_waitcnt vmcnt(0) lgkmcnt(0)
s_add_u32 s76, s76, 0x10000
s_sub_u32 s43, s43, 1
s_cbranch_scc1 EXIT2
s_add_u32 s52, s70, 0x0
s_addc_u32 s53, s71, 0
s_sub_u32 s52, s52, 3072
s_subb_u32 s53, s53, 0
s_mov_b32 m0, 0x22000
s_nop 0
global_load_lds_dwordx4 v0, s[52:53] sc1
s_add_u32 s52, s70, 0x400
s_addc_u32 s53, s71, 0
s_sub_u32 s52, s52, 3072
s_subb_u32 s53, s53, 0
s_mov_b32 m0, 0x22400
s_nop 0
global_load_lds_dwordx4 v0, s[52:53] sc1
s_add_u32 s52, s70, 0x800
s_addc_u32 s53, s71, 0
s_sub_u32 s52, s52, 3072
s_subb_u32 s53, s53, 0
s_mov_b32 m0, 0x22800
s_nop 0
global_load_lds_dwordx4 v0, s[52:53] sc1
s_add_u32 s52, s70, 0xc00
s_addc_u32 s53, s71, 0
s_sub_u32 s52, s52, 3072
s_subb_u32 s53, s53, 0
s_mov_b32 m0, 0x22c00
s_nop 0
global_load_lds_dwordx4 v0, s[52:53] sc1
s_add_u32 s52, s70, 0x1000
s_addc_u32 s53, s71, 0
s_sub_u32 s52, s52, 3072
s_subb_u32 s53, s53, 0
s_mov_b32 m0, 0x23000
s_nop 0
global_load_lds_dwordx4 v0, s[52:53] sc1
s_add_u32 s52, s70, 0x1400
s_addc_u32 s53, s71, 0
s_sub_u32 s52, s52, 3072
s_subb_u32 s53, s53, 0
s_mov_b32 m0, 0x23400
s_nop 0
global_load_lds_dwordx4 v0, s[52:53] sc1
s_add_u32 s52, s70, 0x1800
s_addc_u32 s53, s71, 0
s_sub_u32 s52, s52, 3072
s_subb_u32 s53, s53, 0
s_mov_b32 m0, 0x23800
s_nop 0
global_load_lds_dwordx4 v0, s[52:53] sc1
s_add_u32 s52, s70, 0x1c00
s_addc_u32 s53, s71, 0
s_sub_u32 s52, s52, 3072
s_subb_u32 s53, s53, 0
s_mov_b32 m0, 0x23c00
s_nop 0
global_load_lds_dwordx4 v0, s[52:53] sc1
s_add_u32 s52, s70, 0x2000
s_addc_u32 s53, s71, 0
s_sub_u32 s52, s52, 3072
s_subb_u32 s53, s53, 0
s_mov_b32 m0, 0x27800
s_nop 0
global_load_lds_dwordx4 v0, s[52:53] sc1
ds_read_b128 v[44:47], v0
ds_read_b128 v[48:51], v0 offset:1024
ds_read_b128 v[52:55], v0 offset:2048
ds_read_b128 v[56:59], v0 offset:3072
v_mov_b64 v[28:29], 0
v_mov_b64 v[30:31], 0
v_mov_b64 v[32:33], 0
v_mov_b64 v[34:35], 0
v_mov_b64 v[36:37], 0
v_mov_b64 v[38:39], 0
v_mov_b64 v[40:41], 0
v_mov_b64 v[42:43], 0
s_waitcnt vmcnt(0)
ds_read_b128 v[12:15], v4 offset:8192
ds_read_b128 v[16:19], v4 offset:9216
ds_read_b128 v[20:23], v4 offset:10240
s_add_u32 s52, s36, 0x2000
s_addc_u32 s53, s37, 0
s_waitcnt lgkmcnt(2)
v_smfmac_f32_16x16x64_bf16 v[28:31], v[12:15], v[80:87], v1
ds_read_b128 v[24:27], v4 offset:11264
v_smfmac_f32_16x16x64_bf16 v[32:35], v[12:15], v[88:95], v1
v_smfmac_f32_16x16x64_bf16 v[36:39], v[12:15], v[44:51], v1
ds_read_b128 v[44:47], v0 offset:16384
v_smfmac_f32_16x16x64_bf16 v[40:43], v[12:15], v[52:59], v1
ds_read_b128 v[48:51], v0 offset:17408
s_waitcnt lgkmcnt(4)
v_smfmac_f32_16x16x64_bf16 v[28:31], v[16:19], v[96:103], v1
ds_read_b128 v[52:55], v0 offset:18432
v_smfmac_f32_16x16x64_bf16 v[32:35], v[16:19], v[104:111], v1
ds_read_b128 v[56:59], v0 offset:19456
v_smfmac_f32_16x16x64_bf16 v[36:39], v[16:19], v[224:231], v1
ds_read_b128 v[12:15], v4 offset:12288
v_smfmac_f32_16x16x64_bf16 v[40:43], v[16:19], v[232:239], v1
s_waitcnt lgkmcnt(6)
v_smfmac_f32_16x16x64_bf16 v[28:31], v[20:23], v[112:119], v1
ds_read_b128 v[16:19], v4 offset:13312
v_smfmac_f32_16x16x64_bf16 v[32:35], v[20:23], v[120:127], v1
s_waitcnt lgkmcnt(4)
v_smfmac_f32_16x16x64_bf16 v[36:39], v[20:23], v[44:51], v1
ds_read_b128 v[44:47], v0 offset:32768
s_waitcnt lgkmcnt(3)
v_smfmac_f32_16x16x64_bf16 v[40:43], v[20:23], v[52:59], v1
ds_read_b128 v[48:51], v0 offset:33792
v_smfmac_f32_16x16x64_bf16 v[28:31], v[24:27], v[128:135], v1
ds_read_b128 v[52:55], v0 offset:34816
v_smfmac_f32_16x16x64_bf16 v[32:35], v[24:27], v[136:143], v1
ds_read_b128 v[56:59], v0 offset:35840
v_smfmac_f32_16x16x64_bf16 v[36:39], v[24:27], v[240:247], v1
ds_read_b128 v[20:23], v4 offset:14336
v_smfmac_f32_16x16x64_bf16 v[40:43], v[24:27], v[248:255], v1
s_waitcnt lgkmcnt(6)
v_smfmac_f32_16x16x64_bf16 v[28:31], v[12:15], v[144:151], v1
ds_read_b128 v[24:27], v4 offset:15360
v_smfmac_f32_16x16x64_bf16 v[32:35], v[12:15], v[152:159], v1
s_waitcnt lgkmcnt(4)
v_smfmac_f32_16x16x64_bf16 v[36:39], v[12:15], v[44:51], v1
ds_read_b128 v[44:47], v0 offset:49152
s_waitcnt lgkmcnt(3)
v_smfmac_f32_16x16x64_bf16 v[40:43], v[12:15], v[52:59], v1
ds_read_b128 v[48:51], v0 offset:50176
v_smfmac_f32_16x16x64_bf16 v[28:31], v[16:19], v[160:167], v1
ds_read_b128 v[52:55], v0 offset:51200
v_smfmac_f32_16x16x64_bf16 v[32:35], v[16:19], v[168:175], v1
ds_read_b128 v[56:59], v0 offset:52224
v_smfmac_f32_16x16x64_bf16 v[36:39], v[16:19], a[0:7], v1
ds_read_b128 v[12:15], v4 offset:30720
v_smfmac_f32_16x16x64_bf16 v[40:43], v[16:19], a[8:15], v1
s_waitcnt lgkmcnt(6)
v_smfmac_f32_16x16x64_bf16 v[28:31], v[20:23], v[176:183], v1
s_waitcnt lgkmcnt(3)
v_smfmac_f32_16x16x64_bf16 v[36:39], v[20:23], v[44:51], v1
ds_read_b128 v[44:47], v9
v_smfmac_f32_16x16x64_bf16 v[32:35], v[20:23], v[184:191], v1
ds_read_b128 v[48:51], v9 offset:1024
s_waitcnt lgkmcnt(3)
v_smfmac_f32_16x16x64_bf16 v[40:43], v[20:23], v[52:59], v1
ds_read_b128 v[52:55], v9 offset:2048
v_smfmac_f32_16x16x64_bf16 v[28:31], v[24:27], v[192:199], v1
ds_read_b128 v[56:59], v9 offset:3072
v_smfmac_f32_16x16x64_bf16 v[36:39], v[24:27], a[16:23], v1
s_waitcnt lgkmcnt(4)
v_smfmac_f32_16x16x64_bf16 v[28:31], v[12:15], v[208:215], v1
s_waitcnt lgkmcnt(2)
v_smfmac_f32_16x16x64_bf16 v[36:39], v[12:15], v[44:51], v1
v_smfmac_f32_16x16x64_bf16 v[32:35], v[24:27], v[200:207], v1
v_mov_b64 v[44:45], 0
v_smfmac_f32_16x16x64_bf16 v[40:43], v[24:27], a[24:31], v1
v_mov_b64 v[48:49], 0
s_nop 1
v_add_f32 v28, v28, v30
v_smfmac_f32_16x16x64_bf16 v[32:35], v[12:15], v[216:223], v1
v_add_f32 v29, v29, v31
v_cvt_pk_bf16_f32 v77, v28, v29
v_add_f32 v36, v36, v38
s_waitcnt lgkmcnt(0)
v_smfmac_f32_16x16x64_bf16 v[40:43], v[12:15], v[52:59], v1
v_add_f32 v37, v37, v39
v_cvt_pk_bf16_f32 v76, v36, v37
ds_write_b64 v2, v[76:77]
v_mov_b64 v[46:47], 0
v_mov_b64 v[50:51], 0
s_nop 1
s_branch C\sfx\()0_0_postqk
C\sfx\()0_0_retry0:
s_add_u32 s76, s76, 1
s_waitcnt lgkmcnt(0)
s_nop 3
v_mov_b64 v[28:29], 0
v_mov_b64 v[30:31], 0
v_mov_b64 v[32:33], 0
v_mov_b64 v[34:35], 0
C\sfx\()0_0_retry0_p:
s_mov_b32 m0, 0x22000
s_nop 0
global_load_lds_dwordx4 v0, s[68:69] sc1
global_load_lds_dwordx4 v0, s[68:69] offset:1024 sc1
global_load_lds_dwordx4 v0, s[68:69] offset:2048 sc1
s_waitcnt vmcnt(3)
ds_read_b128 v[12:15], v4 offset:8192
ds_read_b128 v[16:19], v4 offset:9216
ds_read_b128 v[20:23], v4 offset:10240
s_sub_u32 s43, s43, 1
s_cbranch_scc1 EXIT2
s_waitcnt lgkmcnt(0)
v_add_f32 v10, v12, v16
v_cmp_u_f32 vcc, v10, v20
s_cbranch_vccnz C\sfx\()0_0_retry0_p
s_branch C\sfx\()0_0_back0
C\sfx\()0_0_retry1:
s_add_u32 s76, s76, 1
C\sfx\()0_0_retry1_p:
ds_read_b128 v[24:27], v4 offset:11264
ds_read_b128 v[12:15], v4 offset:12288
s_sub_u32 s43, s43, 1
s_cbranch_scc1 EXIT2
s_waitcnt lgkmcnt(0)
v_cmp_u_f32 vcc, v24, v12
s_cbranch_vccnz C\sfx\()0_0_retry1_p
s_branch C\sfx\()0_0_back1
C\sfx\()0_0_retry1b:
s_add_u32 s76, s76, 1
C\sfx\()0_0_retry1b_p:
ds_read_b128 v[16:19], v4 offset:13312
s_sub_u32 s43, s43, 1
s_cbranch_scc1 EXIT2
s_waitcnt lgkmcnt(0)
v_cmp_u_f32 vcc, v16, v16
s_cbranch_vccnz C\sfx\()0_0_retry1b_p
s_branch C\sfx\()0_0_back1b
C\sfx\()0_0_retry2:
s_add_u32 s76, s76, 1
C\sfx\()0_0_retry2_p:
ds_read_b128 v[20:23], v4 offset:14336
ds_read_b128 v[24:27], v4 offset:15360
s_sub_u32 s43, s43, 1
s_cbranch_scc1 EXIT2
s_waitcnt lgkmcnt(0)
v_cmp_u_f32 vcc, v20, v24
s_cbranch_vccnz C\sfx\()0_0_retry2_p
s_branch C\sfx\()0_0_back2
C\sfx\()0_0_retry2b:
s_add_u32 s76, s76, 1
C\sfx\()0_0_retry2b_p:
ds_read_b128 v[12:15], v4 offset:30720
s_sub_u32 s43, s43, 1
s_cbranch_scc1 EXIT2
s_waitcnt lgkmcnt(0)
v_cmp_u_f32 vcc, v12, v12
s_cbranch_vccnz C\sfx\()0_0_retry2b_p
s_branch C\sfx\()0_0_back2b
C\sfx\()0_0_retry_u1:
s_add_u32 s77, s77, 1
s_mov_b32 s74, 1
global_load_dwordx4 v[12:15], v0, s[32:33] sc1
global_load_dwordx4 v[16:19], v0, s[32:33] offset:1024 sc1
global_load_dwordx4 v[20:23], v0, s[32:33] offset:2048 sc1
global_load_dwordx4 v[24:27], v0, s[32:33] offset:3072 sc1
s_sleep 2
global_load_dwordx4 v[28:31], v0, s[32:33] sc1
global_load_dwordx4 v[32:35], v0, s[32:33] offset:1024 sc1
global_load_dwordx4 v[36:39], v0, s[32:33] offset:2048 sc1
global_load_dwordx4 v[40:43], v0, s[32:33] offset:3072 sc1
C\sfx\()0_0_retry_u1_l:
s_waitcnt vmcnt(7)
v_mfma_f32_16x16x32_bf16 v[44:47], v[76:79], v[12:15], 0
s_waitcnt vmcnt(6)
v_mfma_f32_16x16x32_bf16 v[44:47], v[76:79], v[16:19], v[44:47]
s_waitcnt vmcnt(5)
v_mfma_f32_16x16x32_bf16 v[44:47], v[76:79], v[20:23], v[44:47]
v_min3_u32 v48, v15, v19, v23
s_waitcnt vmcnt(4)
v_mfma_f32_16x16x32_bf16 v[44:47], v[76:79], v[24:27], v[44:47]
v_min_u32 v48, v48, v27
v_cmp_ne_u32 vcc, s75, v48
s_nop 4
s_cbranch_vccnz C\sfx\()0_0_retry_u1_m0
v_add_f32_dpp v46, v44, v44 row_ror:8 row_mask:0xf bank_mask:0xf
v_add_f32_dpp v47, v45, v45 row_ror:8 row_mask:0xf bank_mask:0xf
v_cvt_pk_bf16_f32 v44, v46, v47
global_store_dword v7, v44, s[22:23] offset:-3072 \md
s_branch C\sfx\()0_0_done_u1
C\sfx\()0_0_retry_u1_m0:
global_load_dwordx4 v[12:15], v0, s[32:33] sc1
global_load_dwordx4 v[16:19], v0, s[32:33] offset:1024 sc1
global_load_dwordx4 v[20:23], v0, s[32:33] offset:2048 sc1
global_load_dwordx4 v[24:27], v0, s[32:33] offset:3072 sc1
s_sub_u32 s43, s43, 1
s_cbranch_scc1 EXIT2
s_waitcnt vmcnt(7)
v_mfma_f32_16x16x32_bf16 v[44:47], v[76:79], v[28:31], 0
s_waitcnt vmcnt(6)
v_mfma_f32_16x16x32_bf16 v[44:47], v[76:79], v[32:35], v[44:47]
s_waitcnt vmcnt(5)
v_mfma_f32_16x16x32_bf16 v[44:47], v[76:79], v[36:39], v[44:47]
v_min3_u32 v48, v31, v35, v39
s_waitcnt vmcnt(4)
v_mfma_f32_16x16x32_bf16 v[44:47], v[76:79], v[40:43], v[44:47]
v_min_u32 v48, v48, v43
v_cmp_ne_u32 vcc, s75, v48
s_nop 4
s_cbranch_vccnz C\sfx\()0_0_retry_u1_m1
v_add_f32_dpp v46, v44, v44 row_ror:8 row_mask:0xf bank_mask:0xf
v_add_f32_dpp v47, v45, v45 row_ror:8 row_mask:0xf bank_mask:0xf
v_cvt_pk_bf16_f32 v44, v46, v47
global_store_dword v7, v44, s[22:23] offset:-3072 \md
s_branch C\sfx\()0_0_done_u1
C\sfx\()0_0_retry_u1_m1:
global_load_dwordx4 v[28:31], v0, s[32:33] sc1
global_load_dwordx4 v[32:35], v0, s[32:33] offset:1024 sc1
global_load_dwordx4 v[36:39], v0, s[32:33] offset:2048 sc1
global_load_dwordx4 v[40:43], v0, s[32:33] offset:3072 sc1
s_sub_u32 s43, s43, 1
s_cbranch_scc1 EXIT2
s_branch C\sfx\()0_0_retry_u1_l
C\sfx\()0_0_slow:
s_waitcnt lgkmcnt(0)
s_nop 7
ds_read_b64_tr_b16 v[24:25], v3
ds_read_b64_tr_b16 v[26:27], v3 offset:512
ds_read_b128 v[28:31], v4
ds_read_b128 v[32:35], v4 offset:4096
s_waitcnt lgkmcnt(0)
v_mfma_f32_16x16x32_bf16 v[12:15], v[28:31], v[24:27], 0
v_mfma_f32_16x16x32_bf16 v[16:19], v[32:35], v[24:27], 0
v_mfma_f32_16x16x32_bf16 v[20:23], v[24:27], v[24:27], 0
s_nop 7
ds_read_b64_tr_b16 v[24:25], v3 offset:1024
ds_read_b64_tr_b16 v[26:27], v3 offset:1536
ds_read_b128 v[28:31], v4 offset:1024
ds_read_b128 v[32:35], v4 offset:5120
s_waitcnt lgkmcnt(0)
v_mfma_f32_16x16x32_bf16 v[12:15], v[28:31], v[24:27], v[12:15]
v_mfma_f32_16x16x32_bf16 v[16:19], v[32:35], v[24:27], v[16:19]
v_mfma_f32_16x16x32_bf16 v[20:23], v[24:27], v[24:27], v[20:23]
s_nop 7
ds_read_b64_tr_b16 v[24:25], v3 offset:2048
ds_read_b64_tr_b16 v[26:27], v3 offset:2560
ds_read_b128 v[28:31], v4 offset:2048
ds_read_b128 v[32:35], v4 offset:6144
s_waitcnt lgkmcnt(0)
v_mfma_f32_16x16x32_bf16 v[12:15], v[28:31], v[24:27], v[12:15]
v_mfma_f32_16x16x32_bf16 v[16:19], v[32:35], v[24:27], v[16:19]
v_mfma_f32_16x16x32_bf16 v[20:23], v[24:27], v[24:27], v[20:23]
s_nop 7
ds_read_b64_tr_b16 v[24:25], v3 offset:3072
ds_read_b64_tr_b16 v[26:27], v3 offset:3584
ds_read_b128 v[28:31], v4 offset:3072
ds_read_b128 v[32:35], v4 offset:7168
s_waitcnt lgkmcnt(0)
v_mfma_f32_16x16x32_bf16 v[12:15], v[28:31], v[24:27], v[12:15]
v_mfma_f32_16x16x32_bf16 v[16:19], v[32:35], v[24:27], v[16:19]
v_mfma_f32_16x16x32_bf16 v[20:23], v[24:27], v[24:27], v[20:23]
s_nop 7
v_mul_f32 v20, s44, v20
v_mul_f32 v21, s44, v21
v_max3_f32 v22, v20, v21, v12
v_max3_f32 v22, v22, v13, v14
v_max3_f32 v22, v22, v15, v16
v_max3_f32 v22, v22, v17, v18
v_max_f32 v22, v22, v19
v_mov_b32 v23, v22
s_nop 1
v_permlane16_swap_b32 v22, v23
s_nop 1
v_max_f32 v22, v22, v23
v_mov_b32 v23, v22
s_nop 1
v_permlane32_swap_b32 v22, v23
s_nop 1
v_max_f32 v22, v22, v23
v_sub_f32 v12, v12, v22
v_exp_f32 v12, v12
v_sub_f32 v13, v13, v22
v_exp_f32 v13, v13
v_sub_f32 v14, v14, v22
v_exp_f32 v14, v14
v_sub_f32 v15, v15, v22
v_exp_f32 v15, v15
v_sub_f32 v16, v16, v22
v_exp_f32 v16, v16
v_sub_f32 v17, v17, v22
v_exp_f32 v17, v17
v_sub_f32 v18, v18, v22
v_exp_f32 v18, v18
v_sub_f32 v19, v19, v22
v_exp_f32 v19, v19
v_sub_f32 v20, v20, v22
v_exp_f32 v20, v20
v_sub_f32 v21, v21, v22
v_exp_f32 v21, v21
v_cvt_pk_bf16_f32 v76, v12, v13
v_cvt_pk_bf16_f32 v77, v14, v15
v_cvt_pk_bf16_f32 v78, v16, v17
v_cvt_pk_bf16_f32 v79, v18, v19
v_cvt_pk_bf16_f32 v10, v20, v21
ds_read_b128 v[28:31], v4 offset:16384
ds_read_b128 v[32:35], v4 offset:17408
s_waitcnt lgkmcnt(0)
v_mfma_f32_16x16x32_bf16 v[60:63], v[76:79], v[28:31], 0
v_mfma_f32_16x16x32_bf16 v[64:67], v[76:79], v[32:35], 0
v_mfma_f32_16x16x32_bf16 v[40:43], v[76:79], v[36:39], 0
s_nop 5
v_mfma_f32_16x16x16_bf16 v[40:43], v[10:11], v[36:37], v[40:43]
v_mfma_f32_16x16x16_bf16 v[60:63], v[10:11], v[52:53], v[60:63]
v_mfma_f32_16x16x16_bf16 v[64:67], v[10:11], v[56:57], v[64:67]
s_nop 5
v_rcp_f32 v70, v42
v_rcp_f32 v71, v43
v_mul_f32 v62, v62, v70
v_mul_f32 v63, v63, v71
v_cvt_pk_bf16_f32 v68, v62, v63
ds_write_b32 v2, v68 offset:4096
v_mul_f32 v66, v66, v70
v_mul_f32 v67, v67, v71
v_cvt_pk_bf16_f32 v69, v66, v67
ds_write_b32 v2, v69 offset:4608
s_waitcnt lgkmcnt(0)
v_mov_b64 v[12:13], 0
v_mov_b64 v[14:15], 0
v_mov_b64 v[16:17], 0
v_mov_b64 v[18:19], 0
v_mov_b64 v[20:21], 0
v_mov_b64 v[22:23], 0
s_nop 3
s_branch C\sfx\()0_0_oskip
C\sfx\()0_1_retry_ag:
s_waitcnt vmcnt(0) lgkmcnt(0)
s_add_u32 s76, s76, 0x10000
s_sub_u32 s43, s43, 1
s_cbranch_scc1 EXIT2
s_add_u32 s52, s22, 0x0
s_addc_u32 s53, s23, 0
s_sub_u32 s52, s52, 3072
s_subb_u32 s53, s53, 0
s_mov_b32 m0, 0x20000
s_nop 0
global_load_lds_dwordx4 v0, s[52:53] sc1
s_add_u32 s52, s22, 0x400
s_addc_u32 s53, s23, 0
s_sub_u32 s52, s52, 3072
s_subb_u32 s53, s53, 0
s_mov_b32 m0, 0x20400
s_nop 0
global_load_lds_dwordx4 v0, s[52:53] sc1
s_add_u32 s52, s22, 0x800
s_addc_u32 s53, s23, 0
s_sub_u32 s52, s52, 3072
s_subb_u32 s53, s53, 0
s_mov_b32 m0, 0x20800
s_nop 0
global_load_lds_dwordx4 v0, s[52:53] sc1
s_add_u32 s52, s22, 0xc00
s_addc_u32 s53, s23, 0
s_sub_u32 s52, s52, 3072
s_subb_u32 s53, s53, 0
s_mov_b32 m0, 0x20c00
s_nop 0
global_load_lds_dwordx4 v0, s[52:53] sc1
s_add_u32 s52, s22, 0x1000
s_addc_u32 s53, s23, 0
s_sub_u32 s52, s52, 3072
s_subb_u32 s53, s53, 0
s_mov_b32 m0, 0x21000
s_nop 0
global_load_lds_dwordx4 v0, s[52:53] sc1
s_add_u32 s52, s22, 0x1400
s_addc_u32 s53, s23, 0
s_sub_u32 s52, s52, 3072
s_subb_u32 s53, s53, 0
s_mov_b32 m0, 0x21400
s_nop 0
global_load_lds_dwordx4 v0, s[52:53] sc1
s_add_u32 s52, s22, 0x1800
s_addc_u32 s53, s23, 0
s_sub_u32 s52, s52, 3072
s_subb_u32 s53, s53, 0
s_mov_b32 m0, 0x21800
s_nop 0
global_load_lds_dwordx4 v0, s[52:53] sc1
s_add_u32 s52, s22, 0x1c00
s_addc_u32 s53, s23, 0
s_sub_u32 s52, s52, 3072
s_subb_u32 s53, s53, 0
s_mov_b32 m0, 0x21c00
s_nop 0
global_load_lds_dwordx4 v0, s[52:53] sc1
s_add_u32 s52, s22, 0x2000
s_addc_u32 s53, s23, 0
s_sub_u32 s52, s52, 3072
s_subb_u32 s53, s53, 0
s_mov_b32 m0, 0x27800
s_nop 0
global_load_lds_dwordx4 v0, s[52:53] sc1
ds_read_b128 v[44:47], v0
ds_read_b128 v[48:51], v0 offset:1024
ds_read_b128 v[52:55], v0 offset:2048
ds_read_b128 v[56:59], v0 offset:3072
v_mov_b64 v[28:29], 0
v_mov_b64 v[30:31], 0
v_mov_b64 v[32:33], 0
v_mov_b64 v[34:35], 0
v_mov_b64 v[36:37], 0
v_mov_b64 v[38:39], 0
v_mov_b64 v[40:41], 0
v_mov_b64 v[42:43], 0
s_waitcnt vmcnt(0)
ds_read_b128 v[12:15], v4
ds_read_b128 v[16:19], v4 offset:1024
ds_read_b128 v[20:23], v4 offset:2048
s_add_u32 s52, s36, 0x2000
s_addc_u32 s53, s37, 0
s_waitcnt lgkmcnt(2)
v_smfmac_f32_16x16x64_bf16 v[28:31], v[12:15], v[80:87], v1
ds_read_b128 v[24:27], v4 offset:3072
v_smfmac_f32_16x16x64_bf16 v[32:35], v[12:15], v[88:95], v1
v_smfmac_f32_16x16x64_bf16 v[36:39], v[12:15], v[44:51], v1
ds_read_b128 v[44:47], v0 offset:16384
v_smfmac_f32_16x16x64_bf16 v[40:43], v[12:15], v[52:59], v1
ds_read_b128 v[48:51], v0 offset:17408
s_waitcnt lgkmcnt(4)
v_smfmac_f32_16x16x64_bf16 v[28:31], v[16:19], v[96:103], v1
ds_read_b128 v[52:55], v0 offset:18432
v_smfmac_f32_16x16x64_bf16 v[32:35], v[16:19], v[104:111], v1
ds_read_b128 v[56:59], v0 offset:19456
v_smfmac_f32_16x16x64_bf16 v[36:39], v[16:19], v[224:231], v1
ds_read_b128 v[12:15], v4 offset:4096
v_smfmac_f32_16x16x64_bf16 v[40:43], v[16:19], v[232:239], v1
s_waitcnt lgkmcnt(6)
v_smfmac_f32_16x16x64_bf16 v[28:31], v[20:23], v[112:119], v1
ds_read_b128 v[16:19], v4 offset:5120
v_smfmac_f32_16x16x64_bf16 v[32:35], v[20:23], v[120:127], v1
s_waitcnt lgkmcnt(4)
v_smfmac_f32_16x16x64_bf16 v[36:39], v[20:23], v[44:51], v1
ds_read_b128 v[44:47], v0 offset:32768
s_waitcnt lgkmcnt(3)
v_smfmac_f32_16x16x64_bf16 v[40:43], v[20:23], v[52:59], v1
ds_read_b128 v[48:51], v0 offset:33792
v_smfmac_f32_16x16x64_bf16 v[28:31], v[24:27], v[128:135], v1
ds_read_b128 v[52:55], v0 offset:34816
v_smfmac_f32_16x16x64_bf16 v[32:35], v[24:27], v[136:143], v1
ds_read_b128 v[56:59], v0 offset:35840
v_smfmac_f32_16x16x64_bf16 v[36:39], v[24:27], v[240:247], v1
ds_read_b128 v[20:23], v4 offset:6144
v_smfmac_f32_16x16x64_bf16 v[40:43], v[24:27], v[248:255], v1
s_waitcnt lgkmcnt(6)
v_smfmac_f32_16x16x64_bf16 v[28:31], v[12:15], v[144:151], v1
ds_read_b128 v[24:27], v4 offset:7168
v_smfmac_f32_16x16x64_bf16 v[32:35], v[12:15], v[152:159], v1
s_waitcnt lgkmcnt(4)
v_smfmac_f32_16x16x64_bf16 v[36:39], v[12:15], v[44:51], v1
ds_read_b128 v[44:47], v0 offset:49152
s_waitcnt lgkmcnt(3)
v_smfmac_f32_16x16x64_bf16 v[40:43], v[12:15], v[52:59], v1
ds_read_b128 v[48:51], v0 offset:50176
v_smfmac_f32_16x16x64_bf16 v[28:31], v[16:19], v[160:167], v1
ds_read_b128 v[52:55], v0 offset:51200
v_smfmac_f32_16x16x64_bf16 v[32:35], v[16:19], v[168:175], v1
ds_read_b128 v[56:59], v0 offset:52224
v_smfmac_f32_16x16x64_bf16 v[36:39], v[16:19], a[0:7], v1
ds_read_b128 v[12:15], v4 offset:30720
v_smfmac_f32_16x16x64_bf16 v[40:43], v[16:19], a[8:15], v1
s_waitcnt lgkmcnt(6)
v_smfmac_f32_16x16x64_bf16 v[28:31], v[20:23], v[176:183], v1
s_waitcnt lgkmcnt(3)
v_smfmac_f32_16x16x64_bf16 v[36:39], v[20:23], v[44:51], v1
ds_read_b128 v[44:47], v9
v_smfmac_f32_16x16x64_bf16 v[32:35], v[20:23], v[184:191], v1
ds_read_b128 v[48:51], v9 offset:1024
s_waitcnt lgkmcnt(3)
v_smfmac_f32_16x16x64_bf16 v[40:43], v[20:23], v[52:59], v1
ds_read_b128 v[52:55], v9 offset:2048
v_smfmac_f32_16x16x64_bf16 v[28:31], v[24:27], v[192:199], v1
ds_read_b128 v[56:59], v9 offset:3072
v_smfmac_f32_16x16x64_bf16 v[36:39], v[24:27], a[16:23], v1
s_waitcnt lgkmcnt(4)
v_smfmac_f32_16x16x64_bf16 v[28:31], v[12:15], v[208:215], v1
s_waitcnt lgkmcnt(2)
v_smfmac_f32_16x16x64_bf16 v[36:39], v[12:15], v[44:51], v1
v_smfmac_f32_16x16x64_bf16 v[32:35], v[24:27], v[200:207], v1
v_mov_b64 v[44:45], 0
v_smfmac_f32_16x16x64_bf16 v[40:43], v[24:27], a[24:31], v1
v_mov_b64 v[48:49], 0
s_nop 1
v_add_f32 v28, v28, v30
v_smfmac_f32_16x16x64_bf16 v[32:35], v[12:15], v[216:223], v1
v_add_f32 v29, v29, v31
v_cvt_pk_bf16_f32 v77, v28, v29
v_add_f32 v36, v36, v38
s_waitcnt lgkmcnt(0)
v_smfmac_f32_16x16x64_bf16 v[40:43], v[12:15], v[52:59], v1
v_add_f32 v37, v37, v39
v_cvt_pk_bf16_f32 v76, v36, v37
ds_write_b64 v2, v[76:77]
v_mov_b64 v[46:47], 0
v_mov_b64 v[50:51], 0
s_nop 1
s_branch C\sfx\()0_1_postqk
C\sfx\()0_1_retry0:
s_add_u32 s76, s76, 1
s_waitcnt lgkmcnt(0)
s_nop 3
v_mov_b64 v[28:29], 0
v_mov_b64 v[30:31], 0
v_mov_b64 v[32:33], 0
v_mov_b64 v[34:35], 0
C\sfx\()0_1_retry0_p:
s_mov_b32 m0, 0x20000
s_nop 0
global_load_lds_dwordx4 v0, s[20:21] sc1
global_load_lds_dwordx4 v0, s[20:21] offset:1024 sc1
global_load_lds_dwordx4 v0, s[20:21] offset:2048 sc1
s_waitcnt vmcnt(3)
ds_read_b128 v[12:15], v4
ds_read_b128 v[16:19], v4 offset:1024
ds_read_b128 v[20:23], v4 offset:2048
s_sub_u32 s43, s43, 1
s_cbranch_scc1 EXIT2
s_waitcnt lgkmcnt(0)
v_add_f32 v10, v12, v16
v_cmp_u_f32 vcc, v10, v20
s_cbranch_vccnz C\sfx\()0_1_retry0_p
s_branch C\sfx\()0_1_back0
C\sfx\()0_1_retry1:
s_add_u32 s76, s76, 1
C\sfx\()0_1_retry1_p:
ds_read_b128 v[24:27], v4 offset:3072
ds_read_b128 v[12:15], v4 offset:4096
s_sub_u32 s43, s43, 1
s_cbranch_scc1 EXIT2
s_waitcnt lgkmcnt(0)
v_cmp_u_f32 vcc, v24, v12
s_cbranch_vccnz C\sfx\()0_1_retry1_p
s_branch C\sfx\()0_1_back1
C\sfx\()0_1_retry1b:
s_add_u32 s76, s76, 1
C\sfx\()0_1_retry1b_p:
ds_read_b128 v[16:19], v4 offset:5120
s_sub_u32 s43, s43, 1
s_cbranch_scc1 EXIT2
s_waitcnt lgkmcnt(0)
v_cmp_u_f32 vcc, v16, v16
s_cbranch_vccnz C\sfx\()0_1_retry1b_p
s_branch C\sfx\()0_1_back1b
C\sfx\()0_1_retry2:
s_add_u32 s76, s76, 1
C\sfx\()0_1_retry2_p:
ds_read_b128 v[20:23], v4 offset:6144
ds_read_b128 v[24:27], v4 offset:7168
s_sub_u32 s43, s43, 1
s_cbranch_scc1 EXIT2
s_waitcnt lgkmcnt(0)
v_cmp_u_f32 vcc, v20, v24
s_cbranch_vccnz C\sfx\()0_1_retry2_p
s_branch C\sfx\()0_1_back2
C\sfx\()0_1_retry2b:
s_add_u32 s76, s76, 1
C\sfx\()0_1_retry2b_p:
ds_read_b128 v[12:15], v4 offset:30720
s_sub_u32 s43, s43, 1
s_cbranch_scc1 EXIT2
s_waitcnt lgkmcnt(0)
v_cmp_u_f32 vcc, v12, v12
s_cbranch_vccnz C\sfx\()0_1_retry2b_p
s_branch C\sfx\()0_1_back2b
C\sfx\()0_1_retry_u1:
s_add_u32 s77, s77, 1
s_mov_b32 s74, 1
global_load_dwordx4 v[12:15], v0, s[34:35] sc1
global_load_dwordx4 v[16:19], v0, s[34:35] offset:1024 sc1
global_load_dwordx4 v[20:23], v0, s[34:35] offset:2048 sc1
global_load_dwordx4 v[24:27], v0, s[34:35] offset:3072 sc1
s_sleep 2
global_load_dwordx4 v[28:31], v0, s[34:35] sc1
global_load_dwordx4 v[32:35], v0, s[34:35] offset:1024 sc1
global_load_dwordx4 v[36:39], v0, s[34:35] offset:2048 sc1
global_load_dwordx4 v[40:43], v0, s[34:35] offset:3072 sc1
C\sfx\()0_1_retry_u1_l:
s_waitcnt vmcnt(7)
v_mfma_f32_16x16x32_bf16 v[44:47], v[76:79], v[12:15], 0
s_waitcnt vmcnt(6)
v_mfma_f32_16x16x32_bf16 v[44:47], v[76:79], v[16:19], v[44:47]
s_waitcnt vmcnt(5)
v_mfma_f32_16x16x32_bf16 v[44:47], v[76:79], v[20:23], v[44:47]
v_min3_u32 v48, v15, v19, v23
s_waitcnt vmcnt(4)
v_mfma_f32_16x16x32_bf16 v[44:47], v[76:79], v[24:27], v[44:47]
v_min_u32 v48, v48, v27
v_cmp_ne_u32 vcc, s75, v48
s_nop 4
s_cbranch_vccnz C\sfx\()0_1_retry_u1_m0
v_add_f32_dpp v46, v44, v44 row_ror:8 row_mask:0xf bank_mask:0xf
v_add_f32_dpp v47, v45, v45 row_ror:8 row_mask:0xf bank_mask:0xf
v_cvt_pk_bf16_f32 v44, v46, v47
global_store_dword v7, v44, s[70:71] offset:-3072 \md
s_branch C\sfx\()0_1_done_u1
C\sfx\()0_1_retry_u1_m0:
global_load_dwordx4 v[12:15], v0, s[34:35] sc1
global_load_dwordx4 v[16:19], v0, s[34:35] offset:1024 sc1
global_load_dwordx4 v[20:23], v0, s[34:35] offset:2048 sc1
global_load_dwordx4 v[24:27], v0, s[34:35] offset:3072 sc1
s_sub_u32 s43, s43, 1
s_cbranch_scc1 EXIT2
s_waitcnt vmcnt(7)
v_mfma_f32_16x16x32_bf16 v[44:47], v[76:79], v[28:31], 0
s_waitcnt vmcnt(6)
v_mfma_f32_16x16x32_bf16 v[44:47], v[76:79], v[32:35], v[44:47]
s_waitcnt vmcnt(5)
v_mfma_f32_16x16x32_bf16 v[44:47], v[76:79], v[36:39], v[44:47]
v_min3_u32 v48, v31, v35, v39
s_waitcnt vmcnt(4)
v_mfma_f32_16x16x32_bf16 v[44:47], v[76:79], v[40:43], v[44:47]
v_min_u32 v48, v48, v43
v_cmp_ne_u32 vcc, s75, v48
s_nop 4
s_cbranch_vccnz C\sfx\()0_1_retry_u1_m1
v_add_f32_dpp v46, v44, v44 row_ror:8 row_mask:0xf bank_mask:0xf
v_add_f32_dpp v47, v45, v45 row_ror:8 row_mask:0xf bank_mask:0xf
v_cvt_pk_bf16_f32 v44, v46, v47
global_store_dword v7, v44, s[70:71] offset:-3072 \md
s_branch C\sfx\()0_1_done_u1
C\sfx\()0_1_retry_u1_m1:
global_load_dwordx4 v[28:31], v0, s[34:35] sc1
global_load_dwordx4 v[32:35], v0, s[34:35] offset:1024 sc1
global_load_dwordx4 v[36:39], v0, s[34:35] offset:2048 sc1
global_load_dwordx4 v[40:43], v0, s[34:35] offset:3072 sc1
s_sub_u32 s43, s43, 1
s_cbranch_scc1 EXIT2
s_branch C\sfx\()0_1_retry_u1_l
C\sfx\()0_1_slow:
s_waitcnt lgkmcnt(0)
s_nop 7
ds_read_b64_tr_b16 v[24:25], v3
ds_read_b64_tr_b16 v[26:27], v3 offset:512
ds_read_b128 v[28:31], v4 offset:8192
ds_read_b128 v[32:35], v4 offset:12288
s_waitcnt lgkmcnt(0)
v_mfma_f32_16x16x32_bf16 v[12:15], v[28:31], v[24:27], 0
v_mfma_f32_16x16x32_bf16 v[16:19], v[32:35], v[24:27], 0
v_mfma_f32_16x16x32_bf16 v[20:23], v[24:27], v[24:27], 0
s_nop 7
ds_read_b64_tr_b16 v[24:25], v3 offset:1024
ds_read_b64_tr_b16 v[26:27], v3 offset:1536
ds_read_b128 v[28:31], v4 offset:9216
ds_read_b128 v[32:35], v4 offset:13312
s_waitcnt lgkmcnt(0)
v_mfma_f32_16x16x32_bf16 v[12:15], v[28:31], v[24:27], v[12:15]
v_mfma_f32_16x16x32_bf16 v[16:19], v[32:35], v[24:27], v[16:19]
v_mfma_f32_16x16x32_bf16 v[20:23], v[24:27], v[24:27], v[20:23]
s_nop 7
ds_read_b64_tr_b16 v[24:25], v3 offset:2048
ds_read_b64_tr_b16 v[26:27], v3 offset:2560
ds_read_b128 v[28:31], v4 offset:10240
ds_read_b128 v[32:35], v4 offset:14336
s_waitcnt lgkmcnt(0)
v_mfma_f32_16x16x32_bf16 v[12:15], v[28:31], v[24:27], v[12:15]
v_mfma_f32_16x16x32_bf16 v[16:19], v[32:35], v[24:27], v[16:19]
v_mfma_f32_16x16x32_bf16 v[20:23], v[24:27], v[24:27], v[20:23]
s_nop 7
ds_read_b64_tr_b16 v[24:25], v3 offset:3072
ds_read_b64_tr_b16 v[26:27], v3 offset:3584
ds_read_b128 v[28:31], v4 offset:11264
ds_read_b128 v[32:35], v4 offset:15360
s_waitcnt lgkmcnt(0)
v_mfma_f32_16x16x32_bf16 v[12:15], v[28:31], v[24:27], v[12:15]
v_mfma_f32_16x16x32_bf16 v[16:19], v[32:35], v[24:27], v[16:19]
v_mfma_f32_16x16x32_bf16 v[20:23], v[24:27], v[24:27], v[20:23]
s_nop 7
v_mul_f32 v20, s44, v20
v_mul_f32 v21, s44, v21
v_max3_f32 v22, v20, v21, v12
v_max3_f32 v22, v22, v13, v14
v_max3_f32 v22, v22, v15, v16
v_max3_f32 v22, v22, v17, v18
v_max_f32 v22, v22, v19
v_mov_b32 v23, v22
s_nop 1
v_permlane16_swap_b32 v22, v23
s_nop 1
v_max_f32 v22, v22, v23
v_mov_b32 v23, v22
s_nop 1
v_permlane32_swap_b32 v22, v23
s_nop 1
v_max_f32 v22, v22, v23
v_sub_f32 v12, v12, v22
v_exp_f32 v12, v12
v_sub_f32 v13, v13, v22
v_exp_f32 v13, v13
v_sub_f32 v14, v14, v22
v_exp_f32 v14, v14
v_sub_f32 v15, v15, v22
v_exp_f32 v15, v15
v_sub_f32 v16, v16, v22
v_exp_f32 v16, v16
v_sub_f32 v17, v17, v22
v_exp_f32 v17, v17
v_sub_f32 v18, v18, v22
v_exp_f32 v18, v18
v_sub_f32 v19, v19, v22
v_exp_f32 v19, v19
v_sub_f32 v20, v20, v22
v_exp_f32 v20, v20
v_sub_f32 v21, v21, v22
v_exp_f32 v21, v21
v_cvt_pk_bf16_f32 v76, v12, v13
v_cvt_pk_bf16_f32 v77, v14, v15
v_cvt_pk_bf16_f32 v78, v16, v17
v_cvt_pk_bf16_f32 v79, v18, v19
v_cvt_pk_bf16_f32 v10, v20, v21
ds_read_b128 v[28:31], v4 offset:16384
ds_read_b128 v[32:35], v4 offset:17408
s_waitcnt lgkmcnt(0)
v_mfma_f32_16x16x32_bf16 v[60:63], v[76:79], v[28:31], 0
v_mfma_f32_16x16x32_bf16 v[64:67], v[76:79], v[32:35], 0
v_mfma_f32_16x16x32_bf16 v[40:43], v[76:79], v[36:39], 0
s_nop 5
v_mfma_f32_16x16x16_bf16 v[40:43], v[10:11], v[36:37], v[40:43]
v_mfma_f32_16x16x16_bf16 v[60:63], v[10:11], v[52:53], v[60:63]
v_mfma_f32_16x16x16_bf16 v[64:67], v[10:11], v[56:57], v[64:67]
s_nop 5
v_rcp_f32 v70, v42
v_rcp_f32 v71, v43
v_mul_f32 v62, v62, v70
v_mul_f32 v63, v63, v71
v_cvt_pk_bf16_f32 v68, v62, v63
ds_write_b32 v2, v68 offset:4096
v_mul_f32 v66, v66, v70
v_mul_f32 v67, v67, v71
v_cvt_pk_bf16_f32 v69, v66, v67
ds_write_b32 v2, v69 offset:4608
s_waitcnt lgkmcnt(0)
v_mov_b64 v[12:13], 0
v_mov_b64 v[14:15], 0
v_mov_b64 v[16:17], 0
v_mov_b64 v[18:19], 0
v_mov_b64 v[20:21], 0
v_mov_b64 v[22:23], 0
s_nop 3
s_branch C\sfx\()0_1_oskip
.p2align 6
CE\sfx\()1:
ds_read_b128 v[44:47], v0 offset:4096
ds_read_b128 v[48:51], v0 offset:5120
ds_read_b128 v[52:55], v0 offset:6144
ds_read_b128 v[56:59], v0 offset:7168
v_mov_b64 v[28:29], 0
v_mov_b64 v[30:31], 0
v_mov_b64 v[32:33], 0
v_mov_b64 v[34:35], 0
v_mov_b64 v[36:37], 0
v_mov_b64 v[38:39], 0
v_mov_b64 v[40:41], 0
v_mov_b64 v[42:43], 0
s_nop 1
C\sfx\()1_0_qk:
ds_read_b128 v[12:15], v4 offset:8192
ds_read_b128 v[16:19], v4 offset:9216
ds_read_b128 v[20:23], v4 offset:10240
C\sfx\()1_0_back0:
s_waitcnt lgkmcnt(2)
v_smfmac_f32_16x16x64_bf16 v[28:31], v[12:15], v[80:87], v1
s_waitcnt lgkmcnt(0)
v_add_f32 v10, v12, v16
v_cmp_u_f32 vcc, v10, v20
v_smfmac_f32_16x16x64_bf16 v[32:35], v[12:15], v[88:95], v1
s_cbranch_vccnz C\sfx\()1_0_retry0
v_smfmac_f32_16x16x64_bf16 v[36:39], v[12:15], v[44:51], v1
ds_read_b128 v[44:47], v0 offset:20480
v_smfmac_f32_16x16x64_bf16 v[40:43], v[12:15], v[52:59], v1
ds_read_b128 v[48:51], v0 offset:21504
v_smfmac_f32_16x16x64_bf16 v[28:31], v[16:19], v[96:103], v1
ds_read_b128 v[52:55], v0 offset:22528
v_smfmac_f32_16x16x64_bf16 v[32:35], v[16:19], v[104:111], v1
ds_read_b128 v[56:59], v0 offset:23552
global_load_dwordx4 v[60:63], v0, s[40:41] offset:-4096
v_smfmac_f32_16x16x64_bf16 v[36:39], v[16:19], v[224:231], v1
v_smfmac_f32_16x16x64_bf16 v[40:43], v[16:19], v[232:239], v1
v_smfmac_f32_16x16x64_bf16 v[28:31], v[20:23], v[112:119], v1
ds_read_b128 v[24:27], v4 offset:11264
v_smfmac_f32_16x16x64_bf16 v[32:35], v[20:23], v[120:127], v1
ds_read_b128 v[12:15], v4 offset:12288
global_load_dwordx4 v[64:67], v0, s[40:41] offset:-3072
s_waitcnt lgkmcnt(4)
v_smfmac_f32_16x16x64_bf16 v[36:39], v[20:23], v[44:51], v1
ds_read_b128 v[16:19], v4 offset:13312
s_waitcnt lgkmcnt(1)
v_cmp_u_f32 vcc, v24, v12
v_smfmac_f32_16x16x64_bf16 v[40:43], v[20:23], v[52:59], v1
ds_read_b128 v[44:47], v0 offset:36864
s_cbranch_vccnz C\sfx\()1_0_retry1
C\sfx\()1_0_back1:
v_smfmac_f32_16x16x64_bf16 v[28:31], v[24:27], v[128:135], v1
ds_read_b128 v[48:51], v0 offset:37888
v_smfmac_f32_16x16x64_bf16 v[32:35], v[24:27], v[136:143], v1
ds_read_b128 v[52:55], v0 offset:38912
global_load_dwordx4 v[68:71], v0, s[40:41] offset:-2048
v_smfmac_f32_16x16x64_bf16 v[36:39], v[24:27], v[240:247], v1
ds_read_b128 v[56:59], v0 offset:39936
v_smfmac_f32_16x16x64_bf16 v[40:43], v[24:27], v[248:255], v1
v_smfmac_f32_16x16x64_bf16 v[28:31], v[12:15], v[144:151], v1
s_waitcnt lgkmcnt(4)
v_cmp_u_f32 vcc, v16, v16
v_smfmac_f32_16x16x64_bf16 v[32:35], v[12:15], v[152:159], v1
global_load_dwordx4 v[72:75], v0, s[40:41] offset:-1024
s_waitcnt lgkmcnt(2)
v_smfmac_f32_16x16x64_bf16 v[36:39], v[12:15], v[44:51], v1
ds_read_b128 v[20:23], v4 offset:14336
s_cbranch_vccnz C\sfx\()1_0_retry1b
C\sfx\()1_0_back1b:
s_waitcnt lgkmcnt(1)
v_smfmac_f32_16x16x64_bf16 v[40:43], v[12:15], v[52:59], v1
ds_read_b128 v[24:27], v4 offset:15360
v_smfmac_f32_16x16x64_bf16 v[28:31], v[16:19], v[160:167], v1
ds_read_b128 v[44:47], v0 offset:53248
v_smfmac_f32_16x16x64_bf16 v[32:35], v[16:19], v[168:175], v1
ds_read_b128 v[48:51], v0 offset:54272
s_waitcnt lgkmcnt(2)
v_cmp_u_f32 vcc, v20, v24
v_smfmac_f32_16x16x64_bf16 v[36:39], v[16:19], a[0:7], v1
ds_read_b128 v[52:55], v0 offset:55296
v_smfmac_f32_16x16x64_bf16 v[40:43], v[16:19], a[8:15], v1
ds_read_b128 v[56:59], v0 offset:56320
s_cbranch_vccnz C\sfx\()1_0_retry2
C\sfx\()1_0_back2:
v_smfmac_f32_16x16x64_bf16 v[28:31], v[20:23], v[176:183], v1
ds_read_b128 v[12:15], v4 offset:30720
s_waitcnt lgkmcnt(3)
v_smfmac_f32_16x16x64_bf16 v[36:39], v[20:23], v[44:51], v1
ds_read_b128 v[44:47], v9 offset:4096
v_smfmac_f32_16x16x64_bf16 v[32:35], v[20:23], v[184:191], v1
ds_read_b128 v[48:51], v9 offset:5120
s_waitcnt lgkmcnt(3)
v_smfmac_f32_16x16x64_bf16 v[40:43], v[20:23], v[52:59], v1
ds_read_b128 v[52:55], v9 offset:6144
s_waitcnt lgkmcnt(3)
v_cmp_u_f32 vcc, v12, v12
v_smfmac_f32_16x16x64_bf16 v[28:31], v[24:27], v[192:199], v1
ds_read_b128 v[56:59], v9 offset:7168
v_smfmac_f32_16x16x64_bf16 v[36:39], v[24:27], a[16:23], v1
s_cbranch_vccnz C\sfx\()1_0_retry2b
C\sfx\()1_0_back2b:
v_smfmac_f32_16x16x64_bf16 v[28:31], v[12:15], v[208:215], v1
s_add_u32 s52, s36, 0x2000
s_addc_u32 s53, s37, 0
s_waitcnt lgkmcnt(2)
v_smfmac_f32_16x16x64_bf16 v[36:39], v[12:15], v[44:51], v1
v_smfmac_f32_16x16x64_bf16 v[32:35], v[24:27], v[200:207], v1
v_mov_b64 v[44:45], 0
v_smfmac_f32_16x16x64_bf16 v[40:43], v[24:27], a[24:31], v1
v_mov_b64 v[48:49], 0
v_add_f32 v28, v28, v30
v_smfmac_f32_16x16x64_bf16 v[32:35], v[12:15], v[216:223], v1
v_add_f32 v29, v29, v31
v_cvt_pk_bf16_f32 v77, v28, v29
v_add_f32 v36, v36, v38
s_waitcnt lgkmcnt(0)
v_smfmac_f32_16x16x64_bf16 v[40:43], v[12:15], v[52:59], v1
v_add_f32 v37, v37, v39
v_cvt_pk_bf16_f32 v76, v36, v37
ds_write_b64 v2, v[76:77]
v_mov_b64 v[46:47], 0
v_mov_b64 v[50:51], 0
C\sfx\()1_0_postqk:
s_waitcnt vmcnt(0)
v_smfmac_f32_16x16x64_bf16 v[44:47], v[20:23], v[60:67], v1
v_add_f32 v32, v32, v34
v_add_f32 v33, v33, v35
v_cvt_pk_bf16_f32 v79, v32, v33
v_add_f32 v40, v40, v42
v_add_f32 v41, v41, v43
v_cvt_pk_bf16_f32 v78, v40, v41
ds_write_b64 v2, v[78:79] offset:512
v_cmp_u_f32 vcc, v40, v41
v_smfmac_f32_16x16x64_bf16 v[48:51], v[20:23], v[68:75], v1
ds_read_b128 v[28:31], v4
v_smfmac_f32_16x16x64_bf16 v[44:47], v[12:15], a[144:151], v1
ds_read_b128 v[32:35], v4 offset:1024
v_smfmac_f32_16x16x64_bf16 v[48:51], v[12:15], a[152:159], v1
ds_read_b128 v[36:39], v4 offset:2048
s_cbranch_vccnz C\sfx\()1_0_retry_ag
v_smfmac_f32_16x16x64_bf16 v[44:47], v[24:27], a[128:135], v1
ds_read_b128 v[40:43], v4 offset:3072
s_waitcnt lgkmcnt(4)
s_barrier
ds_read_b64_tr_b16 v[60:61], v3
ds_read_b64_tr_b16 v[62:63], v3 offset:512
ds_read_b64_tr_b16 v[64:65], v3 offset:1024
ds_read_b64_tr_b16 v[66:67], v3 offset:1536
v_smfmac_f32_16x16x64_bf16 v[48:51], v[24:27], a[136:143], v1
ds_read_b64_tr_b16 v[68:69], v3 offset:2048
ds_read_b64_tr_b16 v[70:71], v3 offset:2560
ds_read_b64_tr_b16 v[72:73], v3 offset:3072
ds_read_b64_tr_b16 v[74:75], v3 offset:3584
v_smfmac_f32_16x16x64_bf16 v[44:47], v[16:19], a[112:119], v1
ds_read_b128 v[52:55], v4 offset:4096
v_smfmac_f32_16x16x64_bf16 v[48:51], v[16:19], a[120:127], v1
ds_read_b128 v[56:59], v4 offset:5120
s_waitcnt lgkmcnt(8)
v_mfma_f32_16x16x32_bf16 v[76:79], v[28:31], v[60:63], 0
ds_read_b128 v[12:15], v4 offset:6144
s_waitcnt lgkmcnt(7)
v_mfma_f32_16x16x32_bf16 v[76:79], v[32:35], v[64:67], v[76:79]
ds_read_b128 v[24:27], v4 offset:7168
s_waitcnt lgkmcnt(6)
v_mfma_f32_16x16x32_bf16 v[76:79], v[36:39], v[68:71], v[76:79]
ds_read_b128 v[20:23], v4 offset:8192
s_waitcnt lgkmcnt(5)
v_mfma_f32_16x16x32_bf16 v[76:79], v[40:43], v[72:75], v[76:79]
ds_read_b128 v[16:19], v4 offset:9216
s_waitcnt lgkmcnt(5)
v_mfma_f32_16x16x32_bf16 v[28:31], v[52:55], v[60:63], 0
v_mov_b32 v36, s57
v_mov_b32 v37, s57
s_waitcnt lgkmcnt(4)
v_mfma_f32_16x16x32_bf16 v[28:31], v[56:59], v[64:67], v[28:31]
ds_read_b128 v[52:55], v4 offset:18432
v_mov_b32 v38, s57
v_mov_b32 v39, s57
s_waitcnt lgkmcnt(4)
v_mfma_f32_16x16x32_bf16 v[28:31], v[12:15], v[68:71], v[28:31]
ds_read_b128 v[56:59], v4 offset:19456
v_exp_f32 v76, v76
s_waitcnt lgkmcnt(4)
v_mfma_f32_16x16x32_bf16 v[28:31], v[24:27], v[72:75], v[28:31]
ds_read_b128 v[12:15], v4 offset:10240
v_exp_f32 v77, v77
v_mfma_f32_16x16x32_bf16 v[32:35], v[60:63], v[60:63], 0
ds_read_b128 v[24:27], v4 offset:11264
v_exp_f32 v78, v78
v_mfma_f32_16x16x32_bf16 v[32:35], v[64:67], v[64:67], v[32:35]
v_exp_f32 v79, v79
v_mfma_f32_16x16x32_bf16 v[32:35], v[68:71], v[68:71], v[32:35]
v_cvt_pk_bf16_f32 v76, v76, v77
v_cvt_pk_bf16_f32 v77, v78, v79
v_mfma_f32_16x16x32_bf16 v[32:35], v[72:75], v[72:75], v[32:35]
v_exp_f32 v28, v28
s_waitcnt lgkmcnt(5)
v_smfmac_f32_16x16x64_bf16 v[44:47], v[20:23], a[32:39], v1
v_exp_f32 v29, v29
v_smfmac_f32_16x16x64_bf16 v[48:51], v[20:23], a[40:47], v1
v_exp_f32 v30, v30
s_waitcnt lgkmcnt(4)
v_smfmac_f32_16x16x64_bf16 v[44:47], v[16:19], a[48:55], v1
ds_read_b128 v[20:23], v4 offset:12288
v_exp_f32 v31, v31
v_smfmac_f32_16x16x64_bf16 v[48:51], v[16:19], a[56:63], v1
v_mul_f32 v32, s44, v32
s_waitcnt lgkmcnt(2)
v_smfmac_f32_16x16x64_bf16 v[44:47], v[12:15], a[64:71], v1
v_cvt_pk_bf16_f32 v78, v28, v29
v_smfmac_f32_16x16x64_bf16 v[48:51], v[12:15], a[72:79], v1
v_cvt_pk_bf16_f32 v79, v30, v31
s_waitcnt lgkmcnt(1)
v_smfmac_f32_16x16x64_bf16 v[44:47], v[24:27], a[80:87], v1
v_mul_f32 v33, s44, v33
s_waitcnt lgkmcnt(0)
v_smfmac_f32_16x16x64_bf16 v[44:47], v[20:23], a[96:103], v1
v_exp_f32 v32, v32
v_mfma_f32_16x16x32_bf16 v[40:43], v[76:79], v[36:39], 0
v_exp_f32 v33, v33
v_smfmac_f32_16x16x64_bf16 v[48:51], v[24:27], a[88:95], v1
v_cvt_pk_bf16_f32 v10, v32, v33
v_mfma_f32_16x16x32_bf16 v[60:63], v[76:79], v[52:55], 0
v_smfmac_f32_16x16x64_bf16 v[48:51], v[20:23], a[104:111], v1
s_nop 0
v_add_f32 v44, v44, v46
v_mfma_f32_16x16x32_bf16 v[64:67], v[76:79], v[56:59], 0
v_add_f32 v45, v45, v47
v_cvt_pk_bf16_f32 v52, v44, v45
v_mfma_f32_16x16x16_bf16 v[40:43], v[10:11], v[36:37], v[40:43]
s_nop 0
v_mfma_f32_16x16x16_bf16 v[60:63], v[10:11], v[52:53], v[60:63]
v_add_f32 v48, v48, v50
v_add_f32 v49, v49, v51
v_cvt_pk_bf16_f32 v56, v48, v49
s_nop 1
v_mfma_f32_16x16x16_bf16 v[64:67], v[10:11], v[56:57], v[64:67]
v_rcp_f32 v70, v42
v_rcp_f32 v71, v43
v_subrev_u32 v40, s45, v42
v_subrev_u32 v41, s45, v43
v_mul_f32 v62, v62, v70
v_mul_f32 v63, v63, v71
v_cvt_pk_bf16_f32 v68, v62, v63
ds_write_b32 v2, v68 offset:4096
v_mul_f32 v66, v66, v70
v_mul_f32 v67, v67, v71
v_cvt_pk_bf16_f32 v69, v66, v67
ds_write_b32 v2, v69 offset:4608
v_max_u32 v40, v40, v41
v_cmp_le_u32 vcc, s46, v40
v_mov_b64 v[12:13], 0
v_mov_b64 v[14:15], 0
v_mov_b64 v[16:17], 0
v_mov_b64 v[18:19], 0
v_mov_b64 v[20:21], 0
v_mov_b64 v[22:23], 0
s_cbranch_vccnz C\sfx\()1_0_slow
C\sfx\()1_0_oskip:
s_mov_b32 m0, 0x24800
v_mov_b64 v[24:25], 0
v_mov_b64 v[26:27], 0
global_load_lds_dwordx4 v0, s[52:53] sc1
global_load_lds_dwordx4 v0, s[52:53] offset:1024 sc1
s_waitcnt lgkmcnt(0)
s_barrier
ds_read_b64_tr_b16 v[44:45], v3 offset:4096
ds_read_b64_tr_b16 v[46:47], v3 offset:4608
ds_read_b64_tr_b16 v[48:49], v3 offset:5120
ds_read_b64_tr_b16 v[50:51], v3 offset:5632
v_mov_b64 v[28:29], 0
v_mov_b64 v[30:31], 0
v_mov_b64 v[32:33], 0
v_mov_b64 v[34:35], 0
s_waitcnt lgkmcnt(2)
v_smfmac_f32_16x16x64_bf16 v[12:15], v[44:47], a[240:247], v1
ds_read_b128 v[52:55], v9 offset:20480
s_add_u32 s54, s36, 0x400
s_addc_u32 s55, s37, 0
s_waitcnt lgkmcnt(1)
v_smfmac_f32_16x16x64_bf16 v[12:15], v[48:51], a[248:255], v1
ds_read_b128 v[56:59], v9 offset:21504
s_mov_b32 m0, 0x22c00
s_cmp_eq_u32 s42, 63
global_load_lds_dwordx4 v0, s[54:55] sc1
v_smfmac_f32_16x16x64_bf16 v[16:19], v[44:47], a[160:167], v1
ds_read_b128 v[60:63], v9 offset:22528
global_load_lds_dwordx4 v0, s[54:55] offset:1024 sc1
global_load_lds_dwordx4 v0, s[54:55] offset:2048 sc1
s_cbranch_scc1 DONE
v_smfmac_f32_16x16x64_bf16 v[16:19], v[48:51], a[176:183], v1
ds_read_b128 v[64:67], v9 offset:23552
s_add_u32 s42, s42, 1
v_smfmac_f32_16x16x64_bf16 v[20:23], v[44:47], a[168:175], v1
ds_read_b128 v[68:71], v9 offset:36864
s_add_u32 s36, s36, 0x4000
s_addc_u32 s37, s37, 0
v_add_f32 v12, v12, v14
v_smfmac_f32_16x16x64_bf16 v[20:23], v[48:51], a[184:191], v1
ds_read_b128 v[72:75], v9 offset:37888
v_add_f32 v13, v13, v15
v_cvt_pk_bf16_f32 v12, v12, v13
v_smfmac_f32_16x16x64_bf16 v[24:27], v[44:47], a[192:199], v1
v_add_f32 v14, v16, v18
v_add_f32 v15, v17, v19
v_mov_b32_dpp v13, v12 quad_perm:[1,0,3,2] row_mask:0xf bank_mask:0xf
s_waitcnt lgkmcnt(4)
v_smfmac_f32_16x16x64_bf16 v[24:27], v[48:51], v[52:59], v1
ds_read_b128 v[52:55], v9 offset:38912
v_mov_b32 v19, s75
v_perm_b32 v16, v13, v12, v8
v_add_f32 v20, v20, v22
v_add_f32 v21, v21, v23
v_cvt_pk_bf16_f32 v17, v14, v20
v_cvt_pk_bf16_f32 v18, v15, v21
global_store_dwordx4 v5, v[16:19], s[28:29] \md
v_smfmac_f32_16x16x64_bf16 v[28:31], v[44:47], a[200:207], v1
ds_read_b128 v[56:59], v9 offset:39936
s_add_u32 s64, s28, 0x1000
s_addc_u32 s65, s29, 0
v_mov_b64 v[36:37], 0
s_waitcnt lgkmcnt(4)
v_smfmac_f32_16x16x64_bf16 v[28:31], v[48:51], v[60:67], v1
ds_read_b128 v[60:63], v9 offset:53248
v_mov_b64 v[38:39], 0
v_smfmac_f32_16x16x64_bf16 v[32:35], v[44:47], a[208:215], v1
ds_read_b128 v[64:67], v9 offset:54272
v_add_f32 v24, v24, v26
v_mov_b64 v[40:41], 0
s_waitcnt lgkmcnt(4)
v_smfmac_f32_16x16x64_bf16 v[32:35], v[48:51], v[68:75], v1
ds_read_b128 v[68:71], v9 offset:55296
v_add_f32 v25, v25, v27
v_cvt_pk_bf16_f32 v24, v24, v25
v_mov_b64 v[42:43], 0
v_smfmac_f32_16x16x64_bf16 v[36:39], v[44:47], a[216:223], v1
ds_read_b128 v[72:75], v9 offset:56320
v_add_f32 v26, v28, v30
v_add_f32 v27, v29, v31
v_mov_b32_dpp v25, v24 quad_perm:[1,0,3,2] row_mask:0xf bank_mask:0xf
v_mov_b64 v[76:77], 0
s_waitcnt lgkmcnt(4)
v_smfmac_f32_16x16x64_bf16 v[36:39], v[48:51], v[52:59], v1
v_mov_b64 v[78:79], 0
v_mov_b32 v31, s75
v_perm_b32 v28, v25, v24, v8
v_add_f32 v32, v32, v34
v_add_f32 v33, v33, v35
v_cvt_pk_bf16_f32 v29, v26, v32
v_cvt_pk_bf16_f32 v30, v27, v33
global_store_dwordx4 v5, v[28:31], s[64:65] \md
v_smfmac_f32_16x16x64_bf16 v[40:43], v[44:47], a[224:231], v1
s_add_u32 s64, s28, 0x2000
s_addc_u32 s65, s29, 0
s_waitcnt lgkmcnt(2)
v_smfmac_f32_16x16x64_bf16 v[40:43], v[48:51], v[60:67], v1
v_smfmac_f32_16x16x64_bf16 v[76:79], v[44:47], a[232:239], v1
v_add_f32 v36, v36, v38
s_waitcnt lgkmcnt(0)
v_smfmac_f32_16x16x64_bf16 v[76:79], v[48:51], v[68:75], v1
v_add_f32 v37, v37, v39
v_cvt_pk_bf16_f32 v36, v36, v37
s_nop 1
v_add_f32 v38, v40, v42
v_add_f32 v39, v41, v43
v_mov_b32_dpp v37, v36 quad_perm:[1,0,3,2] row_mask:0xf bank_mask:0xf
v_mov_b32 v43, s75
v_perm_b32 v40, v37, v36, v8
v_add_f32 v76, v76, v78
v_add_f32 v77, v77, v79
v_cvt_pk_bf16_f32 v41, v38, v76
v_cvt_pk_bf16_f32 v42, v39, v77
global_store_dwordx4 v5, v[40:43], s[64:65] \md
v_mov_b64 v[60:61], -1
v_mov_b64 v[62:63], -1
ds_write_b128 v4, v[60:63] offset:3072
ds_write_b128 v4, v[60:63] offset:4096
ds_write_b128 v4, v[60:63] offset:5120
v_and_b32 v10, 0x200ff, v4
ds_read_b128 v[76:79], v10 offset:31744
s_add_u32 s51, s56, 0x18c00
s_and_b32 s51, s51, 0x1ffff
s_add_u32 s72, s14, s51
s_addc_u32 s73, s15, 0
s_add_u32 s56, s56, 0x8000
s_and_b32 s56, s56, 0x1ffff
s_add_u32 s51, s56, 3072
s_add_u32 s70, s14, s51
s_addc_u32 s71, s15, 0
s_add_u32 s51, s56, s96
s_add_u32 s68, s14, s51
s_addc_u32 s69, s15, 0
s_mov_b32 s74, 0
s_sleep 2
s_nop 7
s_nop 3
global_load_dwordx4 v[12:15], v0, s[32:33] sc1
global_load_dwordx4 v[16:19], v0, s[32:33] offset:1024 sc1
global_load_dwordx4 v[20:23], v0, s[32:33] offset:2048 sc1
global_load_dwordx4 v[24:27], v0, s[32:33] offset:3072 sc1
s_waitcnt lgkmcnt(0)
s_waitcnt vmcnt(3)
v_mfma_f32_16x16x32_bf16 v[44:47], v[76:79], v[12:15], 0
s_waitcnt vmcnt(2)
v_mfma_f32_16x16x32_bf16 v[44:47], v[76:79], v[16:19], v[44:47]
s_waitcnt vmcnt(1)
v_mfma_f32_16x16x32_bf16 v[44:47], v[76:79], v[20:23], v[44:47]
v_min3_u32 v48, v15, v19, v23
s_waitcnt vmcnt(0)
v_mfma_f32_16x16x32_bf16 v[44:47], v[76:79], v[24:27], v[44:47]
v_min_u32 v48, v48, v27
v_cmp_ne_u32 vcc, s75, v48
s_nop 4
s_cbranch_vccnz C\sfx\()1_0_retry_u1
v_add_f32_dpp v46, v44, v44 row_ror:8 row_mask:0xf bank_mask:0xf
v_add_f32_dpp v47, v45, v45 row_ror:8 row_mask:0xf bank_mask:0xf
v_cvt_pk_bf16_f32 v44, v46, v47
global_store_dword v7, v44, s[22:23] \md
C\sfx\()1_0_done_u1:
v_mov_b32 v48, -1
global_store_dword v7, v48, s[24:25] \md
s_waitcnt vmcnt(2)
ds_read_b128 v[44:47], v0 offset:4096
ds_read_b128 v[48:51], v0 offset:5120
ds_read_b128 v[52:55], v0 offset:6144
ds_read_b128 v[56:59], v0 offset:7168
v_mov_b64 v[28:29], 0
v_mov_b64 v[30:31], 0
v_mov_b64 v[32:33], 0
v_mov_b64 v[34:35], 0
v_mov_b64 v[36:37], 0
v_mov_b64 v[38:39], 0
v_mov_b64 v[40:41], 0
v_mov_b64 v[42:43], 0
s_add_u32 s75, s75, 1
s_barrier
C\sfx\()1_1_qk:
ds_read_b128 v[12:15], v4
ds_read_b128 v[16:19], v4 offset:1024
ds_read_b128 v[20:23], v4 offset:2048
C\sfx\()1_1_back0:
s_waitcnt lgkmcnt(2)
v_smfmac_f32_16x16x64_bf16 v[28:31], v[12:15], v[80:87], v1
s_waitcnt lgkmcnt(0)
v_add_f32 v10, v12, v16
v_cmp_u_f32 vcc, v10, v20
v_smfmac_f32_16x16x64_bf16 v[32:35], v[12:15], v[88:95], v1
s_cbranch_vccnz C\sfx\()1_1_retry0
v_smfmac_f32_16x16x64_bf16 v[36:39], v[12:15], v[44:51], v1
ds_read_b128 v[44:47], v0 offset:20480
v_smfmac_f32_16x16x64_bf16 v[40:43], v[12:15], v[52:59], v1
ds_read_b128 v[48:51], v0 offset:21504
v_smfmac_f32_16x16x64_bf16 v[28:31], v[16:19], v[96:103], v1
ds_read_b128 v[52:55], v0 offset:22528
v_smfmac_f32_16x16x64_bf16 v[32:35], v[16:19], v[104:111], v1
ds_read_b128 v[56:59], v0 offset:23552
global_load_dwordx4 v[60:63], v0, s[40:41] offset:-4096
v_smfmac_f32_16x16x64_bf16 v[36:39], v[16:19], v[224:231], v1
v_smfmac_f32_16x16x64_bf16 v[40:43], v[16:19], v[232:239], v1
v_smfmac_f32_16x16x64_bf16 v[28:31], v[20:23], v[112:119], v1
ds_read_b128 v[24:27], v4 offset:3072
v_smfmac_f32_16x16x64_bf16 v[32:35], v[20:23], v[120:127], v1
ds_read_b128 v[12:15], v4 offset:4096
global_load_dwordx4 v[64:67], v0, s[40:41] offset:-3072
s_waitcnt lgkmcnt(4)
v_smfmac_f32_16x16x64_bf16 v[36:39], v[20:23], v[44:51], v1
ds_read_b128 v[16:19], v4 offset:5120
s_waitcnt lgkmcnt(1)
v_cmp_u_f32 vcc, v24, v12
v_smfmac_f32_16x16x64_bf16 v[40:43], v[20:23], v[52:59], v1
ds_read_b128 v[44:47], v0 offset:36864
s_cbranch_vccnz C\sfx\()1_1_retry1
C\sfx\()1_1_back1:
v_smfmac_f32_16x16x64_bf16 v[28:31], v[24:27], v[128:135], v1
ds_read_b128 v[48:51], v0 offset:37888
v_smfmac_f32_16x16x64_bf16 v[32:35], v[24:27], v[136:143], v1
ds_read_b128 v[52:55], v0 offset:38912
global_load_dwordx4 v[68:71], v0, s[40:41] offset:-2048
v_smfmac_f32_16x16x64_bf16 v[36:39], v[24:27], v[240:247], v1
ds_read_b128 v[56:59], v0 offset:39936
v_smfmac_f32_16x16x64_bf16 v[40:43], v[24:27], v[248:255], v1
v_smfmac_f32_16x16x64_bf16 v[28:31], v[12:15], v[144:151], v1
s_waitcnt lgkmcnt(4)
v_cmp_u_f32 vcc, v16, v16
v_smfmac_f32_16x16x64_bf16 v[32:35], v[12:15], v[152:159], v1
global_load_dwordx4 v[72:75], v0, s[40:41] offset:-1024
s_waitcnt lgkmcnt(2)
v_smfmac_f32_16x16x64_bf16 v[36:39], v[12:15], v[44:51], v1
ds_read_b128 v[20:23], v4 offset:6144
s_cbranch_vccnz C\sfx\()1_1_retry1b
C\sfx\()1_1_back1b:
s_waitcnt lgkmcnt(1)
v_smfmac_f32_16x16x64_bf16 v[40:43], v[12:15], v[52:59], v1
ds_read_b128 v[24:27], v4 offset:7168
v_smfmac_f32_16x16x64_bf16 v[28:31], v[16:19], v[160:167], v1
ds_read_b128 v[44:47], v0 offset:53248
v_smfmac_f32_16x16x64_bf16 v[32:35], v[16:19], v[168:175], v1
ds_read_b128 v[48:51], v0 offset:54272
s_waitcnt lgkmcnt(2)
v_cmp_u_f32 vcc, v20, v24
v_smfmac_f32_16x16x64_bf16 v[36:39], v[16:19], a[0:7], v1
ds_read_b128 v[52:55], v0 offset:55296
v_smfmac_f32_16x16x64_bf16 v[40:43], v[16:19], a[8:15], v1
ds_read_b128 v[56:59], v0 offset:56320
s_cbranch_vccnz C\sfx\()1_1_retry2
C\sfx\()1_1_back2:
v_smfmac_f32_16x16x64_bf16 v[28:31], v[20:23], v[176:183], v1
ds_read_b128 v[12:15], v4 offset:30720
s_waitcnt lgkmcnt(3)
v_smfmac_f32_16x16x64_bf16 v[36:39], v[20:23], v[44:51], v1
ds_read_b128 v[44:47], v9 offset:4096
v_smfmac_f32_16x16x64_bf16 v[32:35], v[20:23], v[184:191], v1
ds_read_b128 v[48:51], v9 offset:5120
s_waitcnt lgkmcnt(3)
v_smfmac_f32_16x16x64_bf16 v[40:43], v[20:23], v[52:59], v1
ds_read_b128 v[52:55], v9 offset:6144
s_waitcnt lgkmcnt(3)
v_cmp_u_f32 vcc, v12, v12
v_smfmac_f32_16x16x64_bf16 v[28:31], v[24:27], v[192:199], v1
ds_read_b128 v[56:59], v9 offset:7168
v_smfmac_f32_16x16x64_bf16 v[36:39], v[24:27], a[16:23], v1
s_cbranch_vccnz C\sfx\()1_1_retry2b
C\sfx\()1_1_back2b:
v_smfmac_f32_16x16x64_bf16 v[28:31], v[12:15], v[208:215], v1
s_add_u32 s52, s36, 0x2000
s_addc_u32 s53, s37, 0
s_waitcnt lgkmcnt(2)
v_smfmac_f32_16x16x64_bf16 v[36:39], v[12:15], v[44:51], v1
v_smfmac_f32_16x16x64_bf16 v[32:35], v[24:27], v[200:207], v1
v_mov_b64 v[44:45], 0
v_smfmac_f32_16x16x64_bf16 v[40:43], v[24:27], a[24:31], v1
v_mov_b64 v[48:49], 0
v_add_f32 v28, v28, v30
v_smfmac_f32_16x16x64_bf16 v[32:35], v[12:15], v[216:223], v1
v_add_f32 v29, v29, v31
v_cvt_pk_bf16_f32 v77, v28, v29
v_add_f32 v36, v36, v38
s_waitcnt lgkmcnt(0)
v_smfmac_f32_16x16x64_bf16 v[40:43], v[12:15], v[52:59], v1
v_add_f32 v37, v37, v39
v_cvt_pk_bf16_f32 v76, v36, v37
ds_write_b64 v2, v[76:77]
v_mov_b64 v[46:47], 0
v_mov_b64 v[50:51], 0
C\sfx\()1_1_postqk:
s_waitcnt vmcnt(0)
v_smfmac_f32_16x16x64_bf16 v[44:47], v[20:23], v[60:67], v1
v_add_f32 v32, v32, v34
v_add_f32 v33, v33, v35
v_cvt_pk_bf16_f32 v79, v32, v33
v_add_f32 v40, v40, v42
v_add_f32 v41, v41, v43
v_cvt_pk_bf16_f32 v78, v40, v41
ds_write_b64 v2, v[78:79] offset:512
v_cmp_u_f32 vcc, v40, v41
v_smfmac_f32_16x16x64_bf16 v[48:51], v[20:23], v[68:75], v1
ds_read_b128 v[28:31], v4 offset:8192
v_smfmac_f32_16x16x64_bf16 v[44:47], v[12:15], a[144:151], v1
ds_read_b128 v[32:35], v4 offset:9216
v_smfmac_f32_16x16x64_bf16 v[48:51], v[12:15], a[152:159], v1
ds_read_b128 v[36:39], v4 offset:10240
s_cbranch_vccnz C\sfx\()1_1_retry_ag
v_smfmac_f32_16x16x64_bf16 v[44:47], v[24:27], a[128:135], v1
ds_read_b128 v[40:43], v4 offset:11264
s_waitcnt lgkmcnt(4)
s_barrier
ds_read_b64_tr_b16 v[60:61], v3
ds_read_b64_tr_b16 v[62:63], v3 offset:512
ds_read_b64_tr_b16 v[64:65], v3 offset:1024
ds_read_b64_tr_b16 v[66:67], v3 offset:1536
v_smfmac_f32_16x16x64_bf16 v[48:51], v[24:27], a[136:143], v1
ds_read_b64_tr_b16 v[68:69], v3 offset:2048
ds_read_b64_tr_b16 v[70:71], v3 offset:2560
ds_read_b64_tr_b16 v[72:73], v3 offset:3072
ds_read_b64_tr_b16 v[74:75], v3 offset:3584
v_smfmac_f32_16x16x64_bf16 v[44:47], v[16:19], a[112:119], v1
ds_read_b128 v[52:55], v4 offset:12288
v_smfmac_f32_16x16x64_bf16 v[48:51], v[16:19], a[120:127], v1
ds_read_b128 v[56:59], v4 offset:13312
s_waitcnt lgkmcnt(8)
v_mfma_f32_16x16x32_bf16 v[76:79], v[28:31], v[60:63], 0
ds_read_b128 v[12:15], v4 offset:14336
s_waitcnt lgkmcnt(7)
v_mfma_f32_16x16x32_bf16 v[76:79], v[32:35], v[64:67], v[76:79]
ds_read_b128 v[24:27], v4 offset:15360
s_waitcnt lgkmcnt(6)
v_mfma_f32_16x16x32_bf16 v[76:79], v[36:39], v[68:71], v[76:79]
ds_read_b128 v[20:23], v4
s_waitcnt lgkmcnt(5)
v_mfma_f32_16x16x32_bf16 v[76:79], v[40:43], v[72:75], v[76:79]
ds_read_b128 v[16:19], v4 offset:1024
s_waitcnt lgkmcnt(5)
v_mfma_f32_16x16x32_bf16 v[28:31], v[52:55], v[60:63], 0
v_mov_b32 v36, s57
v_mov_b32 v37, s57
s_waitcnt lgkmcnt(4)
v_mfma_f32_16x16x32_bf16 v[28:31], v[56:59], v[64:67], v[28:31]
ds_read_b128 v[52:55], v4 offset:18432
v_mov_b32 v38, s57
v_mov_b32 v39, s57
s_waitcnt lgkmcnt(4)
v_mfma_f32_16x16x32_bf16 v[28:31], v[12:15], v[68:71], v[28:31]
ds_read_b128 v[56:59], v4 offset:19456
v_exp_f32 v76, v76
s_waitcnt lgkmcnt(4)
v_mfma_f32_16x16x32_bf16 v[28:31], v[24:27], v[72:75], v[28:31]
ds_read_b128 v[12:15], v4 offset:2048
v_exp_f32 v77, v77
v_mfma_f32_16x16x32_bf16 v[32:35], v[60:63], v[60:63], 0
ds_read_b128 v[24:27], v4 offset:3072
v_exp_f32 v78, v78
v_mfma_f32_16x16x32_bf16 v[32:35], v[64:67], v[64:67], v[32:35]
v_exp_f32 v79, v79
v_mfma_f32_16x16x32_bf16 v[32:35], v[68:71], v[68:71], v[32:35]
v_cvt_pk_bf16_f32 v76, v76, v77
v_cvt_pk_bf16_f32 v77, v78, v79
v_mfma_f32_16x16x32_bf16 v[32:35], v[72:75], v[72:75], v[32:35]
v_exp_f32 v28, v28
s_waitcnt lgkmcnt(5)
v_smfmac_f32_16x16x64_bf16 v[44:47], v[20:23], a[32:39], v1
v_exp_f32 v29, v29
v_smfmac_f32_16x16x64_bf16 v[48:51], v[20:23], a[40:47], v1
v_exp_f32 v30, v30
s_waitcnt lgkmcnt(4)
v_smfmac_f32_16x16x64_bf16 v[44:47], v[16:19], a[48:55], v1
ds_read_b128 v[20:23], v4 offset:4096
v_exp_f32 v31, v31
v_smfmac_f32_16x16x64_bf16 v[48:51], v[16:19], a[56:63], v1
v_mul_f32 v32, s44, v32
s_waitcnt lgkmcnt(2)
v_smfmac_f32_16x16x64_bf16 v[44:47], v[12:15], a[64:71], v1
v_cvt_pk_bf16_f32 v78, v28, v29
v_smfmac_f32_16x16x64_bf16 v[48:51], v[12:15], a[72:79], v1
v_cvt_pk_bf16_f32 v79, v30, v31
s_waitcnt lgkmcnt(1)
v_smfmac_f32_16x16x64_bf16 v[44:47], v[24:27], a[80:87], v1
v_mul_f32 v33, s44, v33
s_waitcnt lgkmcnt(0)
v_smfmac_f32_16x16x64_bf16 v[44:47], v[20:23], a[96:103], v1
v_exp_f32 v32, v32
v_mfma_f32_16x16x32_bf16 v[40:43], v[76:79], v[36:39], 0
v_exp_f32 v33, v33
v_smfmac_f32_16x16x64_bf16 v[48:51], v[24:27], a[88:95], v1
v_cvt_pk_bf16_f32 v10, v32, v33
v_mfma_f32_16x16x32_bf16 v[60:63], v[76:79], v[52:55], 0
v_smfmac_f32_16x16x64_bf16 v[48:51], v[20:23], a[104:111], v1
s_nop 0
v_add_f32 v44, v44, v46
v_mfma_f32_16x16x32_bf16 v[64:67], v[76:79], v[56:59], 0
v_add_f32 v45, v45, v47
v_cvt_pk_bf16_f32 v52, v44, v45
v_mfma_f32_16x16x16_bf16 v[40:43], v[10:11], v[36:37], v[40:43]
s_nop 0
v_mfma_f32_16x16x16_bf16 v[60:63], v[10:11], v[52:53], v[60:63]
v_add_f32 v48, v48, v50
v_add_f32 v49, v49, v51
v_cvt_pk_bf16_f32 v56, v48, v49
s_nop 1
v_mfma_f32_16x16x16_bf16 v[64:67], v[10:11], v[56:57], v[64:67]
v_rcp_f32 v70, v42
v_rcp_f32 v71, v43
v_subrev_u32 v40, s45, v42
v_subrev_u32 v41, s45, v43
v_mul_f32 v62, v62, v70
v_mul_f32 v63, v63, v71
v_cvt_pk_bf16_f32 v68, v62, v63
ds_write_b32 v2, v68 offset:4096
v_mul_f32 v66, v66, v70
v_mul_f32 v67, v67, v71
v_cvt_pk_bf16_f32 v69, v66, v67
ds_write_b32 v2, v69 offset:4608
v_max_u32 v40, v40, v41
v_cmp_le_u32 vcc, s46, v40
v_mov_b64 v[12:13], 0
v_mov_b64 v[14:15], 0
v_mov_b64 v[16:17], 0
v_mov_b64 v[18:19], 0
v_mov_b64 v[20:21], 0
v_mov_b64 v[22:23], 0
s_cbranch_vccnz C\sfx\()1_1_slow
C\sfx\()1_1_oskip:
s_mov_b32 m0, 0x24800
v_mov_b64 v[24:25], 0
v_mov_b64 v[26:27], 0
global_load_lds_dwordx4 v0, s[52:53] sc1
global_load_lds_dwordx4 v0, s[52:53] offset:1024 sc1
s_waitcnt lgkmcnt(0)
s_barrier
ds_read_b64_tr_b16 v[44:45], v3 offset:4096
ds_read_b64_tr_b16 v[46:47], v3 offset:4608
ds_read_b64_tr_b16 v[48:49], v3 offset:5120
ds_read_b64_tr_b16 v[50:51], v3 offset:5632
v_mov_b64 v[28:29], 0
v_mov_b64 v[30:31], 0
v_mov_b64 v[32:33], 0
v_mov_b64 v[34:35], 0
s_waitcnt lgkmcnt(2)
v_smfmac_f32_16x16x64_bf16 v[12:15], v[44:47], a[240:247], v1
ds_read_b128 v[52:55], v9 offset:20480
s_add_u32 s54, s36, 0x400
s_addc_u32 s55, s37, 0
s_waitcnt lgkmcnt(1)
v_smfmac_f32_16x16x64_bf16 v[12:15], v[48:51], a[248:255], v1
ds_read_b128 v[56:59], v9 offset:21504
s_mov_b32 m0, 0x20c00
s_cmp_eq_u32 s42, 63
global_load_lds_dwordx4 v0, s[54:55] sc1
v_smfmac_f32_16x16x64_bf16 v[16:19], v[44:47], a[160:167], v1
ds_read_b128 v[60:63], v9 offset:22528
global_load_lds_dwordx4 v0, s[54:55] offset:1024 sc1
global_load_lds_dwordx4 v0, s[54:55] offset:2048 sc1
s_cbranch_scc1 DONE
v_smfmac_f32_16x16x64_bf16 v[16:19], v[48:51], a[176:183], v1
ds_read_b128 v[64:67], v9 offset:23552
s_add_u32 s42, s42, 1
v_smfmac_f32_16x16x64_bf16 v[20:23], v[44:47], a[168:175], v1
ds_read_b128 v[68:71], v9 offset:36864
s_add_u32 s36, s36, 0x4000
s_addc_u32 s37, s37, 0
v_add_f32 v12, v12, v14
v_smfmac_f32_16x16x64_bf16 v[20:23], v[48:51], a[184:191], v1
ds_read_b128 v[72:75], v9 offset:37888
v_add_f32 v13, v13, v15
v_cvt_pk_bf16_f32 v12, v12, v13
v_smfmac_f32_16x16x64_bf16 v[24:27], v[44:47], a[192:199], v1
v_add_f32 v14, v16, v18
v_add_f32 v15, v17, v19
v_mov_b32_dpp v13, v12 quad_perm:[1,0,3,2] row_mask:0xf bank_mask:0xf
s_waitcnt lgkmcnt(4)
v_smfmac_f32_16x16x64_bf16 v[24:27], v[48:51], v[52:59], v1
ds_read_b128 v[52:55], v9 offset:38912
v_mov_b32 v19, s75
v_perm_b32 v16, v13, v12, v8
v_add_f32 v20, v20, v22
v_add_f32 v21, v21, v23
v_cvt_pk_bf16_f32 v17, v14, v20
v_cvt_pk_bf16_f32 v18, v15, v21
global_store_dwordx4 v5, v[16:19], s[30:31] \md
v_smfmac_f32_16x16x64_bf16 v[28:31], v[44:47], a[200:207], v1
ds_read_b128 v[56:59], v9 offset:39936
s_add_u32 s64, s30, 0x1000
s_addc_u32 s65, s31, 0
v_mov_b64 v[36:37], 0
s_waitcnt lgkmcnt(4)
v_smfmac_f32_16x16x64_bf16 v[28:31], v[48:51], v[60:67], v1
ds_read_b128 v[60:63], v9 offset:53248
v_mov_b64 v[38:39], 0
v_smfmac_f32_16x16x64_bf16 v[32:35], v[44:47], a[208:215], v1
ds_read_b128 v[64:67], v9 offset:54272
v_add_f32 v24, v24, v26
v_mov_b64 v[40:41], 0
s_waitcnt lgkmcnt(4)
v_smfmac_f32_16x16x64_bf16 v[32:35], v[48:51], v[68:75], v1
ds_read_b128 v[68:71], v9 offset:55296
v_add_f32 v25, v25, v27
v_cvt_pk_bf16_f32 v24, v24, v25
v_mov_b64 v[42:43], 0
v_smfmac_f32_16x16x64_bf16 v[36:39], v[44:47], a[216:223], v1
ds_read_b128 v[72:75], v9 offset:56320
v_add_f32 v26, v28, v30
v_add_f32 v27, v29, v31
v_mov_b32_dpp v25, v24 quad_perm:[1,0,3,2] row_mask:0xf bank_mask:0xf
v_mov_b64 v[76:77], 0
s_waitcnt lgkmcnt(4)
v_smfmac_f32_16x16x64_bf16 v[36:39], v[48:51], v[52:59], v1
v_mov_b64 v[78:79], 0
v_mov_b32 v31, s75
v_perm_b32 v28, v25, v24, v8
v_add_f32 v32, v32, v34
v_add_f32 v33, v33, v35
v_cvt_pk_bf16_f32 v29, v26, v32
v_cvt_pk_bf16_f32 v30, v27, v33
global_store_dwordx4 v5, v[28:31], s[64:65] \md
v_smfmac_f32_16x16x64_bf16 v[40:43], v[44:47], a[224:231], v1
s_add_u32 s64, s30, 0x2000
s_addc_u32 s65, s31, 0
s_waitcnt lgkmcnt(2)
v_smfmac_f32_16x16x64_bf16 v[40:43], v[48:51], v[60:67], v1
v_smfmac_f32_16x16x64_bf16 v[76:79], v[44:47], a[232:239], v1
v_add_f32 v36, v36, v38
s_waitcnt lgkmcnt(0)
v_smfmac_f32_16x16x64_bf16 v[76:79], v[48:51], v[68:75], v1
v_add_f32 v37, v37, v39
v_cvt_pk_bf16_f32 v36, v36, v37
s_nop 1
v_add_f32 v38, v40, v42
v_add_f32 v39, v41, v43
v_mov_b32_dpp v37, v36 quad_perm:[1,0,3,2] row_mask:0xf bank_mask:0xf
v_mov_b32 v43, s75
v_perm_b32 v40, v37, v36, v8
v_add_f32 v76, v76, v78
v_add_f32 v77, v77, v79
v_cvt_pk_bf16_f32 v41, v38, v76
v_cvt_pk_bf16_f32 v42, v39, v77
global_store_dwordx4 v5, v[40:43], s[64:65] \md
v_mov_b64 v[60:61], -1
v_mov_b64 v[62:63], -1
ds_write_b128 v4, v[60:63] offset:11264
ds_write_b128 v4, v[60:63] offset:12288
ds_write_b128 v4, v[60:63] offset:13312
v_and_b32 v10, 0x200ff, v4
ds_read_b128 v[76:79], v10 offset:31744
s_add_u32 s51, s56, 0x18c00
s_and_b32 s51, s51, 0x1ffff
s_add_u32 s24, s14, s51
s_addc_u32 s25, s15, 0
s_add_u32 s56, s56, 0x8000
s_and_b32 s56, s56, 0x1ffff
s_add_u32 s51, s56, 3072
s_add_u32 s22, s14, s51
s_addc_u32 s23, s15, 0
s_add_u32 s51, s56, s96
s_add_u32 s20, s14, s51
s_addc_u32 s21, s15, 0
s_mov_b32 s74, 0
s_sleep 2
s_nop 7
s_nop 3
global_load_dwordx4 v[12:15], v0, s[34:35] sc1
global_load_dwordx4 v[16:19], v0, s[34:35] offset:1024 sc1
global_load_dwordx4 v[20:23], v0, s[34:35] offset:2048 sc1
global_load_dwordx4 v[24:27], v0, s[34:35] offset:3072 sc1
s_waitcnt lgkmcnt(0)
s_waitcnt vmcnt(3)
v_mfma_f32_16x16x32_bf16 v[44:47], v[76:79], v[12:15], 0
s_waitcnt vmcnt(2)
v_mfma_f32_16x16x32_bf16 v[44:47], v[76:79], v[16:19], v[44:47]
s_waitcnt vmcnt(1)
v_mfma_f32_16x16x32_bf16 v[44:47], v[76:79], v[20:23], v[44:47]
v_min3_u32 v48, v15, v19, v23
s_waitcnt vmcnt(0)
v_mfma_f32_16x16x32_bf16 v[44:47], v[76:79], v[24:27], v[44:47]
v_min_u32 v48, v48, v27
v_cmp_ne_u32 vcc, s75, v48
s_nop 4
s_cbranch_vccnz C\sfx\()1_1_retry_u1
v_add_f32_dpp v46, v44, v44 row_ror:8 row_mask:0xf bank_mask:0xf
v_add_f32_dpp v47, v45, v45 row_ror:8 row_mask:0xf bank_mask:0xf
v_cvt_pk_bf16_f32 v44, v46, v47
global_store_dword v7, v44, s[70:71] \md
C\sfx\()1_1_done_u1:
v_mov_b32 v48, -1
global_store_dword v7, v48, s[72:73] \md
s_waitcnt vmcnt(2)
ds_read_b128 v[44:47], v0 offset:4096
ds_read_b128 v[48:51], v0 offset:5120
ds_read_b128 v[52:55], v0 offset:6144
ds_read_b128 v[56:59], v0 offset:7168
v_mov_b64 v[28:29], 0
v_mov_b64 v[30:31], 0
v_mov_b64 v[32:33], 0
v_mov_b64 v[34:35], 0
v_mov_b64 v[36:37], 0
v_mov_b64 v[38:39], 0
v_mov_b64 v[40:41], 0
v_mov_b64 v[42:43], 0
s_add_u32 s75, s75, 1
s_barrier
s_branch C\sfx\()1_0_qk
C\sfx\()1_0_retry_ag:
s_waitcnt vmcnt(0) lgkmcnt(0)
s_add_u32 s76, s76, 0x10000
s_sub_u32 s43, s43, 1
s_cbranch_scc1 EXIT2
s_add_u32 s52, s70, 0x0
s_addc_u32 s53, s71, 0
s_sub_u32 s52, s52, 3072
s_subb_u32 s53, s53, 0
s_mov_b32 m0, 0x22000
s_nop 0
global_load_lds_dwordx4 v0, s[52:53] sc1
s_add_u32 s52, s70, 0x400
s_addc_u32 s53, s71, 0
s_sub_u32 s52, s52, 3072
s_subb_u32 s53, s53, 0
s_mov_b32 m0, 0x22400
s_nop 0
global_load_lds_dwordx4 v0, s[52:53] sc1
s_add_u32 s52, s70, 0x800
s_addc_u32 s53, s71, 0
s_sub_u32 s52, s52, 3072
s_subb_u32 s53, s53, 0
s_mov_b32 m0, 0x22800
s_nop 0
global_load_lds_dwordx4 v0, s[52:53] sc1
s_add_u32 s52, s70, 0xc00
s_addc_u32 s53, s71, 0
s_sub_u32 s52, s52, 3072
s_subb_u32 s53, s53, 0
s_mov_b32 m0, 0x22c00
s_nop 0
global_load_lds_dwordx4 v0, s[52:53] sc1
s_add_u32 s52, s70, 0x1000
s_addc_u32 s53, s71, 0
s_sub_u32 s52, s52, 3072
s_subb_u32 s53, s53, 0
s_mov_b32 m0, 0x23000
s_nop 0
global_load_lds_dwordx4 v0, s[52:53] sc1
s_add_u32 s52, s70, 0x1400
s_addc_u32 s53, s71, 0
s_sub_u32 s52, s52, 3072
s_subb_u32 s53, s53, 0
s_mov_b32 m0, 0x23400
s_nop 0
global_load_lds_dwordx4 v0, s[52:53] sc1
s_add_u32 s52, s70, 0x1800
s_addc_u32 s53, s71, 0
s_sub_u32 s52, s52, 3072
s_subb_u32 s53, s53, 0
s_mov_b32 m0, 0x23800
s_nop 0
global_load_lds_dwordx4 v0, s[52:53] sc1
s_add_u32 s52, s70, 0x1c00
s_addc_u32 s53, s71, 0
s_sub_u32 s52, s52, 3072
s_subb_u32 s53, s53, 0
s_mov_b32 m0, 0x23c00
s_nop 0
global_load_lds_dwordx4 v0, s[52:53] sc1
s_add_u32 s52, s70, 0x2000
s_addc_u32 s53, s71, 0
s_sub_u32 s52, s52, 3072
s_subb_u32 s53, s53, 0
s_mov_b32 m0, 0x27800
s_nop 0
global_load_lds_dwordx4 v0, s[52:53] sc1
ds_read_b128 v[44:47], v0 offset:4096
ds_read_b128 v[48:51], v0 offset:5120
ds_read_b128 v[52:55], v0 offset:6144
ds_read_b128 v[56:59], v0 offset:7168
v_mov_b64 v[28:29], 0
v_mov_b64 v[30:31], 0
v_mov_b64 v[32:33], 0
v_mov_b64 v[34:35], 0
v_mov_b64 v[36:37], 0
v_mov_b64 v[38:39], 0
v_mov_b64 v[40:41], 0
v_mov_b64 v[42:43], 0
s_waitcnt vmcnt(0)
ds_read_b128 v[12:15], v4 offset:8192
ds_read_b128 v[16:19], v4 offset:9216
ds_read_b128 v[20:23], v4 offset:10240
s_add_u32 s52, s36, 0x2000
s_addc_u32 s53, s37, 0
s_waitcnt lgkmcnt(2)
v_smfmac_f32_16x16x64_bf16 v[28:31], v[12:15], v[80:87], v1
ds_read_b128 v[24:27], v4 offset:11264
v_smfmac_f32_16x16x64_bf16 v[32:35], v[12:15], v[88:95], v1
v_smfmac_f32_16x16x64_bf16 v[36:39], v[12:15], v[44:51], v1
ds_read_b128 v[44:47], v0 offset:20480
v_smfmac_f32_16x16x64_bf16 v[40:43], v[12:15], v[52:59], v1
ds_read_b128 v[48:51], v0 offset:21504
s_waitcnt lgkmcnt(4)
v_smfmac_f32_16x16x64_bf16 v[28:31], v[16:19], v[96:103], v1
ds_read_b128 v[52:55], v0 offset:22528
v_smfmac_f32_16x16x64_bf16 v[32:35], v[16:19], v[104:111], v1
ds_read_b128 v[56:59], v0 offset:23552
v_smfmac_f32_16x16x64_bf16 v[36:39], v[16:19], v[224:231], v1
ds_read_b128 v[12:15], v4 offset:12288
v_smfmac_f32_16x16x64_bf16 v[40:43], v[16:19], v[232:239], v1
s_waitcnt lgkmcnt(6)
v_smfmac_f32_16x16x64_bf16 v[28:31], v[20:23], v[112:119], v1
ds_read_b128 v[16:19], v4 offset:13312
v_smfmac_f32_16x16x64_bf16 v[32:35], v[20:23], v[120:127], v1
s_waitcnt lgkmcnt(4)
v_smfmac_f32_16x16x64_bf16 v[36:39], v[20:23], v[44:51], v1
ds_read_b128 v[44:47], v0 offset:36864
s_waitcnt lgkmcnt(3)
v_smfmac_f32_16x16x64_bf16 v[40:43], v[20:23], v[52:59], v1
ds_read_b128 v[48:51], v0 offset:37888
v_smfmac_f32_16x16x64_bf16 v[28:31], v[24:27], v[128:135], v1
ds_read_b128 v[52:55], v0 offset:38912
v_smfmac_f32_16x16x64_bf16 v[32:35], v[24:27], v[136:143], v1
ds_read_b128 v[56:59], v0 offset:39936
v_smfmac_f32_16x16x64_bf16 v[36:39], v[24:27], v[240:247], v1
ds_read_b128 v[20:23], v4 offset:14336
v_smfmac_f32_16x16x64_bf16 v[40:43], v[24:27], v[248:255], v1
s_waitcnt lgkmcnt(6)
v_smfmac_f32_16x16x64_bf16 v[28:31], v[12:15], v[144:151], v1
ds_read_b128 v[24:27], v4 offset:15360
v_smfmac_f32_16x16x64_bf16 v[32:35], v[12:15], v[152:159], v1
s_waitcnt lgkmcnt(4)
v_smfmac_f32_16x16x64_bf16 v[36:39], v[12:15], v[44:51], v1
ds_read_b128 v[44:47], v0 offset:53248
s_waitcnt lgkmcnt(3)
v_smfmac_f32_16x16x64_bf16 v[40:43], v[12:15], v[52:59], v1
ds_read_b128 v[48:51], v0 offset:54272
v_smfmac_f32_16x16x64_bf16 v[28:31], v[16:19], v[160:167], v1
ds_read_b128 v[52:55], v0 offset:55296
v_smfmac_f32_16x16x64_bf16 v[32:35], v[16:19], v[168:175], v1
ds_read_b128 v[56:59], v0 offset:56320
v_smfmac_f32_16x16x64_bf16 v[36:39], v[16:19], a[0:7], v1
ds_read_b128 v[12:15], v4 offset:30720
v_smfmac_f32_16x16x64_bf16 v[40:43], v[16:19], a[8:15], v1
s_waitcnt lgkmcnt(6)
v_smfmac_f32_16x16x64_bf16 v[28:31], v[20:23], v[176:183], v1
s_waitcnt lgkmcnt(3)
v_smfmac_f32_16x16x64_bf16 v[36:39], v[20:23], v[44:51], v1
ds_read_b128 v[44:47], v9 offset:4096
v_smfmac_f32_16x16x64_bf16 v[32:35], v[20:23], v[184:191], v1
ds_read_b128 v[48:51], v9 offset:5120
s_waitcnt lgkmcnt(3)
v_smfmac_f32_16x16x64_bf16 v[40:43], v[20:23], v[52:59], v1
ds_read_b128 v[52:55], v9 offset:6144
v_smfmac_f32_16x16x64_bf16 v[28:31], v[24:27], v[192:199], v1
ds_read_b128 v[56:59], v9 offset:7168
v_smfmac_f32_16x16x64_bf16 v[36:39], v[24:27], a[16:23], v1
s_waitcnt lgkmcnt(4)
v_smfmac_f32_16x16x64_bf16 v[28:31], v[12:15], v[208:215], v1
s_waitcnt lgkmcnt(2)
v_smfmac_f32_16x16x64_bf16 v[36:39], v[12:15], v[44:51], v1
v_smfmac_f32_16x16x64_bf16 v[32:35], v[24:27], v[200:207], v1
v_mov_b64 v[44:45], 0
v_smfmac_f32_16x16x64_bf16 v[40:43], v[24:27], a[24:31], v1
v_mov_b64 v[48:49], 0
s_nop 1
v_add_f32 v28, v28, v30
v_smfmac_f32_16x16x64_bf16 v[32:35], v[12:15], v[216:223], v1
v_add_f32 v29, v29, v31
v_cvt_pk_bf16_f32 v77, v28, v29
v_add_f32 v36, v36, v38
s_waitcnt lgkmcnt(0)
v_smfmac_f32_16x16x64_bf16 v[40:43], v[12:15], v[52:59], v1
v_add_f32 v37, v37, v39
v_cvt_pk_bf16_f32 v76, v36, v37
ds_write_b64 v2, v[76:77]
v_mov_b64 v[46:47], 0
v_mov_b64 v[50:51], 0
s_nop 1
s_branch C\sfx\()1_0_postqk
C\sfx\()1_0_retry0:
s_add_u32 s76, s76, 1
s_waitcnt lgkmcnt(0)
s_nop 3
v_mov_b64 v[28:29], 0
v_mov_b64 v[30:31], 0
v_mov_b64 v[32:33], 0
v_mov_b64 v[34:35], 0
C\sfx\()1_0_retry0_p:
ds_read_b128 v[12:15], v4 offset:8192
ds_read_b128 v[16:19], v4 offset:9216
ds_read_b128 v[20:23], v4 offset:10240
s_sub_u32 s43, s43, 1
s_cbranch_scc1 EXIT2
s_waitcnt lgkmcnt(0)
v_add_f32 v10, v12, v16
v_cmp_u_f32 vcc, v10, v20
s_cbranch_vccnz C\sfx\()1_0_retry0_p
s_branch C\sfx\()1_0_back0
C\sfx\()1_0_retry1:
s_add_u32 s76, s76, 1
C\sfx\()1_0_retry1_p:
s_mov_b32 m0, 0x22c00
s_nop 0
global_load_lds_dwordx4 v0, s[68:69] sc1
global_load_lds_dwordx4 v0, s[68:69] offset:1024 sc1
global_load_lds_dwordx4 v0, s[68:69] offset:2048 sc1
s_waitcnt vmcnt(3)
ds_read_b128 v[24:27], v4 offset:11264
ds_read_b128 v[12:15], v4 offset:12288
s_sub_u32 s43, s43, 1
s_cbranch_scc1 EXIT2
s_waitcnt lgkmcnt(0)
v_cmp_u_f32 vcc, v24, v12
s_cbranch_vccnz C\sfx\()1_0_retry1_p
s_branch C\sfx\()1_0_back1
C\sfx\()1_0_retry1b:
s_add_u32 s76, s76, 1
C\sfx\()1_0_retry1b_p:
s_mov_b32 m0, 0x22c00
s_nop 0
global_load_lds_dwordx4 v0, s[68:69] sc1
global_load_lds_dwordx4 v0, s[68:69] offset:1024 sc1
global_load_lds_dwordx4 v0, s[68:69] offset:2048 sc1
s_waitcnt vmcnt(3)
ds_read_b128 v[16:19], v4 offset:13312
s_sub_u32 s43, s43, 1
s_cbranch_scc1 EXIT2
s_waitcnt lgkmcnt(0)
v_cmp_u_f32 vcc, v16, v16
s_cbranch_vccnz C\sfx\()1_0_retry1b_p
s_waitcnt vmcnt(0)
s_branch C\sfx\()1_0_back1b
C\sfx\()1_0_retry2:
s_add_u32 s76, s76, 1
C\sfx\()1_0_retry2_p:
ds_read_b128 v[20:23], v4 offset:14336
ds_read_b128 v[24:27], v4 offset:15360
s_sub_u32 s43, s43, 1
s_cbranch_scc1 EXIT2
s_waitcnt lgkmcnt(0)
v_cmp_u_f32 vcc, v20, v24
s_cbranch_vccnz C\sfx\()1_0_retry2_p
s_branch C\sfx\()1_0_back2
C\sfx\()1_0_retry2b:
s_add_u32 s76, s76, 1
C\sfx\()1_0_retry2b_p:
ds_read_b128 v[12:15], v4 offset:30720
s_sub_u32 s43, s43, 1
s_cbranch_scc1 EXIT2
s_waitcnt lgkmcnt(0)
v_cmp_u_f32 vcc, v12, v12
s_cbranch_vccnz C\sfx\()1_0_retry2b_p
s_branch C\sfx\()1_0_back2b
C\sfx\()1_0_retry_u1:
s_add_u32 s77, s77, 1
s_mov_b32 s74, 1
global_load_dwordx4 v[12:15], v0, s[32:33] sc1
global_load_dwordx4 v[16:19], v0, s[32:33] offset:1024 sc1
global_load_dwordx4 v[20:23], v0, s[32:33] offset:2048 sc1
global_load_dwordx4 v[24:27], v0, s[32:33] offset:3072 sc1
C\sfx\()1_0_retry_u1_l:
s_waitcnt vmcnt(3)
v_mfma_f32_16x16x32_bf16 v[44:47], v[76:79], v[12:15], 0
s_waitcnt vmcnt(2)
v_mfma_f32_16x16x32_bf16 v[44:47], v[76:79], v[16:19], v[44:47]
s_waitcnt vmcnt(1)
v_mfma_f32_16x16x32_bf16 v[44:47], v[76:79], v[20:23], v[44:47]
v_min3_u32 v48, v15, v19, v23
s_waitcnt vmcnt(0)
v_mfma_f32_16x16x32_bf16 v[44:47], v[76:79], v[24:27], v[44:47]
v_min_u32 v48, v48, v27
v_cmp_ne_u32 vcc, s75, v48
s_nop 4
s_cbranch_vccnz C\sfx\()1_0_retry_u1_m0
v_add_f32_dpp v46, v44, v44 row_ror:8 row_mask:0xf bank_mask:0xf
v_add_f32_dpp v47, v45, v45 row_ror:8 row_mask:0xf bank_mask:0xf
v_cvt_pk_bf16_f32 v44, v46, v47
global_store_dword v7, v44, s[22:23] \md
s_branch C\sfx\()1_0_done_u1
C\sfx\()1_0_retry_u1_m0:
global_load_dwordx4 v[12:15], v0, s[32:33] sc1
global_load_dwordx4 v[16:19], v0, s[32:33] offset:1024 sc1
global_load_dwordx4 v[20:23], v0, s[32:33] offset:2048 sc1
global_load_dwordx4 v[24:27], v0, s[32:33] offset:3072 sc1
s_sub_u32 s43, s43, 1
s_cbranch_scc1 EXIT2
s_branch C\sfx\()1_0_retry_u1_l
C\sfx\()1_0_slow:
s_waitcnt lgkmcnt(0)
s_nop 7
ds_read_b64_tr_b16 v[24:25], v3
ds_read_b64_tr_b16 v[26:27], v3 offset:512
ds_read_b128 v[28:31], v4
ds_read_b128 v[32:35], v4 offset:4096
s_waitcnt lgkmcnt(0)
v_mfma_f32_16x16x32_bf16 v[12:15], v[28:31], v[24:27], 0
v_mfma_f32_16x16x32_bf16 v[16:19], v[32:35], v[24:27], 0
v_mfma_f32_16x16x32_bf16 v[20:23], v[24:27], v[24:27], 0
s_nop 7
ds_read_b64_tr_b16 v[24:25], v3 offset:1024
ds_read_b64_tr_b16 v[26:27], v3 offset:1536
ds_read_b128 v[28:31], v4 offset:1024
ds_read_b128 v[32:35], v4 offset:5120
s_waitcnt lgkmcnt(0)
v_mfma_f32_16x16x32_bf16 v[12:15], v[28:31], v[24:27], v[12:15]
v_mfma_f32_16x16x32_bf16 v[16:19], v[32:35], v[24:27], v[16:19]
v_mfma_f32_16x16x32_bf16 v[20:23], v[24:27], v[24:27], v[20:23]
s_nop 7
ds_read_b64_tr_b16 v[24:25], v3 offset:2048
ds_read_b64_tr_b16 v[26:27], v3 offset:2560
ds_read_b128 v[28:31], v4 offset:2048
ds_read_b128 v[32:35], v4 offset:6144
s_waitcnt lgkmcnt(0)
v_mfma_f32_16x16x32_bf16 v[12:15], v[28:31], v[24:27], v[12:15]
v_mfma_f32_16x16x32_bf16 v[16:19], v[32:35], v[24:27], v[16:19]
v_mfma_f32_16x16x32_bf16 v[20:23], v[24:27], v[24:27], v[20:23]
s_nop 7
ds_read_b64_tr_b16 v[24:25], v3 offset:3072
ds_read_b64_tr_b16 v[26:27], v3 offset:3584
ds_read_b128 v[28:31], v4 offset:3072
ds_read_b128 v[32:35], v4 offset:7168
s_waitcnt lgkmcnt(0)
v_mfma_f32_16x16x32_bf16 v[12:15], v[28:31], v[24:27], v[12:15]
v_mfma_f32_16x16x32_bf16 v[16:19], v[32:35], v[24:27], v[16:19]
v_mfma_f32_16x16x32_bf16 v[20:23], v[24:27], v[24:27], v[20:23]
s_nop 7
v_mul_f32 v20, s44, v20
v_mul_f32 v21, s44, v21
v_max3_f32 v22, v20, v21, v12
v_max3_f32 v22, v22, v13, v14
v_max3_f32 v22, v22, v15, v16
v_max3_f32 v22, v22, v17, v18
v_max_f32 v22, v22, v19
v_mov_b32 v23, v22
s_nop 1
v_permlane16_swap_b32 v22, v23
s_nop 1
v_max_f32 v22, v22, v23
v_mov_b32 v23, v22
s_nop 1
v_permlane32_swap_b32 v22, v23
s_nop 1
v_max_f32 v22, v22, v23
v_sub_f32 v12, v12, v22
v_exp_f32 v12, v12
v_sub_f32 v13, v13, v22
v_exp_f32 v13, v13
v_sub_f32 v14, v14, v22
v_exp_f32 v14, v14
v_sub_f32 v15, v15, v22
v_exp_f32 v15, v15
v_sub_f32 v16, v16, v22
v_exp_f32 v16, v16
v_sub_f32 v17, v17, v22
v_exp_f32 v17, v17
v_sub_f32 v18, v18, v22
v_exp_f32 v18, v18
v_sub_f32 v19, v19, v22
v_exp_f32 v19, v19
v_sub_f32 v20, v20, v22
v_exp_f32 v20, v20
v_sub_f32 v21, v21, v22
v_exp_f32 v21, v21
v_cvt_pk_bf16_f32 v76, v12, v13
v_cvt_pk_bf16_f32 v77, v14, v15
v_cvt_pk_bf16_f32 v78, v16, v17
v_cvt_pk_bf16_f32 v79, v18, v19
v_cvt_pk_bf16_f32 v10, v20, v21
ds_read_b128 v[28:31], v4 offset:18432
ds_read_b128 v[32:35], v4 offset:19456
s_waitcnt lgkmcnt(0)
v_mfma_f32_16x16x32_bf16 v[60:63], v[76:79], v[28:31], 0
v_mfma_f32_16x16x32_bf16 v[64:67], v[76:79], v[32:35], 0
v_mfma_f32_16x16x32_bf16 v[40:43], v[76:79], v[36:39], 0
s_nop 5
v_mfma_f32_16x16x16_bf16 v[40:43], v[10:11], v[36:37], v[40:43]
v_mfma_f32_16x16x16_bf16 v[60:63], v[10:11], v[52:53], v[60:63]
v_mfma_f32_16x16x16_bf16 v[64:67], v[10:11], v[56:57], v[64:67]
s_nop 5
v_rcp_f32 v70, v42
v_rcp_f32 v71, v43
v_mul_f32 v62, v62, v70
v_mul_f32 v63, v63, v71
v_cvt_pk_bf16_f32 v68, v62, v63
ds_write_b32 v2, v68 offset:4096
v_mul_f32 v66, v66, v70
v_mul_f32 v67, v67, v71
v_cvt_pk_bf16_f32 v69, v66, v67
ds_write_b32 v2, v69 offset:4608
s_waitcnt lgkmcnt(0)
v_mov_b64 v[12:13], 0
v_mov_b64 v[14:15], 0
v_mov_b64 v[16:17], 0
v_mov_b64 v[18:19], 0
v_mov_b64 v[20:21], 0
v_mov_b64 v[22:23], 0
s_nop 3
s_branch C\sfx\()1_0_oskip
C\sfx\()1_1_retry_ag:
s_waitcnt vmcnt(0) lgkmcnt(0)
s_add_u32 s76, s76, 0x10000
s_sub_u32 s43, s43, 1
s_cbranch_scc1 EXIT2
s_add_u32 s52, s22, 0x0
s_addc_u32 s53, s23, 0
s_sub_u32 s52, s52, 3072
s_subb_u32 s53, s53, 0
s_mov_b32 m0, 0x20000
s_nop 0
global_load_lds_dwordx4 v0, s[52:53] sc1
s_add_u32 s52, s22, 0x400
s_addc_u32 s53, s23, 0
s_sub_u32 s52, s52, 3072
s_subb_u32 s53, s53, 0
s_mov_b32 m0, 0x20400
s_nop 0
global_load_lds_dwordx4 v0, s[52:53] sc1
s_add_u32 s52, s22, 0x800
s_addc_u32 s53, s23, 0
s_sub_u32 s52, s52, 3072
s_subb_u32 s53, s53, 0
s_mov_b32 m0, 0x20800
s_nop 0
global_load_lds_dwordx4 v0, s[52:53] sc1
s_add_u32 s52, s22, 0xc00
s_addc_u32 s53, s23, 0
s_sub_u32 s52, s52, 3072
s_subb_u32 s53, s53, 0
s_mov_b32 m0, 0x20c00
s_nop 0
global_load_lds_dwordx4 v0, s[52:53] sc1
s_add_u32 s52, s22, 0x1000
s_addc_u32 s53, s23, 0
s_sub_u32 s52, s52, 3072
s_subb_u32 s53, s53, 0
s_mov_b32 m0, 0x21000
s_nop 0
global_load_lds_dwordx4 v0, s[52:53] sc1
s_add_u32 s52, s22, 0x1400
s_addc_u32 s53, s23, 0
s_sub_u32 s52, s52, 3072
s_subb_u32 s53, s53, 0
s_mov_b32 m0, 0x21400
s_nop 0
global_load_lds_dwordx4 v0, s[52:53] sc1
s_add_u32 s52, s22, 0x1800
s_addc_u32 s53, s23, 0
s_sub_u32 s52, s52, 3072
s_subb_u32 s53, s53, 0
s_mov_b32 m0, 0x21800
s_nop 0
global_load_lds_dwordx4 v0, s[52:53] sc1
s_add_u32 s52, s22, 0x1c00
s_addc_u32 s53, s23, 0
s_sub_u32 s52, s52, 3072
s_subb_u32 s53, s53, 0
s_mov_b32 m0, 0x21c00
s_nop 0
global_load_lds_dwordx4 v0, s[52:53] sc1
s_add_u32 s52, s22, 0x2000
s_addc_u32 s53, s23, 0
s_sub_u32 s52, s52, 3072
s_subb_u32 s53, s53, 0
s_mov_b32 m0, 0x27800
s_nop 0
global_load_lds_dwordx4 v0, s[52:53] sc1
ds_read_b128 v[44:47], v0 offset:4096
ds_read_b128 v[48:51], v0 offset:5120
ds_read_b128 v[52:55], v0 offset:6144
ds_read_b128 v[56:59], v0 offset:7168
v_mov_b64 v[28:29], 0
v_mov_b64 v[30:31], 0
v_mov_b64 v[32:33], 0
v_mov_b64 v[34:35], 0
v_mov_b64 v[36:37], 0
v_mov_b64 v[38:39], 0
v_mov_b64 v[40:41], 0
v_mov_b64 v[42:43], 0
s_waitcnt vmcnt(0)
ds_read_b128 v[12:15], v4
ds_read_b128 v[16:19], v4 offset:1024
ds_read_b128 v[20:23], v4 offset:2048
s_add_u32 s52, s36, 0x2000
s_addc_u32 s53, s37, 0
s_waitcnt lgkmcnt(2)
v_smfmac_f32_16x16x64_bf16 v[28:31], v[12:15], v[80:87], v1
ds_read_b128 v[24:27], v4 offset:3072
v_smfmac_f32_16x16x64_bf16 v[32:35], v[12:15], v[88:95], v1
v_smfmac_f32_16x16x64_bf16 v[36:39], v[12:15], v[44:51], v1
ds_read_b128 v[44:47], v0 offset:20480
v_smfmac_f32_16x16x64_bf16 v[40:43], v[12:15], v[52:59], v1
ds_read_b128 v[48:51], v0 offset:21504
s_waitcnt lgkmcnt(4)
v_smfmac_f32_16x16x64_bf16 v[28:31], v[16:19], v[96:103], v1
ds_read_b128 v[52:55], v0 offset:22528
v_smfmac_f32_16x16x64_bf16 v[32:35], v[16:19], v[104:111], v1
ds_read_b128 v[56:59], v0 offset:23552
v_smfmac_f32_16x16x64_bf16 v[36:39], v[16:19], v[224:231], v1
ds_read_b128 v[12:15], v4 offset:4096
v_smfmac_f32_16x16x64_bf16 v[40:43], v[16:19], v[232:239], v1
s_waitcnt lgkmcnt(6)
v_smfmac_f32_16x16x64_bf16 v[28:31], v[20:23], v[112:119], v1
ds_read_b128 v[16:19], v4 offset:5120
v_smfmac_f32_16x16x64_bf16 v[32:35], v[20:23], v[120:127], v1
s_waitcnt lgkmcnt(4)
v_smfmac_f32_16x16x64_bf16 v[36:39], v[20:23], v[44:51], v1
ds_read_b128 v[44:47], v0 offset:36864
s_waitcnt lgkmcnt(3)
v_smfmac_f32_16x16x64_bf16 v[40:43], v[20:23], v[52:59], v1
ds_read_b128 v[48:51], v0 offset:37888
v_smfmac_f32_16x16x64_bf16 v[28:31], v[24:27], v[128:135], v1
ds_read_b128 v[52:55], v0 offset:38912
v_smfmac_f32_16x16x64_bf16 v[32:35], v[24:27], v[136:143], v1
ds_read_b128 v[56:59], v0 offset:39936
v_smfmac_f32_16x16x64_bf16 v[36:39], v[24:27], v[240:247], v1
ds_read_b128 v[20:23], v4 offset:6144
v_smfmac_f32_16x16x64_bf16 v[40:43], v[24:27], v[248:255], v1
s_waitcnt lgkmcnt(6)
v_smfmac_f32_16x16x64_bf16 v[28:31], v[12:15], v[144:151], v1
ds_read_b128 v[24:27], v4 offset:7168
v_smfmac_f32_16x16x64_bf16 v[32:35], v[12:15], v[152:159], v1
s_waitcnt lgkmcnt(4)
v_smfmac_f32_16x16x64_bf16 v[36:39], v[12:15], v[44:51], v1
ds_read_b128 v[44:47], v0 offset:53248
s_waitcnt lgkmcnt(3)
v_smfmac_f32_16x16x64_bf16 v[40:43], v[12:15], v[52:59], v1
ds_read_b128 v[48:51], v0 offset:54272
v_smfmac_f32_16x16x64_bf16 v[28:31], v[16:19], v[160:167], v1
ds_read_b128 v[52:55], v0 offset:55296
v_smfmac_f32_16x16x64_bf16 v[32:35], v[16:19], v[168:175], v1
ds_read_b128 v[56:59], v0 offset:56320
v_smfmac_f32_16x16x64_bf16 v[36:39], v[16:19], a[0:7], v1
ds_read_b128 v[12:15], v4 offset:30720
v_smfmac_f32_16x16x64_bf16 v[40:43], v[16:19], a[8:15], v1
s_waitcnt lgkmcnt(6)
v_smfmac_f32_16x16x64_bf16 v[28:31], v[20:23], v[176:183], v1
s_waitcnt lgkmcnt(3)
v_smfmac_f32_16x16x64_bf16 v[36:39], v[20:23], v[44:51], v1
ds_read_b128 v[44:47], v9 offset:4096
v_smfmac_f32_16x16x64_bf16 v[32:35], v[20:23], v[184:191], v1
ds_read_b128 v[48:51], v9 offset:5120
s_waitcnt lgkmcnt(3)
v_smfmac_f32_16x16x64_bf16 v[40:43], v[20:23], v[52:59], v1
ds_read_b128 v[52:55], v9 offset:6144
v_smfmac_f32_16x16x64_bf16 v[28:31], v[24:27], v[192:199], v1
ds_read_b128 v[56:59], v9 offset:7168
v_smfmac_f32_16x16x64_bf16 v[36:39], v[24:27], a[16:23], v1
s_waitcnt lgkmcnt(4)
v_smfmac_f32_16x16x64_bf16 v[28:31], v[12:15], v[208:215], v1
s_waitcnt lgkmcnt(2)
v_smfmac_f32_16x16x64_bf16 v[36:39], v[12:15], v[44:51], v1
v_smfmac_f32_16x16x64_bf16 v[32:35], v[24:27], v[200:207], v1
v_mov_b64 v[44:45], 0
v_smfmac_f32_16x16x64_bf16 v[40:43], v[24:27], a[24:31], v1
v_mov_b64 v[48:49], 0
s_nop 1
v_add_f32 v28, v28, v30
v_smfmac_f32_16x16x64_bf16 v[32:35], v[12:15], v[216:223], v1
v_add_f32 v29, v29, v31
v_cvt_pk_bf16_f32 v77, v28, v29
v_add_f32 v36, v36, v38
s_waitcnt lgkmcnt(0)
v_smfmac_f32_16x16x64_bf16 v[40:43], v[12:15], v[52:59], v1
v_add_f32 v37, v37, v39
v_cvt_pk_bf16_f32 v76, v36, v37
ds_write_b64 v2, v[76:77]
v_mov_b64 v[46:47], 0
v_mov_b64 v[50:51], 0
s_nop 1
s_branch C\sfx\()1_1_postqk
C\sfx\()1_1_retry0:
s_add_u32 s76, s76, 1
s_waitcnt lgkmcnt(0)
s_nop 3
v_mov_b64 v[28:29], 0
v_mov_b64 v[30:31], 0
v_mov_b64 v[32:33], 0
v_mov_b64 v[34:35], 0
C\sfx\()1_1_retry0_p:
ds_read_b128 v[12:15], v4
ds_read_b128 v[16:19], v4 offset:1024
ds_read_b128 v[20:23], v4 offset:2048
s_sub_u32 s43, s43, 1
s_cbranch_scc1 EXIT2
s_waitcnt lgkmcnt(0)
v_add_f32 v10, v12, v16
v_cmp_u_f32 vcc, v10, v20
s_cbranch_vccnz C\sfx\()1_1_retry0_p
s_branch C\sfx\()1_1_back0
C\sfx\()1_1_retry1:
s_add_u32 s76, s76, 1
C\sfx\()1_1_retry1_p:
s_mov_b32 m0, 0x20c00
s_nop 0
global_load_lds_dwordx4 v0, s[20:21] sc1
global_load_lds_dwordx4 v0, s[20:21] offset:1024 sc1
global_load_lds_dwordx4 v0, s[20:21] offset:2048 sc1
s_waitcnt vmcnt(3)
ds_read_b128 v[24:27], v4 offset:3072
ds_read_b128 v[12:15], v4 offset:4096
s_sub_u32 s43, s43, 1
s_cbranch_scc1 EXIT2
s_waitcnt lgkmcnt(0)
v_cmp_u_f32 vcc, v24, v12
s_cbranch_vccnz C\sfx\()1_1_retry1_p
s_branch C\sfx\()1_1_back1
C\sfx\()1_1_retry1b:
s_add_u32 s76, s76, 1
C\sfx\()1_1_retry1b_p:
s_mov_b32 m0, 0x20c00
s_nop 0
global_load_lds_dwordx4 v0, s[20:21] sc1
global_load_lds_dwordx4 v0, s[20:21] offset:1024 sc1
global_load_lds_dwordx4 v0, s[20:21] offset:2048 sc1
s_waitcnt vmcnt(3)
ds_read_b128 v[16:19], v4 offset:5120
s_sub_u32 s43, s43, 1
s_cbranch_scc1 EXIT2
s_waitcnt lgkmcnt(0)
v_cmp_u_f32 vcc, v16, v16
s_cbranch_vccnz C\sfx\()1_1_retry1b_p
s_waitcnt vmcnt(0)
s_branch C\sfx\()1_1_back1b
C\sfx\()1_1_retry2:
s_add_u32 s76, s76, 1
C\sfx\()1_1_retry2_p:
ds_read_b128 v[20:23], v4 offset:6144
ds_read_b128 v[24:27], v4 offset:7168
s_sub_u32 s43, s43, 1
s_cbranch_scc1 EXIT2
s_waitcnt lgkmcnt(0)
v_cmp_u_f32 vcc, v20, v24
s_cbranch_vccnz C\sfx\()1_1_retry2_p
s_branch C\sfx\()1_1_back2
C\sfx\()1_1_retry2b:
s_add_u32 s76, s76, 1
C\sfx\()1_1_retry2b_p:
ds_read_b128 v[12:15], v4 offset:30720
s_sub_u32 s43, s43, 1
s_cbranch_scc1 EXIT2
s_waitcnt lgkmcnt(0)
v_cmp_u_f32 vcc, v12, v12
s_cbranch_vccnz C\sfx\()1_1_retry2b_p
s_branch C\sfx\()1_1_back2b
C\sfx\()1_1_retry_u1:
s_add_u32 s77, s77, 1
s_mov_b32 s74, 1
global_load_dwordx4 v[12:15], v0, s[34:35] sc1
global_load_dwordx4 v[16:19], v0, s[34:35] offset:1024 sc1
global_load_dwordx4 v[20:23], v0, s[34:35] offset:2048 sc1
global_load_dwordx4 v[24:27], v0, s[34:35] offset:3072 sc1
C\sfx\()1_1_retry_u1_l:
s_waitcnt vmcnt(3)
v_mfma_f32_16x16x32_bf16 v[44:47], v[76:79], v[12:15], 0
s_waitcnt vmcnt(2)
v_mfma_f32_16x16x32_bf16 v[44:47], v[76:79], v[16:19], v[44:47]
s_waitcnt vmcnt(1)
v_mfma_f32_16x16x32_bf16 v[44:47], v[76:79], v[20:23], v[44:47]
v_min3_u32 v48, v15, v19, v23
s_waitcnt vmcnt(0)
v_mfma_f32_16x16x32_bf16 v[44:47], v[76:79], v[24:27], v[44:47]
v_min_u32 v48, v48, v27
v_cmp_ne_u32 vcc, s75, v48
s_nop 4
s_cbranch_vccnz C\sfx\()1_1_retry_u1_m0
v_add_f32_dpp v46, v44, v44 row_ror:8 row_mask:0xf bank_mask:0xf
v_add_f32_dpp v47, v45, v45 row_ror:8 row_mask:0xf bank_mask:0xf
v_cvt_pk_bf16_f32 v44, v46, v47
global_store_dword v7, v44, s[70:71] \md
s_branch C\sfx\()1_1_done_u1
C\sfx\()1_1_retry_u1_m0:
global_load_dwordx4 v[12:15], v0, s[34:35] sc1
global_load_dwordx4 v[16:19], v0, s[34:35] offset:1024 sc1
global_load_dwordx4 v[20:23], v0, s[34:35] offset:2048 sc1
global_load_dwordx4 v[24:27], v0, s[34:35] offset:3072 sc1
s_sub_u32 s43, s43, 1
s_cbranch_scc1 EXIT2
s_branch C\sfx\()1_1_retry_u1_l
C\sfx\()1_1_slow:
s_waitcnt lgkmcnt(0)
s_nop 7
ds_read_b64_tr_b16 v[24:25], v3
ds_read_b64_tr_b16 v[26:27], v3 offset:512
ds_read_b128 v[28:31], v4 offset:8192
ds_read_b128 v[32:35], v4 offset:12288
s_waitcnt lgkmcnt(0)
v_mfma_f32_16x16x32_bf16 v[12:15], v[28:31], v[24:27], 0
v_mfma_f32_16x16x32_bf16 v[16:19], v[32:35], v[24:27], 0
v_mfma_f32_16x16x32_bf16 v[20:23], v[24:27], v[24:27], 0
s_nop 7
ds_read_b64_tr_b16 v[24:25], v3 offset:1024
ds_read_b64_tr_b16 v[26:27], v3 offset:1536
ds_read_b128 v[28:31], v4 offset:9216
ds_read_b128 v[32:35], v4 offset:13312
s_waitcnt lgkmcnt(0)
v_mfma_f32_16x16x32_bf16 v[12:15], v[28:31], v[24:27], v[12:15]
v_mfma_f32_16x16x32_bf16 v[16:19], v[32:35], v[24:27], v[16:19]
v_mfma_f32_16x16x32_bf16 v[20:23], v[24:27], v[24:27], v[20:23]
s_nop 7
ds_read_b64_tr_b16 v[24:25], v3 offset:2048
ds_read_b64_tr_b16 v[26:27], v3 offset:2560
ds_read_b128 v[28:31], v4 offset:10240
ds_read_b128 v[32:35], v4 offset:14336
s_waitcnt lgkmcnt(0)
v_mfma_f32_16x16x32_bf16 v[12:15], v[28:31], v[24:27], v[12:15]
v_mfma_f32_16x16x32_bf16 v[16:19], v[32:35], v[24:27], v[16:19]
v_mfma_f32_16x16x32_bf16 v[20:23], v[24:27], v[24:27], v[20:23]
s_nop 7
ds_read_b64_tr_b16 v[24:25], v3 offset:3072
ds_read_b64_tr_b16 v[26:27], v3 offset:3584
ds_read_b128 v[28:31], v4 offset:11264
ds_read_b128 v[32:35], v4 offset:15360
s_waitcnt lgkmcnt(0)
v_mfma_f32_16x16x32_bf16 v[12:15], v[28:31], v[24:27], v[12:15]
v_mfma_f32_16x16x32_bf16 v[16:19], v[32:35], v[24:27], v[16:19]
v_mfma_f32_16x16x32_bf16 v[20:23], v[24:27], v[24:27], v[20:23]
s_nop 7
v_mul_f32 v20, s44, v20
v_mul_f32 v21, s44, v21
v_max3_f32 v22, v20, v21, v12
v_max3_f32 v22, v22, v13, v14
v_max3_f32 v22, v22, v15, v16
v_max3_f32 v22, v22, v17, v18
v_max_f32 v22, v22, v19
v_mov_b32 v23, v22
s_nop 1
v_permlane16_swap_b32 v22, v23
s_nop 1
v_max_f32 v22, v22, v23
v_mov_b32 v23, v22
s_nop 1
v_permlane32_swap_b32 v22, v23
s_nop 1
v_max_f32 v22, v22, v23
v_sub_f32 v12, v12, v22
v_exp_f32 v12, v12
v_sub_f32 v13, v13, v22
v_exp_f32 v13, v13
v_sub_f32 v14, v14, v22
v_exp_f32 v14, v14
v_sub_f32 v15, v15, v22
v_exp_f32 v15, v15
v_sub_f32 v16, v16, v22
v_exp_f32 v16, v16
v_sub_f32 v17, v17, v22
v_exp_f32 v17, v17
v_sub_f32 v18, v18, v22
v_exp_f32 v18, v18
v_sub_f32 v19, v19, v22
v_exp_f32 v19, v19
v_sub_f32 v20, v20, v22
v_exp_f32 v20, v20
v_sub_f32 v21, v21, v22
v_exp_f32 v21, v21
v_cvt_pk_bf16_f32 v76, v12, v13
v_cvt_pk_bf16_f32 v77, v14, v15
v_cvt_pk_bf16_f32 v78, v16, v17
v_cvt_pk_bf16_f32 v79, v18, v19
v_cvt_pk_bf16_f32 v10, v20, v21
ds_read_b128 v[28:31], v4 offset:18432
ds_read_b128 v[32:35], v4 offset:19456
s_waitcnt lgkmcnt(0)
v_mfma_f32_16x16x32_bf16 v[60:63], v[76:79], v[28:31], 0
v_mfma_f32_16x16x32_bf16 v[64:67], v[76:79], v[32:35], 0
v_mfma_f32_16x16x32_bf16 v[40:43], v[76:79], v[36:39], 0
s_nop 5
v_mfma_f32_16x16x16_bf16 v[40:43], v[10:11], v[36:37], v[40:43]
v_mfma_f32_16x16x16_bf16 v[60:63], v[10:11], v[52:53], v[60:63]
v_mfma_f32_16x16x16_bf16 v[64:67], v[10:11], v[56:57], v[64:67]
s_nop 5
v_rcp_f32 v70, v42
v_rcp_f32 v71, v43
v_mul_f32 v62, v62, v70
v_mul_f32 v63, v63, v71
v_cvt_pk_bf16_f32 v68, v62, v63
ds_write_b32 v2, v68 offset:4096
v_mul_f32 v66, v66, v70
v_mul_f32 v67, v67, v71
v_cvt_pk_bf16_f32 v69, v66, v67
ds_write_b32 v2, v69 offset:4608
s_waitcnt lgkmcnt(0)
v_mov_b64 v[12:13], 0
v_mov_b64 v[14:15], 0
v_mov_b64 v[16:17], 0
v_mov_b64 v[18:19], 0
v_mov_b64 v[20:21], 0
v_mov_b64 v[22:23], 0
s_nop 3
s_branch C\sfx\()1_1_oskip
.p2align 6
CE\sfx\()2:
ds_read_b128 v[44:47], v0 offset:8192
ds_read_b128 v[48:51], v0 offset:9216
ds_read_b128 v[52:55], v0 offset:10240
ds_read_b128 v[56:59], v0 offset:11264
v_mov_b64 v[28:29], 0
v_mov_b64 v[30:31], 0
v_mov_b64 v[32:33], 0
v_mov_b64 v[34:35], 0
v_mov_b64 v[36:37], 0
v_mov_b64 v[38:39], 0
v_mov_b64 v[40:41], 0
v_mov_b64 v[42:43], 0
s_nop 1
C\sfx\()2_0_qk:
ds_read_b128 v[12:15], v4 offset:8192
ds_read_b128 v[16:19], v4 offset:9216
ds_read_b128 v[20:23], v4 offset:10240
C\sfx\()2_0_back0:
s_waitcnt lgkmcnt(2)
v_smfmac_f32_16x16x64_bf16 v[28:31], v[12:15], v[80:87], v1
s_mov_b32 m0, 0x23800
s_nop 0
global_load_lds_dwordx4 v0, s[68:69] sc1
global_load_lds_dwordx4 v0, s[68:69] offset:1024 sc1
s_mov_b32 m0, 0x27000
s_nop 0
global_load_lds_dwordx4 v0, s[68:69] offset:2048 sc1
s_waitcnt lgkmcnt(0)
v_add_f32 v10, v12, v16
v_cmp_u_f32 vcc, v10, v20
v_smfmac_f32_16x16x64_bf16 v[32:35], v[12:15], v[88:95], v1
s_cbranch_vccnz C\sfx\()2_0_retry0
v_smfmac_f32_16x16x64_bf16 v[36:39], v[12:15], v[44:51], v1
ds_read_b128 v[44:47], v0 offset:24576
v_smfmac_f32_16x16x64_bf16 v[40:43], v[12:15], v[52:59], v1
ds_read_b128 v[48:51], v0 offset:25600
v_smfmac_f32_16x16x64_bf16 v[28:31], v[16:19], v[96:103], v1
ds_read_b128 v[52:55], v0 offset:26624
s_mov_b32 m0, 0x23800
s_nop 0
global_load_lds_dwordx4 v0, s[68:69] sc1
global_load_lds_dwordx4 v0, s[68:69] offset:1024 sc1
s_mov_b32 m0, 0x27000
s_nop 0
global_load_lds_dwordx4 v0, s[68:69] offset:2048 sc1
v_smfmac_f32_16x16x64_bf16 v[32:35], v[16:19], v[104:111], v1
ds_read_b128 v[56:59], v0 offset:27648
global_load_dwordx4 v[60:63], v0, s[40:41] offset:-4096
v_smfmac_f32_16x16x64_bf16 v[36:39], v[16:19], v[224:231], v1
v_smfmac_f32_16x16x64_bf16 v[40:43], v[16:19], v[232:239], v1
v_smfmac_f32_16x16x64_bf16 v[28:31], v[20:23], v[112:119], v1
ds_read_b128 v[24:27], v4 offset:11264
v_smfmac_f32_16x16x64_bf16 v[32:35], v[20:23], v[120:127], v1
ds_read_b128 v[12:15], v4 offset:12288
global_load_dwordx4 v[64:67], v0, s[40:41] offset:-3072
s_waitcnt lgkmcnt(4)
v_smfmac_f32_16x16x64_bf16 v[36:39], v[20:23], v[44:51], v1
ds_read_b128 v[16:19], v4 offset:13312
s_waitcnt lgkmcnt(1)
v_cmp_u_f32 vcc, v24, v12
v_smfmac_f32_16x16x64_bf16 v[40:43], v[20:23], v[52:59], v1
ds_read_b128 v[44:47], v0 offset:40960
s_cbranch_vccnz C\sfx\()2_0_retry1
C\sfx\()2_0_back1:
v_smfmac_f32_16x16x64_bf16 v[28:31], v[24:27], v[128:135], v1
ds_read_b128 v[48:51], v0 offset:41984
v_smfmac_f32_16x16x64_bf16 v[32:35], v[24:27], v[136:143], v1
ds_read_b128 v[52:55], v0 offset:43008
global_load_dwordx4 v[68:71], v0, s[40:41] offset:-2048
v_smfmac_f32_16x16x64_bf16 v[36:39], v[24:27], v[240:247], v1
ds_read_b128 v[56:59], v0 offset:44032
v_smfmac_f32_16x16x64_bf16 v[40:43], v[24:27], v[248:255], v1
v_smfmac_f32_16x16x64_bf16 v[28:31], v[12:15], v[144:151], v1
s_waitcnt lgkmcnt(4)
v_cmp_u_f32 vcc, v16, v16
v_smfmac_f32_16x16x64_bf16 v[32:35], v[12:15], v[152:159], v1
global_load_dwordx4 v[72:75], v0, s[40:41] offset:-1024
s_waitcnt lgkmcnt(2)
v_smfmac_f32_16x16x64_bf16 v[36:39], v[12:15], v[44:51], v1
ds_read_b128 v[20:23], v4 offset:14336
s_cbranch_vccnz C\sfx\()2_0_retry1b
C\sfx\()2_0_back1b:
s_waitcnt lgkmcnt(1)
v_smfmac_f32_16x16x64_bf16 v[40:43], v[12:15], v[52:59], v1
ds_read_b128 v[24:27], v4 offset:15360
v_smfmac_f32_16x16x64_bf16 v[28:31], v[16:19], v[160:167], v1
ds_read_b128 v[44:47], v0 offset:57344
v_smfmac_f32_16x16x64_bf16 v[32:35], v[16:19], v[168:175], v1
ds_read_b128 v[48:51], v0 offset:58368
s_waitcnt lgkmcnt(2)
v_cmp_u_f32 vcc, v20, v24
v_smfmac_f32_16x16x64_bf16 v[36:39], v[16:19], a[0:7], v1
ds_read_b128 v[52:55], v0 offset:59392
v_smfmac_f32_16x16x64_bf16 v[40:43], v[16:19], a[8:15], v1
ds_read_b128 v[56:59], v0 offset:60416
s_cbranch_vccnz C\sfx\()2_0_retry2
C\sfx\()2_0_back2:
v_smfmac_f32_16x16x64_bf16 v[28:31], v[20:23], v[176:183], v1
ds_read_b128 v[12:15], v4 offset:30720
s_waitcnt lgkmcnt(3)
v_smfmac_f32_16x16x64_bf16 v[36:39], v[20:23], v[44:51], v1
ds_read_b128 v[44:47], v9 offset:8192
v_smfmac_f32_16x16x64_bf16 v[32:35], v[20:23], v[184:191], v1
ds_read_b128 v[48:51], v9 offset:9216
s_waitcnt lgkmcnt(3)
v_smfmac_f32_16x16x64_bf16 v[40:43], v[20:23], v[52:59], v1
ds_read_b128 v[52:55], v9 offset:10240
s_waitcnt lgkmcnt(3)
v_cmp_u_f32 vcc, v12, v12
v_smfmac_f32_16x16x64_bf16 v[28:31], v[24:27], v[192:199], v1
ds_read_b128 v[56:59], v9 offset:11264
v_smfmac_f32_16x16x64_bf16 v[36:39], v[24:27], a[16:23], v1
s_cbranch_vccnz C\sfx\()2_0_retry2b
C\sfx\()2_0_back2b:
v_smfmac_f32_16x16x64_bf16 v[28:31], v[12:15], v[208:215], v1
s_add_u32 s52, s36, 0x2000
s_addc_u32 s53, s37, 0
s_waitcnt lgkmcnt(2)
v_smfmac_f32_16x16x64_bf16 v[36:39], v[12:15], v[44:51], v1
v_smfmac_f32_16x16x64_bf16 v[32:35], v[24:27], v[200:207], v1
v_mov_b64 v[44:45], 0
v_smfmac_f32_16x16x64_bf16 v[40:43], v[24:27], a[24:31], v1
v_mov_b64 v[48:49], 0
v_add_f32 v28, v28, v30
v_smfmac_f32_16x16x64_bf16 v[32:35], v[12:15], v[216:223], v1
v_add_f32 v29, v29, v31
v_cvt_pk_bf16_f32 v77, v28, v29
v_add_f32 v36, v36, v38
s_waitcnt lgkmcnt(0)
v_smfmac_f32_16x16x64_bf16 v[40:43], v[12:15], v[52:59], v1
v_add_f32 v37, v37, v39
v_cvt_pk_bf16_f32 v76, v36, v37
ds_write_b64 v2, v[76:77]
v_mov_b64 v[46:47], 0
v_mov_b64 v[50:51], 0
C\sfx\()2_0_postqk:
s_waitcnt vmcnt(0)
v_smfmac_f32_16x16x64_bf16 v[44:47], v[20:23], v[60:67], v1
v_add_f32 v32, v32, v34
v_add_f32 v33, v33, v35
v_cvt_pk_bf16_f32 v79, v32, v33
v_add_f32 v40, v40, v42
v_add_f32 v41, v41, v43
v_cvt_pk_bf16_f32 v78, v40, v41
ds_write_b64 v2, v[78:79] offset:512
v_cmp_u_f32 vcc, v40, v41
v_smfmac_f32_16x16x64_bf16 v[48:51], v[20:23], v[68:75], v1
ds_read_b128 v[28:31], v4
v_smfmac_f32_16x16x64_bf16 v[44:47], v[12:15], a[144:151], v1
ds_read_b128 v[32:35], v4 offset:1024
v_smfmac_f32_16x16x64_bf16 v[48:51], v[12:15], a[152:159], v1
ds_read_b128 v[36:39], v4 offset:2048
s_cbranch_vccnz C\sfx\()2_0_retry_ag
v_smfmac_f32_16x16x64_bf16 v[44:47], v[24:27], a[128:135], v1
ds_read_b128 v[40:43], v4 offset:3072
s_waitcnt lgkmcnt(4)
s_barrier
ds_read_b64_tr_b16 v[60:61], v3
ds_read_b64_tr_b16 v[62:63], v3 offset:512
ds_read_b64_tr_b16 v[64:65], v3 offset:1024
ds_read_b64_tr_b16 v[66:67], v3 offset:1536
v_smfmac_f32_16x16x64_bf16 v[48:51], v[24:27], a[136:143], v1
ds_read_b64_tr_b16 v[68:69], v3 offset:2048
ds_read_b64_tr_b16 v[70:71], v3 offset:2560
ds_read_b64_tr_b16 v[72:73], v3 offset:3072
ds_read_b64_tr_b16 v[74:75], v3 offset:3584
v_smfmac_f32_16x16x64_bf16 v[44:47], v[16:19], a[112:119], v1
ds_read_b128 v[52:55], v4 offset:4096
v_smfmac_f32_16x16x64_bf16 v[48:51], v[16:19], a[120:127], v1
ds_read_b128 v[56:59], v4 offset:5120
s_waitcnt lgkmcnt(8)
v_mfma_f32_16x16x32_bf16 v[76:79], v[28:31], v[60:63], 0
ds_read_b128 v[12:15], v4 offset:6144
s_waitcnt lgkmcnt(7)
v_mfma_f32_16x16x32_bf16 v[76:79], v[32:35], v[64:67], v[76:79]
ds_read_b128 v[24:27], v4 offset:7168
s_waitcnt lgkmcnt(6)
v_mfma_f32_16x16x32_bf16 v[76:79], v[36:39], v[68:71], v[76:79]
ds_read_b128 v[20:23], v4 offset:8192
s_waitcnt lgkmcnt(5)
v_mfma_f32_16x16x32_bf16 v[76:79], v[40:43], v[72:75], v[76:79]
ds_read_b128 v[16:19], v4 offset:9216
s_waitcnt lgkmcnt(5)
v_mfma_f32_16x16x32_bf16 v[28:31], v[52:55], v[60:63], 0
v_mov_b32 v36, s57
v_mov_b32 v37, s57
s_waitcnt lgkmcnt(4)
v_mfma_f32_16x16x32_bf16 v[28:31], v[56:59], v[64:67], v[28:31]
ds_read_b128 v[52:55], v4 offset:20480
v_mov_b32 v38, s57
v_mov_b32 v39, s57
s_waitcnt lgkmcnt(4)
v_mfma_f32_16x16x32_bf16 v[28:31], v[12:15], v[68:71], v[28:31]
ds_read_b128 v[56:59], v4 offset:21504
v_exp_f32 v76, v76
s_waitcnt lgkmcnt(4)
v_mfma_f32_16x16x32_bf16 v[28:31], v[24:27], v[72:75], v[28:31]
ds_read_b128 v[12:15], v4 offset:10240
v_exp_f32 v77, v77
v_mfma_f32_16x16x32_bf16 v[32:35], v[60:63], v[60:63], 0
ds_read_b128 v[24:27], v4 offset:11264
v_exp_f32 v78, v78
v_mfma_f32_16x16x32_bf16 v[32:35], v[64:67], v[64:67], v[32:35]
v_exp_f32 v79, v79
v_mfma_f32_16x16x32_bf16 v[32:35], v[68:71], v[68:71], v[32:35]
v_cvt_pk_bf16_f32 v76, v76, v77
v_cvt_pk_bf16_f32 v77, v78, v79
v_mfma_f32_16x16x32_bf16 v[32:35], v[72:75], v[72:75], v[32:35]
v_exp_f32 v28, v28
s_waitcnt lgkmcnt(5)
v_smfmac_f32_16x16x64_bf16 v[44:47], v[20:23], a[32:39], v1
v_exp_f32 v29, v29
v_smfmac_f32_16x16x64_bf16 v[48:51], v[20:23], a[40:47], v1
v_exp_f32 v30, v30
s_waitcnt lgkmcnt(4)
v_smfmac_f32_16x16x64_bf16 v[44:47], v[16:19], a[48:55], v1
ds_read_b128 v[20:23], v4 offset:12288
v_exp_f32 v31, v31
v_smfmac_f32_16x16x64_bf16 v[48:51], v[16:19], a[56:63], v1
v_mul_f32 v32, s44, v32
s_waitcnt lgkmcnt(2)
v_smfmac_f32_16x16x64_bf16 v[44:47], v[12:15], a[64:71], v1
v_cvt_pk_bf16_f32 v78, v28, v29
v_smfmac_f32_16x16x64_bf16 v[48:51], v[12:15], a[72:79], v1
v_cvt_pk_bf16_f32 v79, v30, v31
s_waitcnt lgkmcnt(1)
v_smfmac_f32_16x16x64_bf16 v[44:47], v[24:27], a[80:87], v1
v_mul_f32 v33, s44, v33
s_waitcnt lgkmcnt(0)
v_smfmac_f32_16x16x64_bf16 v[44:47], v[20:23], a[96:103], v1
v_exp_f32 v32, v32
v_mfma_f32_16x16x32_bf16 v[40:43], v[76:79], v[36:39], 0
v_exp_f32 v33, v33
v_smfmac_f32_16x16x64_bf16 v[48:51], v[24:27], a[88:95], v1
v_cvt_pk_bf16_f32 v10, v32, v33
v_mfma_f32_16x16x32_bf16 v[60:63], v[76:79], v[52:55], 0
v_smfmac_f32_16x16x64_bf16 v[48:51], v[20:23], a[104:111], v1
s_nop 0
v_add_f32 v44, v44, v46
v_mfma_f32_16x16x32_bf16 v[64:67], v[76:79], v[56:59], 0
v_add_f32 v45, v45, v47
v_cvt_pk_bf16_f32 v52, v44, v45
v_mfma_f32_16x16x16_bf16 v[40:43], v[10:11], v[36:37], v[40:43]
s_nop 0
v_mfma_f32_16x16x16_bf16 v[60:63], v[10:11], v[52:53], v[60:63]
v_add_f32 v48, v48, v50
v_add_f32 v49, v49, v51
v_cvt_pk_bf16_f32 v56, v48, v49
s_nop 1
v_mfma_f32_16x16x16_bf16 v[64:67], v[10:11], v[56:57], v[64:67]
v_rcp_f32 v70, v42
v_rcp_f32 v71, v43
v_subrev_u32 v40, s45, v42
v_subrev_u32 v41, s45, v43
v_mul_f32 v62, v62, v70
v_mul_f32 v63, v63, v71
v_cvt_pk_bf16_f32 v68, v62, v63
ds_write_b32 v2, v68 offset:2052
v_mul_f32 v66, v66, v70
v_mul_f32 v67, v67, v71
v_cvt_pk_bf16_f32 v69, v66, v67
ds_write_b32 v2, v69 offset:2564
v_max_u32 v40, v40, v41
v_cmp_le_u32 vcc, s46, v40
v_mov_b64 v[12:13], 0
v_mov_b64 v[14:15], 0
v_mov_b64 v[16:17], 0
v_mov_b64 v[18:19], 0
v_mov_b64 v[20:21], 0
v_mov_b64 v[22:23], 0
s_cbranch_vccnz C\sfx\()2_0_slow
C\sfx\()2_0_oskip:
s_mov_b32 m0, 0x25000
v_mov_b64 v[24:25], 0
v_mov_b64 v[26:27], 0
global_load_lds_dwordx4 v0, s[52:53] sc1
global_load_lds_dwordx4 v0, s[52:53] offset:1024 sc1
s_waitcnt lgkmcnt(0)
s_barrier
ds_read_b64_tr_b16 v[44:45], v3 offset:4096
ds_read_b64_tr_b16 v[46:47], v3 offset:4608
ds_read_b64_tr_b16 v[48:49], v3 offset:5120
ds_read_b64_tr_b16 v[50:51], v3 offset:5632
v_mov_b64 v[28:29], 0
v_mov_b64 v[30:31], 0
v_mov_b64 v[32:33], 0
v_mov_b64 v[34:35], 0
s_waitcnt lgkmcnt(2)
v_smfmac_f32_16x16x64_bf16 v[12:15], v[44:47], a[240:247], v1
ds_read_b128 v[52:55], v9 offset:24576
s_add_u32 s54, s36, 0x800
s_addc_u32 s55, s37, 0
s_waitcnt lgkmcnt(1)
v_smfmac_f32_16x16x64_bf16 v[12:15], v[48:51], a[248:255], v1
ds_read_b128 v[56:59], v9 offset:25600
s_mov_b32 m0, 0x23800
s_cmp_eq_u32 s42, 63
global_load_lds_dwordx4 v0, s[54:55] sc1
v_smfmac_f32_16x16x64_bf16 v[16:19], v[44:47], a[160:167], v1
ds_read_b128 v[60:63], v9 offset:26624
global_load_lds_dwordx4 v0, s[54:55] offset:1024 sc1
s_cbranch_scc1 DONE
v_smfmac_f32_16x16x64_bf16 v[16:19], v[48:51], a[176:183], v1
ds_read_b128 v[64:67], v9 offset:27648
s_add_u32 s42, s42, 1
v_smfmac_f32_16x16x64_bf16 v[20:23], v[44:47], a[168:175], v1
ds_read_b128 v[68:71], v9 offset:40960
s_add_u32 s36, s36, 0x4000
s_addc_u32 s37, s37, 0
v_add_f32 v12, v12, v14
v_smfmac_f32_16x16x64_bf16 v[20:23], v[48:51], a[184:191], v1
ds_read_b128 v[72:75], v9 offset:41984
v_add_f32 v13, v13, v15
v_cvt_pk_bf16_f32 v12, v12, v13
v_smfmac_f32_16x16x64_bf16 v[24:27], v[44:47], a[192:199], v1
v_add_f32 v14, v16, v18
v_add_f32 v15, v17, v19
v_mov_b32_dpp v13, v12 quad_perm:[1,0,3,2] row_mask:0xf bank_mask:0xf
s_waitcnt lgkmcnt(4)
v_smfmac_f32_16x16x64_bf16 v[24:27], v[48:51], v[52:59], v1
ds_read_b128 v[52:55], v9 offset:43008
v_mov_b32 v19, s75
v_perm_b32 v16, v13, v12, v8
v_add_f32 v20, v20, v22
v_add_f32 v21, v21, v23
v_cvt_pk_bf16_f32 v17, v14, v20
v_cvt_pk_bf16_f32 v18, v15, v21
global_store_dwordx4 v5, v[16:19], s[28:29] \md
v_smfmac_f32_16x16x64_bf16 v[28:31], v[44:47], a[200:207], v1
ds_read_b128 v[56:59], v9 offset:44032
s_add_u32 s64, s28, 0x1000
s_addc_u32 s65, s29, 0
v_mov_b64 v[36:37], 0
s_waitcnt lgkmcnt(4)
v_smfmac_f32_16x16x64_bf16 v[28:31], v[48:51], v[60:67], v1
ds_read_b128 v[60:63], v9 offset:57344
v_mov_b64 v[38:39], 0
v_smfmac_f32_16x16x64_bf16 v[32:35], v[44:47], a[208:215], v1
ds_read_b128 v[64:67], v9 offset:58368
v_add_f32 v24, v24, v26
v_mov_b64 v[40:41], 0
s_waitcnt lgkmcnt(4)
v_smfmac_f32_16x16x64_bf16 v[32:35], v[48:51], v[68:75], v1
ds_read_b128 v[68:71], v9 offset:59392
v_add_f32 v25, v25, v27
v_cvt_pk_bf16_f32 v24, v24, v25
v_mov_b64 v[42:43], 0
v_smfmac_f32_16x16x64_bf16 v[36:39], v[44:47], a[216:223], v1
ds_read_b128 v[72:75], v9 offset:60416
v_add_f32 v26, v28, v30
v_add_f32 v27, v29, v31
v_mov_b32_dpp v25, v24 quad_perm:[1,0,3,2] row_mask:0xf bank_mask:0xf
v_mov_b64 v[76:77], 0
s_waitcnt lgkmcnt(4)
v_smfmac_f32_16x16x64_bf16 v[36:39], v[48:51], v[52:59], v1
v_mov_b64 v[78:79], 0
v_mov_b32 v31, s75
v_perm_b32 v28, v25, v24, v8
v_add_f32 v32, v32, v34
v_add_f32 v33, v33, v35
v_cvt_pk_bf16_f32 v29, v26, v32
v_cvt_pk_bf16_f32 v30, v27, v33
global_store_dwordx4 v5, v[28:31], s[64:65] \md
v_smfmac_f32_16x16x64_bf16 v[40:43], v[44:47], a[224:231], v1
s_add_u32 s64, s28, 0x2000
s_addc_u32 s65, s29, 0
s_waitcnt lgkmcnt(2)
v_smfmac_f32_16x16x64_bf16 v[40:43], v[48:51], v[60:67], v1
v_smfmac_f32_16x16x64_bf16 v[76:79], v[44:47], a[232:239], v1
v_add_f32 v36, v36, v38
s_waitcnt lgkmcnt(0)
v_smfmac_f32_16x16x64_bf16 v[76:79], v[48:51], v[68:75], v1
v_add_f32 v37, v37, v39
v_cvt_pk_bf16_f32 v36, v36, v37
s_nop 1
v_add_f32 v38, v40, v42
v_add_f32 v39, v41, v43
v_mov_b32_dpp v37, v36 quad_perm:[1,0,3,2] row_mask:0xf bank_mask:0xf
v_mov_b32 v43, s75
v_perm_b32 v40, v37, v36, v8
v_add_f32 v76, v76, v78
v_add_f32 v77, v77, v79
v_cvt_pk_bf16_f32 v41, v38, v76
v_cvt_pk_bf16_f32 v42, v39, v77
global_store_dwordx4 v5, v[40:43], s[64:65] \md
v_mov_b64 v[60:61], -1
v_mov_b64 v[62:63], -1
ds_write_b128 v4, v[60:63] offset:6144
ds_write_b128 v4, v[60:63] offset:7168
ds_write_b128 v4, v[60:63] offset:30720
v_and_b32 v10, 0x200ff, v4
ds_read_b128 v[76:79], v10 offset:31744
s_add_u32 s51, s56, 0x18c00
s_and_b32 s51, s51, 0x1ffff
s_add_u32 s72, s14, s51
s_addc_u32 s73, s15, 0
s_add_u32 s56, s56, 0x8000
s_and_b32 s56, s56, 0x1ffff
s_add_u32 s51, s56, 3072
s_add_u32 s70, s14, s51
s_addc_u32 s71, s15, 0
s_add_u32 s51, s56, s96
s_add_u32 s68, s14, s51
s_addc_u32 s69, s15, 0
s_mov_b32 s74, 0
s_sleep 5
global_load_dwordx4 v[12:15], v0, s[32:33] sc1
global_load_dwordx4 v[16:19], v0, s[32:33] offset:1024 sc1
global_load_dwordx4 v[20:23], v0, s[32:33] offset:2048 sc1
global_load_dwordx4 v[24:27], v0, s[32:33] offset:3072 sc1
s_waitcnt lgkmcnt(0)
s_waitcnt vmcnt(3)
v_mfma_f32_16x16x32_bf16 v[44:47], v[76:79], v[12:15], 0
s_waitcnt vmcnt(2)
v_mfma_f32_16x16x32_bf16 v[44:47], v[76:79], v[16:19], v[44:47]
s_waitcnt vmcnt(1)
v_mfma_f32_16x16x32_bf16 v[44:47], v[76:79], v[20:23], v[44:47]
v_min3_u32 v48, v15, v19, v23
s_waitcnt vmcnt(0)
v_mfma_f32_16x16x32_bf16 v[44:47], v[76:79], v[24:27], v[44:47]
v_min_u32 v48, v48, v27
v_cmp_ne_u32 vcc, s75, v48
s_nop 4
s_cbranch_vccnz C\sfx\()2_0_retry_u1
v_add_f32_dpp v46, v44, v44 row_ror:8 row_mask:0xf bank_mask:0xf
v_add_f32_dpp v47, v45, v45 row_ror:8 row_mask:0xf bank_mask:0xf
v_cvt_pk_bf16_f32 v44, v46, v47
global_store_dword v7, v44, s[22:23] offset:3072 \md
C\sfx\()2_0_done_u1:
v_mov_b32 v48, -1
global_store_dword v7, v48, s[24:25] offset:3072 \md
s_waitcnt vmcnt(2)
ds_read_b128 v[44:47], v0 offset:8192
ds_read_b128 v[48:51], v0 offset:9216
ds_read_b128 v[52:55], v0 offset:10240
ds_read_b128 v[56:59], v0 offset:11264
v_mov_b64 v[28:29], 0
v_mov_b64 v[30:31], 0
v_mov_b64 v[32:33], 0
v_mov_b64 v[34:35], 0
v_mov_b64 v[36:37], 0
v_mov_b64 v[38:39], 0
v_mov_b64 v[40:41], 0
v_mov_b64 v[42:43], 0
s_add_u32 s75, s75, 1
s_barrier
C\sfx\()2_1_qk:
ds_read_b128 v[12:15], v4
ds_read_b128 v[16:19], v4 offset:1024
ds_read_b128 v[20:23], v4 offset:2048
C\sfx\()2_1_back0:
s_waitcnt lgkmcnt(2)
v_smfmac_f32_16x16x64_bf16 v[28:31], v[12:15], v[80:87], v1
s_mov_b32 m0, 0x21800
s_nop 0
global_load_lds_dwordx4 v0, s[20:21] sc1
global_load_lds_dwordx4 v0, s[20:21] offset:1024 sc1
s_mov_b32 m0, 0x27000
s_nop 0
global_load_lds_dwordx4 v0, s[20:21] offset:2048 sc1
s_waitcnt lgkmcnt(0)
v_add_f32 v10, v12, v16
v_cmp_u_f32 vcc, v10, v20
v_smfmac_f32_16x16x64_bf16 v[32:35], v[12:15], v[88:95], v1
s_cbranch_vccnz C\sfx\()2_1_retry0
v_smfmac_f32_16x16x64_bf16 v[36:39], v[12:15], v[44:51], v1
ds_read_b128 v[44:47], v0 offset:24576
v_smfmac_f32_16x16x64_bf16 v[40:43], v[12:15], v[52:59], v1
ds_read_b128 v[48:51], v0 offset:25600
v_smfmac_f32_16x16x64_bf16 v[28:31], v[16:19], v[96:103], v1
ds_read_b128 v[52:55], v0 offset:26624
s_mov_b32 m0, 0x21800
s_nop 0
global_load_lds_dwordx4 v0, s[20:21] sc1
global_load_lds_dwordx4 v0, s[20:21] offset:1024 sc1
s_mov_b32 m0, 0x27000
s_nop 0
global_load_lds_dwordx4 v0, s[20:21] offset:2048 sc1
v_smfmac_f32_16x16x64_bf16 v[32:35], v[16:19], v[104:111], v1
ds_read_b128 v[56:59], v0 offset:27648
global_load_dwordx4 v[60:63], v0, s[40:41] offset:-4096
v_smfmac_f32_16x16x64_bf16 v[36:39], v[16:19], v[224:231], v1
v_smfmac_f32_16x16x64_bf16 v[40:43], v[16:19], v[232:239], v1
v_smfmac_f32_16x16x64_bf16 v[28:31], v[20:23], v[112:119], v1
ds_read_b128 v[24:27], v4 offset:3072
v_smfmac_f32_16x16x64_bf16 v[32:35], v[20:23], v[120:127], v1
ds_read_b128 v[12:15], v4 offset:4096
global_load_dwordx4 v[64:67], v0, s[40:41] offset:-3072
s_waitcnt lgkmcnt(4)
v_smfmac_f32_16x16x64_bf16 v[36:39], v[20:23], v[44:51], v1
ds_read_b128 v[16:19], v4 offset:5120
s_waitcnt lgkmcnt(1)
v_cmp_u_f32 vcc, v24, v12
v_smfmac_f32_16x16x64_bf16 v[40:43], v[20:23], v[52:59], v1
ds_read_b128 v[44:47], v0 offset:40960
s_cbranch_vccnz C\sfx\()2_1_retry1
C\sfx\()2_1_back1:
v_smfmac_f32_16x16x64_bf16 v[28:31], v[24:27], v[128:135], v1
ds_read_b128 v[48:51], v0 offset:41984
v_smfmac_f32_16x16x64_bf16 v[32:35], v[24:27], v[136:143], v1
ds_read_b128 v[52:55], v0 offset:43008
global_load_dwordx4 v[68:71], v0, s[40:41] offset:-2048
v_smfmac_f32_16x16x64_bf16 v[36:39], v[24:27], v[240:247], v1
ds_read_b128 v[56:59], v0 offset:44032
v_smfmac_f32_16x16x64_bf16 v[40:43], v[24:27], v[248:255], v1
v_smfmac_f32_16x16x64_bf16 v[28:31], v[12:15], v[144:151], v1
s_waitcnt lgkmcnt(4)
v_cmp_u_f32 vcc, v16, v16
v_smfmac_f32_16x16x64_bf16 v[32:35], v[12:15], v[152:159], v1
global_load_dwordx4 v[72:75], v0, s[40:41] offset:-1024
s_waitcnt lgkmcnt(2)
v_smfmac_f32_16x16x64_bf16 v[36:39], v[12:15], v[44:51], v1
ds_read_b128 v[20:23], v4 offset:6144
s_cbranch_vccnz C\sfx\()2_1_retry1b
C\sfx\()2_1_back1b:
s_waitcnt lgkmcnt(1)
v_smfmac_f32_16x16x64_bf16 v[40:43], v[12:15], v[52:59], v1
ds_read_b128 v[24:27], v4 offset:7168
v_smfmac_f32_16x16x64_bf16 v[28:31], v[16:19], v[160:167], v1
ds_read_b128 v[44:47], v0 offset:57344
v_smfmac_f32_16x16x64_bf16 v[32:35], v[16:19], v[168:175], v1
ds_read_b128 v[48:51], v0 offset:58368
s_waitcnt lgkmcnt(2)
v_cmp_u_f32 vcc, v20, v24
v_smfmac_f32_16x16x64_bf16 v[36:39], v[16:19], a[0:7], v1
ds_read_b128 v[52:55], v0 offset:59392
v_smfmac_f32_16x16x64_bf16 v[40:43], v[16:19], a[8:15], v1
ds_read_b128 v[56:59], v0 offset:60416
s_cbranch_vccnz C\sfx\()2_1_retry2
C\sfx\()2_1_back2:
v_smfmac_f32_16x16x64_bf16 v[28:31], v[20:23], v[176:183], v1
ds_read_b128 v[12:15], v4 offset:30720
s_waitcnt lgkmcnt(3)
v_smfmac_f32_16x16x64_bf16 v[36:39], v[20:23], v[44:51], v1
ds_read_b128 v[44:47], v9 offset:8192
v_smfmac_f32_16x16x64_bf16 v[32:35], v[20:23], v[184:191], v1
ds_read_b128 v[48:51], v9 offset:9216
s_waitcnt lgkmcnt(3)
v_smfmac_f32_16x16x64_bf16 v[40:43], v[20:23], v[52:59], v1
ds_read_b128 v[52:55], v9 offset:10240
s_waitcnt lgkmcnt(3)
v_cmp_u_f32 vcc, v12, v12
v_smfmac_f32_16x16x64_bf16 v[28:31], v[24:27], v[192:199], v1
ds_read_b128 v[56:59], v9 offset:11264
v_smfmac_f32_16x16x64_bf16 v[36:39], v[24:27], a[16:23], v1
s_cbranch_vccnz C\sfx\()2_1_retry2b
C\sfx\()2_1_back2b:
v_smfmac_f32_16x16x64_bf16 v[28:31], v[12:15], v[208:215], v1
s_add_u32 s52, s36, 0x2000
s_addc_u32 s53, s37, 0
s_waitcnt lgkmcnt(2)
v_smfmac_f32_16x16x64_bf16 v[36:39], v[12:15], v[44:51], v1
v_smfmac_f32_16x16x64_bf16 v[32:35], v[24:27], v[200:207], v1
v_mov_b64 v[44:45], 0
v_smfmac_f32_16x16x64_bf16 v[40:43], v[24:27], a[24:31], v1
v_mov_b64 v[48:49], 0
v_add_f32 v28, v28, v30
v_smfmac_f32_16x16x64_bf16 v[32:35], v[12:15], v[216:223], v1
v_add_f32 v29, v29, v31
v_cvt_pk_bf16_f32 v77, v28, v29
v_add_f32 v36, v36, v38
s_waitcnt lgkmcnt(0)
v_smfmac_f32_16x16x64_bf16 v[40:43], v[12:15], v[52:59], v1
v_add_f32 v37, v37, v39
v_cvt_pk_bf16_f32 v76, v36, v37
ds_write_b64 v2, v[76:77]
v_mov_b64 v[46:47], 0
v_mov_b64 v[50:51], 0
C\sfx\()2_1_postqk:
s_waitcnt vmcnt(0)
v_smfmac_f32_16x16x64_bf16 v[44:47], v[20:23], v[60:67], v1
v_add_f32 v32, v32, v34
v_add_f32 v33, v33, v35
v_cvt_pk_bf16_f32 v79, v32, v33
v_add_f32 v40, v40, v42
v_add_f32 v41, v41, v43
v_cvt_pk_bf16_f32 v78, v40, v41
ds_write_b64 v2, v[78:79] offset:512
v_cmp_u_f32 vcc, v40, v41
v_smfmac_f32_16x16x64_bf16 v[48:51], v[20:23], v[68:75], v1
ds_read_b128 v[28:31], v4 offset:8192
v_smfmac_f32_16x16x64_bf16 v[44:47], v[12:15], a[144:151], v1
ds_read_b128 v[32:35], v4 offset:9216
v_smfmac_f32_16x16x64_bf16 v[48:51], v[12:15], a[152:159], v1
ds_read_b128 v[36:39], v4 offset:10240
s_cbranch_vccnz C\sfx\()2_1_retry_ag
v_smfmac_f32_16x16x64_bf16 v[44:47], v[24:27], a[128:135], v1
ds_read_b128 v[40:43], v4 offset:11264
s_waitcnt lgkmcnt(4)
s_barrier
ds_read_b64_tr_b16 v[60:61], v3
ds_read_b64_tr_b16 v[62:63], v3 offset:512
ds_read_b64_tr_b16 v[64:65], v3 offset:1024
ds_read_b64_tr_b16 v[66:67], v3 offset:1536
v_smfmac_f32_16x16x64_bf16 v[48:51], v[24:27], a[136:143], v1
ds_read_b64_tr_b16 v[68:69], v3 offset:2048
ds_read_b64_tr_b16 v[70:71], v3 offset:2560
ds_read_b64_tr_b16 v[72:73], v3 offset:3072
ds_read_b64_tr_b16 v[74:75], v3 offset:3584
v_smfmac_f32_16x16x64_bf16 v[44:47], v[16:19], a[112:119], v1
ds_read_b128 v[52:55], v4 offset:12288
v_smfmac_f32_16x16x64_bf16 v[48:51], v[16:19], a[120:127], v1
ds_read_b128 v[56:59], v4 offset:13312
s_waitcnt lgkmcnt(8)
v_mfma_f32_16x16x32_bf16 v[76:79], v[28:31], v[60:63], 0
ds_read_b128 v[12:15], v4 offset:14336
s_waitcnt lgkmcnt(7)
v_mfma_f32_16x16x32_bf16 v[76:79], v[32:35], v[64:67], v[76:79]
ds_read_b128 v[24:27], v4 offset:15360
s_waitcnt lgkmcnt(6)
v_mfma_f32_16x16x32_bf16 v[76:79], v[36:39], v[68:71], v[76:79]
ds_read_b128 v[20:23], v4
s_waitcnt lgkmcnt(5)
v_mfma_f32_16x16x32_bf16 v[76:79], v[40:43], v[72:75], v[76:79]
ds_read_b128 v[16:19], v4 offset:1024
s_waitcnt lgkmcnt(5)
v_mfma_f32_16x16x32_bf16 v[28:31], v[52:55], v[60:63], 0
v_mov_b32 v36, s57
v_mov_b32 v37, s57
s_waitcnt lgkmcnt(4)
v_mfma_f32_16x16x32_bf16 v[28:31], v[56:59], v[64:67], v[28:31]
ds_read_b128 v[52:55], v4 offset:20480
v_mov_b32 v38, s57
v_mov_b32 v39, s57
s_waitcnt lgkmcnt(4)
v_mfma_f32_16x16x32_bf16 v[28:31], v[12:15], v[68:71], v[28:31]
ds_read_b128 v[56:59], v4 offset:21504
v_exp_f32 v76, v76
s_waitcnt lgkmcnt(4)
v_mfma_f32_16x16x32_bf16 v[28:31], v[24:27], v[72:75], v[28:31]
ds_read_b128 v[12:15], v4 offset:2048
v_exp_f32 v77, v77
v_mfma_f32_16x16x32_bf16 v[32:35], v[60:63], v[60:63], 0
ds_read_b128 v[24:27], v4 offset:3072
v_exp_f32 v78, v78
v_mfma_f32_16x16x32_bf16 v[32:35], v[64:67], v[64:67], v[32:35]
v_exp_f32 v79, v79
v_mfma_f32_16x16x32_bf16 v[32:35], v[68:71], v[68:71], v[32:35]
v_cvt_pk_bf16_f32 v76, v76, v77
v_cvt_pk_bf16_f32 v77, v78, v79
v_mfma_f32_16x16x32_bf16 v[32:35], v[72:75], v[72:75], v[32:35]
v_exp_f32 v28, v28
s_waitcnt lgkmcnt(5)
v_smfmac_f32_16x16x64_bf16 v[44:47], v[20:23], a[32:39], v1
v_exp_f32 v29, v29
v_smfmac_f32_16x16x64_bf16 v[48:51], v[20:23], a[40:47], v1
v_exp_f32 v30, v30
s_waitcnt lgkmcnt(4)
v_smfmac_f32_16x16x64_bf16 v[44:47], v[16:19], a[48:55], v1
ds_read_b128 v[20:23], v4 offset:4096
v_exp_f32 v31, v31
v_smfmac_f32_16x16x64_bf16 v[48:51], v[16:19], a[56:63], v1
v_mul_f32 v32, s44, v32
s_waitcnt lgkmcnt(2)
v_smfmac_f32_16x16x64_bf16 v[44:47], v[12:15], a[64:71], v1
v_cvt_pk_bf16_f32 v78, v28, v29
v_smfmac_f32_16x16x64_bf16 v[48:51], v[12:15], a[72:79], v1
v_cvt_pk_bf16_f32 v79, v30, v31
s_waitcnt lgkmcnt(1)
v_smfmac_f32_16x16x64_bf16 v[44:47], v[24:27], a[80:87], v1
v_mul_f32 v33, s44, v33
s_waitcnt lgkmcnt(0)
v_smfmac_f32_16x16x64_bf16 v[44:47], v[20:23], a[96:103], v1
v_exp_f32 v32, v32
v_mfma_f32_16x16x32_bf16 v[40:43], v[76:79], v[36:39], 0
v_exp_f32 v33, v33
v_smfmac_f32_16x16x64_bf16 v[48:51], v[24:27], a[88:95], v1
v_cvt_pk_bf16_f32 v10, v32, v33
v_mfma_f32_16x16x32_bf16 v[60:63], v[76:79], v[52:55], 0
v_smfmac_f32_16x16x64_bf16 v[48:51], v[20:23], a[104:111], v1
s_nop 0
v_add_f32 v44, v44, v46
v_mfma_f32_16x16x32_bf16 v[64:67], v[76:79], v[56:59], 0
v_add_f32 v45, v45, v47
v_cvt_pk_bf16_f32 v52, v44, v45
v_mfma_f32_16x16x16_bf16 v[40:43], v[10:11], v[36:37], v[40:43]
s_nop 0
v_mfma_f32_16x16x16_bf16 v[60:63], v[10:11], v[52:53], v[60:63]
v_add_f32 v48, v48, v50
v_add_f32 v49, v49, v51
v_cvt_pk_bf16_f32 v56, v48, v49
s_nop 1
v_mfma_f32_16x16x16_bf16 v[64:67], v[10:11], v[56:57], v[64:67]
v_rcp_f32 v70, v42
v_rcp_f32 v71, v43
v_subrev_u32 v40, s45, v42
v_subrev_u32 v41, s45, v43
v_mul_f32 v62, v62, v70
v_mul_f32 v63, v63, v71
v_cvt_pk_bf16_f32 v68, v62, v63
ds_write_b32 v2, v68 offset:2052
v_mul_f32 v66, v66, v70
v_mul_f32 v67, v67, v71
v_cvt_pk_bf16_f32 v69, v66, v67
ds_write_b32 v2, v69 offset:2564
v_max_u32 v40, v40, v41
v_cmp_le_u32 vcc, s46, v40
v_mov_b64 v[12:13], 0
v_mov_b64 v[14:15], 0
v_mov_b64 v[16:17], 0
v_mov_b64 v[18:19], 0
v_mov_b64 v[20:21], 0
v_mov_b64 v[22:23], 0
s_cbranch_vccnz C\sfx\()2_1_slow
C\sfx\()2_1_oskip:
s_mov_b32 m0, 0x25000
v_mov_b64 v[24:25], 0
v_mov_b64 v[26:27], 0
global_load_lds_dwordx4 v0, s[52:53] sc1
global_load_lds_dwordx4 v0, s[52:53] offset:1024 sc1
s_waitcnt lgkmcnt(0)
s_barrier
ds_read_b64_tr_b16 v[44:45], v3 offset:4096
ds_read_b64_tr_b16 v[46:47], v3 offset:4608
ds_read_b64_tr_b16 v[48:49], v3 offset:5120
ds_read_b64_tr_b16 v[50:51], v3 offset:5632
v_mov_b64 v[28:29], 0
v_mov_b64 v[30:31], 0
v_mov_b64 v[32:33], 0
v_mov_b64 v[34:35], 0
s_waitcnt lgkmcnt(2)
v_smfmac_f32_16x16x64_bf16 v[12:15], v[44:47], a[240:247], v1
ds_read_b128 v[52:55], v9 offset:24576
s_add_u32 s54, s36, 0x800
s_addc_u32 s55, s37, 0
s_waitcnt lgkmcnt(1)
v_smfmac_f32_16x16x64_bf16 v[12:15], v[48:51], a[248:255], v1
ds_read_b128 v[56:59], v9 offset:25600
s_mov_b32 m0, 0x21800
s_cmp_eq_u32 s42, 63
global_load_lds_dwordx4 v0, s[54:55] sc1
v_smfmac_f32_16x16x64_bf16 v[16:19], v[44:47], a[160:167], v1
ds_read_b128 v[60:63], v9 offset:26624
global_load_lds_dwordx4 v0, s[54:55] offset:1024 sc1
s_cbranch_scc1 DONE
v_smfmac_f32_16x16x64_bf16 v[16:19], v[48:51], a[176:183], v1
ds_read_b128 v[64:67], v9 offset:27648
s_add_u32 s42, s42, 1
v_smfmac_f32_16x16x64_bf16 v[20:23], v[44:47], a[168:175], v1
ds_read_b128 v[68:71], v9 offset:40960
s_add_u32 s36, s36, 0x4000
s_addc_u32 s37, s37, 0
v_add_f32 v12, v12, v14
v_smfmac_f32_16x16x64_bf16 v[20:23], v[48:51], a[184:191], v1
ds_read_b128 v[72:75], v9 offset:41984
v_add_f32 v13, v13, v15
v_cvt_pk_bf16_f32 v12, v12, v13
v_smfmac_f32_16x16x64_bf16 v[24:27], v[44:47], a[192:199], v1
v_add_f32 v14, v16, v18
v_add_f32 v15, v17, v19
v_mov_b32_dpp v13, v12 quad_perm:[1,0,3,2] row_mask:0xf bank_mask:0xf
s_waitcnt lgkmcnt(4)
v_smfmac_f32_16x16x64_bf16 v[24:27], v[48:51], v[52:59], v1
ds_read_b128 v[52:55], v9 offset:43008
v_mov_b32 v19, s75
v_perm_b32 v16, v13, v12, v8
v_add_f32 v20, v20, v22
v_add_f32 v21, v21, v23
v_cvt_pk_bf16_f32 v17, v14, v20
v_cvt_pk_bf16_f32 v18, v15, v21
global_store_dwordx4 v5, v[16:19], s[30:31] \md
v_smfmac_f32_16x16x64_bf16 v[28:31], v[44:47], a[200:207], v1
ds_read_b128 v[56:59], v9 offset:44032
s_add_u32 s64, s30, 0x1000
s_addc_u32 s65, s31, 0
v_mov_b64 v[36:37], 0
s_waitcnt lgkmcnt(4)
v_smfmac_f32_16x16x64_bf16 v[28:31], v[48:51], v[60:67], v1
ds_read_b128 v[60:63], v9 offset:57344
v_mov_b64 v[38:39], 0
v_smfmac_f32_16x16x64_bf16 v[32:35], v[44:47], a[208:215], v1
ds_read_b128 v[64:67], v9 offset:58368
v_add_f32 v24, v24, v26
v_mov_b64 v[40:41], 0
s_waitcnt lgkmcnt(4)
v_smfmac_f32_16x16x64_bf16 v[32:35], v[48:51], v[68:75], v1
ds_read_b128 v[68:71], v9 offset:59392
v_add_f32 v25, v25, v27
v_cvt_pk_bf16_f32 v24, v24, v25
v_mov_b64 v[42:43], 0
v_smfmac_f32_16x16x64_bf16 v[36:39], v[44:47], a[216:223], v1
ds_read_b128 v[72:75], v9 offset:60416
v_add_f32 v26, v28, v30
v_add_f32 v27, v29, v31
v_mov_b32_dpp v25, v24 quad_perm:[1,0,3,2] row_mask:0xf bank_mask:0xf
v_mov_b64 v[76:77], 0
s_waitcnt lgkmcnt(4)
v_smfmac_f32_16x16x64_bf16 v[36:39], v[48:51], v[52:59], v1
v_mov_b64 v[78:79], 0
v_mov_b32 v31, s75
v_perm_b32 v28, v25, v24, v8
v_add_f32 v32, v32, v34
v_add_f32 v33, v33, v35
v_cvt_pk_bf16_f32 v29, v26, v32
v_cvt_pk_bf16_f32 v30, v27, v33
global_store_dwordx4 v5, v[28:31], s[64:65] \md
v_smfmac_f32_16x16x64_bf16 v[40:43], v[44:47], a[224:231], v1
s_add_u32 s64, s30, 0x2000
s_addc_u32 s65, s31, 0
s_waitcnt lgkmcnt(2)
v_smfmac_f32_16x16x64_bf16 v[40:43], v[48:51], v[60:67], v1
v_smfmac_f32_16x16x64_bf16 v[76:79], v[44:47], a[232:239], v1
v_add_f32 v36, v36, v38
s_waitcnt lgkmcnt(0)
v_smfmac_f32_16x16x64_bf16 v[76:79], v[48:51], v[68:75], v1
v_add_f32 v37, v37, v39
v_cvt_pk_bf16_f32 v36, v36, v37
s_nop 1
v_add_f32 v38, v40, v42
v_add_f32 v39, v41, v43
v_mov_b32_dpp v37, v36 quad_perm:[1,0,3,2] row_mask:0xf bank_mask:0xf
v_mov_b32 v43, s75
v_perm_b32 v40, v37, v36, v8
v_add_f32 v76, v76, v78
v_add_f32 v77, v77, v79
v_cvt_pk_bf16_f32 v41, v38, v76
v_cvt_pk_bf16_f32 v42, v39, v77
global_store_dwordx4 v5, v[40:43], s[64:65] \md
v_mov_b64 v[60:61], -1
v_mov_b64 v[62:63], -1
ds_write_b128 v4, v[60:63] offset:14336
ds_write_b128 v4, v[60:63] offset:15360
ds_write_b128 v4, v[60:63] offset:30720
v_and_b32 v10, 0x200ff, v4
ds_read_b128 v[76:79], v10 offset:31744
s_add_u32 s51, s56, 0x18c00
s_and_b32 s51, s51, 0x1ffff
s_add_u32 s24, s14, s51
s_addc_u32 s25, s15, 0
s_add_u32 s56, s56, 0x8000
s_and_b32 s56, s56, 0x1ffff
s_add_u32 s51, s56, 3072
s_add_u32 s22, s14, s51
s_addc_u32 s23, s15, 0
s_add_u32 s51, s56, s96
s_add_u32 s20, s14, s51
s_addc_u32 s21, s15, 0
s_mov_b32 s74, 0
s_sleep 5
global_load_dwordx4 v[12:15], v0, s[34:35] sc1
global_load_dwordx4 v[16:19], v0, s[34:35] offset:1024 sc1
global_load_dwordx4 v[20:23], v0, s[34:35] offset:2048 sc1
global_load_dwordx4 v[24:27], v0, s[34:35] offset:3072 sc1
s_waitcnt lgkmcnt(0)
s_waitcnt vmcnt(3)
v_mfma_f32_16x16x32_bf16 v[44:47], v[76:79], v[12:15], 0
s_waitcnt vmcnt(2)
v_mfma_f32_16x16x32_bf16 v[44:47], v[76:79], v[16:19], v[44:47]
s_waitcnt vmcnt(1)
v_mfma_f32_16x16x32_bf16 v[44:47], v[76:79], v[20:23], v[44:47]
v_min3_u32 v48, v15, v19, v23
s_waitcnt vmcnt(0)
v_mfma_f32_16x16x32_bf16 v[44:47], v[76:79], v[24:27], v[44:47]
v_min_u32 v48, v48, v27
v_cmp_ne_u32 vcc, s75, v48
s_nop 4
s_cbranch_vccnz C\sfx\()2_1_retry_u1
v_add_f32_dpp v46, v44, v44 row_ror:8 row_mask:0xf bank_mask:0xf
v_add_f32_dpp v47, v45, v45 row_ror:8 row_mask:0xf bank_mask:0xf
v_cvt_pk_bf16_f32 v44, v46, v47
global_store_dword v7, v44, s[70:71] offset:3072 \md
C\sfx\()2_1_done_u1:
v_mov_b32 v48, -1
global_store_dword v7, v48, s[72:73] offset:3072 \md
s_waitcnt vmcnt(2)
ds_read_b128 v[44:47], v0 offset:8192
ds_read_b128 v[48:51], v0 offset:9216
ds_read_b128 v[52:55], v0 offset:10240
ds_read_b128 v[56:59], v0 offset:11264
v_mov_b64 v[28:29], 0
v_mov_b64 v[30:31], 0
v_mov_b64 v[32:33], 0
v_mov_b64 v[34:35], 0
v_mov_b64 v[36:37], 0
v_mov_b64 v[38:39], 0
v_mov_b64 v[40:41], 0
v_mov_b64 v[42:43], 0
s_add_u32 s75, s75, 1
s_barrier
s_branch C\sfx\()2_0_qk
C\sfx\()2_0_retry_ag:
s_waitcnt vmcnt(0) lgkmcnt(0)
s_add_u32 s76, s76, 0x10000
s_sub_u32 s43, s43, 1
s_cbranch_scc1 EXIT2
s_add_u32 s52, s70, 0x0
s_addc_u32 s53, s71, 0
s_sub_u32 s52, s52, 3072
s_subb_u32 s53, s53, 0
s_mov_b32 m0, 0x22000
s_nop 0
global_load_lds_dwordx4 v0, s[52:53] sc1
s_add_u32 s52, s70, 0x400
s_addc_u32 s53, s71, 0
s_sub_u32 s52, s52, 3072
s_subb_u32 s53, s53, 0
s_mov_b32 m0, 0x22400
s_nop 0
global_load_lds_dwordx4 v0, s[52:53] sc1
s_add_u32 s52, s70, 0x800
s_addc_u32 s53, s71, 0
s_sub_u32 s52, s52, 3072
s_subb_u32 s53, s53, 0
s_mov_b32 m0, 0x22800
s_nop 0
global_load_lds_dwordx4 v0, s[52:53] sc1
s_add_u32 s52, s70, 0xc00
s_addc_u32 s53, s71, 0
s_sub_u32 s52, s52, 3072
s_subb_u32 s53, s53, 0
s_mov_b32 m0, 0x22c00
s_nop 0
global_load_lds_dwordx4 v0, s[52:53] sc1
s_add_u32 s52, s70, 0x1000
s_addc_u32 s53, s71, 0
s_sub_u32 s52, s52, 3072
s_subb_u32 s53, s53, 0
s_mov_b32 m0, 0x23000
s_nop 0
global_load_lds_dwordx4 v0, s[52:53] sc1
s_add_u32 s52, s70, 0x1400
s_addc_u32 s53, s71, 0
s_sub_u32 s52, s52, 3072
s_subb_u32 s53, s53, 0
s_mov_b32 m0, 0x23400
s_nop 0
global_load_lds_dwordx4 v0, s[52:53] sc1
s_add_u32 s52, s70, 0x1800
s_addc_u32 s53, s71, 0
s_sub_u32 s52, s52, 3072
s_subb_u32 s53, s53, 0
s_mov_b32 m0, 0x23800
s_nop 0
global_load_lds_dwordx4 v0, s[52:53] sc1
s_add_u32 s52, s70, 0x1c00
s_addc_u32 s53, s71, 0
s_sub_u32 s52, s52, 3072
s_subb_u32 s53, s53, 0
s_mov_b32 m0, 0x23c00
s_nop 0
global_load_lds_dwordx4 v0, s[52:53] sc1
s_add_u32 s52, s70, 0x2000
s_addc_u32 s53, s71, 0
s_sub_u32 s52, s52, 3072
s_subb_u32 s53, s53, 0
s_mov_b32 m0, 0x27800
s_nop 0
global_load_lds_dwordx4 v0, s[52:53] sc1
ds_read_b128 v[44:47], v0 offset:8192
ds_read_b128 v[48:51], v0 offset:9216
ds_read_b128 v[52:55], v0 offset:10240
ds_read_b128 v[56:59], v0 offset:11264
v_mov_b64 v[28:29], 0
v_mov_b64 v[30:31], 0
v_mov_b64 v[32:33], 0
v_mov_b64 v[34:35], 0
v_mov_b64 v[36:37], 0
v_mov_b64 v[38:39], 0
v_mov_b64 v[40:41], 0
v_mov_b64 v[42:43], 0
s_waitcnt vmcnt(0)
ds_read_b128 v[12:15], v4 offset:8192
ds_read_b128 v[16:19], v4 offset:9216
ds_read_b128 v[20:23], v4 offset:10240
s_add_u32 s52, s36, 0x2000
s_addc_u32 s53, s37, 0
s_waitcnt lgkmcnt(2)
v_smfmac_f32_16x16x64_bf16 v[28:31], v[12:15], v[80:87], v1
ds_read_b128 v[24:27], v4 offset:11264
v_smfmac_f32_16x16x64_bf16 v[32:35], v[12:15], v[88:95], v1
v_smfmac_f32_16x16x64_bf16 v[36:39], v[12:15], v[44:51], v1
ds_read_b128 v[44:47], v0 offset:24576
v_smfmac_f32_16x16x64_bf16 v[40:43], v[12:15], v[52:59], v1
ds_read_b128 v[48:51], v0 offset:25600
s_waitcnt lgkmcnt(4)
v_smfmac_f32_16x16x64_bf16 v[28:31], v[16:19], v[96:103], v1
ds_read_b128 v[52:55], v0 offset:26624
v_smfmac_f32_16x16x64_bf16 v[32:35], v[16:19], v[104:111], v1
ds_read_b128 v[56:59], v0 offset:27648
v_smfmac_f32_16x16x64_bf16 v[36:39], v[16:19], v[224:231], v1
ds_read_b128 v[12:15], v4 offset:12288
v_smfmac_f32_16x16x64_bf16 v[40:43], v[16:19], v[232:239], v1
s_waitcnt lgkmcnt(6)
v_smfmac_f32_16x16x64_bf16 v[28:31], v[20:23], v[112:119], v1
ds_read_b128 v[16:19], v4 offset:13312
v_smfmac_f32_16x16x64_bf16 v[32:35], v[20:23], v[120:127], v1
s_waitcnt lgkmcnt(4)
v_smfmac_f32_16x16x64_bf16 v[36:39], v[20:23], v[44:51], v1
ds_read_b128 v[44:47], v0 offset:40960
s_waitcnt lgkmcnt(3)
v_smfmac_f32_16x16x64_bf16 v[40:43], v[20:23], v[52:59], v1
ds_read_b128 v[48:51], v0 offset:41984
v_smfmac_f32_16x16x64_bf16 v[28:31], v[24:27], v[128:135], v1
ds_read_b128 v[52:55], v0 offset:43008
v_smfmac_f32_16x16x64_bf16 v[32:35], v[24:27], v[136:143], v1
ds_read_b128 v[56:59], v0 offset:44032
v_smfmac_f32_16x16x64_bf16 v[36:39], v[24:27], v[240:247], v1
ds_read_b128 v[20:23], v4 offset:14336
v_smfmac_f32_16x16x64_bf16 v[40:43], v[24:27], v[248:255], v1
s_waitcnt lgkmcnt(6)
v_smfmac_f32_16x16x64_bf16 v[28:31], v[12:15], v[144:151], v1
ds_read_b128 v[24:27], v4 offset:15360
v_smfmac_f32_16x16x64_bf16 v[32:35], v[12:15], v[152:159], v1
s_waitcnt lgkmcnt(4)
v_smfmac_f32_16x16x64_bf16 v[36:39], v[12:15], v[44:51], v1
ds_read_b128 v[44:47], v0 offset:57344
s_waitcnt lgkmcnt(3)
v_smfmac_f32_16x16x64_bf16 v[40:43], v[12:15], v[52:59], v1
ds_read_b128 v[48:51], v0 offset:58368
v_smfmac_f32_16x16x64_bf16 v[28:31], v[16:19], v[160:167], v1
ds_read_b128 v[52:55], v0 offset:59392
v_smfmac_f32_16x16x64_bf16 v[32:35], v[16:19], v[168:175], v1
ds_read_b128 v[56:59], v0 offset:60416
v_smfmac_f32_16x16x64_bf16 v[36:39], v[16:19], a[0:7], v1
ds_read_b128 v[12:15], v4 offset:30720
v_smfmac_f32_16x16x64_bf16 v[40:43], v[16:19], a[8:15], v1
s_waitcnt lgkmcnt(6)
v_smfmac_f32_16x16x64_bf16 v[28:31], v[20:23], v[176:183], v1
s_waitcnt lgkmcnt(3)
v_smfmac_f32_16x16x64_bf16 v[36:39], v[20:23], v[44:51], v1
ds_read_b128 v[44:47], v9 offset:8192
v_smfmac_f32_16x16x64_bf16 v[32:35], v[20:23], v[184:191], v1
ds_read_b128 v[48:51], v9 offset:9216
s_waitcnt lgkmcnt(3)
v_smfmac_f32_16x16x64_bf16 v[40:43], v[20:23], v[52:59], v1
ds_read_b128 v[52:55], v9 offset:10240
v_smfmac_f32_16x16x64_bf16 v[28:31], v[24:27], v[192:199], v1
ds_read_b128 v[56:59], v9 offset:11264
v_smfmac_f32_16x16x64_bf16 v[36:39], v[24:27], a[16:23], v1
s_waitcnt lgkmcnt(4)
v_smfmac_f32_16x16x64_bf16 v[28:31], v[12:15], v[208:215], v1
s_waitcnt lgkmcnt(2)
v_smfmac_f32_16x16x64_bf16 v[36:39], v[12:15], v[44:51], v1
v_smfmac_f32_16x16x64_bf16 v[32:35], v[24:27], v[200:207], v1
v_mov_b64 v[44:45], 0
v_smfmac_f32_16x16x64_bf16 v[40:43], v[24:27], a[24:31], v1
v_mov_b64 v[48:49], 0
s_nop 1
v_add_f32 v28, v28, v30
v_smfmac_f32_16x16x64_bf16 v[32:35], v[12:15], v[216:223], v1
v_add_f32 v29, v29, v31
v_cvt_pk_bf16_f32 v77, v28, v29
v_add_f32 v36, v36, v38
s_waitcnt lgkmcnt(0)
v_smfmac_f32_16x16x64_bf16 v[40:43], v[12:15], v[52:59], v1
v_add_f32 v37, v37, v39
v_cvt_pk_bf16_f32 v76, v36, v37
ds_write_b64 v2, v[76:77]
v_mov_b64 v[46:47], 0
v_mov_b64 v[50:51], 0
s_nop 1
s_branch C\sfx\()2_0_postqk
C\sfx\()2_0_retry0:
s_add_u32 s76, s76, 1
s_waitcnt lgkmcnt(0)
s_nop 3
v_mov_b64 v[28:29], 0
v_mov_b64 v[30:31], 0
v_mov_b64 v[32:33], 0
v_mov_b64 v[34:35], 0
C\sfx\()2_0_retry0_p:
ds_read_b128 v[12:15], v4 offset:8192
ds_read_b128 v[16:19], v4 offset:9216
ds_read_b128 v[20:23], v4 offset:10240
s_sub_u32 s43, s43, 1
s_cbranch_scc1 EXIT2
s_waitcnt lgkmcnt(0)
v_add_f32 v10, v12, v16
v_cmp_u_f32 vcc, v10, v20
s_cbranch_vccnz C\sfx\()2_0_retry0_p
s_branch C\sfx\()2_0_back0
C\sfx\()2_0_retry1:
s_add_u32 s76, s76, 1
C\sfx\()2_0_retry1_p:
ds_read_b128 v[24:27], v4 offset:11264
ds_read_b128 v[12:15], v4 offset:12288
s_sub_u32 s43, s43, 1
s_cbranch_scc1 EXIT2
s_waitcnt lgkmcnt(0)
v_cmp_u_f32 vcc, v24, v12
s_cbranch_vccnz C\sfx\()2_0_retry1_p
s_branch C\sfx\()2_0_back1
C\sfx\()2_0_retry1b:
s_add_u32 s76, s76, 1
C\sfx\()2_0_retry1b_p:
ds_read_b128 v[16:19], v4 offset:13312
s_sub_u32 s43, s43, 1
s_cbranch_scc1 EXIT2
s_waitcnt lgkmcnt(0)
v_cmp_u_f32 vcc, v16, v16
s_cbranch_vccnz C\sfx\()2_0_retry1b_p
s_branch C\sfx\()2_0_back1b
C\sfx\()2_0_retry2:
s_add_u32 s76, s76, 1
C\sfx\()2_0_retry2_p:
s_mov_b32 m0, 0x23800
s_nop 0
global_load_lds_dwordx4 v0, s[68:69] sc1
global_load_lds_dwordx4 v0, s[68:69] offset:1024 sc1
s_mov_b32 m0, 0x27000
s_nop 0
global_load_lds_dwordx4 v0, s[68:69] offset:2048 sc1
s_waitcnt vmcnt(3)
ds_read_b128 v[20:23], v4 offset:14336
ds_read_b128 v[24:27], v4 offset:15360
s_sub_u32 s43, s43, 1
s_cbranch_scc1 EXIT2
s_waitcnt lgkmcnt(0)
v_cmp_u_f32 vcc, v20, v24
s_cbranch_vccnz C\sfx\()2_0_retry2_p
s_branch C\sfx\()2_0_back2
C\sfx\()2_0_retry2b:
s_add_u32 s76, s76, 1
C\sfx\()2_0_retry2b_p:
s_mov_b32 m0, 0x23800
s_nop 0
global_load_lds_dwordx4 v0, s[68:69] sc1
global_load_lds_dwordx4 v0, s[68:69] offset:1024 sc1
s_mov_b32 m0, 0x27000
s_nop 0
global_load_lds_dwordx4 v0, s[68:69] offset:2048 sc1
s_waitcnt vmcnt(3)
ds_read_b128 v[12:15], v4 offset:30720
s_sub_u32 s43, s43, 1
s_cbranch_scc1 EXIT2
s_waitcnt lgkmcnt(0)
v_cmp_u_f32 vcc, v12, v12
s_cbranch_vccnz C\sfx\()2_0_retry2b_p
s_waitcnt vmcnt(0)
s_branch C\sfx\()2_0_back2b
C\sfx\()2_0_retry_u1:
s_add_u32 s77, s77, 1
s_mov_b32 s74, 1
global_load_dwordx4 v[12:15], v0, s[32:33] sc1
global_load_dwordx4 v[16:19], v0, s[32:33] offset:1024 sc1
global_load_dwordx4 v[20:23], v0, s[32:33] offset:2048 sc1
global_load_dwordx4 v[24:27], v0, s[32:33] offset:3072 sc1
C\sfx\()2_0_retry_u1_l:
s_waitcnt vmcnt(3)
v_mfma_f32_16x16x32_bf16 v[44:47], v[76:79], v[12:15], 0
s_waitcnt vmcnt(2)
v_mfma_f32_16x16x32_bf16 v[44:47], v[76:79], v[16:19], v[44:47]
s_waitcnt vmcnt(1)
v_mfma_f32_16x16x32_bf16 v[44:47], v[76:79], v[20:23], v[44:47]
v_min3_u32 v48, v15, v19, v23
s_waitcnt vmcnt(0)
v_mfma_f32_16x16x32_bf16 v[44:47], v[76:79], v[24:27], v[44:47]
v_min_u32 v48, v48, v27
v_cmp_ne_u32 vcc, s75, v48
s_nop 4
s_cbranch_vccnz C\sfx\()2_0_retry_u1_m0
v_add_f32_dpp v46, v44, v44 row_ror:8 row_mask:0xf bank_mask:0xf
v_add_f32_dpp v47, v45, v45 row_ror:8 row_mask:0xf bank_mask:0xf
v_cvt_pk_bf16_f32 v44, v46, v47
global_store_dword v7, v44, s[22:23] offset:3072 \md
s_branch C\sfx\()2_0_done_u1
C\sfx\()2_0_retry_u1_m0:
global_load_dwordx4 v[12:15], v0, s[32:33] sc1
global_load_dwordx4 v[16:19], v0, s[32:33] offset:1024 sc1
global_load_dwordx4 v[20:23], v0, s[32:33] offset:2048 sc1
global_load_dwordx4 v[24:27], v0, s[32:33] offset:3072 sc1
s_sub_u32 s43, s43, 1
s_cbranch_scc1 EXIT2
s_branch C\sfx\()2_0_retry_u1_l
C\sfx\()2_0_slow:
s_waitcnt lgkmcnt(0)
s_nop 7
ds_read_b64_tr_b16 v[24:25], v3
ds_read_b64_tr_b16 v[26:27], v3 offset:512
ds_read_b128 v[28:31], v4
ds_read_b128 v[32:35], v4 offset:4096
s_waitcnt lgkmcnt(0)
v_mfma_f32_16x16x32_bf16 v[12:15], v[28:31], v[24:27], 0
v_mfma_f32_16x16x32_bf16 v[16:19], v[32:35], v[24:27], 0
v_mfma_f32_16x16x32_bf16 v[20:23], v[24:27], v[24:27], 0
s_nop 7
ds_read_b64_tr_b16 v[24:25], v3 offset:1024
ds_read_b64_tr_b16 v[26:27], v3 offset:1536
ds_read_b128 v[28:31], v4 offset:1024
ds_read_b128 v[32:35], v4 offset:5120
s_waitcnt lgkmcnt(0)
v_mfma_f32_16x16x32_bf16 v[12:15], v[28:31], v[24:27], v[12:15]
v_mfma_f32_16x16x32_bf16 v[16:19], v[32:35], v[24:27], v[16:19]
v_mfma_f32_16x16x32_bf16 v[20:23], v[24:27], v[24:27], v[20:23]
s_nop 7
ds_read_b64_tr_b16 v[24:25], v3 offset:2048
ds_read_b64_tr_b16 v[26:27], v3 offset:2560
ds_read_b128 v[28:31], v4 offset:2048
ds_read_b128 v[32:35], v4 offset:6144
s_waitcnt lgkmcnt(0)
v_mfma_f32_16x16x32_bf16 v[12:15], v[28:31], v[24:27], v[12:15]
v_mfma_f32_16x16x32_bf16 v[16:19], v[32:35], v[24:27], v[16:19]
v_mfma_f32_16x16x32_bf16 v[20:23], v[24:27], v[24:27], v[20:23]
s_nop 7
ds_read_b64_tr_b16 v[24:25], v3 offset:3072
ds_read_b64_tr_b16 v[26:27], v3 offset:3584
ds_read_b128 v[28:31], v4 offset:3072
ds_read_b128 v[32:35], v4 offset:7168
s_waitcnt lgkmcnt(0)
v_mfma_f32_16x16x32_bf16 v[12:15], v[28:31], v[24:27], v[12:15]
v_mfma_f32_16x16x32_bf16 v[16:19], v[32:35], v[24:27], v[16:19]
v_mfma_f32_16x16x32_bf16 v[20:23], v[24:27], v[24:27], v[20:23]
s_nop 7
v_mul_f32 v20, s44, v20
v_mul_f32 v21, s44, v21
v_max3_f32 v22, v20, v21, v12
v_max3_f32 v22, v22, v13, v14
v_max3_f32 v22, v22, v15, v16
v_max3_f32 v22, v22, v17, v18
v_max_f32 v22, v22, v19
v_mov_b32 v23, v22
s_nop 1
v_permlane16_swap_b32 v22, v23
s_nop 1
v_max_f32 v22, v22, v23
v_mov_b32 v23, v22
s_nop 1
v_permlane32_swap_b32 v22, v23
s_nop 1
v_max_f32 v22, v22, v23
v_sub_f32 v12, v12, v22
v_exp_f32 v12, v12
v_sub_f32 v13, v13, v22
v_exp_f32 v13, v13
v_sub_f32 v14, v14, v22
v_exp_f32 v14, v14
v_sub_f32 v15, v15, v22
v_exp_f32 v15, v15
v_sub_f32 v16, v16, v22
v_exp_f32 v16, v16
v_sub_f32 v17, v17, v22
v_exp_f32 v17, v17
v_sub_f32 v18, v18, v22
v_exp_f32 v18, v18
v_sub_f32 v19, v19, v22
v_exp_f32 v19, v19
v_sub_f32 v20, v20, v22
v_exp_f32 v20, v20
v_sub_f32 v21, v21, v22
v_exp_f32 v21, v21
v_cvt_pk_bf16_f32 v76, v12, v13
v_cvt_pk_bf16_f32 v77, v14, v15
v_cvt_pk_bf16_f32 v78, v16, v17
v_cvt_pk_bf16_f32 v79, v18, v19
v_cvt_pk_bf16_f32 v10, v20, v21
ds_read_b128 v[28:31], v4 offset:20480
ds_read_b128 v[32:35], v4 offset:21504
s_waitcnt lgkmcnt(0)
v_mfma_f32_16x16x32_bf16 v[60:63], v[76:79], v[28:31], 0
v_mfma_f32_16x16x32_bf16 v[64:67], v[76:79], v[32:35], 0
v_mfma_f32_16x16x32_bf16 v[40:43], v[76:79], v[36:39], 0
s_nop 5
v_mfma_f32_16x16x16_bf16 v[40:43], v[10:11], v[36:37], v[40:43]
v_mfma_f32_16x16x16_bf16 v[60:63], v[10:11], v[52:53], v[60:63]
v_mfma_f32_16x16x16_bf16 v[64:67], v[10:11], v[56:57], v[64:67]
s_nop 5
v_rcp_f32 v70, v42
v_rcp_f32 v71, v43
v_mul_f32 v62, v62, v70
v_mul_f32 v63, v63, v71
v_cvt_pk_bf16_f32 v68, v62, v63
ds_write_b32 v2, v68 offset:2052
v_mul_f32 v66, v66, v70
v_mul_f32 v67, v67, v71
v_cvt_pk_bf16_f32 v69, v66, v67
ds_write_b32 v2, v69 offset:2564
s_waitcnt lgkmcnt(0)
v_mov_b64 v[12:13], 0
v_mov_b64 v[14:15], 0
v_mov_b64 v[16:17], 0
v_mov_b64 v[18:19], 0
v_mov_b64 v[20:21], 0
v_mov_b64 v[22:23], 0
s_nop 3
s_branch C\sfx\()2_0_oskip
C\sfx\()2_1_retry_ag:
s_waitcnt vmcnt(0) lgkmcnt(0)
s_add_u32 s76, s76, 0x10000
s_sub_u32 s43, s43, 1
s_cbranch_scc1 EXIT2
s_add_u32 s52, s22, 0x0
s_addc_u32 s53, s23, 0
s_sub_u32 s52, s52, 3072
s_subb_u32 s53, s53, 0
s_mov_b32 m0, 0x20000
s_nop 0
global_load_lds_dwordx4 v0, s[52:53] sc1
s_add_u32 s52, s22, 0x400
s_addc_u32 s53, s23, 0
s_sub_u32 s52, s52, 3072
s_subb_u32 s53, s53, 0
s_mov_b32 m0, 0x20400
s_nop 0
global_load_lds_dwordx4 v0, s[52:53] sc1
s_add_u32 s52, s22, 0x800
s_addc_u32 s53, s23, 0
s_sub_u32 s52, s52, 3072
s_subb_u32 s53, s53, 0
s_mov_b32 m0, 0x20800
s_nop 0
global_load_lds_dwordx4 v0, s[52:53] sc1
s_add_u32 s52, s22, 0xc00
s_addc_u32 s53, s23, 0
s_sub_u32 s52, s52, 3072
s_subb_u32 s53, s53, 0
s_mov_b32 m0, 0x20c00
s_nop 0
global_load_lds_dwordx4 v0, s[52:53] sc1
s_add_u32 s52, s22, 0x1000
s_addc_u32 s53, s23, 0
s_sub_u32 s52, s52, 3072
s_subb_u32 s53, s53, 0
s_mov_b32 m0, 0x21000
s_nop 0
global_load_lds_dwordx4 v0, s[52:53] sc1
s_add_u32 s52, s22, 0x1400
s_addc_u32 s53, s23, 0
s_sub_u32 s52, s52, 3072
s_subb_u32 s53, s53, 0
s_mov_b32 m0, 0x21400
s_nop 0
global_load_lds_dwordx4 v0, s[52:53] sc1
s_add_u32 s52, s22, 0x1800
s_addc_u32 s53, s23, 0
s_sub_u32 s52, s52, 3072
s_subb_u32 s53, s53, 0
s_mov_b32 m0, 0x21800
s_nop 0
global_load_lds_dwordx4 v0, s[52:53] sc1
s_add_u32 s52, s22, 0x1c00
s_addc_u32 s53, s23, 0
s_sub_u32 s52, s52, 3072
s_subb_u32 s53, s53, 0
s_mov_b32 m0, 0x21c00
s_nop 0
global_load_lds_dwordx4 v0, s[52:53] sc1
s_add_u32 s52, s22, 0x2000
s_addc_u32 s53, s23, 0
s_sub_u32 s52, s52, 3072
s_subb_u32 s53, s53, 0
s_mov_b32 m0, 0x27800
s_nop 0
global_load_lds_dwordx4 v0, s[52:53] sc1
ds_read_b128 v[44:47], v0 offset:8192
ds_read_b128 v[48:51], v0 offset:9216
ds_read_b128 v[52:55], v0 offset:10240
ds_read_b128 v[56:59], v0 offset:11264
v_mov_b64 v[28:29], 0
v_mov_b64 v[30:31], 0
v_mov_b64 v[32:33], 0
v_mov_b64 v[34:35], 0
v_mov_b64 v[36:37], 0
v_mov_b64 v[38:39], 0
v_mov_b64 v[40:41], 0
v_mov_b64 v[42:43], 0
s_waitcnt vmcnt(0)
ds_read_b128 v[12:15], v4
ds_read_b128 v[16:19], v4 offset:1024
ds_read_b128 v[20:23], v4 offset:2048
s_add_u32 s52, s36, 0x2000
s_addc_u32 s53, s37, 0
s_waitcnt lgkmcnt(2)
v_smfmac_f32_16x16x64_bf16 v[28:31], v[12:15], v[80:87], v1
ds_read_b128 v[24:27], v4 offset:3072
v_smfmac_f32_16x16x64_bf16 v[32:35], v[12:15], v[88:95], v1
v_smfmac_f32_16x16x64_bf16 v[36:39], v[12:15], v[44:51], v1
ds_read_b128 v[44:47], v0 offset:24576
v_smfmac_f32_16x16x64_bf16 v[40:43], v[12:15], v[52:59], v1
ds_read_b128 v[48:51], v0 offset:25600
s_waitcnt lgkmcnt(4)
v_smfmac_f32_16x16x64_bf16 v[28:31], v[16:19], v[96:103], v1
ds_read_b128 v[52:55], v0 offset:26624
v_smfmac_f32_16x16x64_bf16 v[32:35], v[16:19], v[104:111], v1
ds_read_b128 v[56:59], v0 offset:27648
v_smfmac_f32_16x16x64_bf16 v[36:39], v[16:19], v[224:231], v1
ds_read_b128 v[12:15], v4 offset:4096
v_smfmac_f32_16x16x64_bf16 v[40:43], v[16:19], v[232:239], v1
s_waitcnt lgkmcnt(6)
v_smfmac_f32_16x16x64_bf16 v[28:31], v[20:23], v[112:119], v1
ds_read_b128 v[16:19], v4 offset:5120
v_smfmac_f32_16x16x64_bf16 v[32:35], v[20:23], v[120:127], v1
s_waitcnt lgkmcnt(4)
v_smfmac_f32_16x16x64_bf16 v[36:39], v[20:23], v[44:51], v1
ds_read_b128 v[44:47], v0 offset:40960
s_waitcnt lgkmcnt(3)
v_smfmac_f32_16x16x64_bf16 v[40:43], v[20:23], v[52:59], v1
ds_read_b128 v[48:51], v0 offset:41984
v_smfmac_f32_16x16x64_bf16 v[28:31], v[24:27], v[128:135], v1
ds_read_b128 v[52:55], v0 offset:43008
v_smfmac_f32_16x16x64_bf16 v[32:35], v[24:27], v[136:143], v1
ds_read_b128 v[56:59], v0 offset:44032
v_smfmac_f32_16x16x64_bf16 v[36:39], v[24:27], v[240:247], v1
ds_read_b128 v[20:23], v4 offset:6144
v_smfmac_f32_16x16x64_bf16 v[40:43], v[24:27], v[248:255], v1
s_waitcnt lgkmcnt(6)
v_smfmac_f32_16x16x64_bf16 v[28:31], v[12:15], v[144:151], v1
ds_read_b128 v[24:27], v4 offset:7168
v_smfmac_f32_16x16x64_bf16 v[32:35], v[12:15], v[152:159], v1
s_waitcnt lgkmcnt(4)
v_smfmac_f32_16x16x64_bf16 v[36:39], v[12:15], v[44:51], v1
ds_read_b128 v[44:47], v0 offset:57344
s_waitcnt lgkmcnt(3)
v_smfmac_f32_16x16x64_bf16 v[40:43], v[12:15], v[52:59], v1
ds_read_b128 v[48:51], v0 offset:58368
v_smfmac_f32_16x16x64_bf16 v[28:31], v[16:19], v[160:167], v1
ds_read_b128 v[52:55], v0 offset:59392
v_smfmac_f32_16x16x64_bf16 v[32:35], v[16:19], v[168:175], v1
ds_read_b128 v[56:59], v0 offset:60416
v_smfmac_f32_16x16x64_bf16 v[36:39], v[16:19], a[0:7], v1
ds_read_b128 v[12:15], v4 offset:30720
v_smfmac_f32_16x16x64_bf16 v[40:43], v[16:19], a[8:15], v1
s_waitcnt lgkmcnt(6)
v_smfmac_f32_16x16x64_bf16 v[28:31], v[20:23], v[176:183], v1
s_waitcnt lgkmcnt(3)
v_smfmac_f32_16x16x64_bf16 v[36:39], v[20:23], v[44:51], v1
ds_read_b128 v[44:47], v9 offset:8192
v_smfmac_f32_16x16x64_bf16 v[32:35], v[20:23], v[184:191], v1
ds_read_b128 v[48:51], v9 offset:9216
s_waitcnt lgkmcnt(3)
v_smfmac_f32_16x16x64_bf16 v[40:43], v[20:23], v[52:59], v1
ds_read_b128 v[52:55], v9 offset:10240
v_smfmac_f32_16x16x64_bf16 v[28:31], v[24:27], v[192:199], v1
ds_read_b128 v[56:59], v9 offset:11264
v_smfmac_f32_16x16x64_bf16 v[36:39], v[24:27], a[16:23], v1
s_waitcnt lgkmcnt(4)
v_smfmac_f32_16x16x64_bf16 v[28:31], v[12:15], v[208:215], v1
s_waitcnt lgkmcnt(2)
v_smfmac_f32_16x16x64_bf16 v[36:39], v[12:15], v[44:51], v1
v_smfmac_f32_16x16x64_bf16 v[32:35], v[24:27], v[200:207], v1
v_mov_b64 v[44:45], 0
v_smfmac_f32_16x16x64_bf16 v[40:43], v[24:27], a[24:31], v1
v_mov_b64 v[48:49], 0
s_nop 1
v_add_f32 v28, v28, v30
v_smfmac_f32_16x16x64_bf16 v[32:35], v[12:15], v[216:223], v1
v_add_f32 v29, v29, v31
v_cvt_pk_bf16_f32 v77, v28, v29
v_add_f32 v36, v36, v38
s_waitcnt lgkmcnt(0)
v_smfmac_f32_16x16x64_bf16 v[40:43], v[12:15], v[52:59], v1
v_add_f32 v37, v37, v39
v_cvt_pk_bf16_f32 v76, v36, v37
ds_write_b64 v2, v[76:77]
v_mov_b64 v[46:47], 0
v_mov_b64 v[50:51], 0
s_nop 1
s_branch C\sfx\()2_1_postqk
C\sfx\()2_1_retry0:
s_add_u32 s76, s76, 1
s_waitcnt lgkmcnt(0)
s_nop 3
v_mov_b64 v[28:29], 0
v_mov_b64 v[30:31], 0
v_mov_b64 v[32:33], 0
v_mov_b64 v[34:35], 0
C\sfx\()2_1_retry0_p:
ds_read_b128 v[12:15], v4
ds_read_b128 v[16:19], v4 offset:1024
ds_read_b128 v[20:23], v4 offset:2048
s_sub_u32 s43, s43, 1
s_cbranch_scc1 EXIT2
s_waitcnt lgkmcnt(0)
v_add_f32 v10, v12, v16
v_cmp_u_f32 vcc, v10, v20
s_cbranch_vccnz C\sfx\()2_1_retry0_p
s_branch C\sfx\()2_1_back0
C\sfx\()2_1_retry1:
s_add_u32 s76, s76, 1
C\sfx\()2_1_retry1_p:
ds_read_b128 v[24:27], v4 offset:3072
ds_read_b128 v[12:15], v4 offset:4096
s_sub_u32 s43, s43, 1
s_cbranch_scc1 EXIT2
s_waitcnt lgkmcnt(0)
v_cmp_u_f32 vcc, v24, v12
s_cbranch_vccnz C\sfx\()2_1_retry1_p
s_branch C\sfx\()2_1_back1
C\sfx\()2_1_retry1b:
s_add_u32 s76, s76, 1
C\sfx\()2_1_retry1b_p:
ds_read_b128 v[16:19], v4 offset:5120
s_sub_u32 s43, s43, 1
s_cbranch_scc1 EXIT2
s_waitcnt lgkmcnt(0)
v_cmp_u_f32 vcc, v16, v16
s_cbranch_vccnz C\sfx\()2_1_retry1b_p
s_branch C\sfx\()2_1_back1b
C\sfx\()2_1_retry2:
s_add_u32 s76, s76, 1
C\sfx\()2_1_retry2_p:
s_mov_b32 m0, 0x21800
s_nop 0
global_load_lds_dwordx4 v0, s[20:21] sc1
global_load_lds_dwordx4 v0, s[20:21] offset:1024 sc1
s_mov_b32 m0, 0x27000
s_nop 0
global_load_lds_dwordx4 v0, s[20:21] offset:2048 sc1
s_waitcnt vmcnt(3)
ds_read_b128 v[20:23], v4 offset:6144
ds_read_b128 v[24:27], v4 offset:7168
s_sub_u32 s43, s43, 1
s_cbranch_scc1 EXIT2
s_waitcnt lgkmcnt(0)
v_cmp_u_f32 vcc, v20, v24
s_cbranch_vccnz C\sfx\()2_1_retry2_p
s_branch C\sfx\()2_1_back2
C\sfx\()2_1_retry2b:
s_add_u32 s76, s76, 1
C\sfx\()2_1_retry2b_p:
s_mov_b32 m0, 0x21800
s_nop 0
global_load_lds_dwordx4 v0, s[20:21] sc1
global_load_lds_dwordx4 v0, s[20:21] offset:1024 sc1
s_mov_b32 m0, 0x27000
s_nop 0
global_load_lds_dwordx4 v0, s[20:21] offset:2048 sc1
s_waitcnt vmcnt(3)
ds_read_b128 v[12:15], v4 offset:30720
s_sub_u32 s43, s43, 1
s_cbranch_scc1 EXIT2
s_waitcnt lgkmcnt(0)
v_cmp_u_f32 vcc, v12, v12
s_cbranch_vccnz C\sfx\()2_1_retry2b_p
s_waitcnt vmcnt(0)
s_branch C\sfx\()2_1_back2b
C\sfx\()2_1_retry_u1:
s_add_u32 s77, s77, 1
s_mov_b32 s74, 1
global_load_dwordx4 v[12:15], v0, s[34:35] sc1
global_load_dwordx4 v[16:19], v0, s[34:35] offset:1024 sc1
global_load_dwordx4 v[20:23], v0, s[34:35] offset:2048 sc1
global_load_dwordx4 v[24:27], v0, s[34:35] offset:3072 sc1
C\sfx\()2_1_retry_u1_l:
s_waitcnt vmcnt(3)
v_mfma_f32_16x16x32_bf16 v[44:47], v[76:79], v[12:15], 0
s_waitcnt vmcnt(2)
v_mfma_f32_16x16x32_bf16 v[44:47], v[76:79], v[16:19], v[44:47]
s_waitcnt vmcnt(1)
v_mfma_f32_16x16x32_bf16 v[44:47], v[76:79], v[20:23], v[44:47]
v_min3_u32 v48, v15, v19, v23
s_waitcnt vmcnt(0)
v_mfma_f32_16x16x32_bf16 v[44:47], v[76:79], v[24:27], v[44:47]
v_min_u32 v48, v48, v27
v_cmp_ne_u32 vcc, s75, v48
s_nop 4
s_cbranch_vccnz C\sfx\()2_1_retry_u1_m0
v_add_f32_dpp v46, v44, v44 row_ror:8 row_mask:0xf bank_mask:0xf
v_add_f32_dpp v47, v45, v45 row_ror:8 row_mask:0xf bank_mask:0xf
v_cvt_pk_bf16_f32 v44, v46, v47
global_store_dword v7, v44, s[70:71] offset:3072 \md
s_branch C\sfx\()2_1_done_u1
C\sfx\()2_1_retry_u1_m0:
global_load_dwordx4 v[12:15], v0, s[34:35] sc1
global_load_dwordx4 v[16:19], v0, s[34:35] offset:1024 sc1
global_load_dwordx4 v[20:23], v0, s[34:35] offset:2048 sc1
global_load_dwordx4 v[24:27], v0, s[34:35] offset:3072 sc1
s_sub_u32 s43, s43, 1
s_cbranch_scc1 EXIT2
s_branch C\sfx\()2_1_retry_u1_l
C\sfx\()2_1_slow:
s_waitcnt lgkmcnt(0)
s_nop 7
ds_read_b64_tr_b16 v[24:25], v3
ds_read_b64_tr_b16 v[26:27], v3 offset:512
ds_read_b128 v[28:31], v4 offset:8192
ds_read_b128 v[32:35], v4 offset:12288
s_waitcnt lgkmcnt(0)
v_mfma_f32_16x16x32_bf16 v[12:15], v[28:31], v[24:27], 0
v_mfma_f32_16x16x32_bf16 v[16:19], v[32:35], v[24:27], 0
v_mfma_f32_16x16x32_bf16 v[20:23], v[24:27], v[24:27], 0
s_nop 7
ds_read_b64_tr_b16 v[24:25], v3 offset:1024
ds_read_b64_tr_b16 v[26:27], v3 offset:1536
ds_read_b128 v[28:31], v4 offset:9216
ds_read_b128 v[32:35], v4 offset:13312
s_waitcnt lgkmcnt(0)
v_mfma_f32_16x16x32_bf16 v[12:15], v[28:31], v[24:27], v[12:15]
v_mfma_f32_16x16x32_bf16 v[16:19], v[32:35], v[24:27], v[16:19]
v_mfma_f32_16x16x32_bf16 v[20:23], v[24:27], v[24:27], v[20:23]
s_nop 7
ds_read_b64_tr_b16 v[24:25], v3 offset:2048
ds_read_b64_tr_b16 v[26:27], v3 offset:2560
ds_read_b128 v[28:31], v4 offset:10240
ds_read_b128 v[32:35], v4 offset:14336
s_waitcnt lgkmcnt(0)
v_mfma_f32_16x16x32_bf16 v[12:15], v[28:31], v[24:27], v[12:15]
v_mfma_f32_16x16x32_bf16 v[16:19], v[32:35], v[24:27], v[16:19]
v_mfma_f32_16x16x32_bf16 v[20:23], v[24:27], v[24:27], v[20:23]
s_nop 7
ds_read_b64_tr_b16 v[24:25], v3 offset:3072
ds_read_b64_tr_b16 v[26:27], v3 offset:3584
ds_read_b128 v[28:31], v4 offset:11264
ds_read_b128 v[32:35], v4 offset:15360
s_waitcnt lgkmcnt(0)
v_mfma_f32_16x16x32_bf16 v[12:15], v[28:31], v[24:27], v[12:15]
v_mfma_f32_16x16x32_bf16 v[16:19], v[32:35], v[24:27], v[16:19]
v_mfma_f32_16x16x32_bf16 v[20:23], v[24:27], v[24:27], v[20:23]
s_nop 7
v_mul_f32 v20, s44, v20
v_mul_f32 v21, s44, v21
v_max3_f32 v22, v20, v21, v12
v_max3_f32 v22, v22, v13, v14
v_max3_f32 v22, v22, v15, v16
v_max3_f32 v22, v22, v17, v18
v_max_f32 v22, v22, v19
v_mov_b32 v23, v22
s_nop 1
v_permlane16_swap_b32 v22, v23
s_nop 1
v_max_f32 v22, v22, v23
v_mov_b32 v23, v22
s_nop 1
v_permlane32_swap_b32 v22, v23
s_nop 1
v_max_f32 v22, v22, v23
v_sub_f32 v12, v12, v22
v_exp_f32 v12, v12
v_sub_f32 v13, v13, v22
v_exp_f32 v13, v13
v_sub_f32 v14, v14, v22
v_exp_f32 v14, v14
v_sub_f32 v15, v15, v22
v_exp_f32 v15, v15
v_sub_f32 v16, v16, v22
v_exp_f32 v16, v16
v_sub_f32 v17, v17, v22
v_exp_f32 v17, v17
v_sub_f32 v18, v18, v22
v_exp_f32 v18, v18
v_sub_f32 v19, v19, v22
v_exp_f32 v19, v19
v_sub_f32 v20, v20, v22
v_exp_f32 v20, v20
v_sub_f32 v21, v21, v22
v_exp_f32 v21, v21
v_cvt_pk_bf16_f32 v76, v12, v13
v_cvt_pk_bf16_f32 v77, v14, v15
v_cvt_pk_bf16_f32 v78, v16, v17
v_cvt_pk_bf16_f32 v79, v18, v19
v_cvt_pk_bf16_f32 v10, v20, v21
ds_read_b128 v[28:31], v4 offset:20480
ds_read_b128 v[32:35], v4 offset:21504
s_waitcnt lgkmcnt(0)
v_mfma_f32_16x16x32_bf16 v[60:63], v[76:79], v[28:31], 0
v_mfma_f32_16x16x32_bf16 v[64:67], v[76:79], v[32:35], 0
v_mfma_f32_16x16x32_bf16 v[40:43], v[76:79], v[36:39], 0
s_nop 5
v_mfma_f32_16x16x16_bf16 v[40:43], v[10:11], v[36:37], v[40:43]
v_mfma_f32_16x16x16_bf16 v[60:63], v[10:11], v[52:53], v[60:63]
v_mfma_f32_16x16x16_bf16 v[64:67], v[10:11], v[56:57], v[64:67]
s_nop 5
v_rcp_f32 v70, v42
v_rcp_f32 v71, v43
v_mul_f32 v62, v62, v70
v_mul_f32 v63, v63, v71
v_cvt_pk_bf16_f32 v68, v62, v63
ds_write_b32 v2, v68 offset:2052
v_mul_f32 v66, v66, v70
v_mul_f32 v67, v67, v71
v_cvt_pk_bf16_f32 v69, v66, v67
ds_write_b32 v2, v69 offset:2564
s_waitcnt lgkmcnt(0)
v_mov_b64 v[12:13], 0
v_mov_b64 v[14:15], 0
v_mov_b64 v[16:17], 0
v_mov_b64 v[18:19], 0
v_mov_b64 v[20:21], 0
v_mov_b64 v[22:23], 0
s_nop 3
s_branch C\sfx\()2_1_oskip
.p2align 6
CE\sfx\()3:
ds_read_b128 v[44:47], v0 offset:12288
ds_read_b128 v[48:51], v0 offset:13312
ds_read_b128 v[52:55], v0 offset:14336
ds_read_b128 v[56:59], v0 offset:15360
v_mov_b64 v[28:29], 0
v_mov_b64 v[30:31], 0
v_mov_b64 v[32:33], 0
v_mov_b64 v[34:35], 0
v_mov_b64 v[36:37], 0
v_mov_b64 v[38:39], 0
v_mov_b64 v[40:41], 0
v_mov_b64 v[42:43], 0
s_nop 1
C\sfx\()3_0_qk:
ds_read_b128 v[12:15], v4 offset:8192
ds_read_b128 v[16:19], v4 offset:9216
ds_read_b128 v[20:23], v4 offset:10240
C\sfx\()3_0_back0:
s_waitcnt lgkmcnt(2)
v_smfmac_f32_16x16x64_bf16 v[28:31], v[12:15], v[80:87], v1
s_waitcnt lgkmcnt(0)
v_add_f32 v10, v12, v16
v_cmp_u_f32 vcc, v10, v20
v_smfmac_f32_16x16x64_bf16 v[32:35], v[12:15], v[88:95], v1
s_cbranch_vccnz C\sfx\()3_0_retry0
v_smfmac_f32_16x16x64_bf16 v[36:39], v[12:15], v[44:51], v1
ds_read_b128 v[44:47], v0 offset:28672
v_smfmac_f32_16x16x64_bf16 v[40:43], v[12:15], v[52:59], v1
ds_read_b128 v[48:51], v0 offset:29696
v_smfmac_f32_16x16x64_bf16 v[28:31], v[16:19], v[96:103], v1
ds_read_b128 v[52:55], v0 offset:30720
v_smfmac_f32_16x16x64_bf16 v[32:35], v[16:19], v[104:111], v1
ds_read_b128 v[56:59], v0 offset:31744
global_load_dwordx4 v[60:63], v0, s[40:41] offset:-4096
v_smfmac_f32_16x16x64_bf16 v[36:39], v[16:19], v[224:231], v1
v_smfmac_f32_16x16x64_bf16 v[40:43], v[16:19], v[232:239], v1
v_smfmac_f32_16x16x64_bf16 v[28:31], v[20:23], v[112:119], v1
ds_read_b128 v[24:27], v4 offset:11264
v_smfmac_f32_16x16x64_bf16 v[32:35], v[20:23], v[120:127], v1
ds_read_b128 v[12:15], v4 offset:12288
global_load_dwordx4 v[64:67], v0, s[40:41] offset:-3072
s_waitcnt lgkmcnt(4)
v_smfmac_f32_16x16x64_bf16 v[36:39], v[20:23], v[44:51], v1
ds_read_b128 v[16:19], v4 offset:13312
s_waitcnt lgkmcnt(1)
v_cmp_u_f32 vcc, v24, v12
v_smfmac_f32_16x16x64_bf16 v[40:43], v[20:23], v[52:59], v1
ds_read_b128 v[44:47], v0 offset:45056
s_cbranch_vccnz C\sfx\()3_0_retry1
C\sfx\()3_0_back1:
v_smfmac_f32_16x16x64_bf16 v[28:31], v[24:27], v[128:135], v1
ds_read_b128 v[48:51], v0 offset:46080
v_smfmac_f32_16x16x64_bf16 v[32:35], v[24:27], v[136:143], v1
ds_read_b128 v[52:55], v0 offset:47104
global_load_dwordx4 v[68:71], v0, s[40:41] offset:-2048
v_smfmac_f32_16x16x64_bf16 v[36:39], v[24:27], v[240:247], v1
ds_read_b128 v[56:59], v0 offset:48128
v_smfmac_f32_16x16x64_bf16 v[40:43], v[24:27], v[248:255], v1
v_smfmac_f32_16x16x64_bf16 v[28:31], v[12:15], v[144:151], v1
s_waitcnt lgkmcnt(4)
v_cmp_u_f32 vcc, v16, v16
v_smfmac_f32_16x16x64_bf16 v[32:35], v[12:15], v[152:159], v1
global_load_dwordx4 v[72:75], v0, s[40:41] offset:-1024
s_waitcnt lgkmcnt(2)
v_smfmac_f32_16x16x64_bf16 v[36:39], v[12:15], v[44:51], v1
ds_read_b128 v[20:23], v4 offset:14336
s_cbranch_vccnz C\sfx\()3_0_retry1b
C\sfx\()3_0_back1b:
s_waitcnt lgkmcnt(1)
v_smfmac_f32_16x16x64_bf16 v[40:43], v[12:15], v[52:59], v1
ds_read_b128 v[24:27], v4 offset:15360
v_smfmac_f32_16x16x64_bf16 v[28:31], v[16:19], v[160:167], v1
ds_read_b128 v[44:47], v0 offset:61440
s_sub_u32 s66, s36, 6144
s_subb_u32 s67, s37, 0
v_lshlrev_b32 v6, 3, v0
global_load_dword v7, v6, s[66:67] sc1
v_smfmac_f32_16x16x64_bf16 v[32:35], v[16:19], v[168:175], v1
ds_read_b128 v[48:51], v0 offset:62464
s_waitcnt lgkmcnt(2)
v_cmp_u_f32 vcc, v20, v24
v_smfmac_f32_16x16x64_bf16 v[36:39], v[16:19], a[0:7], v1
ds_read_b128 v[52:55], v0 offset:63488
s_cmp_eq_u32 s42, s27
s_cbranch_scc1 C\sfx\()3_0_fetch
global_load_dword v7, v11, s[40:41]
C\sfx\()3_0_fetch_back:
v_smfmac_f32_16x16x64_bf16 v[40:43], v[16:19], a[8:15], v1
ds_read_b128 v[56:59], v0 offset:64512
s_cbranch_vccnz C\sfx\()3_0_retry2
C\sfx\()3_0_back2:
v_smfmac_f32_16x16x64_bf16 v[28:31], v[20:23], v[176:183], v1
ds_read_b128 v[12:15], v4 offset:30720
s_waitcnt vmcnt(13)
s_waitcnt lgkmcnt(3)
v_smfmac_f32_16x16x64_bf16 v[36:39], v[20:23], v[44:51], v1
ds_read_b128 v[44:47], v9 offset:12288
v_add_u32 v10, s97, v0
v_cmp_gt_u32 vcc, 8192, v10
v_add_u32 v76, 139264, v10
v_add_u32 v10, 153600, v10
v_cndmask_b32 v10, v10, v76, vcc
v_min_u32 v10, 163824, v10
ds_read_b128 v[76:79], v10
v_smfmac_f32_16x16x64_bf16 v[32:35], v[20:23], v[184:191], v1
ds_read_b128 v[48:51], v9 offset:13312
s_waitcnt lgkmcnt(4)
v_smfmac_f32_16x16x64_bf16 v[40:43], v[20:23], v[52:59], v1
ds_read_b128 v[52:55], v9 offset:14336
s_waitcnt lgkmcnt(4)
v_cmp_u_f32 vcc, v12, v12
v_smfmac_f32_16x16x64_bf16 v[28:31], v[24:27], v[192:199], v1
ds_read_b128 v[56:59], v9 offset:15360
v_smfmac_f32_16x16x64_bf16 v[36:39], v[24:27], a[16:23], v1
s_cbranch_vccnz C\sfx\()3_0_retry2b
C\sfx\()3_0_back2b:
v_smfmac_f32_16x16x64_bf16 v[28:31], v[12:15], v[208:215], v1
s_add_u32 s52, s36, 0x2000
s_addc_u32 s53, s37, 0
s_waitcnt lgkmcnt(3)
s_mov_b64 exec, 0x3ffff
global_store_dwordx4 v0, v[76:79], s[38:39] sc1
s_mov_b64 exec, -1
s_add_u32 s38, s38, 0x2400
s_addc_u32 s39, s39, 0
s_waitcnt lgkmcnt(2)
v_smfmac_f32_16x16x64_bf16 v[36:39], v[12:15], v[44:51], v1
v_smfmac_f32_16x16x64_bf16 v[32:35], v[24:27], v[200:207], v1
v_mov_b32 v76, s26
v_mov_b32 v77, s42
s_mov_b64 exec, 1
global_store_dword v76, v77, s[14:15] sc1
s_mov_b64 exec, -1
v_mov_b64 v[44:45], 0
v_smfmac_f32_16x16x64_bf16 v[40:43], v[24:27], a[24:31], v1
v_mov_b64 v[48:49], 0
v_add_f32 v28, v28, v30
v_smfmac_f32_16x16x64_bf16 v[32:35], v[12:15], v[216:223], v1
v_add_f32 v29, v29, v31
v_cvt_pk_bf16_f32 v77, v28, v29
v_add_f32 v36, v36, v38
s_waitcnt lgkmcnt(0)
v_smfmac_f32_16x16x64_bf16 v[40:43], v[12:15], v[52:59], v1
v_add_f32 v37, v37, v39
v_cvt_pk_bf16_f32 v76, v36, v37
ds_write_b64 v2, v[76:77]
v_mov_b64 v[46:47], 0
v_mov_b64 v[50:51], 0
C\sfx\()3_0_postqk:
s_waitcnt vmcnt(4)
v_smfmac_f32_16x16x64_bf16 v[44:47], v[20:23], v[60:67], v1
v_add_f32 v32, v32, v34
v_add_f32 v33, v33, v35
v_cvt_pk_bf16_f32 v79, v32, v33
v_add_f32 v40, v40, v42
v_add_f32 v41, v41, v43
v_cvt_pk_bf16_f32 v78, v40, v41
ds_write_b64 v2, v[78:79] offset:512
v_cmp_u_f32 vcc, v40, v41
v_smfmac_f32_16x16x64_bf16 v[48:51], v[20:23], v[68:75], v1
ds_read_b128 v[28:31], v4
v_smfmac_f32_16x16x64_bf16 v[44:47], v[12:15], a[144:151], v1
ds_read_b128 v[32:35], v4 offset:1024
v_smfmac_f32_16x16x64_bf16 v[48:51], v[12:15], a[152:159], v1
ds_read_b128 v[36:39], v4 offset:2048
s_cbranch_vccnz C\sfx\()3_0_retry_ag
s_add_u32 s66, s66, 0x2000
s_addc_u32 s67, s67, 0
v_lshlrev_b32 v6, 3, v0
global_load_dword v7, v6, s[66:67] sc1
v_smfmac_f32_16x16x64_bf16 v[44:47], v[24:27], a[128:135], v1
ds_read_b128 v[40:43], v4 offset:3072
s_waitcnt lgkmcnt(4)
s_barrier
ds_read_b64_tr_b16 v[60:61], v3
ds_read_b64_tr_b16 v[62:63], v3 offset:512
ds_read_b64_tr_b16 v[64:65], v3 offset:1024
ds_read_b64_tr_b16 v[66:67], v3 offset:1536
v_smfmac_f32_16x16x64_bf16 v[48:51], v[24:27], a[136:143], v1
ds_read_b64_tr_b16 v[68:69], v3 offset:2048
ds_read_b64_tr_b16 v[70:71], v3 offset:2560
ds_read_b64_tr_b16 v[72:73], v3 offset:3072
ds_read_b64_tr_b16 v[74:75], v3 offset:3584
v_smfmac_f32_16x16x64_bf16 v[44:47], v[16:19], a[112:119], v1
ds_read_b128 v[52:55], v4 offset:4096
v_smfmac_f32_16x16x64_bf16 v[48:51], v[16:19], a[120:127], v1
ds_read_b128 v[56:59], v4 offset:5120
s_waitcnt lgkmcnt(8)
v_mfma_f32_16x16x32_bf16 v[76:79], v[28:31], v[60:63], 0
ds_read_b128 v[12:15], v4 offset:6144
s_waitcnt lgkmcnt(7)
v_mfma_f32_16x16x32_bf16 v[76:79], v[32:35], v[64:67], v[76:79]
ds_read_b128 v[24:27], v4 offset:7168
s_waitcnt lgkmcnt(6)
v_mfma_f32_16x16x32_bf16 v[76:79], v[36:39], v[68:71], v[76:79]
ds_read_b128 v[20:23], v4 offset:8192
s_waitcnt lgkmcnt(5)
v_mfma_f32_16x16x32_bf16 v[76:79], v[40:43], v[72:75], v[76:79]
ds_read_b128 v[16:19], v4 offset:9216
s_waitcnt lgkmcnt(5)
v_mfma_f32_16x16x32_bf16 v[28:31], v[52:55], v[60:63], 0
v_mov_b32 v36, s57
v_mov_b32 v37, s57
s_waitcnt lgkmcnt(4)
v_mfma_f32_16x16x32_bf16 v[28:31], v[56:59], v[64:67], v[28:31]
ds_read_b128 v[52:55], v4 offset:22528
v_mov_b32 v38, s57
v_mov_b32 v39, s57
s_waitcnt lgkmcnt(4)
v_mfma_f32_16x16x32_bf16 v[28:31], v[12:15], v[68:71], v[28:31]
ds_read_b128 v[56:59], v4 offset:23552
v_exp_f32 v76, v76
s_waitcnt lgkmcnt(4)
v_mfma_f32_16x16x32_bf16 v[28:31], v[24:27], v[72:75], v[28:31]
ds_read_b128 v[12:15], v4 offset:10240
v_exp_f32 v77, v77
v_mfma_f32_16x16x32_bf16 v[32:35], v[60:63], v[60:63], 0
ds_read_b128 v[24:27], v4 offset:11264
v_exp_f32 v78, v78
v_mfma_f32_16x16x32_bf16 v[32:35], v[64:67], v[64:67], v[32:35]
v_exp_f32 v79, v79
v_mfma_f32_16x16x32_bf16 v[32:35], v[68:71], v[68:71], v[32:35]
v_cvt_pk_bf16_f32 v76, v76, v77
v_cvt_pk_bf16_f32 v77, v78, v79
v_mfma_f32_16x16x32_bf16 v[32:35], v[72:75], v[72:75], v[32:35]
v_exp_f32 v28, v28
s_waitcnt lgkmcnt(5)
v_smfmac_f32_16x16x64_bf16 v[44:47], v[20:23], a[32:39], v1
v_exp_f32 v29, v29
v_smfmac_f32_16x16x64_bf16 v[48:51], v[20:23], a[40:47], v1
v_exp_f32 v30, v30
s_waitcnt lgkmcnt(4)
v_smfmac_f32_16x16x64_bf16 v[44:47], v[16:19], a[48:55], v1
ds_read_b128 v[20:23], v4 offset:12288
v_exp_f32 v31, v31
v_smfmac_f32_16x16x64_bf16 v[48:51], v[16:19], a[56:63], v1
v_mul_f32 v32, s44, v32
s_waitcnt lgkmcnt(2)
v_smfmac_f32_16x16x64_bf16 v[44:47], v[12:15], a[64:71], v1
v_cvt_pk_bf16_f32 v78, v28, v29
v_smfmac_f32_16x16x64_bf16 v[48:51], v[12:15], a[72:79], v1
v_cvt_pk_bf16_f32 v79, v30, v31
s_waitcnt lgkmcnt(1)
v_smfmac_f32_16x16x64_bf16 v[44:47], v[24:27], a[80:87], v1
v_mul_f32 v33, s44, v33
s_waitcnt lgkmcnt(0)
v_smfmac_f32_16x16x64_bf16 v[44:47], v[20:23], a[96:103], v1
v_exp_f32 v32, v32
v_mfma_f32_16x16x32_bf16 v[40:43], v[76:79], v[36:39], 0
v_exp_f32 v33, v33
v_smfmac_f32_16x16x64_bf16 v[48:51], v[24:27], a[88:95], v1
v_cvt_pk_bf16_f32 v10, v32, v33
v_mfma_f32_16x16x32_bf16 v[60:63], v[76:79], v[52:55], 0
v_smfmac_f32_16x16x64_bf16 v[48:51], v[20:23], a[104:111], v1
s_nop 0
v_add_f32 v44, v44, v46
v_mfma_f32_16x16x32_bf16 v[64:67], v[76:79], v[56:59], 0
v_add_f32 v45, v45, v47
v_cvt_pk_bf16_f32 v52, v44, v45
v_mfma_f32_16x16x16_bf16 v[40:43], v[10:11], v[36:37], v[40:43]
s_nop 0
v_mfma_f32_16x16x16_bf16 v[60:63], v[10:11], v[52:53], v[60:63]
v_add_f32 v48, v48, v50
v_add_f32 v49, v49, v51
v_cvt_pk_bf16_f32 v56, v48, v49
s_nop 1
v_mfma_f32_16x16x16_bf16 v[64:67], v[10:11], v[56:57], v[64:67]
v_rcp_f32 v70, v42
v_rcp_f32 v71, v43
v_subrev_u32 v40, s45, v42
v_subrev_u32 v41, s45, v43
v_mul_f32 v62, v62, v70
v_mul_f32 v63, v63, v71
v_cvt_pk_bf16_f32 v68, v62, v63
ds_write_b32 v2, v68 offset:2052
v_mul_f32 v66, v66, v70
v_mul_f32 v67, v67, v71
v_cvt_pk_bf16_f32 v69, v66, v67
ds_write_b32 v2, v69 offset:2564
v_max_u32 v40, v40, v41
v_cmp_le_u32 vcc, s46, v40
v_mov_b64 v[12:13], 0
v_mov_b64 v[14:15], 0
v_mov_b64 v[16:17], 0
v_mov_b64 v[18:19], 0
v_mov_b64 v[20:21], 0
v_mov_b64 v[22:23], 0
s_cbranch_vccnz C\sfx\()3_0_slow
C\sfx\()3_0_oskip:
s_mov_b32 m0, 0x25800
v_mov_b64 v[24:25], 0
v_mov_b64 v[26:27], 0
global_load_lds_dwordx4 v0, s[52:53] sc1
global_load_lds_dwordx4 v0, s[52:53] offset:1024 sc1
s_waitcnt lgkmcnt(0)
s_barrier
ds_read_b64_tr_b16 v[44:45], v3 offset:4096
ds_read_b64_tr_b16 v[46:47], v3 offset:4608
ds_read_b64_tr_b16 v[48:49], v3 offset:5120
ds_read_b64_tr_b16 v[50:51], v3 offset:5632
v_mov_b64 v[28:29], 0
v_mov_b64 v[30:31], 0
v_mov_b64 v[32:33], 0
v_mov_b64 v[34:35], 0
s_waitcnt lgkmcnt(2)
v_smfmac_f32_16x16x64_bf16 v[12:15], v[44:47], a[240:247], v1
ds_read_b128 v[52:55], v9 offset:28672
s_waitcnt lgkmcnt(1)
v_smfmac_f32_16x16x64_bf16 v[12:15], v[48:51], a[248:255], v1
ds_read_b128 v[56:59], v9 offset:29696
s_cmp_eq_u32 s42, 63
v_smfmac_f32_16x16x64_bf16 v[16:19], v[44:47], a[160:167], v1
ds_read_b128 v[60:63], v9 offset:30720
s_cbranch_scc1 DONE
v_smfmac_f32_16x16x64_bf16 v[16:19], v[48:51], a[176:183], v1
ds_read_b128 v[64:67], v9 offset:31744
s_add_u32 s42, s42, 1
v_smfmac_f32_16x16x64_bf16 v[20:23], v[44:47], a[168:175], v1
ds_read_b128 v[68:71], v9 offset:45056
s_add_u32 s36, s36, 0x4000
s_addc_u32 s37, s37, 0
v_add_f32 v12, v12, v14
v_smfmac_f32_16x16x64_bf16 v[20:23], v[48:51], a[184:191], v1
ds_read_b128 v[72:75], v9 offset:46080
v_add_f32 v13, v13, v15
v_cvt_pk_bf16_f32 v12, v12, v13
v_smfmac_f32_16x16x64_bf16 v[24:27], v[44:47], a[192:199], v1
v_add_f32 v14, v16, v18
v_add_f32 v15, v17, v19
v_mov_b32_dpp v13, v12 quad_perm:[1,0,3,2] row_mask:0xf bank_mask:0xf
s_waitcnt lgkmcnt(4)
v_smfmac_f32_16x16x64_bf16 v[24:27], v[48:51], v[52:59], v1
ds_read_b128 v[52:55], v9 offset:47104
v_mov_b32 v19, s75
v_perm_b32 v16, v13, v12, v8
v_add_f32 v20, v20, v22
v_add_f32 v21, v21, v23
v_cvt_pk_bf16_f32 v17, v14, v20
v_cvt_pk_bf16_f32 v18, v15, v21
global_store_dwordx4 v5, v[16:19], s[28:29] \md
v_smfmac_f32_16x16x64_bf16 v[28:31], v[44:47], a[200:207], v1
ds_read_b128 v[56:59], v9 offset:48128
s_add_u32 s64, s28, 0x1000
s_addc_u32 s65, s29, 0
v_mov_b64 v[36:37], 0
s_waitcnt lgkmcnt(4)
v_smfmac_f32_16x16x64_bf16 v[28:31], v[48:51], v[60:67], v1
ds_read_b128 v[60:63], v9 offset:61440
v_mov_b64 v[38:39], 0
v_smfmac_f32_16x16x64_bf16 v[32:35], v[44:47], a[208:215], v1
ds_read_b128 v[64:67], v9 offset:62464
v_add_f32 v24, v24, v26
v_mov_b64 v[40:41], 0
s_waitcnt lgkmcnt(4)
v_smfmac_f32_16x16x64_bf16 v[32:35], v[48:51], v[68:75], v1
ds_read_b128 v[68:71], v9 offset:63488
v_add_f32 v25, v25, v27
v_cvt_pk_bf16_f32 v24, v24, v25
v_mov_b64 v[42:43], 0
v_smfmac_f32_16x16x64_bf16 v[36:39], v[44:47], a[216:223], v1
ds_read_b128 v[72:75], v9 offset:64512
v_add_f32 v26, v28, v30
v_add_f32 v27, v29, v31
v_mov_b32_dpp v25, v24 quad_perm:[1,0,3,2] row_mask:0xf bank_mask:0xf
v_mov_b64 v[76:77], 0
s_waitcnt lgkmcnt(4)
v_smfmac_f32_16x16x64_bf16 v[36:39], v[48:51], v[52:59], v1
v_mov_b64 v[78:79], 0
v_mov_b32 v31, s75
v_perm_b32 v28, v25, v24, v8
v_add_f32 v32, v32, v34
v_add_f32 v33, v33, v35
v_cvt_pk_bf16_f32 v29, v26, v32
v_cvt_pk_bf16_f32 v30, v27, v33
global_store_dwordx4 v5, v[28:31], s[64:65] \md
v_smfmac_f32_16x16x64_bf16 v[40:43], v[44:47], a[224:231], v1
s_add_u32 s64, s28, 0x2000
s_addc_u32 s65, s29, 0
s_waitcnt lgkmcnt(2)
v_smfmac_f32_16x16x64_bf16 v[40:43], v[48:51], v[60:67], v1
v_smfmac_f32_16x16x64_bf16 v[76:79], v[44:47], a[232:239], v1
v_add_f32 v36, v36, v38
s_waitcnt lgkmcnt(0)
v_smfmac_f32_16x16x64_bf16 v[76:79], v[48:51], v[68:75], v1
v_add_f32 v37, v37, v39
v_cvt_pk_bf16_f32 v36, v36, v37
s_nop 1
v_add_f32 v38, v40, v42
v_add_f32 v39, v41, v43
v_mov_b32_dpp v37, v36 quad_perm:[1,0,3,2] row_mask:0xf bank_mask:0xf
v_mov_b32 v43, s75
v_perm_b32 v40, v37, v36, v8
v_add_f32 v76, v76, v78
v_add_f32 v77, v77, v79
v_cvt_pk_bf16_f32 v41, v38, v76
v_cvt_pk_bf16_f32 v42, v39, v77
global_store_dwordx4 v5, v[40:43], s[64:65] \md
s_add_u32 s51, s56, 0x18c00
s_and_b32 s51, s51, 0x1ffff
s_add_u32 s72, s14, s51
s_addc_u32 s73, s15, 0
s_add_u32 s56, s56, 0x8000
s_and_b32 s56, s56, 0x1ffff
s_add_u32 s51, s56, 3072
s_add_u32 s70, s14, s51
s_addc_u32 s71, s15, 0
s_add_u32 s51, s56, s96
s_add_u32 s68, s14, s51
s_addc_u32 s69, s15, 0
s_cmp_eq_u32 s42, s47
s_cbranch_scc1 C\sfx\()3_0_late
C\sfx\()3_0_late_back:
ds_read_b128 v[44:47], v0 offset:12288
ds_read_b128 v[48:51], v0 offset:13312
ds_read_b128 v[52:55], v0 offset:14336
ds_read_b128 v[56:59], v0 offset:15360
v_mov_b64 v[28:29], 0
v_mov_b64 v[30:31], 0
v_mov_b64 v[32:33], 0
v_mov_b64 v[34:35], 0
v_mov_b64 v[36:37], 0
v_mov_b64 v[38:39], 0
v_mov_b64 v[40:41], 0
v_mov_b64 v[42:43], 0
s_add_u32 s75, s75, 1
s_barrier
C\sfx\()3_1_qk:
ds_read_b128 v[12:15], v4
ds_read_b128 v[16:19], v4 offset:1024
ds_read_b128 v[20:23], v4 offset:2048
C\sfx\()3_1_back0:
s_waitcnt lgkmcnt(2)
v_smfmac_f32_16x16x64_bf16 v[28:31], v[12:15], v[80:87], v1
s_waitcnt lgkmcnt(0)
v_add_f32 v10, v12, v16
v_cmp_u_f32 vcc, v10, v20
v_smfmac_f32_16x16x64_bf16 v[32:35], v[12:15], v[88:95], v1
s_cbranch_vccnz C\sfx\()3_1_retry0
v_smfmac_f32_16x16x64_bf16 v[36:39], v[12:15], v[44:51], v1
ds_read_b128 v[44:47], v0 offset:28672
v_smfmac_f32_16x16x64_bf16 v[40:43], v[12:15], v[52:59], v1
ds_read_b128 v[48:51], v0 offset:29696
v_smfmac_f32_16x16x64_bf16 v[28:31], v[16:19], v[96:103], v1
ds_read_b128 v[52:55], v0 offset:30720
v_smfmac_f32_16x16x64_bf16 v[32:35], v[16:19], v[104:111], v1
ds_read_b128 v[56:59], v0 offset:31744
global_load_dwordx4 v[60:63], v0, s[40:41] offset:-4096
v_smfmac_f32_16x16x64_bf16 v[36:39], v[16:19], v[224:231], v1
v_smfmac_f32_16x16x64_bf16 v[40:43], v[16:19], v[232:239], v1
v_smfmac_f32_16x16x64_bf16 v[28:31], v[20:23], v[112:119], v1
ds_read_b128 v[24:27], v4 offset:3072
v_smfmac_f32_16x16x64_bf16 v[32:35], v[20:23], v[120:127], v1
ds_read_b128 v[12:15], v4 offset:4096
global_load_dwordx4 v[64:67], v0, s[40:41] offset:-3072
s_waitcnt lgkmcnt(4)
v_smfmac_f32_16x16x64_bf16 v[36:39], v[20:23], v[44:51], v1
ds_read_b128 v[16:19], v4 offset:5120
s_waitcnt lgkmcnt(1)
v_cmp_u_f32 vcc, v24, v12
v_smfmac_f32_16x16x64_bf16 v[40:43], v[20:23], v[52:59], v1
ds_read_b128 v[44:47], v0 offset:45056
s_cbranch_vccnz C\sfx\()3_1_retry1
C\sfx\()3_1_back1:
v_smfmac_f32_16x16x64_bf16 v[28:31], v[24:27], v[128:135], v1
ds_read_b128 v[48:51], v0 offset:46080
v_smfmac_f32_16x16x64_bf16 v[32:35], v[24:27], v[136:143], v1
ds_read_b128 v[52:55], v0 offset:47104
global_load_dwordx4 v[68:71], v0, s[40:41] offset:-2048
v_smfmac_f32_16x16x64_bf16 v[36:39], v[24:27], v[240:247], v1
ds_read_b128 v[56:59], v0 offset:48128
v_smfmac_f32_16x16x64_bf16 v[40:43], v[24:27], v[248:255], v1
v_smfmac_f32_16x16x64_bf16 v[28:31], v[12:15], v[144:151], v1
s_waitcnt lgkmcnt(4)
v_cmp_u_f32 vcc, v16, v16
v_smfmac_f32_16x16x64_bf16 v[32:35], v[12:15], v[152:159], v1
global_load_dwordx4 v[72:75], v0, s[40:41] offset:-1024
s_waitcnt lgkmcnt(2)
v_smfmac_f32_16x16x64_bf16 v[36:39], v[12:15], v[44:51], v1
ds_read_b128 v[20:23], v4 offset:6144
s_cbranch_vccnz C\sfx\()3_1_retry1b
C\sfx\()3_1_back1b:
s_waitcnt lgkmcnt(1)
v_smfmac_f32_16x16x64_bf16 v[40:43], v[12:15], v[52:59], v1
ds_read_b128 v[24:27], v4 offset:7168
v_smfmac_f32_16x16x64_bf16 v[28:31], v[16:19], v[160:167], v1
ds_read_b128 v[44:47], v0 offset:61440
s_sub_u32 s66, s36, 6144
s_subb_u32 s67, s37, 0
v_lshlrev_b32 v6, 3, v0
global_load_dword v7, v6, s[66:67] sc1
v_smfmac_f32_16x16x64_bf16 v[32:35], v[16:19], v[168:175], v1
ds_read_b128 v[48:51], v0 offset:62464
s_waitcnt lgkmcnt(2)
v_cmp_u_f32 vcc, v20, v24
v_smfmac_f32_16x16x64_bf16 v[36:39], v[16:19], a[0:7], v1
ds_read_b128 v[52:55], v0 offset:63488
v_smfmac_f32_16x16x64_bf16 v[40:43], v[16:19], a[8:15], v1
ds_read_b128 v[56:59], v0 offset:64512
s_cbranch_vccnz C\sfx\()3_1_retry2
C\sfx\()3_1_back2:
v_smfmac_f32_16x16x64_bf16 v[28:31], v[20:23], v[176:183], v1
ds_read_b128 v[12:15], v4 offset:30720
s_waitcnt vmcnt(12)
s_waitcnt lgkmcnt(3)
v_smfmac_f32_16x16x64_bf16 v[36:39], v[20:23], v[44:51], v1
ds_read_b128 v[44:47], v9 offset:12288
v_add_u32 v10, s97, v0
v_cmp_gt_u32 vcc, 8192, v10
v_add_u32 v76, 131072, v10
v_add_u32 v10, 153600, v10
v_cndmask_b32 v10, v10, v76, vcc
v_min_u32 v10, 163824, v10
ds_read_b128 v[76:79], v10
v_smfmac_f32_16x16x64_bf16 v[32:35], v[20:23], v[184:191], v1
ds_read_b128 v[48:51], v9 offset:13312
s_waitcnt lgkmcnt(4)
v_smfmac_f32_16x16x64_bf16 v[40:43], v[20:23], v[52:59], v1
ds_read_b128 v[52:55], v9 offset:14336
s_waitcnt lgkmcnt(4)
v_cmp_u_f32 vcc, v12, v12
v_smfmac_f32_16x16x64_bf16 v[28:31], v[24:27], v[192:199], v1
ds_read_b128 v[56:59], v9 offset:15360
v_smfmac_f32_16x16x64_bf16 v[36:39], v[24:27], a[16:23], v1
s_cbranch_vccnz C\sfx\()3_1_retry2b
C\sfx\()3_1_back2b:
v_smfmac_f32_16x16x64_bf16 v[28:31], v[12:15], v[208:215], v1
s_add_u32 s52, s36, 0x2000
s_addc_u32 s53, s37, 0
s_cmp_eq_u32 s42, 63
s_cbranch_scc1 C\sfx\()3_1_fin3
s_waitcnt lgkmcnt(3)
s_mov_b64 exec, 0x3ffff
global_store_dwordx4 v0, v[76:79], s[38:39] sc1
s_mov_b64 exec, -1
s_add_u32 s38, s38, 0x2400
s_addc_u32 s39, s39, 0
s_waitcnt lgkmcnt(2)
v_smfmac_f32_16x16x64_bf16 v[36:39], v[12:15], v[44:51], v1
v_smfmac_f32_16x16x64_bf16 v[32:35], v[24:27], v[200:207], v1
v_mov_b32 v76, s26
v_mov_b32 v77, s42
s_mov_b64 exec, 1
global_store_dword v76, v77, s[14:15] sc1
s_mov_b64 exec, -1
v_mov_b64 v[44:45], 0
v_smfmac_f32_16x16x64_bf16 v[40:43], v[24:27], a[24:31], v1
v_mov_b64 v[48:49], 0
v_add_f32 v28, v28, v30
v_smfmac_f32_16x16x64_bf16 v[32:35], v[12:15], v[216:223], v1
v_add_f32 v29, v29, v31
v_cvt_pk_bf16_f32 v77, v28, v29
v_add_f32 v36, v36, v38
s_waitcnt lgkmcnt(0)
v_smfmac_f32_16x16x64_bf16 v[40:43], v[12:15], v[52:59], v1
v_add_f32 v37, v37, v39
v_cvt_pk_bf16_f32 v76, v36, v37
ds_write_b64 v2, v[76:77]
v_mov_b64 v[46:47], 0
v_mov_b64 v[50:51], 0
C\sfx\()3_1_postqk:
s_waitcnt vmcnt(3)
v_smfmac_f32_16x16x64_bf16 v[44:47], v[20:23], v[60:67], v1
v_add_f32 v32, v32, v34
v_add_f32 v33, v33, v35
v_cvt_pk_bf16_f32 v79, v32, v33
v_add_f32 v40, v40, v42
v_add_f32 v41, v41, v43
v_cvt_pk_bf16_f32 v78, v40, v41
ds_write_b64 v2, v[78:79] offset:512
v_cmp_u_f32 vcc, v40, v41
v_smfmac_f32_16x16x64_bf16 v[48:51], v[20:23], v[68:75], v1
ds_read_b128 v[28:31], v4 offset:8192
v_smfmac_f32_16x16x64_bf16 v[44:47], v[12:15], a[144:151], v1
ds_read_b128 v[32:35], v4 offset:9216
v_smfmac_f32_16x16x64_bf16 v[48:51], v[12:15], a[152:159], v1
ds_read_b128 v[36:39], v4 offset:10240
s_cbranch_vccnz C\sfx\()3_1_retry_ag
s_add_u32 s66, s66, 0x2000
s_addc_u32 s67, s67, 0
v_lshlrev_b32 v6, 3, v0
global_load_dword v7, v6, s[66:67] sc1
v_smfmac_f32_16x16x64_bf16 v[44:47], v[24:27], a[128:135], v1
ds_read_b128 v[40:43], v4 offset:11264
s_waitcnt lgkmcnt(4)
s_barrier
ds_read_b64_tr_b16 v[60:61], v3
ds_read_b64_tr_b16 v[62:63], v3 offset:512
ds_read_b64_tr_b16 v[64:65], v3 offset:1024
ds_read_b64_tr_b16 v[66:67], v3 offset:1536
v_smfmac_f32_16x16x64_bf16 v[48:51], v[24:27], a[136:143], v1
ds_read_b64_tr_b16 v[68:69], v3 offset:2048
ds_read_b64_tr_b16 v[70:71], v3 offset:2560
ds_read_b64_tr_b16 v[72:73], v3 offset:3072
ds_read_b64_tr_b16 v[74:75], v3 offset:3584
v_smfmac_f32_16x16x64_bf16 v[44:47], v[16:19], a[112:119], v1
ds_read_b128 v[52:55], v4 offset:12288
v_smfmac_f32_16x16x64_bf16 v[48:51], v[16:19], a[120:127], v1
ds_read_b128 v[56:59], v4 offset:13312
s_waitcnt lgkmcnt(8)
v_mfma_f32_16x16x32_bf16 v[76:79], v[28:31], v[60:63], 0
ds_read_b128 v[12:15], v4 offset:14336
s_waitcnt lgkmcnt(7)
v_mfma_f32_16x16x32_bf16 v[76:79], v[32:35], v[64:67], v[76:79]
ds_read_b128 v[24:27], v4 offset:15360
s_waitcnt lgkmcnt(6)
v_mfma_f32_16x16x32_bf16 v[76:79], v[36:39], v[68:71], v[76:79]
ds_read_b128 v[20:23], v4
s_waitcnt lgkmcnt(5)
v_mfma_f32_16x16x32_bf16 v[76:79], v[40:43], v[72:75], v[76:79]
ds_read_b128 v[16:19], v4 offset:1024
s_waitcnt lgkmcnt(5)
v_mfma_f32_16x16x32_bf16 v[28:31], v[52:55], v[60:63], 0
v_mov_b32 v36, s57
v_mov_b32 v37, s57
s_waitcnt lgkmcnt(4)
v_mfma_f32_16x16x32_bf16 v[28:31], v[56:59], v[64:67], v[28:31]
ds_read_b128 v[52:55], v4 offset:22528
v_mov_b32 v38, s57
v_mov_b32 v39, s57
s_waitcnt lgkmcnt(4)
v_mfma_f32_16x16x32_bf16 v[28:31], v[12:15], v[68:71], v[28:31]
ds_read_b128 v[56:59], v4 offset:23552
v_exp_f32 v76, v76
s_waitcnt lgkmcnt(4)
v_mfma_f32_16x16x32_bf16 v[28:31], v[24:27], v[72:75], v[28:31]
ds_read_b128 v[12:15], v4 offset:2048
v_exp_f32 v77, v77
v_mfma_f32_16x16x32_bf16 v[32:35], v[60:63], v[60:63], 0
ds_read_b128 v[24:27], v4 offset:3072
v_exp_f32 v78, v78
v_mfma_f32_16x16x32_bf16 v[32:35], v[64:67], v[64:67], v[32:35]
v_exp_f32 v79, v79
v_mfma_f32_16x16x32_bf16 v[32:35], v[68:71], v[68:71], v[32:35]
v_cvt_pk_bf16_f32 v76, v76, v77
v_cvt_pk_bf16_f32 v77, v78, v79
v_mfma_f32_16x16x32_bf16 v[32:35], v[72:75], v[72:75], v[32:35]
v_exp_f32 v28, v28
s_waitcnt lgkmcnt(5)
v_smfmac_f32_16x16x64_bf16 v[44:47], v[20:23], a[32:39], v1
v_exp_f32 v29, v29
v_smfmac_f32_16x16x64_bf16 v[48:51], v[20:23], a[40:47], v1
v_exp_f32 v30, v30
s_waitcnt lgkmcnt(4)
v_smfmac_f32_16x16x64_bf16 v[44:47], v[16:19], a[48:55], v1
ds_read_b128 v[20:23], v4 offset:4096
v_exp_f32 v31, v31
v_smfmac_f32_16x16x64_bf16 v[48:51], v[16:19], a[56:63], v1
v_mul_f32 v32, s44, v32
s_waitcnt lgkmcnt(2)
v_smfmac_f32_16x16x64_bf16 v[44:47], v[12:15], a[64:71], v1
v_cvt_pk_bf16_f32 v78, v28, v29
v_smfmac_f32_16x16x64_bf16 v[48:51], v[12:15], a[72:79], v1
v_cvt_pk_bf16_f32 v79, v30, v31
s_waitcnt lgkmcnt(1)
v_smfmac_f32_16x16x64_bf16 v[44:47], v[24:27], a[80:87], v1
v_mul_f32 v33, s44, v33
s_waitcnt lgkmcnt(0)
v_smfmac_f32_16x16x64_bf16 v[44:47], v[20:23], a[96:103], v1
v_exp_f32 v32, v32
v_mfma_f32_16x16x32_bf16 v[40:43], v[76:79], v[36:39], 0
v_exp_f32 v33, v33
v_smfmac_f32_16x16x64_bf16 v[48:51], v[24:27], a[88:95], v1
v_cvt_pk_bf16_f32 v10, v32, v33
v_mfma_f32_16x16x32_bf16 v[60:63], v[76:79], v[52:55], 0
v_smfmac_f32_16x16x64_bf16 v[48:51], v[20:23], a[104:111], v1
s_nop 0
v_add_f32 v44, v44, v46
v_mfma_f32_16x16x32_bf16 v[64:67], v[76:79], v[56:59], 0
v_add_f32 v45, v45, v47
v_cvt_pk_bf16_f32 v52, v44, v45
v_mfma_f32_16x16x16_bf16 v[40:43], v[10:11], v[36:37], v[40:43]
s_nop 0
v_mfma_f32_16x16x16_bf16 v[60:63], v[10:11], v[52:53], v[60:63]
v_add_f32 v48, v48, v50
v_add_f32 v49, v49, v51
v_cvt_pk_bf16_f32 v56, v48, v49
s_nop 1
v_mfma_f32_16x16x16_bf16 v[64:67], v[10:11], v[56:57], v[64:67]
v_rcp_f32 v70, v42
v_rcp_f32 v71, v43
v_subrev_u32 v40, s45, v42
v_subrev_u32 v41, s45, v43
v_mul_f32 v62, v62, v70
v_mul_f32 v63, v63, v71
v_cvt_pk_bf16_f32 v68, v62, v63
ds_write_b32 v2, v68 offset:2052
v_mul_f32 v66, v66, v70
v_mul_f32 v67, v67, v71
v_cvt_pk_bf16_f32 v69, v66, v67
ds_write_b32 v2, v69 offset:2564
v_max_u32 v40, v40, v41
v_cmp_le_u32 vcc, s46, v40
v_mov_b64 v[12:13], 0
v_mov_b64 v[14:15], 0
v_mov_b64 v[16:17], 0
v_mov_b64 v[18:19], 0
v_mov_b64 v[20:21], 0
v_mov_b64 v[22:23], 0
s_cbranch_vccnz C\sfx\()3_1_slow
C\sfx\()3_1_oskip:
s_mov_b32 m0, 0x25800
v_mov_b64 v[24:25], 0
v_mov_b64 v[26:27], 0
global_load_lds_dwordx4 v0, s[52:53] sc1
global_load_lds_dwordx4 v0, s[52:53] offset:1024 sc1
s_waitcnt lgkmcnt(0)
s_barrier
ds_read_b64_tr_b16 v[44:45], v3 offset:4096
ds_read_b64_tr_b16 v[46:47], v3 offset:4608
ds_read_b64_tr_b16 v[48:49], v3 offset:5120
ds_read_b64_tr_b16 v[50:51], v3 offset:5632
v_mov_b64 v[28:29], 0
v_mov_b64 v[30:31], 0
v_mov_b64 v[32:33], 0
v_mov_b64 v[34:35], 0
s_waitcnt lgkmcnt(2)
v_smfmac_f32_16x16x64_bf16 v[12:15], v[44:47], a[240:247], v1
ds_read_b128 v[52:55], v9 offset:28672
s_waitcnt lgkmcnt(1)
v_smfmac_f32_16x16x64_bf16 v[12:15], v[48:51], a[248:255], v1
ds_read_b128 v[56:59], v9 offset:29696
s_cmp_eq_u32 s42, 63
v_smfmac_f32_16x16x64_bf16 v[16:19], v[44:47], a[160:167], v1
ds_read_b128 v[60:63], v9 offset:30720
s_cbranch_scc1 DONE
v_smfmac_f32_16x16x64_bf16 v[16:19], v[48:51], a[176:183], v1
ds_read_b128 v[64:67], v9 offset:31744
s_add_u32 s42, s42, 1
v_smfmac_f32_16x16x64_bf16 v[20:23], v[44:47], a[168:175], v1
ds_read_b128 v[68:71], v9 offset:45056
s_add_u32 s36, s36, 0x4000
s_addc_u32 s37, s37, 0
v_add_f32 v12, v12, v14
v_smfmac_f32_16x16x64_bf16 v[20:23], v[48:51], a[184:191], v1
ds_read_b128 v[72:75], v9 offset:46080
v_add_f32 v13, v13, v15
v_cvt_pk_bf16_f32 v12, v12, v13
v_smfmac_f32_16x16x64_bf16 v[24:27], v[44:47], a[192:199], v1
v_add_f32 v14, v16, v18
v_add_f32 v15, v17, v19
v_mov_b32_dpp v13, v12 quad_perm:[1,0,3,2] row_mask:0xf bank_mask:0xf
s_waitcnt lgkmcnt(4)
v_smfmac_f32_16x16x64_bf16 v[24:27], v[48:51], v[52:59], v1
ds_read_b128 v[52:55], v9 offset:47104
v_mov_b32 v19, s75
v_perm_b32 v16, v13, v12, v8
v_add_f32 v20, v20, v22
v_add_f32 v21, v21, v23
v_cvt_pk_bf16_f32 v17, v14, v20
v_cvt_pk_bf16_f32 v18, v15, v21
global_store_dwordx4 v5, v[16:19], s[30:31] \md
v_smfmac_f32_16x16x64_bf16 v[28:31], v[44:47], a[200:207], v1
ds_read_b128 v[56:59], v9 offset:48128
s_add_u32 s64, s30, 0x1000
s_addc_u32 s65, s31, 0
v_mov_b64 v[36:37], 0
s_waitcnt lgkmcnt(4)
v_smfmac_f32_16x16x64_bf16 v[28:31], v[48:51], v[60:67], v1
ds_read_b128 v[60:63], v9 offset:61440
v_mov_b64 v[38:39], 0
v_smfmac_f32_16x16x64_bf16 v[32:35], v[44:47], a[208:215], v1
ds_read_b128 v[64:67], v9 offset:62464
v_add_f32 v24, v24, v26
v_mov_b64 v[40:41], 0
s_waitcnt lgkmcnt(4)
v_smfmac_f32_16x16x64_bf16 v[32:35], v[48:51], v[68:75], v1
ds_read_b128 v[68:71], v9 offset:63488
v_add_f32 v25, v25, v27
v_cvt_pk_bf16_f32 v24, v24, v25
v_mov_b64 v[42:43], 0
v_smfmac_f32_16x16x64_bf16 v[36:39], v[44:47], a[216:223], v1
ds_read_b128 v[72:75], v9 offset:64512
v_add_f32 v26, v28, v30
v_add_f32 v27, v29, v31
v_mov_b32_dpp v25, v24 quad_perm:[1,0,3,2] row_mask:0xf bank_mask:0xf
v_mov_b64 v[76:77], 0
s_waitcnt lgkmcnt(4)
v_smfmac_f32_16x16x64_bf16 v[36:39], v[48:51], v[52:59], v1
v_mov_b64 v[78:79], 0
v_mov_b32 v31, s75
v_perm_b32 v28, v25, v24, v8
v_add_f32 v32, v32, v34
v_add_f32 v33, v33, v35
v_cvt_pk_bf16_f32 v29, v26, v32
v_cvt_pk_bf16_f32 v30, v27, v33
global_store_dwordx4 v5, v[28:31], s[64:65] \md
v_smfmac_f32_16x16x64_bf16 v[40:43], v[44:47], a[224:231], v1
s_add_u32 s64, s30, 0x2000
s_addc_u32 s65, s31, 0
s_waitcnt lgkmcnt(2)
v_smfmac_f32_16x16x64_bf16 v[40:43], v[48:51], v[60:67], v1
v_smfmac_f32_16x16x64_bf16 v[76:79], v[44:47], a[232:239], v1
v_add_f32 v36, v36, v38
s_waitcnt lgkmcnt(0)
v_smfmac_f32_16x16x64_bf16 v[76:79], v[48:51], v[68:75], v1
v_add_f32 v37, v37, v39
v_cvt_pk_bf16_f32 v36, v36, v37
s_nop 1
v_add_f32 v38, v40, v42
v_add_f32 v39, v41, v43
v_mov_b32_dpp v37, v36 quad_perm:[1,0,3,2] row_mask:0xf bank_mask:0xf
v_mov_b32 v43, s75
v_perm_b32 v40, v37, v36, v8
v_add_f32 v76, v76, v78
v_add_f32 v77, v77, v79
v_cvt_pk_bf16_f32 v41, v38, v76
v_cvt_pk_bf16_f32 v42, v39, v77
global_store_dwordx4 v5, v[40:43], s[64:65] \md
s_add_u32 s51, s56, 0x18c00
s_and_b32 s51, s51, 0x1ffff
s_add_u32 s24, s14, s51
s_addc_u32 s25, s15, 0
s_add_u32 s56, s56, 0x8000
s_and_b32 s56, s56, 0x1ffff
s_add_u32 s51, s56, 3072
s_add_u32 s22, s14, s51
s_addc_u32 s23, s15, 0
s_add_u32 s51, s56, s96
s_add_u32 s20, s14, s51
s_addc_u32 s21, s15, 0
s_cmp_eq_u32 s42, s47
s_cbranch_scc1 C\sfx\()3_1_late
C\sfx\()3_1_late_back:
ds_read_b128 v[44:47], v0 offset:12288
ds_read_b128 v[48:51], v0 offset:13312
ds_read_b128 v[52:55], v0 offset:14336
ds_read_b128 v[56:59], v0 offset:15360
v_mov_b64 v[28:29], 0
v_mov_b64 v[30:31], 0
v_mov_b64 v[32:33], 0
v_mov_b64 v[34:35], 0
v_mov_b64 v[36:37], 0
v_mov_b64 v[38:39], 0
v_mov_b64 v[40:41], 0
v_mov_b64 v[42:43], 0
s_add_u32 s75, s75, 1
s_barrier
s_branch C\sfx\()3_0_qk
C\sfx\()3_0_retry_ag:
s_waitcnt vmcnt(0) lgkmcnt(0)
s_add_u32 s76, s76, 0x10000
s_sub_u32 s43, s43, 1
s_cbranch_scc1 EXIT2
s_add_u32 s52, s70, 0x0
s_addc_u32 s53, s71, 0
s_sub_u32 s52, s52, 3072
s_subb_u32 s53, s53, 0
s_mov_b32 m0, 0x22000
s_nop 0
global_load_lds_dwordx4 v0, s[52:53] sc1
s_add_u32 s52, s70, 0x400
s_addc_u32 s53, s71, 0
s_sub_u32 s52, s52, 3072
s_subb_u32 s53, s53, 0
s_mov_b32 m0, 0x22400
s_nop 0
global_load_lds_dwordx4 v0, s[52:53] sc1
s_add_u32 s52, s70, 0x800
s_addc_u32 s53, s71, 0
s_sub_u32 s52, s52, 3072
s_subb_u32 s53, s53, 0
s_mov_b32 m0, 0x22800
s_nop 0
global_load_lds_dwordx4 v0, s[52:53] sc1
s_add_u32 s52, s70, 0xc00
s_addc_u32 s53, s71, 0
s_sub_u32 s52, s52, 3072
s_subb_u32 s53, s53, 0
s_mov_b32 m0, 0x22c00
s_nop 0
global_load_lds_dwordx4 v0, s[52:53] sc1
s_add_u32 s52, s70, 0x1000
s_addc_u32 s53, s71, 0
s_sub_u32 s52, s52, 3072
s_subb_u32 s53, s53, 0
s_mov_b32 m0, 0x23000
s_nop 0
global_load_lds_dwordx4 v0, s[52:53] sc1
s_add_u32 s52, s70, 0x1400
s_addc_u32 s53, s71, 0
s_sub_u32 s52, s52, 3072
s_subb_u32 s53, s53, 0
s_mov_b32 m0, 0x23400
s_nop 0
global_load_lds_dwordx4 v0, s[52:53] sc1
s_add_u32 s52, s70, 0x1800
s_addc_u32 s53, s71, 0
s_sub_u32 s52, s52, 3072
s_subb_u32 s53, s53, 0
s_mov_b32 m0, 0x23800
s_nop 0
global_load_lds_dwordx4 v0, s[52:53] sc1
s_add_u32 s52, s70, 0x1c00
s_addc_u32 s53, s71, 0
s_sub_u32 s52, s52, 3072
s_subb_u32 s53, s53, 0
s_mov_b32 m0, 0x23c00
s_nop 0
global_load_lds_dwordx4 v0, s[52:53] sc1
s_add_u32 s52, s70, 0x2000
s_addc_u32 s53, s71, 0
s_sub_u32 s52, s52, 3072
s_subb_u32 s53, s53, 0
s_mov_b32 m0, 0x27800
s_nop 0
global_load_lds_dwordx4 v0, s[52:53] sc1
ds_read_b128 v[44:47], v0 offset:12288
ds_read_b128 v[48:51], v0 offset:13312
ds_read_b128 v[52:55], v0 offset:14336
ds_read_b128 v[56:59], v0 offset:15360
v_mov_b64 v[28:29], 0
v_mov_b64 v[30:31], 0
v_mov_b64 v[32:33], 0
v_mov_b64 v[34:35], 0
v_mov_b64 v[36:37], 0
v_mov_b64 v[38:39], 0
v_mov_b64 v[40:41], 0
v_mov_b64 v[42:43], 0
s_waitcnt vmcnt(0)
ds_read_b128 v[12:15], v4 offset:8192
ds_read_b128 v[16:19], v4 offset:9216
ds_read_b128 v[20:23], v4 offset:10240
s_add_u32 s52, s36, 0x2000
s_addc_u32 s53, s37, 0
s_waitcnt lgkmcnt(2)
v_smfmac_f32_16x16x64_bf16 v[28:31], v[12:15], v[80:87], v1
ds_read_b128 v[24:27], v4 offset:11264
v_smfmac_f32_16x16x64_bf16 v[32:35], v[12:15], v[88:95], v1
v_smfmac_f32_16x16x64_bf16 v[36:39], v[12:15], v[44:51], v1
ds_read_b128 v[44:47], v0 offset:28672
v_smfmac_f32_16x16x64_bf16 v[40:43], v[12:15], v[52:59], v1
ds_read_b128 v[48:51], v0 offset:29696
s_waitcnt lgkmcnt(4)
v_smfmac_f32_16x16x64_bf16 v[28:31], v[16:19], v[96:103], v1
ds_read_b128 v[52:55], v0 offset:30720
v_smfmac_f32_16x16x64_bf16 v[32:35], v[16:19], v[104:111], v1
ds_read_b128 v[56:59], v0 offset:31744
v_smfmac_f32_16x16x64_bf16 v[36:39], v[16:19], v[224:231], v1
ds_read_b128 v[12:15], v4 offset:12288
v_smfmac_f32_16x16x64_bf16 v[40:43], v[16:19], v[232:239], v1
s_waitcnt lgkmcnt(6)
v_smfmac_f32_16x16x64_bf16 v[28:31], v[20:23], v[112:119], v1
ds_read_b128 v[16:19], v4 offset:13312
v_smfmac_f32_16x16x64_bf16 v[32:35], v[20:23], v[120:127], v1
s_waitcnt lgkmcnt(4)
v_smfmac_f32_16x16x64_bf16 v[36:39], v[20:23], v[44:51], v1
ds_read_b128 v[44:47], v0 offset:45056
s_waitcnt lgkmcnt(3)
v_smfmac_f32_16x16x64_bf16 v[40:43], v[20:23], v[52:59], v1
ds_read_b128 v[48:51], v0 offset:46080
v_smfmac_f32_16x16x64_bf16 v[28:31], v[24:27], v[128:135], v1
ds_read_b128 v[52:55], v0 offset:47104
v_smfmac_f32_16x16x64_bf16 v[32:35], v[24:27], v[136:143], v1
ds_read_b128 v[56:59], v0 offset:48128
v_smfmac_f32_16x16x64_bf16 v[36:39], v[24:27], v[240:247], v1
ds_read_b128 v[20:23], v4 offset:14336
v_smfmac_f32_16x16x64_bf16 v[40:43], v[24:27], v[248:255], v1
s_waitcnt lgkmcnt(6)
v_smfmac_f32_16x16x64_bf16 v[28:31], v[12:15], v[144:151], v1
ds_read_b128 v[24:27], v4 offset:15360
v_smfmac_f32_16x16x64_bf16 v[32:35], v[12:15], v[152:159], v1
s_waitcnt lgkmcnt(4)
v_smfmac_f32_16x16x64_bf16 v[36:39], v[12:15], v[44:51], v1
ds_read_b128 v[44:47], v0 offset:61440
s_waitcnt lgkmcnt(3)
v_smfmac_f32_16x16x64_bf16 v[40:43], v[12:15], v[52:59], v1
ds_read_b128 v[48:51], v0 offset:62464
v_smfmac_f32_16x16x64_bf16 v[28:31], v[16:19], v[160:167], v1
ds_read_b128 v[52:55], v0 offset:63488
v_smfmac_f32_16x16x64_bf16 v[32:35], v[16:19], v[168:175], v1
ds_read_b128 v[56:59], v0 offset:64512
v_smfmac_f32_16x16x64_bf16 v[36:39], v[16:19], a[0:7], v1
ds_read_b128 v[12:15], v4 offset:30720
v_smfmac_f32_16x16x64_bf16 v[40:43], v[16:19], a[8:15], v1
s_waitcnt lgkmcnt(6)
v_smfmac_f32_16x16x64_bf16 v[28:31], v[20:23], v[176:183], v1
s_waitcnt lgkmcnt(3)
v_smfmac_f32_16x16x64_bf16 v[36:39], v[20:23], v[44:51], v1
ds_read_b128 v[44:47], v9 offset:12288
s_sub_u32 s38, s38, 9216
s_subb_u32 s39, s39, 0
v_add_u32 v10, s97, v0
v_cmp_gt_u32 vcc, 8192, v10
v_add_u32 v76, 139264, v10
v_add_u32 v10, 153600, v10
v_cndmask_b32 v10, v10, v76, vcc
v_min_u32 v10, 163824, v10
ds_read_b128 v[76:79], v10
v_smfmac_f32_16x16x64_bf16 v[32:35], v[20:23], v[184:191], v1
ds_read_b128 v[48:51], v9 offset:13312
s_waitcnt lgkmcnt(4)
v_smfmac_f32_16x16x64_bf16 v[40:43], v[20:23], v[52:59], v1
ds_read_b128 v[52:55], v9 offset:14336
v_smfmac_f32_16x16x64_bf16 v[28:31], v[24:27], v[192:199], v1
ds_read_b128 v[56:59], v9 offset:15360
v_smfmac_f32_16x16x64_bf16 v[36:39], v[24:27], a[16:23], v1
s_waitcnt lgkmcnt(5)
v_smfmac_f32_16x16x64_bf16 v[28:31], v[12:15], v[208:215], v1
s_waitcnt lgkmcnt(3)
s_mov_b64 exec, 0x3ffff
global_store_dwordx4 v0, v[76:79], s[38:39] sc1
s_mov_b64 exec, -1
s_add_u32 s38, s38, 0x2400
s_addc_u32 s39, s39, 0
s_waitcnt lgkmcnt(2)
v_smfmac_f32_16x16x64_bf16 v[36:39], v[12:15], v[44:51], v1
v_smfmac_f32_16x16x64_bf16 v[32:35], v[24:27], v[200:207], v1
v_mov_b64 v[44:45], 0
v_smfmac_f32_16x16x64_bf16 v[40:43], v[24:27], a[24:31], v1
v_mov_b64 v[48:49], 0
v_add_f32 v28, v28, v30
v_smfmac_f32_16x16x64_bf16 v[32:35], v[12:15], v[216:223], v1
v_add_f32 v29, v29, v31
v_cvt_pk_bf16_f32 v77, v28, v29
v_add_f32 v36, v36, v38
s_waitcnt lgkmcnt(0)
v_smfmac_f32_16x16x64_bf16 v[40:43], v[12:15], v[52:59], v1
v_add_f32 v37, v37, v39
v_cvt_pk_bf16_f32 v76, v36, v37
ds_write_b64 v2, v[76:77]
v_mov_b64 v[46:47], 0
v_mov_b64 v[50:51], 0
s_nop 1
s_branch C\sfx\()3_0_postqk
C\sfx\()3_0_retry0:
s_add_u32 s76, s76, 1
s_waitcnt lgkmcnt(0)
s_nop 3
v_mov_b64 v[28:29], 0
v_mov_b64 v[30:31], 0
v_mov_b64 v[32:33], 0
v_mov_b64 v[34:35], 0
C\sfx\()3_0_retry0_p:
ds_read_b128 v[12:15], v4 offset:8192
ds_read_b128 v[16:19], v4 offset:9216
ds_read_b128 v[20:23], v4 offset:10240
s_sub_u32 s43, s43, 1
s_cbranch_scc1 EXIT2
s_waitcnt lgkmcnt(0)
v_add_f32 v10, v12, v16
v_cmp_u_f32 vcc, v10, v20
s_cbranch_vccnz C\sfx\()3_0_retry0_p
s_branch C\sfx\()3_0_back0
C\sfx\()3_0_retry1:
s_add_u32 s76, s76, 1
C\sfx\()3_0_retry1_p:
ds_read_b128 v[24:27], v4 offset:11264
ds_read_b128 v[12:15], v4 offset:12288
s_sub_u32 s43, s43, 1
s_cbranch_scc1 EXIT2
s_waitcnt lgkmcnt(0)
v_cmp_u_f32 vcc, v24, v12
s_cbranch_vccnz C\sfx\()3_0_retry1_p
s_branch C\sfx\()3_0_back1
C\sfx\()3_0_retry1b:
s_add_u32 s76, s76, 1
C\sfx\()3_0_retry1b_p:
ds_read_b128 v[16:19], v4 offset:13312
s_sub_u32 s43, s43, 1
s_cbranch_scc1 EXIT2
s_waitcnt lgkmcnt(0)
v_cmp_u_f32 vcc, v16, v16
s_cbranch_vccnz C\sfx\()3_0_retry1b_p
s_branch C\sfx\()3_0_back1b
C\sfx\()3_0_retry2:
s_add_u32 s76, s76, 1
C\sfx\()3_0_retry2_p:
ds_read_b128 v[20:23], v4 offset:14336
ds_read_b128 v[24:27], v4 offset:15360
s_sub_u32 s43, s43, 1
s_cbranch_scc1 EXIT2
s_waitcnt lgkmcnt(0)
v_cmp_u_f32 vcc, v20, v24
s_cbranch_vccnz C\sfx\()3_0_retry2_p
s_branch C\sfx\()3_0_back2
C\sfx\()3_0_retry2b:
s_add_u32 s76, s76, 1
C\sfx\()3_0_retry2b_p:
ds_read_b128 v[12:15], v4 offset:30720
s_sub_u32 s43, s43, 1
s_cbranch_scc1 EXIT2
s_waitcnt lgkmcnt(0)
v_cmp_u_f32 vcc, v12, v12
s_cbranch_vccnz C\sfx\()3_0_retry2b_p
v_add_u32 v10, s97, v0
v_cmp_gt_u32 vcc, 8192, v10
v_add_u32 v76, 139264, v10
v_add_u32 v10, 153600, v10
v_cndmask_b32 v10, v10, v76, vcc
v_min_u32 v10, 163824, v10
ds_read_b128 v[76:79], v10
s_waitcnt lgkmcnt(0)
s_branch C\sfx\()3_0_back2b
C\sfx\()3_0_late:
s_waitcnt lgkmcnt(0)
v_lshrrev_b32 v76, 2, v0
v_add_u32 v76, 163072, v76
ds_read_b32 v77, v76
s_waitcnt lgkmcnt(0)
v_cmp_gt_u32 vcc, 64, v77
s_cmp_eq_u32 s27, 18
s_cbranch_scc1 HL\sfx\()_85
s_mov_b32 s27, 18
s_and_b64 vcc, vcc, 7
s_cbranch_vccz HD\sfx\()_84
v_lshrrev_b32 v76, 4, v0
v_min_u32 v76, 2, v76
v_lshlrev_b32 v76, 7, v76
v_add_u32 v76, 0x20000, v76
PF\sfx\()_86:
global_load_dword v77, v76, s[14:15] sc1
s_waitcnt vmcnt(0)
v_cmp_gt_u32 vcc, 64, v77
s_cbranch_vccz PH\sfx\()_87
s_sub_u32 s43, s43, 1
s_cbranch_scc1 EXIT2
s_sleep 2
s_branch PF\sfx\()_86
PH\sfx\()_87:
s_branch HD\sfx\()_84
HL\sfx\()_85:
s_cbranch_vccz HD\sfx\()_84
v_lshrrev_b32 v76, 4, v0
v_min_u32 v76, 4, v76
v_lshlrev_b32 v76, 7, v76
v_add_u32 v76, 0x20180, v76
PF\sfx\()_88:
global_load_dword v77, v76, s[14:15] sc1
s_waitcnt vmcnt(0)
v_cmp_gt_u32 vcc, 64, v77
s_cbranch_vccz PH\sfx\()_89
s_sub_u32 s43, s43, 1
s_cbranch_scc1 EXIT2
s_sleep 2
s_branch PF\sfx\()_88
PH\sfx\()_89:
HD\sfx\()_84:
s_branch C\sfx\()3_0_late_back
C\sfx\()3_0_fetch:
v_lshrrev_b32 v6, 4, v0
v_min_u32 v6, 7, v6
v_lshlrev_b32 v6, 7, v6
v_add_u32 v6, 0x20000, v6
s_mov_b32 m0, 0x27d00
s_nop 0
global_load_lds_dword v6, s[14:15] sc1
s_add_u32 s47, s27, 2
s_branch C\sfx\()3_0_fetch_back
C\sfx\()3_0_slow:
s_waitcnt lgkmcnt(0)
s_nop 7
ds_read_b64_tr_b16 v[24:25], v3
ds_read_b64_tr_b16 v[26:27], v3 offset:512
ds_read_b128 v[28:31], v4
ds_read_b128 v[32:35], v4 offset:4096
s_waitcnt lgkmcnt(0)
v_mfma_f32_16x16x32_bf16 v[12:15], v[28:31], v[24:27], 0
v_mfma_f32_16x16x32_bf16 v[16:19], v[32:35], v[24:27], 0
v_mfma_f32_16x16x32_bf16 v[20:23], v[24:27], v[24:27], 0
s_nop 7
ds_read_b64_tr_b16 v[24:25], v3 offset:1024
ds_read_b64_tr_b16 v[26:27], v3 offset:1536
ds_read_b128 v[28:31], v4 offset:1024
ds_read_b128 v[32:35], v4 offset:5120
s_waitcnt lgkmcnt(0)
v_mfma_f32_16x16x32_bf16 v[12:15], v[28:31], v[24:27], v[12:15]
v_mfma_f32_16x16x32_bf16 v[16:19], v[32:35], v[24:27], v[16:19]
v_mfma_f32_16x16x32_bf16 v[20:23], v[24:27], v[24:27], v[20:23]
s_nop 7
ds_read_b64_tr_b16 v[24:25], v3 offset:2048
ds_read_b64_tr_b16 v[26:27], v3 offset:2560
ds_read_b128 v[28:31], v4 offset:2048
ds_read_b128 v[32:35], v4 offset:6144
s_waitcnt lgkmcnt(0)
v_mfma_f32_16x16x32_bf16 v[12:15], v[28:31], v[24:27], v[12:15]
v_mfma_f32_16x16x32_bf16 v[16:19], v[32:35], v[24:27], v[16:19]
v_mfma_f32_16x16x32_bf16 v[20:23], v[24:27], v[24:27], v[20:23]
s_nop 7
ds_read_b64_tr_b16 v[24:25], v3 offset:3072
ds_read_b64_tr_b16 v[26:27], v3 offset:3584
ds_read_b128 v[28:31], v4 offset:3072
ds_read_b128 v[32:35], v4 offset:7168
s_waitcnt lgkmcnt(0)
v_mfma_f32_16x16x32_bf16 v[12:15], v[28:31], v[24:27], v[12:15]
v_mfma_f32_16x16x32_bf16 v[16:19], v[32:35], v[24:27], v[16:19]
v_mfma_f32_16x16x32_bf16 v[20:23], v[24:27], v[24:27], v[20:23]
s_nop 7
v_mul_f32 v20, s44, v20
v_mul_f32 v21, s44, v21
v_max3_f32 v22, v20, v21, v12
v_max3_f32 v22, v22, v13, v14
v_max3_f32 v22, v22, v15, v16
v_max3_f32 v22, v22, v17, v18
v_max_f32 v22, v22, v19
v_mov_b32 v23, v22
s_nop 1
v_permlane16_swap_b32 v22, v23
s_nop 1
v_max_f32 v22, v22, v23
v_mov_b32 v23, v22
s_nop 1
v_permlane32_swap_b32 v22, v23
s_nop 1
v_max_f32 v22, v22, v23
v_sub_f32 v12, v12, v22
v_exp_f32 v12, v12
v_sub_f32 v13, v13, v22
v_exp_f32 v13, v13
v_sub_f32 v14, v14, v22
v_exp_f32 v14, v14
v_sub_f32 v15, v15, v22
v_exp_f32 v15, v15
v_sub_f32 v16, v16, v22
v_exp_f32 v16, v16
v_sub_f32 v17, v17, v22
v_exp_f32 v17, v17
v_sub_f32 v18, v18, v22
v_exp_f32 v18, v18
v_sub_f32 v19, v19, v22
v_exp_f32 v19, v19
v_sub_f32 v20, v20, v22
v_exp_f32 v20, v20
v_sub_f32 v21, v21, v22
v_exp_f32 v21, v21
v_cvt_pk_bf16_f32 v76, v12, v13
v_cvt_pk_bf16_f32 v77, v14, v15
v_cvt_pk_bf16_f32 v78, v16, v17
v_cvt_pk_bf16_f32 v79, v18, v19
v_cvt_pk_bf16_f32 v10, v20, v21
ds_read_b128 v[28:31], v4 offset:22528
ds_read_b128 v[32:35], v4 offset:23552
s_waitcnt lgkmcnt(0)
v_mfma_f32_16x16x32_bf16 v[60:63], v[76:79], v[28:31], 0
v_mfma_f32_16x16x32_bf16 v[64:67], v[76:79], v[32:35], 0
v_mfma_f32_16x16x32_bf16 v[40:43], v[76:79], v[36:39], 0
s_nop 5
v_mfma_f32_16x16x16_bf16 v[40:43], v[10:11], v[36:37], v[40:43]
v_mfma_f32_16x16x16_bf16 v[60:63], v[10:11], v[52:53], v[60:63]
v_mfma_f32_16x16x16_bf16 v[64:67], v[10:11], v[56:57], v[64:67]
s_nop 5
v_rcp_f32 v70, v42
v_rcp_f32 v71, v43
v_mul_f32 v62, v62, v70
v_mul_f32 v63, v63, v71
v_cvt_pk_bf16_f32 v68, v62, v63
ds_write_b32 v2, v68 offset:2052
v_mul_f32 v66, v66, v70
v_mul_f32 v67, v67, v71
v_cvt_pk_bf16_f32 v69, v66, v67
ds_write_b32 v2, v69 offset:2564
s_waitcnt lgkmcnt(0)
v_mov_b64 v[12:13], 0
v_mov_b64 v[14:15], 0
v_mov_b64 v[16:17], 0
v_mov_b64 v[18:19], 0
v_mov_b64 v[20:21], 0
v_mov_b64 v[22:23], 0
s_nop 3
s_branch C\sfx\()3_0_oskip
C\sfx\()3_1_retry_ag:
s_waitcnt vmcnt(0) lgkmcnt(0)
s_add_u32 s76, s76, 0x10000
s_sub_u32 s43, s43, 1
s_cbranch_scc1 EXIT2
s_add_u32 s52, s22, 0x0
s_addc_u32 s53, s23, 0
s_sub_u32 s52, s52, 3072
s_subb_u32 s53, s53, 0
s_mov_b32 m0, 0x20000
s_nop 0
global_load_lds_dwordx4 v0, s[52:53] sc1
s_add_u32 s52, s22, 0x400
s_addc_u32 s53, s23, 0
s_sub_u32 s52, s52, 3072
s_subb_u32 s53, s53, 0
s_mov_b32 m0, 0x20400
s_nop 0
global_load_lds_dwordx4 v0, s[52:53] sc1
s_add_u32 s52, s22, 0x800
s_addc_u32 s53, s23, 0
s_sub_u32 s52, s52, 3072
s_subb_u32 s53, s53, 0
s_mov_b32 m0, 0x20800
s_nop 0
global_load_lds_dwordx4 v0, s[52:53] sc1
s_add_u32 s52, s22, 0xc00
s_addc_u32 s53, s23, 0
s_sub_u32 s52, s52, 3072
s_subb_u32 s53, s53, 0
s_mov_b32 m0, 0x20c00
s_nop 0
global_load_lds_dwordx4 v0, s[52:53] sc1
s_add_u32 s52, s22, 0x1000
s_addc_u32 s53, s23, 0
s_sub_u32 s52, s52, 3072
s_subb_u32 s53, s53, 0
s_mov_b32 m0, 0x21000
s_nop 0
global_load_lds_dwordx4 v0, s[52:53] sc1
s_add_u32 s52, s22, 0x1400
s_addc_u32 s53, s23, 0
s_sub_u32 s52, s52, 3072
s_subb_u32 s53, s53, 0
s_mov_b32 m0, 0x21400
s_nop 0
global_load_lds_dwordx4 v0, s[52:53] sc1
s_add_u32 s52, s22, 0x1800
s_addc_u32 s53, s23, 0
s_sub_u32 s52, s52, 3072
s_subb_u32 s53, s53, 0
s_mov_b32 m0, 0x21800
s_nop 0
global_load_lds_dwordx4 v0, s[52:53] sc1
s_add_u32 s52, s22, 0x1c00
s_addc_u32 s53, s23, 0
s_sub_u32 s52, s52, 3072
s_subb_u32 s53, s53, 0
s_mov_b32 m0, 0x21c00
s_nop 0
global_load_lds_dwordx4 v0, s[52:53] sc1
s_add_u32 s52, s22, 0x2000
s_addc_u32 s53, s23, 0
s_sub_u32 s52, s52, 3072
s_subb_u32 s53, s53, 0
s_mov_b32 m0, 0x27800
s_nop 0
global_load_lds_dwordx4 v0, s[52:53] sc1
ds_read_b128 v[44:47], v0 offset:12288
ds_read_b128 v[48:51], v0 offset:13312
ds_read_b128 v[52:55], v0 offset:14336
ds_read_b128 v[56:59], v0 offset:15360
v_mov_b64 v[28:29], 0
v_mov_b64 v[30:31], 0
v_mov_b64 v[32:33], 0
v_mov_b64 v[34:35], 0
v_mov_b64 v[36:37], 0
v_mov_b64 v[38:39], 0
v_mov_b64 v[40:41], 0
v_mov_b64 v[42:43], 0
s_waitcnt vmcnt(0)
ds_read_b128 v[12:15], v4
ds_read_b128 v[16:19], v4 offset:1024
ds_read_b128 v[20:23], v4 offset:2048
s_add_u32 s52, s36, 0x2000
s_addc_u32 s53, s37, 0
s_waitcnt lgkmcnt(2)
v_smfmac_f32_16x16x64_bf16 v[28:31], v[12:15], v[80:87], v1
ds_read_b128 v[24:27], v4 offset:3072
v_smfmac_f32_16x16x64_bf16 v[32:35], v[12:15], v[88:95], v1
v_smfmac_f32_16x16x64_bf16 v[36:39], v[12:15], v[44:51], v1
ds_read_b128 v[44:47], v0 offset:28672
v_smfmac_f32_16x16x64_bf16 v[40:43], v[12:15], v[52:59], v1
ds_read_b128 v[48:51], v0 offset:29696
s_waitcnt lgkmcnt(4)
v_smfmac_f32_16x16x64_bf16 v[28:31], v[16:19], v[96:103], v1
ds_read_b128 v[52:55], v0 offset:30720
v_smfmac_f32_16x16x64_bf16 v[32:35], v[16:19], v[104:111], v1
ds_read_b128 v[56:59], v0 offset:31744
v_smfmac_f32_16x16x64_bf16 v[36:39], v[16:19], v[224:231], v1
ds_read_b128 v[12:15], v4 offset:4096
v_smfmac_f32_16x16x64_bf16 v[40:43], v[16:19], v[232:239], v1
s_waitcnt lgkmcnt(6)
v_smfmac_f32_16x16x64_bf16 v[28:31], v[20:23], v[112:119], v1
ds_read_b128 v[16:19], v4 offset:5120
v_smfmac_f32_16x16x64_bf16 v[32:35], v[20:23], v[120:127], v1
s_waitcnt lgkmcnt(4)
v_smfmac_f32_16x16x64_bf16 v[36:39], v[20:23], v[44:51], v1
ds_read_b128 v[44:47], v0 offset:45056
s_waitcnt lgkmcnt(3)
v_smfmac_f32_16x16x64_bf16 v[40:43], v[20:23], v[52:59], v1
ds_read_b128 v[48:51], v0 offset:46080
v_smfmac_f32_16x16x64_bf16 v[28:31], v[24:27], v[128:135], v1
ds_read_b128 v[52:55], v0 offset:47104
v_smfmac_f32_16x16x64_bf16 v[32:35], v[24:27], v[136:143], v1
ds_read_b128 v[56:59], v0 offset:48128
v_smfmac_f32_16x16x64_bf16 v[36:39], v[24:27], v[240:247], v1
ds_read_b128 v[20:23], v4 offset:6144
v_smfmac_f32_16x16x64_bf16 v[40:43], v[24:27], v[248:255], v1
s_waitcnt lgkmcnt(6)
v_smfmac_f32_16x16x64_bf16 v[28:31], v[12:15], v[144:151], v1
ds_read_b128 v[24:27], v4 offset:7168
v_smfmac_f32_16x16x64_bf16 v[32:35], v[12:15], v[152:159], v1
s_waitcnt lgkmcnt(4)
v_smfmac_f32_16x16x64_bf16 v[36:39], v[12:15], v[44:51], v1
ds_read_b128 v[44:47], v0 offset:61440
s_waitcnt lgkmcnt(3)
v_smfmac_f32_16x16x64_bf16 v[40:43], v[12:15], v[52:59], v1
ds_read_b128 v[48:51], v0 offset:62464
v_smfmac_f32_16x16x64_bf16 v[28:31], v[16:19], v[160:167], v1
ds_read_b128 v[52:55], v0 offset:63488
v_smfmac_f32_16x16x64_bf16 v[32:35], v[16:19], v[168:175], v1
ds_read_b128 v[56:59], v0 offset:64512
v_smfmac_f32_16x16x64_bf16 v[36:39], v[16:19], a[0:7], v1
ds_read_b128 v[12:15], v4 offset:30720
v_smfmac_f32_16x16x64_bf16 v[40:43], v[16:19], a[8:15], v1
s_waitcnt lgkmcnt(6)
v_smfmac_f32_16x16x64_bf16 v[28:31], v[20:23], v[176:183], v1
s_waitcnt lgkmcnt(3)
v_smfmac_f32_16x16x64_bf16 v[36:39], v[20:23], v[44:51], v1
ds_read_b128 v[44:47], v9 offset:12288
s_sub_u32 s38, s38, 9216
s_subb_u32 s39, s39, 0
v_add_u32 v10, s97, v0
v_cmp_gt_u32 vcc, 8192, v10
v_add_u32 v76, 131072, v10
v_add_u32 v10, 153600, v10
v_cndmask_b32 v10, v10, v76, vcc
v_min_u32 v10, 163824, v10
ds_read_b128 v[76:79], v10
v_smfmac_f32_16x16x64_bf16 v[32:35], v[20:23], v[184:191], v1
ds_read_b128 v[48:51], v9 offset:13312
s_waitcnt lgkmcnt(4)
v_smfmac_f32_16x16x64_bf16 v[40:43], v[20:23], v[52:59], v1
ds_read_b128 v[52:55], v9 offset:14336
v_smfmac_f32_16x16x64_bf16 v[28:31], v[24:27], v[192:199], v1
ds_read_b128 v[56:59], v9 offset:15360
v_smfmac_f32_16x16x64_bf16 v[36:39], v[24:27], a[16:23], v1
s_waitcnt lgkmcnt(5)
v_smfmac_f32_16x16x64_bf16 v[28:31], v[12:15], v[208:215], v1
s_waitcnt lgkmcnt(3)
s_mov_b64 exec, 0x3ffff
global_store_dwordx4 v0, v[76:79], s[38:39] sc1
s_mov_b64 exec, -1
s_add_u32 s38, s38, 0x2400
s_addc_u32 s39, s39, 0
s_waitcnt lgkmcnt(2)
v_smfmac_f32_16x16x64_bf16 v[36:39], v[12:15], v[44:51], v1
v_smfmac_f32_16x16x64_bf16 v[32:35], v[24:27], v[200:207], v1
v_mov_b64 v[44:45], 0
v_smfmac_f32_16x16x64_bf16 v[40:43], v[24:27], a[24:31], v1
v_mov_b64 v[48:49], 0
v_add_f32 v28, v28, v30
v_smfmac_f32_16x16x64_bf16 v[32:35], v[12:15], v[216:223], v1
v_add_f32 v29, v29, v31
v_cvt_pk_bf16_f32 v77, v28, v29
v_add_f32 v36, v36, v38
s_waitcnt lgkmcnt(0)
v_smfmac_f32_16x16x64_bf16 v[40:43], v[12:15], v[52:59], v1
v_add_f32 v37, v37, v39
v_cvt_pk_bf16_f32 v76, v36, v37
ds_write_b64 v2, v[76:77]
v_mov_b64 v[46:47], 0
v_mov_b64 v[50:51], 0
s_nop 1
s_branch C\sfx\()3_1_postqk
C\sfx\()3_1_retry0:
s_add_u32 s76, s76, 1
s_waitcnt lgkmcnt(0)
s_nop 3
v_mov_b64 v[28:29], 0
v_mov_b64 v[30:31], 0
v_mov_b64 v[32:33], 0
v_mov_b64 v[34:35], 0
C\sfx\()3_1_retry0_p:
ds_read_b128 v[12:15], v4
ds_read_b128 v[16:19], v4 offset:1024
ds_read_b128 v[20:23], v4 offset:2048
s_sub_u32 s43, s43, 1
s_cbranch_scc1 EXIT2
s_waitcnt lgkmcnt(0)
v_add_f32 v10, v12, v16
v_cmp_u_f32 vcc, v10, v20
s_cbranch_vccnz C\sfx\()3_1_retry0_p
s_branch C\sfx\()3_1_back0
C\sfx\()3_1_retry1:
s_add_u32 s76, s76, 1
C\sfx\()3_1_retry1_p:
ds_read_b128 v[24:27], v4 offset:3072
ds_read_b128 v[12:15], v4 offset:4096
s_sub_u32 s43, s43, 1
s_cbranch_scc1 EXIT2
s_waitcnt lgkmcnt(0)
v_cmp_u_f32 vcc, v24, v12
s_cbranch_vccnz C\sfx\()3_1_retry1_p
s_branch C\sfx\()3_1_back1
C\sfx\()3_1_retry1b:
s_add_u32 s76, s76, 1
C\sfx\()3_1_retry1b_p:
ds_read_b128 v[16:19], v4 offset:5120
s_sub_u32 s43, s43, 1
s_cbranch_scc1 EXIT2
s_waitcnt lgkmcnt(0)
v_cmp_u_f32 vcc, v16, v16
s_cbranch_vccnz C\sfx\()3_1_retry1b_p
s_branch C\sfx\()3_1_back1b
C\sfx\()3_1_retry2:
s_add_u32 s76, s76, 1
C\sfx\()3_1_retry2_p:
ds_read_b128 v[20:23], v4 offset:6144
ds_read_b128 v[24:27], v4 offset:7168
s_sub_u32 s43, s43, 1
s_cbranch_scc1 EXIT2
s_waitcnt lgkmcnt(0)
v_cmp_u_f32 vcc, v20, v24
s_cbranch_vccnz C\sfx\()3_1_retry2_p
s_branch C\sfx\()3_1_back2
C\sfx\()3_1_retry2b:
s_add_u32 s76, s76, 1
C\sfx\()3_1_retry2b_p:
ds_read_b128 v[12:15], v4 offset:30720
s_sub_u32 s43, s43, 1
s_cbranch_scc1 EXIT2
s_waitcnt lgkmcnt(0)
v_cmp_u_f32 vcc, v12, v12
s_cbranch_vccnz C\sfx\()3_1_retry2b_p
v_add_u32 v10, s97, v0
v_cmp_gt_u32 vcc, 8192, v10
v_add_u32 v76, 131072, v10
v_add_u32 v10, 153600, v10
v_cndmask_b32 v10, v10, v76, vcc
v_min_u32 v10, 163824, v10
ds_read_b128 v[76:79], v10
s_waitcnt lgkmcnt(0)
s_branch C\sfx\()3_1_back2b
C\sfx\()3_1_late:
s_waitcnt lgkmcnt(0)
v_lshrrev_b32 v76, 2, v0
v_add_u32 v76, 163072, v76
ds_read_b32 v77, v76
s_waitcnt lgkmcnt(0)
v_cmp_gt_u32 vcc, 64, v77
s_cmp_eq_u32 s27, 18
s_cbranch_scc1 HL\sfx\()_92
s_mov_b32 s27, 18
s_and_b64 vcc, vcc, 7
s_cbranch_vccz HD\sfx\()_91
v_lshrrev_b32 v76, 4, v0
v_min_u32 v76, 2, v76
v_lshlrev_b32 v76, 7, v76
v_add_u32 v76, 0x20000, v76
PF\sfx\()_93:
global_load_dword v77, v76, s[14:15] sc1
s_waitcnt vmcnt(0)
v_cmp_gt_u32 vcc, 64, v77
s_cbranch_vccz PH\sfx\()_94
s_sub_u32 s43, s43, 1
s_cbranch_scc1 EXIT2
s_sleep 2
s_branch PF\sfx\()_93
PH\sfx\()_94:
s_branch HD\sfx\()_91
HL\sfx\()_92:
s_cbranch_vccz HD\sfx\()_91
v_lshrrev_b32 v76, 4, v0
v_min_u32 v76, 4, v76
v_lshlrev_b32 v76, 7, v76
v_add_u32 v76, 0x20180, v76
PF\sfx\()_95:
global_load_dword v77, v76, s[14:15] sc1
s_waitcnt vmcnt(0)
v_cmp_gt_u32 vcc, 64, v77
s_cbranch_vccz PH\sfx\()_96
s_sub_u32 s43, s43, 1
s_cbranch_scc1 EXIT2
s_sleep 2
s_branch PF\sfx\()_95
PH\sfx\()_96:
HD\sfx\()_91:
s_branch C\sfx\()3_1_late_back
C\sfx\()3_1_fin3:
s_waitcnt lgkmcnt(0)
C\sfx\()3_1_fin3_p:
v_add_u32 v10, s97, v0
v_cmp_gt_u32 vcc, 8192, v10
v_add_u32 v76, 131072, v10
v_add_u32 v10, 153600, v10
v_cndmask_b32 v10, v10, v76, vcc
v_min_u32 v10, 163824, v10
ds_read_b128 v[76:79], v10
s_sub_u32 s43, s43, 1
s_cbranch_scc1 EXIT2
s_waitcnt lgkmcnt(0)
v_add_f32 v10, v76, v77
v_add_f32 v6, v78, v79
v_cmp_u_f32 vcc, v10, v6
s_nop 0
s_and_b64 vcc, vcc, 0x3ffff
s_cbranch_vccnz C\sfx\()3_1_fin3_p
s_mov_b64 exec, 0x3ffff
global_store_dwordx4 v0, v[76:79], s[38:39] sc1
s_mov_b64 exec, -1
s_add_u32 s38, s38, 0x2400
s_addc_u32 s39, s39, 0
s_branch DONE
C\sfx\()3_1_slow:
s_waitcnt lgkmcnt(0)
s_nop 7
ds_read_b64_tr_b16 v[24:25], v3
ds_read_b64_tr_b16 v[26:27], v3 offset:512
ds_read_b128 v[28:31], v4 offset:8192
ds_read_b128 v[32:35], v4 offset:12288
s_waitcnt lgkmcnt(0)
v_mfma_f32_16x16x32_bf16 v[12:15], v[28:31], v[24:27], 0
v_mfma_f32_16x16x32_bf16 v[16:19], v[32:35], v[24:27], 0
v_mfma_f32_16x16x32_bf16 v[20:23], v[24:27], v[24:27], 0
s_nop 7
ds_read_b64_tr_b16 v[24:25], v3 offset:1024
ds_read_b64_tr_b16 v[26:27], v3 offset:1536
ds_read_b128 v[28:31], v4 offset:9216
ds_read_b128 v[32:35], v4 offset:13312
s_waitcnt lgkmcnt(0)
v_mfma_f32_16x16x32_bf16 v[12:15], v[28:31], v[24:27], v[12:15]
v_mfma_f32_16x16x32_bf16 v[16:19], v[32:35], v[24:27], v[16:19]
v_mfma_f32_16x16x32_bf16 v[20:23], v[24:27], v[24:27], v[20:23]
s_nop 7
ds_read_b64_tr_b16 v[24:25], v3 offset:2048
ds_read_b64_tr_b16 v[26:27], v3 offset:2560
ds_read_b128 v[28:31], v4 offset:10240
ds_read_b128 v[32:35], v4 offset:14336
s_waitcnt lgkmcnt(0)
v_mfma_f32_16x16x32_bf16 v[12:15], v[28:31], v[24:27], v[12:15]
v_mfma_f32_16x16x32_bf16 v[16:19], v[32:35], v[24:27], v[16:19]
v_mfma_f32_16x16x32_bf16 v[20:23], v[24:27], v[24:27], v[20:23]
s_nop 7
ds_read_b64_tr_b16 v[24:25], v3 offset:3072
ds_read_b64_tr_b16 v[26:27], v3 offset:3584
ds_read_b128 v[28:31], v4 offset:11264
ds_read_b128 v[32:35], v4 offset:15360
s_waitcnt lgkmcnt(0)
v_mfma_f32_16x16x32_bf16 v[12:15], v[28:31], v[24:27], v[12:15]
v_mfma_f32_16x16x32_bf16 v[16:19], v[32:35], v[24:27], v[16:19]
v_mfma_f32_16x16x32_bf16 v[20:23], v[24:27], v[24:27], v[20:23]
s_nop 7
v_mul_f32 v20, s44, v20
v_mul_f32 v21, s44, v21
v_max3_f32 v22, v20, v21, v12
v_max3_f32 v22, v22, v13, v14
v_max3_f32 v22, v22, v15, v16
v_max3_f32 v22, v22, v17, v18
v_max_f32 v22, v22, v19
v_mov_b32 v23, v22
s_nop 1
v_permlane16_swap_b32 v22, v23
s_nop 1
v_max_f32 v22, v22, v23
v_mov_b32 v23, v22
s_nop 1
v_permlane32_swap_b32 v22, v23
s_nop 1
v_max_f32 v22, v22, v23
v_sub_f32 v12, v12, v22
v_exp_f32 v12, v12
v_sub_f32 v13, v13, v22
v_exp_f32 v13, v13
v_sub_f32 v14, v14, v22
v_exp_f32 v14, v14
v_sub_f32 v15, v15, v22
v_exp_f32 v15, v15
v_sub_f32 v16, v16, v22
v_exp_f32 v16, v16
v_sub_f32 v17, v17, v22
v_exp_f32 v17, v17
v_sub_f32 v18, v18, v22
v_exp_f32 v18, v18
v_sub_f32 v19, v19, v22
v_exp_f32 v19, v19
v_sub_f32 v20, v20, v22
v_exp_f32 v20, v20
v_sub_f32 v21, v21, v22
v_exp_f32 v21, v21
v_cvt_pk_bf16_f32 v76, v12, v13
v_cvt_pk_bf16_f32 v77, v14, v15
v_cvt_pk_bf16_f32 v78, v16, v17
v_cvt_pk_bf16_f32 v79, v18, v19
v_cvt_pk_bf16_f32 v10, v20, v21
ds_read_b128 v[28:31], v4 offset:22528
ds_read_b128 v[32:35], v4 offset:23552
s_waitcnt lgkmcnt(0)
v_mfma_f32_16x16x32_bf16 v[60:63], v[76:79], v[28:31], 0
v_mfma_f32_16x16x32_bf16 v[64:67], v[76:79], v[32:35], 0
v_mfma_f32_16x16x32_bf16 v[40:43], v[76:79], v[36:39], 0
s_nop 5
v_mfma_f32_16x16x16_bf16 v[40:43], v[10:11], v[36:37], v[40:43]
v_mfma_f32_16x16x16_bf16 v[60:63], v[10:11], v[52:53], v[60:63]
v_mfma_f32_16x16x16_bf16 v[64:67], v[10:11], v[56:57], v[64:67]
s_nop 5
v_rcp_f32 v70, v42
v_rcp_f32 v71, v43
v_mul_f32 v62, v62, v70
v_mul_f32 v63, v63, v71
v_cvt_pk_bf16_f32 v68, v62, v63
ds_write_b32 v2, v68 offset:2052
v_mul_f32 v66, v66, v70
v_mul_f32 v67, v67, v71
v_cvt_pk_bf16_f32 v69, v66, v67
ds_write_b32 v2, v69 offset:2564
s_waitcnt lgkmcnt(0)
v_mov_b64 v[12:13], 0
v_mov_b64 v[14:15], 0
v_mov_b64 v[16:17], 0
v_mov_b64 v[18:19], 0
v_mov_b64 v[20:21], 0
v_mov_b64 v[22:23], 0
s_nop 3
s_branch C\sfx\()3_1_oskip
.endm
CHAINLOOPS 0,
CHAINLOOPS 1, sc1
.section .rodata,"a"
.p2align 6
.amdhsa_kernel gated_mix__softmax_full_mha__memory_aug_recurrent_mem_tr__prompt_kernel
  .amdhsa_next_free_vgpr 512
  .amdhsa_next_free_sgpr 102
  .amdhsa_accum_offset 256
  .amdhsa_group_segment_fixed_size 0
  .amdhsa_kernarg_size 112
  .amdhsa_user_sgpr_count 2
  .amdhsa_user_sgpr_kernarg_segment_ptr 1
  .amdhsa_system_sgpr_workgroup_id_x 1
.end_amdhsa_kernel
```
